```python
import torch

def _softmax(x, axis=-1):
    return torch.softmax(x, dim=axis)
def _gelu(x):
    return torch.nn.functional.gelu(x, approximate="tanh")
def _silu(x):
    return torch.nn.functional.silu(x)
def _sigmoid(x):
    return torch.sigmoid(x)
def _layernorm(x, axis=-1, eps=1e-5):
    m = x.mean(dim=axis, keepdim=True)
    v = x.var(dim=axis, keepdim=True, unbiased=False)
    return (x - m) / torch.sqrt(v + eps)
def _scatter_add(tgt, idx, src, axis=0):
    return tgt.clone().index_add_(axis, idx, src)
def _segment_sum(src, seg, n):
    out = torch.zeros((n,) + src.shape[1:], dtype=src.dtype)
    return out.index_add_(0, seg, src)
def _pad(x, pw):
    flat = tuple(v for pair in reversed(pw) for v in pair)
    return torch.nn.functional.pad(x, flat)

kernel_name = 'interleave_layers__mha_block__glu_gated_swiglu__prompt'

def setup_inputs():

    _w = (lambda a: (lambda t: t.to(torch.bfloat16) if t.is_floating_point() else t)(torch.as_tensor(a)))
    def _A_setup():
        B, S, D, H = 1, 2048, 448, 16
        return {
            "x": _w((lambda *s: torch.randn(*s, dtype=torch.bfloat16) * 0.05)(B, S, D)),
            "wqkv": _w((lambda *s: torch.randn(*s, dtype=torch.bfloat16) * 0.05)(D, 3 * D)),
            "wo": _w((lambda *s: torch.randn(*s, dtype=torch.bfloat16) * 0.05)(D, D)),
        }
    _A_in = _A_setup()

    def _B_setup():
        B, S, D, F = 1, 2048, 448, 1792
        return {
            "x": _w((lambda *s: torch.randn(*s, dtype=torch.bfloat16) * 0.05)(B, S, D)),
            "w1": _w((lambda *s: torch.randn(*s, dtype=torch.bfloat16) * 0.4)(D, F) * (2.0 / D) ** 0.5),
            "w3": _w((lambda *s: torch.randn(*s, dtype=torch.bfloat16) * 0.4)(D, F) * (2.0 / D) ** 0.5),
            "w2": _w((lambda *s: torch.randn(*s, dtype=torch.bfloat16) * 0.4)(F, D) * (2.0 / F) ** 0.5),
        }
    _B_in = _B_setup()

    return {
        "A_x": _A_in["x"],
        "A_wqkv": _A_in["wqkv"],
        "A_wo": _A_in["wo"],
        "B_x": _B_in["x"],
        "B_w1": _B_in["w1"],
        "B_w3": _B_in["w3"],
        "B_w2": _B_in["w2"],
    }

def reference(A_x, A_wqkv, A_wo, B_x, B_w1, B_w3, B_w2):
    def _A_ref(x, wqkv, wo):
        B, S, D = x.shape
        H = 16
        Dh = D // H
        qkv = (lambda x, *d: x.permute(*d))((x @ wqkv).reshape(B, S, 3, H, Dh), 2, 0, 3, 1, 4)
        q, k, v = qkv[0], qkv[1], qkv[2]
        scores = torch.einsum("bhqd,bhkd->bhqk", q, k) * (Dh ** -0.5)
        p = _softmax(scores, axis=-1)
        o = torch.einsum("bhqk,bhkd->bhqd", p, v)
        return (lambda x, *d: x.permute(*d))(o, 0, 2, 1, 3).reshape(B, S, D) @ wo

    def _B_ref(x, w1, w3, w2):
        gate = torch.einsum("bsd,df->bsf", x, w1)
        up = torch.einsum("bsd,df->bsf", x, w3)
        h = _silu(gate) * up
        out = torch.einsum("bsf,fd->bsd", h, w2)
        return out

    x = A_x
    x = x + _A_ref(_layernorm(x, axis=-1), A_wqkv, A_wo)
    x = x + _B_ref(_layernorm(x, axis=-1), B_w1, B_w3, B_w2)
    x = x + _A_ref(_layernorm(x, axis=-1), A_wqkv, A_wo)
    x = x + _B_ref(_layernorm(x, axis=-1), B_w1, B_w3, B_w2)
    return x
```

```asm
; @launch kernel=g1_0_kernel grid=(252,1,1) block=(256,1,1) lds=113664
; @launch kernel=attn_0_kernel grid=(512,1,1) block=(256,1,1) lds=73728
; @launch kernel=g3_0_kernel grid=(224,1,1) block=(256,1,1) lds=65536
; @launch kernel=g4_0_kernel grid=(256,1,1) block=(256,1,1) lds=55296
; @launch kernel=g5_0_kernel grid=(224,1,1) block=(256,1,1) lds=65536
; @launch kernel=g1_1_kernel grid=(224,1,1) block=(256,1,1) lds=113664
; @launch kernel=attn_1_kernel grid=(512,1,1) block=(256,1,1) lds=73728
; @launch kernel=g3_1_kernel grid=(224,1,1) block=(256,1,1) lds=65536
; @launch kernel=g4_1_kernel grid=(224,1,1) block=(256,1,1) lds=55296
; @launch kernel=g5_1_kernel grid=(224,1,1) block=(256,1,1) lds=65536
.amdgcn_target "amdgcn-amd-amdhsa--gfx950"
.text
.globl g1_0_kernel
.p2align 8
.type g1_0_kernel,@function
g1_0_kernel:
    s_load_dwordx16 s[32:47], s[0:1], 0
    s_load_dwordx4 s[48:51], s[0:1], 64
    s_cmp_ge_u32 s2, 224
    s_cbranch_scc1 L_side_g1_0_kernel
    s_lshr_b32 s28, s2, 3
    s_and_b32 s29, s2, 7
    s_mul_hi_u32 s24, s28, 0x24924925
    s_mul_i32 s27, s24, 7
    s_sub_u32 s25, s28, s27
    s_and_b32 s27, s29, 7
    s_mul_i32 s27, s27, 4
    s_add_u32 s24, s24, s27
    s_lshr_b32 s27, s29, 3
    s_mul_i32 s27, s27, 7
    s_add_u32 s25, s25, s27
    s_mov_b32 s30, 0
    s_mov_b32 s31, 28672
    v_and_b32 v1, 63, v0
    v_lshrrev_b32 v2, 6, v0
    v_lshrrev_b32 v3, 3, v0
    v_and_b32 v4, 7, v0
    v_lshlrev_b32 v4, 4, v4
    s_mul_i32 s27, s24, 57344
    v_mul_u32_u24 v7, 896, v3
    v_add3_u32 v7, v7, v4, s27
    v_mul_u32_u24 v8, 144, v3
    v_add_u32 v8, v8, v4
    s_mul_i32 s27, s25, 384
    v_add_u32 v5, 0, v0
    v_mul_u32_u24 v3, 0xaaab, v5
    v_lshrrev_b32 v3, 20, v3
    v_mul_u32_u24 v4, 24, v3
    v_sub_u32 v4, v5, v4
    v_lshlrev_b32 v4, 4, v4
    v_mul_u32_u24 v9, 2688, v3
    v_add3_u32 v9, v9, v4, s27
    v_mul_u32_u24 v15, 448, v3
    v_add_u32 v15, v15, v4
    v_add_u32 v15, 9216, v15
    v_add_u32 v5, 256, v0
    v_mul_u32_u24 v3, 0xaaab, v5
    v_lshrrev_b32 v3, 20, v3
    v_mul_u32_u24 v4, 24, v3
    v_sub_u32 v4, v5, v4
    v_lshlrev_b32 v4, 4, v4
    v_mul_u32_u24 v10, 2688, v3
    v_add3_u32 v10, v10, v4, s27
    v_mul_u32_u24 v16, 448, v3
    v_add_u32 v16, v16, v4
    v_add_u32 v16, 9216, v16
    v_add_u32 v5, 512, v0
    v_mul_u32_u24 v3, 0xaaab, v5
    v_lshrrev_b32 v3, 20, v3
    v_mul_u32_u24 v4, 24, v3
    v_sub_u32 v4, v5, v4
    v_lshlrev_b32 v4, 4, v4
    v_mul_u32_u24 v11, 2688, v3
    v_add3_u32 v11, v11, v4, s27
    v_mul_u32_u24 v17, 448, v3
    v_add_u32 v17, v17, v4
    v_add_u32 v17, 9216, v17
    v_add_u32 v5, 768, v0
    v_mul_u32_u24 v3, 0xaaab, v5
    v_lshrrev_b32 v3, 20, v3
    v_mul_u32_u24 v4, 24, v3
    v_sub_u32 v4, v5, v4
    v_lshlrev_b32 v4, 4, v4
    v_mul_u32_u24 v12, 2688, v3
    v_add3_u32 v12, v12, v4, s27
    v_mul_u32_u24 v18, 448, v3
    v_add_u32 v18, v18, v4
    v_add_u32 v18, 9216, v18
    v_add_u32 v5, 1024, v0
    v_mul_u32_u24 v3, 0xaaab, v5
    v_lshrrev_b32 v3, 20, v3
    v_mul_u32_u24 v4, 24, v3
    v_sub_u32 v4, v5, v4
    v_lshlrev_b32 v4, 4, v4
    v_mul_u32_u24 v13, 2688, v3
    v_add3_u32 v13, v13, v4, s27
    v_mul_u32_u24 v19, 448, v3
    v_add_u32 v19, v19, v4
    v_add_u32 v19, 9216, v19
    v_add_u32 v5, 1280, v0
    v_mul_u32_u24 v3, 0xaaab, v5
    v_lshrrev_b32 v3, 20, v3
    v_mul_u32_u24 v4, 24, v3
    v_sub_u32 v4, v5, v4
    v_lshlrev_b32 v4, 4, v4
    v_mul_u32_u24 v14, 2688, v3
    v_add3_u32 v14, v14, v4, s27
    v_mul_u32_u24 v20, 448, v3
    v_add_u32 v20, v20, v4
    v_add_u32 v20, 9216, v20
    v_lshrrev_b32 v3, 1, v2
    v_and_b32 v4, 1, v2
    v_mul_u32_u24 v3, 32, v3
    v_and_b32 v5, 31, v1
    v_add_u32 v5, v5, v3
    v_mul_u32_u24 v21, 144, v5
    v_lshrrev_b32 v6, 5, v1
    v_lshlrev_b32 v6, 4, v6
    v_add_u32 v21, v21, v6
    v_lshrrev_b32 v3, 5, v1
    v_lshlrev_b32 v3, 3, v3
    v_bfe_u32 v5, v1, 2, 2
    v_add_u32 v3, v3, v5
    v_mul_u32_u24 v22, 448, v3
    v_bfe_u32 v5, v1, 4, 1
    v_lshlrev_b32 v5, 5, v5
    v_and_b32 v6, 3, v1
    v_lshlrev_b32 v6, 3, v6
    v_add3_u32 v22, v22, v5, v6
    v_mul_u32_u24 v4, 192, v4
    v_add_u32 v22, v22, v4
    v_add_u32 v22, 9216, v22
    v_add_u32 v23, 37888, v21
    v_add_u32 v24, 75776, v21
    v_add_u32 v25, 37888, v22
    v_add_u32 v26, 75776, v22
    v_add_u32 v27, 37888, v8
    v_add_u32 v28, 75776, v8
    v_add_u32 v29, 37888, v15
    v_add_u32 v30, 75776, v15
    v_add_u32 v31, 37888, v16
    v_add_u32 v32, 75776, v16
    v_add_u32 v33, 37888, v17
    v_add_u32 v34, 75776, v17
    v_add_u32 v35, 37888, v18
    v_add_u32 v36, 75776, v18
    v_add_u32 v37, 37888, v19
    v_add_u32 v38, 75776, v19
    v_add_u32 v39, 37888, v20
    v_add_u32 v40, 75776, v20
    s_waitcnt lgkmcnt(0)
    s_mov_b32 s8, s32
    s_and_b32 s9, s33, 0xffff
    s_mov_b32 s10, 0x1c0000
    s_mov_b32 s11, 0x00020000
    s_mov_b32 s12, s34
    s_and_b32 s13, s35, 0xffff
    s_mov_b32 s14, 0x126000
    s_mov_b32 s15, 0x00020000
    buffer_load_dwordx4 v[44:47], v7, s[8:11], s30 offen offset:0
    buffer_load_dwordx4 v[48:51], v7, s[8:11], s31 offen offset:0
    buffer_load_dwordx4 v[52:55], v7, s[8:11], s30 offen offset:128
    buffer_load_dwordx4 v[56:59], v7, s[8:11], s31 offen offset:128
    buffer_load_dwordx4 v[60:63], v7, s[8:11], s30 offen offset:256
    buffer_load_dwordx4 v[64:67], v7, s[8:11], s31 offen offset:256
    buffer_load_dwordx4 v[68:71], v7, s[8:11], s30 offen offset:384
    buffer_load_dwordx4 v[72:75], v7, s[8:11], s31 offen offset:384
    buffer_load_dwordx4 v[76:79], v7, s[8:11], s30 offen offset:512
    buffer_load_dwordx4 v[80:83], v7, s[8:11], s31 offen offset:512
    buffer_load_dwordx4 v[84:87], v7, s[8:11], s30 offen offset:640
    buffer_load_dwordx4 v[88:91], v7, s[8:11], s31 offen offset:640
    buffer_load_dwordx4 v[92:95], v7, s[8:11], s30 offen offset:768
    buffer_load_dwordx4 v[96:99], v7, s[8:11], s31 offen offset:768
    s_mov_b32 s26, 0
    buffer_load_dwordx4 v[100:103], v9, s[12:15], s26 offen
    buffer_load_dwordx4 v[104:107], v10, s[12:15], s26 offen
    buffer_load_dwordx4 v[108:111], v11, s[12:15], s26 offen
    buffer_load_dwordx4 v[112:115], v12, s[12:15], s26 offen
    buffer_load_dwordx4 v[116:119], v13, s[12:15], s26 offen
    buffer_load_dwordx4 v[120:123], v14, s[12:15], s26 offen
    s_mov_b32 s26, 172032
    buffer_load_dwordx4 v[124:127], v9, s[12:15], s26 offen
    buffer_load_dwordx4 v[128:131], v10, s[12:15], s26 offen
    buffer_load_dwordx4 v[132:135], v11, s[12:15], s26 offen
    buffer_load_dwordx4 v[136:139], v12, s[12:15], s26 offen
    buffer_load_dwordx4 v[140:143], v13, s[12:15], s26 offen
    buffer_load_dwordx4 v[144:147], v14, s[12:15], s26 offen
    s_mul_i32 s27, s25, 384
    v_add_u32 v5, 0, v0
    v_mul_u32_u24 v3, 0x55556, v5
    v_lshrrev_b32 v3, 20, v3
    v_mul_u32_u24 v4, 3, v3
    v_sub_u32 v4, v5, v4
    v_lshlrev_b32 v4, 7, v4
    v_add_u32 v3, 128, v3
    v_mul_u32_u24 v228, 2688, v3
    v_add3_u32 v228, v228, v4, s27
    buffer_load_dword v229, v228, s[12:15], 0 offen
    v_add_u32 v5, 256, v0
    v_mul_u32_u24 v3, 0x55556, v5
    v_lshrrev_b32 v3, 20, v3
    v_mul_u32_u24 v4, 3, v3
    v_sub_u32 v4, v5, v4
    v_lshlrev_b32 v4, 7, v4
    v_add_u32 v3, 128, v3
    v_mul_u32_u24 v228, 2688, v3
    v_add3_u32 v228, v228, v4, s27
    buffer_load_dword v229, v228, s[12:15], 0 offen
    v_add_u32 v5, 512, v0
    v_mul_u32_u24 v3, 0x55556, v5
    v_lshrrev_b32 v3, 20, v3
    v_mul_u32_u24 v4, 3, v3
    v_sub_u32 v4, v5, v4
    v_lshlrev_b32 v4, 7, v4
    v_add_u32 v3, 128, v3
    v_mul_u32_u24 v228, 2688, v3
    v_add3_u32 v228, v228, v4, s27
    buffer_load_dword v229, v228, s[12:15], 0 offen
    v_add_u32 v5, 768, v0
    v_mul_u32_u24 v3, 0x55556, v5
    v_lshrrev_b32 v3, 20, v3
    v_mul_u32_u24 v4, 3, v3
    v_sub_u32 v4, v5, v4
    v_lshlrev_b32 v4, 7, v4
    v_add_u32 v3, 128, v3
    v_mul_u32_u24 v228, 2688, v3
    v_add3_u32 v228, v228, v4, s27
    buffer_load_dword v229, v228, s[12:15], 0 offen
    v_mov_b32 v234, 0x3f803f80
    v_mov_b32 v230, 0
    v_mov_b32 v232, 0
    v_mov_b32 v231, 0
    v_mov_b32 v233, 0
    s_waitcnt vmcnt(29)
    v_dot2_f32_bf16 v230, v44, v234, v230
    v_dot2_f32_bf16 v232, v44, v44, v232
    v_dot2_f32_bf16 v230, v45, v234, v230
    v_dot2_f32_bf16 v232, v45, v45, v232
    v_dot2_f32_bf16 v230, v46, v234, v230
    v_dot2_f32_bf16 v232, v46, v46, v232
    v_dot2_f32_bf16 v230, v47, v234, v230
    v_dot2_f32_bf16 v232, v47, v47, v232
    s_waitcnt vmcnt(28)
    v_dot2_f32_bf16 v231, v48, v234, v231
    v_dot2_f32_bf16 v233, v48, v48, v233
    v_dot2_f32_bf16 v231, v49, v234, v231
    v_dot2_f32_bf16 v233, v49, v49, v233
    v_dot2_f32_bf16 v231, v50, v234, v231
    v_dot2_f32_bf16 v233, v50, v50, v233
    v_dot2_f32_bf16 v231, v51, v234, v231
    v_dot2_f32_bf16 v233, v51, v51, v233
    s_waitcnt vmcnt(27)
    v_dot2_f32_bf16 v230, v52, v234, v230
    v_dot2_f32_bf16 v232, v52, v52, v232
    v_dot2_f32_bf16 v230, v53, v234, v230
    v_dot2_f32_bf16 v232, v53, v53, v232
    v_dot2_f32_bf16 v230, v54, v234, v230
    v_dot2_f32_bf16 v232, v54, v54, v232
    v_dot2_f32_bf16 v230, v55, v234, v230
    v_dot2_f32_bf16 v232, v55, v55, v232
    s_waitcnt vmcnt(26)
    v_dot2_f32_bf16 v231, v56, v234, v231
    v_dot2_f32_bf16 v233, v56, v56, v233
    v_dot2_f32_bf16 v231, v57, v234, v231
    v_dot2_f32_bf16 v233, v57, v57, v233
    v_dot2_f32_bf16 v231, v58, v234, v231
    v_dot2_f32_bf16 v233, v58, v58, v233
    v_dot2_f32_bf16 v231, v59, v234, v231
    v_dot2_f32_bf16 v233, v59, v59, v233
    s_waitcnt vmcnt(25)
    v_dot2_f32_bf16 v230, v60, v234, v230
    v_dot2_f32_bf16 v232, v60, v60, v232
    v_dot2_f32_bf16 v230, v61, v234, v230
    v_dot2_f32_bf16 v232, v61, v61, v232
    v_dot2_f32_bf16 v230, v62, v234, v230
    v_dot2_f32_bf16 v232, v62, v62, v232
    v_dot2_f32_bf16 v230, v63, v234, v230
    v_dot2_f32_bf16 v232, v63, v63, v232
    s_waitcnt vmcnt(24)
    v_dot2_f32_bf16 v231, v64, v234, v231
    v_dot2_f32_bf16 v233, v64, v64, v233
    v_dot2_f32_bf16 v231, v65, v234, v231
    v_dot2_f32_bf16 v233, v65, v65, v233
    v_dot2_f32_bf16 v231, v66, v234, v231
    v_dot2_f32_bf16 v233, v66, v66, v233
    v_dot2_f32_bf16 v231, v67, v234, v231
    v_dot2_f32_bf16 v233, v67, v67, v233
    s_waitcnt vmcnt(23)
    v_dot2_f32_bf16 v230, v68, v234, v230
    v_dot2_f32_bf16 v232, v68, v68, v232
    v_dot2_f32_bf16 v230, v69, v234, v230
    v_dot2_f32_bf16 v232, v69, v69, v232
    v_dot2_f32_bf16 v230, v70, v234, v230
    v_dot2_f32_bf16 v232, v70, v70, v232
    v_dot2_f32_bf16 v230, v71, v234, v230
    v_dot2_f32_bf16 v232, v71, v71, v232
    s_waitcnt vmcnt(22)
    v_dot2_f32_bf16 v231, v72, v234, v231
    v_dot2_f32_bf16 v233, v72, v72, v233
    v_dot2_f32_bf16 v231, v73, v234, v231
    v_dot2_f32_bf16 v233, v73, v73, v233
    v_dot2_f32_bf16 v231, v74, v234, v231
    v_dot2_f32_bf16 v233, v74, v74, v233
    v_dot2_f32_bf16 v231, v75, v234, v231
    v_dot2_f32_bf16 v233, v75, v75, v233
    s_waitcnt vmcnt(21)
    v_dot2_f32_bf16 v230, v76, v234, v230
    v_dot2_f32_bf16 v232, v76, v76, v232
    v_dot2_f32_bf16 v230, v77, v234, v230
    v_dot2_f32_bf16 v232, v77, v77, v232
    v_dot2_f32_bf16 v230, v78, v234, v230
    v_dot2_f32_bf16 v232, v78, v78, v232
    v_dot2_f32_bf16 v230, v79, v234, v230
    v_dot2_f32_bf16 v232, v79, v79, v232
    s_waitcnt vmcnt(20)
    v_dot2_f32_bf16 v231, v80, v234, v231
    v_dot2_f32_bf16 v233, v80, v80, v233
    v_dot2_f32_bf16 v231, v81, v234, v231
    v_dot2_f32_bf16 v233, v81, v81, v233
    v_dot2_f32_bf16 v231, v82, v234, v231
    v_dot2_f32_bf16 v233, v82, v82, v233
    v_dot2_f32_bf16 v231, v83, v234, v231
    v_dot2_f32_bf16 v233, v83, v83, v233
    s_waitcnt vmcnt(19)
    v_dot2_f32_bf16 v230, v84, v234, v230
    v_dot2_f32_bf16 v232, v84, v84, v232
    v_dot2_f32_bf16 v230, v85, v234, v230
    v_dot2_f32_bf16 v232, v85, v85, v232
    v_dot2_f32_bf16 v230, v86, v234, v230
    v_dot2_f32_bf16 v232, v86, v86, v232
    v_dot2_f32_bf16 v230, v87, v234, v230
    v_dot2_f32_bf16 v232, v87, v87, v232
    s_waitcnt vmcnt(18)
    v_dot2_f32_bf16 v231, v88, v234, v231
    v_dot2_f32_bf16 v233, v88, v88, v233
    v_dot2_f32_bf16 v231, v89, v234, v231
    v_dot2_f32_bf16 v233, v89, v89, v233
    v_dot2_f32_bf16 v231, v90, v234, v231
    v_dot2_f32_bf16 v233, v90, v90, v233
    v_dot2_f32_bf16 v231, v91, v234, v231
    v_dot2_f32_bf16 v233, v91, v91, v233
    s_waitcnt vmcnt(17)
    v_dot2_f32_bf16 v230, v92, v234, v230
    v_dot2_f32_bf16 v232, v92, v92, v232
    v_dot2_f32_bf16 v230, v93, v234, v230
    v_dot2_f32_bf16 v232, v93, v93, v232
    v_dot2_f32_bf16 v230, v94, v234, v230
    v_dot2_f32_bf16 v232, v94, v94, v232
    v_dot2_f32_bf16 v230, v95, v234, v230
    v_dot2_f32_bf16 v232, v95, v95, v232
    s_waitcnt vmcnt(16)
    v_dot2_f32_bf16 v231, v96, v234, v231
    v_dot2_f32_bf16 v233, v96, v96, v233
    v_dot2_f32_bf16 v231, v97, v234, v231
    v_dot2_f32_bf16 v233, v97, v97, v233
    v_dot2_f32_bf16 v231, v98, v234, v231
    v_dot2_f32_bf16 v233, v98, v98, v233
    v_dot2_f32_bf16 v231, v99, v234, v231
    v_dot2_f32_bf16 v233, v99, v99, v233
    v_add_f32_dpp v3, v230, v230 quad_perm:[1,0,3,2] row_mask:0xf bank_mask:0xf
    v_add_f32_dpp v4, v232, v232 quad_perm:[1,0,3,2] row_mask:0xf bank_mask:0xf
    v_mov_b32 v230, v3
    v_mov_b32 v232, v4
    s_nop 0
    v_add_f32_dpp v3, v230, v230 quad_perm:[2,3,0,1] row_mask:0xf bank_mask:0xf
    v_add_f32_dpp v4, v232, v232 quad_perm:[2,3,0,1] row_mask:0xf bank_mask:0xf
    v_mov_b32 v230, v3
    v_mov_b32 v232, v4
    s_nop 0
    v_add_f32_dpp v3, v230, v230 row_half_mirror row_mask:0xf bank_mask:0xf
    v_add_f32_dpp v4, v232, v232 row_half_mirror row_mask:0xf bank_mask:0xf
    v_mov_b32 v230, v3
    v_mov_b32 v232, v4
    v_mul_f32 v230, 0x3b124925, v230
    v_mul_f32 v232, 0x3b124925, v232
    v_fma_f32 v232, -v230, v230, v232
    v_max_f32 v232, 0, v232
    v_cvt_pk_bf16_f32 v3, v230, v232
    v_lshlrev_b32 v230, 16, v3
    v_and_b32 v232, 0xffff0000, v3
    v_add_f32 v232, 0x3727c5ac, v232
    v_cvt_pk_bf16_f32 v3, v232, v232
    v_lshlrev_b32 v232, 16, v3
    v_sqrt_f32 v232, v232
    s_nop 0
    v_cvt_pk_bf16_f32 v3, v232, v232
    v_lshlrev_b32 v232, 16, v3
    v_rcp_f32 v232, v232
    s_nop 0
    v_mov_b32 v236, v232
    v_mov_b32 v237, v232
    v_mul_f32 v240, v230, v232
    v_sub_f32 v240, 0, v240
    v_mov_b32 v241, v240
    v_add_f32_dpp v3, v231, v231 quad_perm:[1,0,3,2] row_mask:0xf bank_mask:0xf
    v_add_f32_dpp v4, v233, v233 quad_perm:[1,0,3,2] row_mask:0xf bank_mask:0xf
    v_mov_b32 v231, v3
    v_mov_b32 v233, v4
    s_nop 0
    v_add_f32_dpp v3, v231, v231 quad_perm:[2,3,0,1] row_mask:0xf bank_mask:0xf
    v_add_f32_dpp v4, v233, v233 quad_perm:[2,3,0,1] row_mask:0xf bank_mask:0xf
    v_mov_b32 v231, v3
    v_mov_b32 v233, v4
    s_nop 0
    v_add_f32_dpp v3, v231, v231 row_half_mirror row_mask:0xf bank_mask:0xf
    v_add_f32_dpp v4, v233, v233 row_half_mirror row_mask:0xf bank_mask:0xf
    v_mov_b32 v231, v3
    v_mov_b32 v233, v4
    v_mul_f32 v231, 0x3b124925, v231
    v_mul_f32 v233, 0x3b124925, v233
    v_fma_f32 v233, -v231, v231, v233
    v_max_f32 v233, 0, v233
    v_cvt_pk_bf16_f32 v3, v231, v233
    v_lshlrev_b32 v231, 16, v3
    v_and_b32 v233, 0xffff0000, v3
    v_add_f32 v233, 0x3727c5ac, v233
    v_cvt_pk_bf16_f32 v3, v233, v233
    v_lshlrev_b32 v233, 16, v3
    v_sqrt_f32 v233, v233
    s_nop 0
    v_cvt_pk_bf16_f32 v3, v233, v233
    v_lshlrev_b32 v233, 16, v3
    v_rcp_f32 v233, v233
    s_nop 0
    v_mov_b32 v238, v233
    v_mov_b32 v239, v233
    v_mul_f32 v242, v231, v233
    v_sub_f32 v242, 0, v242
    v_mov_b32 v243, v242
    v_lshlrev_b32 v244, 16, v44
    v_and_b32 v245, 0xffff0000, v44
    v_fma_f32 v244, v244, v236, v240
    v_fma_f32 v245, v245, v236, v240
    v_cvt_pk_bf16_f32 v44, v244, v245
    v_lshlrev_b32 v244, 16, v45
    v_and_b32 v245, 0xffff0000, v45
    v_fma_f32 v244, v244, v236, v240
    v_fma_f32 v245, v245, v236, v240
    v_cvt_pk_bf16_f32 v45, v244, v245
    v_lshlrev_b32 v244, 16, v46
    v_and_b32 v245, 0xffff0000, v46
    v_fma_f32 v244, v244, v236, v240
    v_fma_f32 v245, v245, v236, v240
    v_cvt_pk_bf16_f32 v46, v244, v245
    v_lshlrev_b32 v244, 16, v47
    v_and_b32 v245, 0xffff0000, v47
    v_fma_f32 v244, v244, v236, v240
    v_fma_f32 v245, v245, v236, v240
    v_cvt_pk_bf16_f32 v47, v244, v245
    ds_write_b128 v8, v[44:47] offset:0
    v_lshlrev_b32 v244, 16, v48
    v_and_b32 v245, 0xffff0000, v48
    v_fma_f32 v244, v244, v238, v242
    v_fma_f32 v245, v245, v238, v242
    v_cvt_pk_bf16_f32 v48, v244, v245
    v_lshlrev_b32 v244, 16, v49
    v_and_b32 v245, 0xffff0000, v49
    v_fma_f32 v244, v244, v238, v242
    v_fma_f32 v245, v245, v238, v242
    v_cvt_pk_bf16_f32 v49, v244, v245
    v_lshlrev_b32 v244, 16, v50
    v_and_b32 v245, 0xffff0000, v50
    v_fma_f32 v244, v244, v238, v242
    v_fma_f32 v245, v245, v238, v242
    v_cvt_pk_bf16_f32 v50, v244, v245
    v_lshlrev_b32 v244, 16, v51
    v_and_b32 v245, 0xffff0000, v51
    v_fma_f32 v244, v244, v238, v242
    v_fma_f32 v245, v245, v238, v242
    v_cvt_pk_bf16_f32 v51, v244, v245
    ds_write_b128 v8, v[48:51] offset:4608
    s_waitcnt vmcnt(15)
    ds_write_b128 v15, v[100:103] offset:0
    s_waitcnt vmcnt(14)
    ds_write_b128 v16, v[104:107] offset:0
    s_waitcnt vmcnt(13)
    ds_write_b128 v17, v[108:111] offset:0
    s_waitcnt vmcnt(12)
    ds_write_b128 v18, v[112:115] offset:0
    s_waitcnt vmcnt(11)
    ds_write_b128 v19, v[116:119] offset:0
    s_waitcnt vmcnt(10)
    ds_write_b128 v20, v[120:123] offset:0
    s_mov_b32 s26, 344064
    buffer_load_dwordx4 v[100:103], v9, s[12:15], s26 offen
    buffer_load_dwordx4 v[104:107], v10, s[12:15], s26 offen
    buffer_load_dwordx4 v[108:111], v11, s[12:15], s26 offen
    buffer_load_dwordx4 v[112:115], v12, s[12:15], s26 offen
    buffer_load_dwordx4 v[116:119], v13, s[12:15], s26 offen
    buffer_load_dwordx4 v[120:123], v14, s[12:15], s26 offen
    v_lshlrev_b32 v244, 16, v52
    v_and_b32 v245, 0xffff0000, v52
    v_fma_f32 v244, v244, v236, v240
    v_fma_f32 v245, v245, v236, v240
    v_cvt_pk_bf16_f32 v52, v244, v245
    v_lshlrev_b32 v244, 16, v53
    v_and_b32 v245, 0xffff0000, v53
    v_fma_f32 v244, v244, v236, v240
    v_fma_f32 v245, v245, v236, v240
    v_cvt_pk_bf16_f32 v53, v244, v245
    v_lshlrev_b32 v244, 16, v54
    v_and_b32 v245, 0xffff0000, v54
    v_fma_f32 v244, v244, v236, v240
    v_fma_f32 v245, v245, v236, v240
    v_cvt_pk_bf16_f32 v54, v244, v245
    v_lshlrev_b32 v244, 16, v55
    v_and_b32 v245, 0xffff0000, v55
    v_fma_f32 v244, v244, v236, v240
    v_fma_f32 v245, v245, v236, v240
    v_cvt_pk_bf16_f32 v55, v244, v245
    ds_write_b128 v27, v[52:55] offset:0
    v_lshlrev_b32 v244, 16, v56
    v_and_b32 v245, 0xffff0000, v56
    v_fma_f32 v244, v244, v238, v242
    v_fma_f32 v245, v245, v238, v242
    v_cvt_pk_bf16_f32 v56, v244, v245
    v_lshlrev_b32 v244, 16, v57
    v_and_b32 v245, 0xffff0000, v57
    v_fma_f32 v244, v244, v238, v242
    v_fma_f32 v245, v245, v238, v242
    v_cvt_pk_bf16_f32 v57, v244, v245
    v_lshlrev_b32 v244, 16, v58
    v_and_b32 v245, 0xffff0000, v58
    v_fma_f32 v244, v244, v238, v242
    v_fma_f32 v245, v245, v238, v242
    v_cvt_pk_bf16_f32 v58, v244, v245
    v_lshlrev_b32 v244, 16, v59
    v_and_b32 v245, 0xffff0000, v59
    v_fma_f32 v244, v244, v238, v242
    v_fma_f32 v245, v245, v238, v242
    v_cvt_pk_bf16_f32 v59, v244, v245
    ds_write_b128 v27, v[56:59] offset:4608
    s_waitcnt vmcnt(15)
    ds_write_b128 v29, v[124:127] offset:0
    s_waitcnt vmcnt(14)
    ds_write_b128 v31, v[128:131] offset:0
    s_waitcnt vmcnt(13)
    ds_write_b128 v33, v[132:135] offset:0
    s_waitcnt vmcnt(12)
    ds_write_b128 v35, v[136:139] offset:0
    s_waitcnt vmcnt(11)
    ds_write_b128 v37, v[140:143] offset:0
    s_waitcnt vmcnt(10)
    ds_write_b128 v39, v[144:147] offset:0
    s_mov_b32 s26, 516096
    buffer_load_dwordx4 v[124:127], v9, s[12:15], s26 offen
    buffer_load_dwordx4 v[128:131], v10, s[12:15], s26 offen
    buffer_load_dwordx4 v[132:135], v11, s[12:15], s26 offen
    buffer_load_dwordx4 v[136:139], v12, s[12:15], s26 offen
    buffer_load_dwordx4 v[140:143], v13, s[12:15], s26 offen
    buffer_load_dwordx4 v[144:147], v14, s[12:15], s26 offen
    s_waitcnt lgkmcnt(0)
    s_barrier
    ds_read_b128 v[148:151], v21 offset:0
    ds_read_b64_tr_b16 v[156:157], v22 offset:0
    ds_read_b64_tr_b16 v[158:159], v22 offset:1792
    ds_read_b64_tr_b16 v[160:161], v22 offset:64
    ds_read_b64_tr_b16 v[162:163], v22 offset:1856
    ds_read_b64_tr_b16 v[164:165], v22 offset:128
    ds_read_b64_tr_b16 v[166:167], v22 offset:1920
    s_waitcnt lgkmcnt(4)
    v_mfma_f32_32x32x16_bf16 v[180:195], v[156:159], v[148:151], 0
    ds_read_b128 v[152:155], v21 offset:32
    ds_read_b64_tr_b16 v[168:169], v22 offset:7168
    ds_read_b64_tr_b16 v[170:171], v22 offset:8960
    v_lshlrev_b32 v244, 16, v60
    v_and_b32 v245, 0xffff0000, v60
    v_fma_f32 v244, v244, v236, v240
    v_fma_f32 v245, v245, v236, v240
    v_cvt_pk_bf16_f32 v60, v244, v245
    v_lshlrev_b32 v244, 16, v61
    v_and_b32 v245, 0xffff0000, v61
    v_fma_f32 v244, v244, v236, v240
    v_fma_f32 v245, v245, v236, v240
    s_waitcnt lgkmcnt(5)
    v_mfma_f32_32x32x16_bf16 v[196:211], v[160:163], v[148:151], 0
    ds_read_b64_tr_b16 v[172:173], v22 offset:7232
    ds_read_b64_tr_b16 v[174:175], v22 offset:9024
    ds_read_b64_tr_b16 v[176:177], v22 offset:7296
    ds_read_b64_tr_b16 v[178:179], v22 offset:9088
    v_cvt_pk_bf16_f32 v61, v244, v245
    v_lshlrev_b32 v244, 16, v62
    v_and_b32 v245, 0xffff0000, v62
    v_fma_f32 v244, v244, v236, v240
    v_fma_f32 v245, v245, v236, v240
    v_cvt_pk_bf16_f32 v62, v244, v245
    v_lshlrev_b32 v244, 16, v63
    v_and_b32 v245, 0xffff0000, v63
    v_fma_f32 v244, v244, v236, v240
    s_waitcnt lgkmcnt(7)
    v_mfma_f32_32x32x16_bf16 v[212:227], v[164:167], v[148:151], 0
    v_fma_f32 v245, v245, v236, v240
    v_cvt_pk_bf16_f32 v63, v244, v245
    ds_write_b128 v28, v[60:63] offset:0
    v_lshlrev_b32 v244, 16, v64
    v_and_b32 v245, 0xffff0000, v64
    v_fma_f32 v244, v244, v238, v242
    v_fma_f32 v245, v245, v238, v242
    s_waitcnt lgkmcnt(5)
    v_mfma_f32_32x32x16_bf16 v[180:195], v[168:171], v[152:155], v[180:195]
    ds_read_b128 v[148:151], v21 offset:64
    ds_read_b64_tr_b16 v[156:157], v22 offset:14336
    ds_read_b64_tr_b16 v[158:159], v22 offset:16128
    v_cvt_pk_bf16_f32 v64, v244, v245
    v_lshlrev_b32 v244, 16, v65
    v_and_b32 v245, 0xffff0000, v65
    v_fma_f32 v244, v244, v238, v242
    v_fma_f32 v245, v245, v238, v242
    v_cvt_pk_bf16_f32 v65, v244, v245
    v_lshlrev_b32 v244, 16, v66
    v_and_b32 v245, 0xffff0000, v66
    s_waitcnt lgkmcnt(6)
    v_mfma_f32_32x32x16_bf16 v[196:211], v[172:175], v[152:155], v[196:211]
    ds_read_b64_tr_b16 v[160:161], v22 offset:14400
    ds_read_b64_tr_b16 v[162:163], v22 offset:16192
    ds_read_b64_tr_b16 v[164:165], v22 offset:14464
    ds_read_b64_tr_b16 v[166:167], v22 offset:16256
    v_fma_f32 v244, v244, v238, v242
    v_fma_f32 v245, v245, v238, v242
    v_cvt_pk_bf16_f32 v66, v244, v245
    v_lshlrev_b32 v244, 16, v67
    v_and_b32 v245, 0xffff0000, v67
    v_fma_f32 v244, v244, v238, v242
    v_fma_f32 v245, v245, v238, v242
    v_cvt_pk_bf16_f32 v67, v244, v245
    ds_write_b128 v28, v[64:67] offset:4608
    s_waitcnt lgkmcnt(9)
    v_mfma_f32_32x32x16_bf16 v[212:227], v[176:179], v[152:155], v[212:227]
    s_waitcnt vmcnt(11)
    ds_write_b128 v30, v[100:103] offset:0
    s_waitcnt vmcnt(10)
    ds_write_b128 v32, v[104:107] offset:0
    s_waitcnt lgkmcnt(7)
    v_mfma_f32_32x32x16_bf16 v[180:195], v[156:159], v[148:151], v[180:195]
    ds_read_b128 v[152:155], v21 offset:96
    ds_read_b64_tr_b16 v[168:169], v22 offset:21504
    ds_read_b64_tr_b16 v[170:171], v22 offset:23296
    s_waitcnt vmcnt(9)
    ds_write_b128 v34, v[108:111] offset:0
    s_waitcnt vmcnt(8)
    ds_write_b128 v36, v[112:115] offset:0
    s_waitcnt vmcnt(7)
    ds_write_b128 v38, v[116:119] offset:0
    s_waitcnt lgkmcnt(11)
    v_mfma_f32_32x32x16_bf16 v[196:211], v[160:163], v[148:151], v[196:211]
    ds_read_b64_tr_b16 v[172:173], v22 offset:21568
    ds_read_b64_tr_b16 v[174:175], v22 offset:23360
    ds_read_b64_tr_b16 v[176:177], v22 offset:21632
    ds_read_b64_tr_b16 v[178:179], v22 offset:23424
    s_waitcnt vmcnt(6)
    ds_write_b128 v40, v[120:123] offset:0
    s_mov_b32 s26, 688128
    buffer_load_dwordx4 v[100:103], v9, s[12:15], s26 offen
    buffer_load_dwordx4 v[104:107], v10, s[12:15], s26 offen
    s_waitcnt lgkmcnt(14)
    v_mfma_f32_32x32x16_bf16 v[212:227], v[164:167], v[148:151], v[212:227]
    buffer_load_dwordx4 v[108:111], v11, s[12:15], s26 offen
    buffer_load_dwordx4 v[112:115], v12, s[12:15], s26 offen
    buffer_load_dwordx4 v[116:119], v13, s[12:15], s26 offen
    s_waitcnt lgkmcnt(8)
    v_mfma_f32_32x32x16_bf16 v[180:195], v[168:171], v[152:155], v[180:195]
    ds_read_b128 v[148:151], v23 offset:0
    ds_read_b64_tr_b16 v[156:157], v25 offset:0
    ds_read_b64_tr_b16 v[158:159], v25 offset:1792
    buffer_load_dwordx4 v[120:123], v14, s[12:15], s26 offen
    s_waitcnt lgkmcnt(6)
    v_mfma_f32_32x32x16_bf16 v[196:211], v[172:175], v[152:155], v[196:211]
    ds_read_b64_tr_b16 v[160:161], v25 offset:64
    ds_read_b64_tr_b16 v[162:163], v25 offset:1856
    ds_read_b64_tr_b16 v[164:165], v25 offset:128
    ds_read_b64_tr_b16 v[166:167], v25 offset:1920
    s_waitcnt lgkmcnt(8)
    v_mfma_f32_32x32x16_bf16 v[212:227], v[176:179], v[152:155], v[212:227]
    s_waitcnt lgkmcnt(7)
    s_barrier
    s_waitcnt lgkmcnt(4)
    v_mfma_f32_32x32x16_bf16 v[180:195], v[156:159], v[148:151], v[180:195]
    ds_read_b128 v[152:155], v23 offset:32
    ds_read_b64_tr_b16 v[168:169], v25 offset:7168
    ds_read_b64_tr_b16 v[170:171], v25 offset:8960
    v_lshlrev_b32 v244, 16, v68
    v_and_b32 v245, 0xffff0000, v68
    v_fma_f32 v244, v244, v236, v240
    v_fma_f32 v245, v245, v236, v240
    v_cvt_pk_bf16_f32 v68, v244, v245
    v_lshlrev_b32 v244, 16, v69
    v_and_b32 v245, 0xffff0000, v69
    v_fma_f32 v244, v244, v236, v240
    v_fma_f32 v245, v245, v236, v240
    s_waitcnt lgkmcnt(5)
    v_mfma_f32_32x32x16_bf16 v[196:211], v[160:163], v[148:151], v[196:211]
    ds_read_b64_tr_b16 v[172:173], v25 offset:7232
    ds_read_b64_tr_b16 v[174:175], v25 offset:9024
    ds_read_b64_tr_b16 v[176:177], v25 offset:7296
    ds_read_b64_tr_b16 v[178:179], v25 offset:9088
    v_cvt_pk_bf16_f32 v69, v244, v245
    v_lshlrev_b32 v244, 16, v70
    v_and_b32 v245, 0xffff0000, v70
    v_fma_f32 v244, v244, v236, v240
    v_fma_f32 v245, v245, v236, v240
    v_cvt_pk_bf16_f32 v70, v244, v245
    v_lshlrev_b32 v244, 16, v71
    v_and_b32 v245, 0xffff0000, v71
    v_fma_f32 v244, v244, v236, v240
    s_waitcnt lgkmcnt(7)
    v_mfma_f32_32x32x16_bf16 v[212:227], v[164:167], v[148:151], v[212:227]
    v_fma_f32 v245, v245, v236, v240
    v_cvt_pk_bf16_f32 v71, v244, v245
    ds_write_b128 v8, v[68:71] offset:0
    v_lshlrev_b32 v244, 16, v72
    v_and_b32 v245, 0xffff0000, v72
    v_fma_f32 v244, v244, v238, v242
    v_fma_f32 v245, v245, v238, v242
    s_waitcnt lgkmcnt(5)
    v_mfma_f32_32x32x16_bf16 v[180:195], v[168:171], v[152:155], v[180:195]
    ds_read_b128 v[148:151], v23 offset:64
    ds_read_b64_tr_b16 v[156:157], v25 offset:14336
    ds_read_b64_tr_b16 v[158:159], v25 offset:16128
    v_cvt_pk_bf16_f32 v72, v244, v245
    v_lshlrev_b32 v244, 16, v73
    v_and_b32 v245, 0xffff0000, v73
    v_fma_f32 v244, v244, v238, v242
    v_fma_f32 v245, v245, v238, v242
    v_cvt_pk_bf16_f32 v73, v244, v245
    v_lshlrev_b32 v244, 16, v74
    v_and_b32 v245, 0xffff0000, v74
    s_waitcnt lgkmcnt(6)
    v_mfma_f32_32x32x16_bf16 v[196:211], v[172:175], v[152:155], v[196:211]
    ds_read_b64_tr_b16 v[160:161], v25 offset:14400
    ds_read_b64_tr_b16 v[162:163], v25 offset:16192
    ds_read_b64_tr_b16 v[164:165], v25 offset:14464
    ds_read_b64_tr_b16 v[166:167], v25 offset:16256
    v_fma_f32 v244, v244, v238, v242
    v_fma_f32 v245, v245, v238, v242
    v_cvt_pk_bf16_f32 v74, v244, v245
    v_lshlrev_b32 v244, 16, v75
    v_and_b32 v245, 0xffff0000, v75
    v_fma_f32 v244, v244, v238, v242
    v_fma_f32 v245, v245, v238, v242
    v_cvt_pk_bf16_f32 v75, v244, v245
    ds_write_b128 v8, v[72:75] offset:4608
    s_waitcnt lgkmcnt(9)
    v_mfma_f32_32x32x16_bf16 v[212:227], v[176:179], v[152:155], v[212:227]
    s_waitcnt vmcnt(11)
    ds_write_b128 v15, v[124:127] offset:0
    s_waitcnt vmcnt(10)
    ds_write_b128 v16, v[128:131] offset:0
    s_waitcnt lgkmcnt(7)
    v_mfma_f32_32x32x16_bf16 v[180:195], v[156:159], v[148:151], v[180:195]
    ds_read_b128 v[152:155], v23 offset:96
    ds_read_b64_tr_b16 v[168:169], v25 offset:21504
    ds_read_b64_tr_b16 v[170:171], v25 offset:23296
    s_waitcnt vmcnt(9)
    ds_write_b128 v17, v[132:135] offset:0
    s_waitcnt vmcnt(8)
    ds_write_b128 v18, v[136:139] offset:0
    s_waitcnt vmcnt(7)
    ds_write_b128 v19, v[140:143] offset:0
    s_waitcnt lgkmcnt(11)
    v_mfma_f32_32x32x16_bf16 v[196:211], v[160:163], v[148:151], v[196:211]
    ds_read_b64_tr_b16 v[172:173], v25 offset:21568
    ds_read_b64_tr_b16 v[174:175], v25 offset:23360
    ds_read_b64_tr_b16 v[176:177], v25 offset:21632
    ds_read_b64_tr_b16 v[178:179], v25 offset:23424
    s_waitcnt vmcnt(6)
    ds_write_b128 v20, v[144:147] offset:0
    s_mov_b32 s26, 860160
    buffer_load_dwordx4 v[124:127], v9, s[12:15], s26 offen
    buffer_load_dwordx4 v[128:131], v10, s[12:15], s26 offen
    s_waitcnt lgkmcnt(14)
    v_mfma_f32_32x32x16_bf16 v[212:227], v[164:167], v[148:151], v[212:227]
    buffer_load_dwordx4 v[132:135], v11, s[12:15], s26 offen
    buffer_load_dwordx4 v[136:139], v12, s[12:15], s26 offen
    buffer_load_dwordx4 v[140:143], v13, s[12:15], s26 offen
    s_waitcnt lgkmcnt(8)
    v_mfma_f32_32x32x16_bf16 v[180:195], v[168:171], v[152:155], v[180:195]
    ds_read_b128 v[148:151], v24 offset:0
    ds_read_b64_tr_b16 v[156:157], v26 offset:0
    ds_read_b64_tr_b16 v[158:159], v26 offset:1792
    buffer_load_dwordx4 v[144:147], v14, s[12:15], s26 offen
    s_waitcnt lgkmcnt(6)
    v_mfma_f32_32x32x16_bf16 v[196:211], v[172:175], v[152:155], v[196:211]
    ds_read_b64_tr_b16 v[160:161], v26 offset:64
    ds_read_b64_tr_b16 v[162:163], v26 offset:1856
    ds_read_b64_tr_b16 v[164:165], v26 offset:128
    ds_read_b64_tr_b16 v[166:167], v26 offset:1920
    s_waitcnt lgkmcnt(8)
    v_mfma_f32_32x32x16_bf16 v[212:227], v[176:179], v[152:155], v[212:227]
    s_waitcnt lgkmcnt(7)
    s_barrier
    s_waitcnt lgkmcnt(4)
    v_mfma_f32_32x32x16_bf16 v[180:195], v[156:159], v[148:151], v[180:195]
    ds_read_b128 v[152:155], v24 offset:32
    ds_read_b64_tr_b16 v[168:169], v26 offset:7168
    ds_read_b64_tr_b16 v[170:171], v26 offset:8960
    v_lshlrev_b32 v244, 16, v76
    v_and_b32 v245, 0xffff0000, v76
    v_fma_f32 v244, v244, v236, v240
    v_fma_f32 v245, v245, v236, v240
    v_cvt_pk_bf16_f32 v76, v244, v245
    v_lshlrev_b32 v244, 16, v77
    v_and_b32 v245, 0xffff0000, v77
    v_fma_f32 v244, v244, v236, v240
    v_fma_f32 v245, v245, v236, v240
    s_waitcnt lgkmcnt(5)
    v_mfma_f32_32x32x16_bf16 v[196:211], v[160:163], v[148:151], v[196:211]
    ds_read_b64_tr_b16 v[172:173], v26 offset:7232
    ds_read_b64_tr_b16 v[174:175], v26 offset:9024
    ds_read_b64_tr_b16 v[176:177], v26 offset:7296
    ds_read_b64_tr_b16 v[178:179], v26 offset:9088
    v_cvt_pk_bf16_f32 v77, v244, v245
    v_lshlrev_b32 v244, 16, v78
    v_and_b32 v245, 0xffff0000, v78
    v_fma_f32 v244, v244, v236, v240
    v_fma_f32 v245, v245, v236, v240
    v_cvt_pk_bf16_f32 v78, v244, v245
    v_lshlrev_b32 v244, 16, v79
    v_and_b32 v245, 0xffff0000, v79
    v_fma_f32 v244, v244, v236, v240
    s_waitcnt lgkmcnt(7)
    v_mfma_f32_32x32x16_bf16 v[212:227], v[164:167], v[148:151], v[212:227]
    v_fma_f32 v245, v245, v236, v240
    v_cvt_pk_bf16_f32 v79, v244, v245
    ds_write_b128 v27, v[76:79] offset:0
    v_lshlrev_b32 v244, 16, v80
    v_and_b32 v245, 0xffff0000, v80
    v_fma_f32 v244, v244, v238, v242
    v_fma_f32 v245, v245, v238, v242
    s_waitcnt lgkmcnt(5)
    v_mfma_f32_32x32x16_bf16 v[180:195], v[168:171], v[152:155], v[180:195]
    ds_read_b128 v[148:151], v24 offset:64
    ds_read_b64_tr_b16 v[156:157], v26 offset:14336
    ds_read_b64_tr_b16 v[158:159], v26 offset:16128
    v_cvt_pk_bf16_f32 v80, v244, v245
    v_lshlrev_b32 v244, 16, v81
    v_and_b32 v245, 0xffff0000, v81
    v_fma_f32 v244, v244, v238, v242
    v_fma_f32 v245, v245, v238, v242
    v_cvt_pk_bf16_f32 v81, v244, v245
    v_lshlrev_b32 v244, 16, v82
    v_and_b32 v245, 0xffff0000, v82
    s_waitcnt lgkmcnt(6)
    v_mfma_f32_32x32x16_bf16 v[196:211], v[172:175], v[152:155], v[196:211]
    ds_read_b64_tr_b16 v[160:161], v26 offset:14400
    ds_read_b64_tr_b16 v[162:163], v26 offset:16192
    ds_read_b64_tr_b16 v[164:165], v26 offset:14464
    ds_read_b64_tr_b16 v[166:167], v26 offset:16256
    v_fma_f32 v244, v244, v238, v242
    v_fma_f32 v245, v245, v238, v242
    v_cvt_pk_bf16_f32 v82, v244, v245
    v_lshlrev_b32 v244, 16, v83
    v_and_b32 v245, 0xffff0000, v83
    v_fma_f32 v244, v244, v238, v242
    v_fma_f32 v245, v245, v238, v242
    v_cvt_pk_bf16_f32 v83, v244, v245
    ds_write_b128 v27, v[80:83] offset:4608
    s_waitcnt lgkmcnt(9)
    v_mfma_f32_32x32x16_bf16 v[212:227], v[176:179], v[152:155], v[212:227]
    s_waitcnt vmcnt(11)
    ds_write_b128 v29, v[100:103] offset:0
    s_waitcnt vmcnt(10)
    ds_write_b128 v31, v[104:107] offset:0
    s_waitcnt lgkmcnt(7)
    v_mfma_f32_32x32x16_bf16 v[180:195], v[156:159], v[148:151], v[180:195]
    ds_read_b128 v[152:155], v24 offset:96
    ds_read_b64_tr_b16 v[168:169], v26 offset:21504
    ds_read_b64_tr_b16 v[170:171], v26 offset:23296
    s_waitcnt vmcnt(9)
    ds_write_b128 v33, v[108:111] offset:0
    s_waitcnt vmcnt(8)
    ds_write_b128 v35, v[112:115] offset:0
    s_waitcnt vmcnt(7)
    ds_write_b128 v37, v[116:119] offset:0
    s_waitcnt lgkmcnt(11)
    v_mfma_f32_32x32x16_bf16 v[196:211], v[160:163], v[148:151], v[196:211]
    ds_read_b64_tr_b16 v[172:173], v26 offset:21568
    ds_read_b64_tr_b16 v[174:175], v26 offset:23360
    ds_read_b64_tr_b16 v[176:177], v26 offset:21632
    ds_read_b64_tr_b16 v[178:179], v26 offset:23424
    s_waitcnt vmcnt(6)
    ds_write_b128 v39, v[120:123] offset:0
    s_mov_b32 s26, 1032192
    buffer_load_dwordx4 v[100:103], v9, s[12:15], s26 offen
    buffer_load_dwordx4 v[104:107], v10, s[12:15], s26 offen
    s_waitcnt lgkmcnt(14)
    v_mfma_f32_32x32x16_bf16 v[212:227], v[164:167], v[148:151], v[212:227]
    buffer_load_dwordx4 v[108:111], v11, s[12:15], s26 offen
    buffer_load_dwordx4 v[112:115], v12, s[12:15], s26 offen
    buffer_load_dwordx4 v[116:119], v13, s[12:15], s26 offen
    s_waitcnt lgkmcnt(8)
    v_mfma_f32_32x32x16_bf16 v[180:195], v[168:171], v[152:155], v[180:195]
    ds_read_b128 v[148:151], v21 offset:0
    ds_read_b64_tr_b16 v[156:157], v22 offset:0
    ds_read_b64_tr_b16 v[158:159], v22 offset:1792
    buffer_load_dwordx4 v[120:123], v14, s[12:15], s26 offen
    s_waitcnt lgkmcnt(6)
    v_mfma_f32_32x32x16_bf16 v[196:211], v[172:175], v[152:155], v[196:211]
    ds_read_b64_tr_b16 v[160:161], v22 offset:64
    ds_read_b64_tr_b16 v[162:163], v22 offset:1856
    ds_read_b64_tr_b16 v[164:165], v22 offset:128
    ds_read_b64_tr_b16 v[166:167], v22 offset:1920
    s_waitcnt lgkmcnt(8)
    v_mfma_f32_32x32x16_bf16 v[212:227], v[176:179], v[152:155], v[212:227]
    s_waitcnt lgkmcnt(7)
    s_barrier
    s_waitcnt lgkmcnt(4)
    v_mfma_f32_32x32x16_bf16 v[180:195], v[156:159], v[148:151], v[180:195]
    ds_read_b128 v[152:155], v21 offset:32
    ds_read_b64_tr_b16 v[168:169], v22 offset:7168
    ds_read_b64_tr_b16 v[170:171], v22 offset:8960
    v_lshlrev_b32 v244, 16, v84
    v_and_b32 v245, 0xffff0000, v84
    v_fma_f32 v244, v244, v236, v240
    v_fma_f32 v245, v245, v236, v240
    v_cvt_pk_bf16_f32 v84, v244, v245
    v_lshlrev_b32 v244, 16, v85
    v_and_b32 v245, 0xffff0000, v85
    s_waitcnt lgkmcnt(5)
    v_mfma_f32_32x32x16_bf16 v[196:211], v[160:163], v[148:151], v[196:211]
    ds_read_b64_tr_b16 v[172:173], v22 offset:7232
    ds_read_b64_tr_b16 v[174:175], v22 offset:9024
    ds_read_b64_tr_b16 v[176:177], v22 offset:7296
    ds_read_b64_tr_b16 v[178:179], v22 offset:9088
    v_fma_f32 v244, v244, v236, v240
    v_fma_f32 v245, v245, v236, v240
    v_cvt_pk_bf16_f32 v85, v244, v245
    v_lshlrev_b32 v244, 16, v86
    v_and_b32 v245, 0xffff0000, v86
    v_fma_f32 v244, v244, v236, v240
    v_fma_f32 v245, v245, v236, v240
    s_waitcnt lgkmcnt(7)
    v_mfma_f32_32x32x16_bf16 v[212:227], v[164:167], v[148:151], v[212:227]
    v_cvt_pk_bf16_f32 v86, v244, v245
    v_lshlrev_b32 v244, 16, v87
    v_and_b32 v245, 0xffff0000, v87
    v_fma_f32 v244, v244, v236, v240
    v_fma_f32 v245, v245, v236, v240
    v_cvt_pk_bf16_f32 v87, v244, v245
    ds_write_b128 v28, v[84:87] offset:0
    s_waitcnt lgkmcnt(5)
    v_mfma_f32_32x32x16_bf16 v[180:195], v[168:171], v[152:155], v[180:195]
    ds_read_b128 v[148:151], v21 offset:64
    ds_read_b64_tr_b16 v[156:157], v22 offset:14336
    ds_read_b64_tr_b16 v[158:159], v22 offset:16128
    v_lshlrev_b32 v244, 16, v88
    v_and_b32 v245, 0xffff0000, v88
    v_fma_f32 v244, v244, v238, v242
    v_fma_f32 v245, v245, v238, v242
    v_cvt_pk_bf16_f32 v88, v244, v245
    s_waitcnt lgkmcnt(6)
    v_mfma_f32_32x32x16_bf16 v[196:211], v[172:175], v[152:155], v[196:211]
    ds_read_b64_tr_b16 v[160:161], v22 offset:14400
    ds_read_b64_tr_b16 v[162:163], v22 offset:16192
    ds_read_b64_tr_b16 v[164:165], v22 offset:14464
    ds_read_b64_tr_b16 v[166:167], v22 offset:16256
    v_lshlrev_b32 v244, 16, v89
    v_and_b32 v245, 0xffff0000, v89
    v_fma_f32 v244, v244, v238, v242
    v_fma_f32 v245, v245, v238, v242
    v_cvt_pk_bf16_f32 v89, v244, v245
    v_lshlrev_b32 v244, 16, v90
    v_and_b32 v245, 0xffff0000, v90
    s_waitcnt lgkmcnt(8)
    v_mfma_f32_32x32x16_bf16 v[212:227], v[176:179], v[152:155], v[212:227]
    v_fma_f32 v244, v244, v238, v242
    v_fma_f32 v245, v245, v238, v242
    v_cvt_pk_bf16_f32 v90, v244, v245
    v_lshlrev_b32 v244, 16, v91
    v_and_b32 v245, 0xffff0000, v91
    v_fma_f32 v244, v244, v238, v242
    s_waitcnt lgkmcnt(4)
    v_mfma_f32_32x32x16_bf16 v[180:195], v[156:159], v[148:151], v[180:195]
    ds_read_b128 v[152:155], v21 offset:96
    ds_read_b64_tr_b16 v[168:169], v22 offset:21504
    ds_read_b64_tr_b16 v[170:171], v22 offset:23296
    v_fma_f32 v245, v245, v238, v242
    v_cvt_pk_bf16_f32 v91, v244, v245
    ds_write_b128 v28, v[88:91] offset:4608
    s_waitcnt vmcnt(11)
    ds_write_b128 v30, v[124:127] offset:0
    s_waitcnt lgkmcnt(7)
    v_mfma_f32_32x32x16_bf16 v[196:211], v[160:163], v[148:151], v[196:211]
    ds_read_b64_tr_b16 v[172:173], v22 offset:21568
    ds_read_b64_tr_b16 v[174:175], v22 offset:23360
    ds_read_b64_tr_b16 v[176:177], v22 offset:21632
    ds_read_b64_tr_b16 v[178:179], v22 offset:23424
    s_waitcnt vmcnt(10)
    ds_write_b128 v32, v[128:131] offset:0
    s_waitcnt vmcnt(9)
    ds_write_b128 v34, v[132:135] offset:0
    s_waitcnt lgkmcnt(11)
    v_mfma_f32_32x32x16_bf16 v[212:227], v[164:167], v[148:151], v[212:227]
    s_waitcnt vmcnt(8)
    ds_write_b128 v36, v[136:139] offset:0
    s_waitcnt vmcnt(7)
    ds_write_b128 v38, v[140:143] offset:0
    s_waitcnt lgkmcnt(10)
    v_mfma_f32_32x32x16_bf16 v[180:195], v[168:171], v[152:155], v[180:195]
    ds_read_b128 v[148:151], v23 offset:0
    ds_read_b64_tr_b16 v[156:157], v25 offset:0
    ds_read_b64_tr_b16 v[158:159], v25 offset:1792
    s_waitcnt vmcnt(6)
    ds_write_b128 v40, v[144:147] offset:0
    s_waitcnt lgkmcnt(10)
    v_mfma_f32_32x32x16_bf16 v[196:211], v[172:175], v[152:155], v[196:211]
    ds_read_b64_tr_b16 v[160:161], v25 offset:64
    ds_read_b64_tr_b16 v[162:163], v25 offset:1856
    ds_read_b64_tr_b16 v[164:165], v25 offset:128
    ds_read_b64_tr_b16 v[166:167], v25 offset:1920
    s_waitcnt lgkmcnt(12)
    v_mfma_f32_32x32x16_bf16 v[212:227], v[176:179], v[152:155], v[212:227]
    s_waitcnt lgkmcnt(4)
    s_barrier
    v_mfma_f32_32x32x16_bf16 v[180:195], v[156:159], v[148:151], v[180:195]
    ds_read_b128 v[152:155], v23 offset:32
    ds_read_b64_tr_b16 v[168:169], v25 offset:7168
    ds_read_b64_tr_b16 v[170:171], v25 offset:8960
    v_lshlrev_b32 v244, 16, v92
    v_and_b32 v245, 0xffff0000, v92
    v_fma_f32 v244, v244, v236, v240
    v_fma_f32 v245, v245, v236, v240
    v_cvt_pk_bf16_f32 v92, v244, v245
    v_lshlrev_b32 v244, 16, v93
    v_and_b32 v245, 0xffff0000, v93
    s_waitcnt lgkmcnt(5)
    v_mfma_f32_32x32x16_bf16 v[196:211], v[160:163], v[148:151], v[196:211]
    ds_read_b64_tr_b16 v[172:173], v25 offset:7232
    ds_read_b64_tr_b16 v[174:175], v25 offset:9024
    ds_read_b64_tr_b16 v[176:177], v25 offset:7296
    ds_read_b64_tr_b16 v[178:179], v25 offset:9088
    v_fma_f32 v244, v244, v236, v240
    v_fma_f32 v245, v245, v236, v240
    v_cvt_pk_bf16_f32 v93, v244, v245
    v_lshlrev_b32 v244, 16, v94
    v_and_b32 v245, 0xffff0000, v94
    v_fma_f32 v244, v244, v236, v240
    v_fma_f32 v245, v245, v236, v240
    s_waitcnt lgkmcnt(7)
    v_mfma_f32_32x32x16_bf16 v[212:227], v[164:167], v[148:151], v[212:227]
    v_cvt_pk_bf16_f32 v94, v244, v245
    v_lshlrev_b32 v244, 16, v95
    v_and_b32 v245, 0xffff0000, v95
    v_fma_f32 v244, v244, v236, v240
    v_fma_f32 v245, v245, v236, v240
    v_cvt_pk_bf16_f32 v95, v244, v245
    ds_write_b128 v8, v[92:95] offset:0
    s_waitcnt lgkmcnt(5)
    v_mfma_f32_32x32x16_bf16 v[180:195], v[168:171], v[152:155], v[180:195]
    ds_read_b128 v[148:151], v23 offset:64
    ds_read_b64_tr_b16 v[156:157], v25 offset:14336
    ds_read_b64_tr_b16 v[158:159], v25 offset:16128
    v_lshlrev_b32 v244, 16, v96
    v_and_b32 v245, 0xffff0000, v96
    v_fma_f32 v244, v244, v238, v242
    v_fma_f32 v245, v245, v238, v242
    v_cvt_pk_bf16_f32 v96, v244, v245
    s_waitcnt lgkmcnt(6)
    v_mfma_f32_32x32x16_bf16 v[196:211], v[172:175], v[152:155], v[196:211]
    ds_read_b64_tr_b16 v[160:161], v25 offset:14400
    ds_read_b64_tr_b16 v[162:163], v25 offset:16192
    ds_read_b64_tr_b16 v[164:165], v25 offset:14464
    ds_read_b64_tr_b16 v[166:167], v25 offset:16256
    v_lshlrev_b32 v244, 16, v97
    v_and_b32 v245, 0xffff0000, v97
    v_fma_f32 v244, v244, v238, v242
    v_fma_f32 v245, v245, v238, v242
    v_cvt_pk_bf16_f32 v97, v244, v245
    v_lshlrev_b32 v244, 16, v98
    v_and_b32 v245, 0xffff0000, v98
    s_waitcnt lgkmcnt(8)
    v_mfma_f32_32x32x16_bf16 v[212:227], v[176:179], v[152:155], v[212:227]
    v_fma_f32 v244, v244, v238, v242
    v_fma_f32 v245, v245, v238, v242
    v_cvt_pk_bf16_f32 v98, v244, v245
    v_lshlrev_b32 v244, 16, v99
    v_and_b32 v245, 0xffff0000, v99
    v_fma_f32 v244, v244, v238, v242
    s_waitcnt lgkmcnt(4)
    v_mfma_f32_32x32x16_bf16 v[180:195], v[156:159], v[148:151], v[180:195]
    ds_read_b128 v[152:155], v23 offset:96
    ds_read_b64_tr_b16 v[168:169], v25 offset:21504
    ds_read_b64_tr_b16 v[170:171], v25 offset:23296
    v_fma_f32 v245, v245, v238, v242
    v_cvt_pk_bf16_f32 v99, v244, v245
    ds_write_b128 v8, v[96:99] offset:4608
    s_waitcnt vmcnt(5)
    ds_write_b128 v15, v[100:103] offset:0
    s_waitcnt lgkmcnt(7)
    v_mfma_f32_32x32x16_bf16 v[196:211], v[160:163], v[148:151], v[196:211]
    ds_read_b64_tr_b16 v[172:173], v25 offset:21568
    ds_read_b64_tr_b16 v[174:175], v25 offset:23360
    ds_read_b64_tr_b16 v[176:177], v25 offset:21632
    ds_read_b64_tr_b16 v[178:179], v25 offset:23424
    s_waitcnt vmcnt(4)
    ds_write_b128 v16, v[104:107] offset:0
    s_waitcnt vmcnt(3)
    ds_write_b128 v17, v[108:111] offset:0
    s_waitcnt lgkmcnt(11)
    v_mfma_f32_32x32x16_bf16 v[212:227], v[164:167], v[148:151], v[212:227]
    s_waitcnt vmcnt(2)
    ds_write_b128 v18, v[112:115] offset:0
    s_waitcnt vmcnt(1)
    ds_write_b128 v19, v[116:119] offset:0
    s_waitcnt lgkmcnt(10)
    v_mfma_f32_32x32x16_bf16 v[180:195], v[168:171], v[152:155], v[180:195]
    ds_read_b128 v[148:151], v24 offset:0
    ds_read_b64_tr_b16 v[156:157], v26 offset:0
    ds_read_b64_tr_b16 v[158:159], v26 offset:1792
    s_waitcnt vmcnt(0)
    ds_write_b128 v20, v[120:123] offset:0
    s_waitcnt lgkmcnt(10)
    v_mfma_f32_32x32x16_bf16 v[196:211], v[172:175], v[152:155], v[196:211]
    ds_read_b64_tr_b16 v[160:161], v26 offset:64
    ds_read_b64_tr_b16 v[162:163], v26 offset:1856
    ds_read_b64_tr_b16 v[164:165], v26 offset:128
    ds_read_b64_tr_b16 v[166:167], v26 offset:1920
    s_waitcnt lgkmcnt(12)
    v_mfma_f32_32x32x16_bf16 v[212:227], v[176:179], v[152:155], v[212:227]
    s_waitcnt lgkmcnt(4)
    s_barrier
    v_mfma_f32_32x32x16_bf16 v[180:195], v[156:159], v[148:151], v[180:195]
    ds_read_b128 v[152:155], v24 offset:32
    ds_read_b64_tr_b16 v[168:169], v26 offset:7168
    ds_read_b64_tr_b16 v[170:171], v26 offset:8960
    s_waitcnt lgkmcnt(5)
    v_mfma_f32_32x32x16_bf16 v[196:211], v[160:163], v[148:151], v[196:211]
    ds_read_b64_tr_b16 v[172:173], v26 offset:7232
    ds_read_b64_tr_b16 v[174:175], v26 offset:9024
    ds_read_b64_tr_b16 v[176:177], v26 offset:7296
    ds_read_b64_tr_b16 v[178:179], v26 offset:9088
    s_waitcnt lgkmcnt(7)
    v_mfma_f32_32x32x16_bf16 v[212:227], v[164:167], v[148:151], v[212:227]
    s_waitcnt lgkmcnt(4)
    v_mfma_f32_32x32x16_bf16 v[180:195], v[168:171], v[152:155], v[180:195]
    ds_read_b128 v[148:151], v24 offset:64
    ds_read_b64_tr_b16 v[156:157], v26 offset:14336
    ds_read_b64_tr_b16 v[158:159], v26 offset:16128
    s_waitcnt lgkmcnt(5)
    v_mfma_f32_32x32x16_bf16 v[196:211], v[172:175], v[152:155], v[196:211]
    ds_read_b64_tr_b16 v[160:161], v26 offset:14400
    ds_read_b64_tr_b16 v[162:163], v26 offset:16192
    ds_read_b64_tr_b16 v[164:165], v26 offset:14464
    ds_read_b64_tr_b16 v[166:167], v26 offset:16256
    s_waitcnt lgkmcnt(7)
    v_mfma_f32_32x32x16_bf16 v[212:227], v[176:179], v[152:155], v[212:227]
    s_waitcnt lgkmcnt(4)
    v_mfma_f32_32x32x16_bf16 v[180:195], v[156:159], v[148:151], v[180:195]
    ds_read_b128 v[152:155], v24 offset:96
    ds_read_b64_tr_b16 v[168:169], v26 offset:21504
    ds_read_b64_tr_b16 v[170:171], v26 offset:23296
    s_waitcnt lgkmcnt(5)
    v_mfma_f32_32x32x16_bf16 v[196:211], v[160:163], v[148:151], v[196:211]
    ds_read_b64_tr_b16 v[172:173], v26 offset:21568
    ds_read_b64_tr_b16 v[174:175], v26 offset:23360
    ds_read_b64_tr_b16 v[176:177], v26 offset:21632
    ds_read_b64_tr_b16 v[178:179], v26 offset:23424
    s_waitcnt lgkmcnt(7)
    v_mfma_f32_32x32x16_bf16 v[212:227], v[164:167], v[148:151], v[212:227]
    s_waitcnt lgkmcnt(4)
    v_mfma_f32_32x32x16_bf16 v[180:195], v[168:171], v[152:155], v[180:195]
    ds_read_b128 v[148:151], v21 offset:0
    ds_read_b64_tr_b16 v[156:157], v22 offset:0
    ds_read_b64_tr_b16 v[158:159], v22 offset:1792
    s_waitcnt lgkmcnt(5)
    v_mfma_f32_32x32x16_bf16 v[196:211], v[172:175], v[152:155], v[196:211]
    ds_read_b64_tr_b16 v[160:161], v22 offset:64
    ds_read_b64_tr_b16 v[162:163], v22 offset:1856
    ds_read_b64_tr_b16 v[164:165], v22 offset:128
    ds_read_b64_tr_b16 v[166:167], v22 offset:1920
    s_waitcnt lgkmcnt(7)
    v_mfma_f32_32x32x16_bf16 v[212:227], v[176:179], v[152:155], v[212:227]
    s_waitcnt lgkmcnt(4)
    v_mfma_f32_32x32x16_bf16 v[180:195], v[156:159], v[148:151], v[180:195]
    ds_read_b128 v[152:155], v21 offset:32
    ds_read_b64_tr_b16 v[168:169], v22 offset:7168
    ds_read_b64_tr_b16 v[170:171], v22 offset:8960
    s_waitcnt lgkmcnt(5)
    v_mfma_f32_32x32x16_bf16 v[196:211], v[160:163], v[148:151], v[196:211]
    ds_read_b64_tr_b16 v[172:173], v22 offset:7232
    ds_read_b64_tr_b16 v[174:175], v22 offset:9024
    ds_read_b64_tr_b16 v[176:177], v22 offset:7296
    ds_read_b64_tr_b16 v[178:179], v22 offset:9088
    s_waitcnt lgkmcnt(7)
    v_mfma_f32_32x32x16_bf16 v[212:227], v[164:167], v[148:151], v[212:227]
    s_waitcnt lgkmcnt(4)
    v_mfma_f32_32x32x16_bf16 v[180:195], v[168:171], v[152:155], v[180:195]
    ds_read_b128 v[148:151], v21 offset:64
    ds_read_b64_tr_b16 v[156:157], v22 offset:14336
    ds_read_b64_tr_b16 v[158:159], v22 offset:16128
    s_waitcnt lgkmcnt(5)
    v_mfma_f32_32x32x16_bf16 v[196:211], v[172:175], v[152:155], v[196:211]
    ds_read_b64_tr_b16 v[160:161], v22 offset:14400
    ds_read_b64_tr_b16 v[162:163], v22 offset:16192
    ds_read_b64_tr_b16 v[164:165], v22 offset:14464
    ds_read_b64_tr_b16 v[166:167], v22 offset:16256
    s_waitcnt lgkmcnt(7)
    v_mfma_f32_32x32x16_bf16 v[212:227], v[176:179], v[152:155], v[212:227]
    s_waitcnt lgkmcnt(4)
    v_mfma_f32_32x32x16_bf16 v[180:195], v[156:159], v[148:151], v[180:195]
    ds_read_b128 v[152:155], v21 offset:96
    ds_read_b64_tr_b16 v[168:169], v22 offset:21504
    ds_read_b64_tr_b16 v[170:171], v22 offset:23296
    s_waitcnt lgkmcnt(5)
    v_mfma_f32_32x32x16_bf16 v[196:211], v[160:163], v[148:151], v[196:211]
    ds_read_b64_tr_b16 v[172:173], v22 offset:21568
    ds_read_b64_tr_b16 v[174:175], v22 offset:23360
    ds_read_b64_tr_b16 v[176:177], v22 offset:21632
    ds_read_b64_tr_b16 v[178:179], v22 offset:23424
    s_waitcnt lgkmcnt(7)
    v_mfma_f32_32x32x16_bf16 v[212:227], v[164:167], v[148:151], v[212:227]
    s_waitcnt lgkmcnt(4)
    v_mfma_f32_32x32x16_bf16 v[180:195], v[168:171], v[152:155], v[180:195]
    s_waitcnt lgkmcnt(2)
    v_mfma_f32_32x32x16_bf16 v[196:211], v[172:175], v[152:155], v[196:211]
    s_waitcnt lgkmcnt(0)
    v_mfma_f32_32x32x16_bf16 v[212:227], v[176:179], v[152:155], v[212:227]
    s_mul_i32 s27, s24, 64
    s_mul_i32 s28, s25, 192
    v_and_b32 v5, 31, v1
    v_lshrrev_b32 v6, 5, v1
    v_lshlrev_b32 v6, 2, v6
    v_lshrrev_b32 v3, 1, v2
    v_and_b32 v4, 1, v2
    v_mul_u32_u24 v3, 32, v3
    v_mul_u32_u24 v4, 96, v4
    v_add3_u32 v44, v3, v5, s27
    v_add3_u32 v45, v4, v6, s28
    s_mov_b32 s16, s50
    s_and_b32 s17, s51, 0xffff
    s_mov_b32 s18, 0x600000
    s_mov_b32 s19, 0x00020000
    v_lshrrev_b32 v59, 2, v45
    v_lshrrev_b32 v3, 5, v1
    v_add_u32 v59, v59, v3
    v_cvt_pk_bf16_f32 v48, v180, v181
    v_cvt_pk_bf16_f32 v49, v182, v183
    v_cvt_pk_bf16_f32 v50, v184, v185
    v_cvt_pk_bf16_f32 v51, v186, v187
    v_add_u32 v3, 0, v59
    v_mul_u32_u24 v4, 0x2493, v3
    v_lshrrev_b32 v4, 16, v4
    v_mul_u32_u24 v5, 7, v4
    v_sub_u32 v5, v3, v5
    v_lshlrev_b32 v4, 17, v4
    v_lshl_add_u32 v4, v44, 6, v4
    v_lshl_add_u32 v56, v5, 3, v4
    v_permlane32_swap_b32 v48, v50
    v_permlane32_swap_b32 v49, v51
    buffer_store_dwordx4 v[48:51], v56, s[16:19], 0 offen
    v_add_u32 v58, 0x20000, v4
    v_cmp_eq_u32 vcc, 6, v5
    s_nop 0
    s_and_saveexec_b64 s[52:53], vcc
    s_nop 2
    s_cbranch_execz L_q1_g1_0_kernel
    buffer_store_dwordx2 v[50:51], v58, s[16:19], 0 offen
L_q1_g1_0_kernel:
    s_mov_b64 exec, s[52:53]
    v_cvt_pk_bf16_f32 v52, v188, v189
    v_cvt_pk_bf16_f32 v53, v190, v191
    v_cvt_pk_bf16_f32 v54, v192, v193
    v_cvt_pk_bf16_f32 v55, v194, v195
    v_add_u32 v3, 4, v59
    v_mul_u32_u24 v4, 0x2493, v3
    v_lshrrev_b32 v4, 16, v4
    v_mul_u32_u24 v5, 7, v4
    v_sub_u32 v5, v3, v5
    v_lshlrev_b32 v4, 17, v4
    v_lshl_add_u32 v4, v44, 6, v4
    v_lshl_add_u32 v57, v5, 3, v4
    v_permlane32_swap_b32 v52, v54
    v_permlane32_swap_b32 v53, v55
    buffer_store_dwordx4 v[52:55], v57, s[16:19], 0 offen
    v_add_u32 v58, 0x20000, v4
    v_cmp_eq_u32 vcc, 6, v5
    s_nop 0
    s_and_saveexec_b64 s[52:53], vcc
    s_nop 2
    s_cbranch_execz L_q2_g1_0_kernel
    buffer_store_dwordx2 v[54:55], v58, s[16:19], 0 offen
L_q2_g1_0_kernel:
    s_mov_b64 exec, s[52:53]
    v_cvt_pk_bf16_f32 v48, v196, v197
    v_cvt_pk_bf16_f32 v49, v198, v199
    v_cvt_pk_bf16_f32 v50, v200, v201
    v_cvt_pk_bf16_f32 v51, v202, v203
    v_add_u32 v3, 8, v59
    v_mul_u32_u24 v4, 0x2493, v3
    v_lshrrev_b32 v4, 16, v4
    v_mul_u32_u24 v5, 7, v4
    v_sub_u32 v5, v3, v5
    v_lshlrev_b32 v4, 17, v4
    v_lshl_add_u32 v4, v44, 6, v4
    v_lshl_add_u32 v56, v5, 3, v4
    v_permlane32_swap_b32 v48, v50
    v_permlane32_swap_b32 v49, v51
    buffer_store_dwordx4 v[48:51], v56, s[16:19], 0 offen
    v_add_u32 v58, 0x20000, v4
    v_cmp_eq_u32 vcc, 6, v5
    s_nop 0
    s_and_saveexec_b64 s[52:53], vcc
    s_nop 2
    s_cbranch_execz L_q3_g1_0_kernel
    buffer_store_dwordx2 v[50:51], v58, s[16:19], 0 offen
L_q3_g1_0_kernel:
    s_mov_b64 exec, s[52:53]
    v_cvt_pk_bf16_f32 v52, v204, v205
    v_cvt_pk_bf16_f32 v53, v206, v207
    v_cvt_pk_bf16_f32 v54, v208, v209
    v_cvt_pk_bf16_f32 v55, v210, v211
    v_add_u32 v3, 12, v59
    v_mul_u32_u24 v4, 0x2493, v3
    v_lshrrev_b32 v4, 16, v4
    v_mul_u32_u24 v5, 7, v4
    v_sub_u32 v5, v3, v5
    v_lshlrev_b32 v4, 17, v4
    v_lshl_add_u32 v4, v44, 6, v4
    v_lshl_add_u32 v57, v5, 3, v4
    v_permlane32_swap_b32 v52, v54
    v_permlane32_swap_b32 v53, v55
    buffer_store_dwordx4 v[52:55], v57, s[16:19], 0 offen
    v_add_u32 v58, 0x20000, v4
    v_cmp_eq_u32 vcc, 6, v5
    s_nop 0
    s_and_saveexec_b64 s[52:53], vcc
    s_nop 2
    s_cbranch_execz L_q4_g1_0_kernel
    buffer_store_dwordx2 v[54:55], v58, s[16:19], 0 offen
L_q4_g1_0_kernel:
    s_mov_b64 exec, s[52:53]
    v_cvt_pk_bf16_f32 v48, v212, v213
    v_cvt_pk_bf16_f32 v49, v214, v215
    v_cvt_pk_bf16_f32 v50, v216, v217
    v_cvt_pk_bf16_f32 v51, v218, v219
    v_add_u32 v3, 16, v59
    v_mul_u32_u24 v4, 0x2493, v3
    v_lshrrev_b32 v4, 16, v4
    v_mul_u32_u24 v5, 7, v4
    v_sub_u32 v5, v3, v5
    v_lshlrev_b32 v4, 17, v4
    v_lshl_add_u32 v4, v44, 6, v4
    v_lshl_add_u32 v56, v5, 3, v4
    v_permlane32_swap_b32 v48, v50
    v_permlane32_swap_b32 v49, v51
    buffer_store_dwordx4 v[48:51], v56, s[16:19], 0 offen
    v_add_u32 v58, 0x20000, v4
    v_cmp_eq_u32 vcc, 6, v5
    s_nop 0
    s_and_saveexec_b64 s[52:53], vcc
    s_nop 2
    s_cbranch_execz L_q5_g1_0_kernel
    buffer_store_dwordx2 v[50:51], v58, s[16:19], 0 offen
L_q5_g1_0_kernel:
    s_mov_b64 exec, s[52:53]
    v_cvt_pk_bf16_f32 v52, v220, v221
    v_cvt_pk_bf16_f32 v53, v222, v223
    v_cvt_pk_bf16_f32 v54, v224, v225
    v_cvt_pk_bf16_f32 v55, v226, v227
    v_add_u32 v3, 20, v59
    v_mul_u32_u24 v4, 0x2493, v3
    v_lshrrev_b32 v4, 16, v4
    v_mul_u32_u24 v5, 7, v4
    v_sub_u32 v5, v3, v5
    v_lshlrev_b32 v4, 17, v4
    v_lshl_add_u32 v4, v44, 6, v4
    v_lshl_add_u32 v57, v5, 3, v4
    v_permlane32_swap_b32 v52, v54
    v_permlane32_swap_b32 v53, v55
    buffer_store_dwordx4 v[52:55], v57, s[16:19], 0 offen
    v_add_u32 v58, 0x20000, v4
    v_cmp_eq_u32 vcc, 6, v5
    s_nop 0
    s_and_saveexec_b64 s[52:53], vcc
    s_nop 2
    s_cbranch_execz L_q6_g1_0_kernel
    buffer_store_dwordx2 v[54:55], v58, s[16:19], 0 offen
L_q6_g1_0_kernel:
    s_mov_b64 exec, s[52:53]
L_end_g1_0_kernel:
    s_endpgm
L_side_g1_0_kernel:
    s_waitcnt lgkmcnt(0)
    s_sub_u32 s3, s2, 224
    s_cmp_ge_u32 s3, 28
    s_cbranch_scc1 L_send_g1_0_kernel
    s_load_dwordx2 s[4:5], s[0:1], 32
    s_load_dwordx2 s[6:7], s[0:1], 40
    s_load_dwordx2 s[24:25], s[0:1], 72
    s_waitcnt lgkmcnt(0)
    s_mov_b32 s10, s3
    s_mov_b32 s12, 0x1500000
    s_cmp_lt_u32 s3, 14
    s_cbranch_scc1 L_sel_g1_0_kernel
    s_mov_b32 s4, s6
    s_mov_b32 s5, s7
    s_sub_u32 s10, s3, 14
    s_mov_b32 s12, 0x1690000
L_sel_g1_0_kernel:
    s_mov_b32 s16, s4
    s_and_b32 s17, s5, 0xffff
    s_mov_b32 s18, 1605632
    s_mov_b32 s19, 0x00020000
    s_add_u32 s20, s24, s12
    s_addc_u32 s21, s25, 0
    s_and_b32 s21, s21, 0xffff
    s_mov_b32 s22, 1605632
    s_mov_b32 s23, 0x00020000
    v_lshrrev_b32 v1, 4, v0
    v_and_b32 v2, 15, v0
    v_lshlrev_b32 v2, 4, v2
    s_lshl_b32 s13, s10, 8
    v_mul_u32_u24 v3, 3584, v1
    v_add3_u32 v3, v3, v2, s13
    v_mul_u32_u24 v4, 320, v1
    v_add_u32 v4, v4, v2
    s_mov_b32 s14, 0
    buffer_load_dwordx4 v[16:19], v3, s[16:19], s14 offen
    s_mov_b32 s14, 57344
    buffer_load_dwordx4 v[20:23], v3, s[16:19], s14 offen
    s_mov_b32 s14, 114688
    buffer_load_dwordx4 v[24:27], v3, s[16:19], s14 offen
    s_mov_b32 s14, 172032
    buffer_load_dwordx4 v[28:31], v3, s[16:19], s14 offen
    s_mov_b32 s14, 229376
    buffer_load_dwordx4 v[32:35], v3, s[16:19], s14 offen
    s_mov_b32 s14, 286720
    buffer_load_dwordx4 v[36:39], v3, s[16:19], s14 offen
    s_mov_b32 s14, 344064
    buffer_load_dwordx4 v[40:43], v3, s[16:19], s14 offen
    s_mov_b32 s14, 401408
    buffer_load_dwordx4 v[44:47], v3, s[16:19], s14 offen
    s_mov_b32 s14, 458752
    buffer_load_dwordx4 v[48:51], v3, s[16:19], s14 offen
    s_mov_b32 s14, 516096
    buffer_load_dwordx4 v[52:55], v3, s[16:19], s14 offen
    s_mov_b32 s14, 573440
    buffer_load_dwordx4 v[56:59], v3, s[16:19], s14 offen
    s_mov_b32 s14, 630784
    buffer_load_dwordx4 v[60:63], v3, s[16:19], s14 offen
    s_mov_b32 s14, 688128
    buffer_load_dwordx4 v[64:67], v3, s[16:19], s14 offen
    s_mov_b32 s14, 745472
    buffer_load_dwordx4 v[68:71], v3, s[16:19], s14 offen
    s_mov_b32 s14, 802816
    buffer_load_dwordx4 v[72:75], v3, s[16:19], s14 offen
    s_mov_b32 s14, 860160
    buffer_load_dwordx4 v[76:79], v3, s[16:19], s14 offen
    s_mov_b32 s14, 917504
    buffer_load_dwordx4 v[80:83], v3, s[16:19], s14 offen
    s_mov_b32 s14, 974848
    buffer_load_dwordx4 v[84:87], v3, s[16:19], s14 offen
    s_mov_b32 s14, 1032192
    buffer_load_dwordx4 v[88:91], v3, s[16:19], s14 offen
    s_mov_b32 s14, 1089536
    buffer_load_dwordx4 v[92:95], v3, s[16:19], s14 offen
    s_mov_b32 s14, 1146880
    buffer_load_dwordx4 v[96:99], v3, s[16:19], s14 offen
    s_mov_b32 s14, 1204224
    buffer_load_dwordx4 v[100:103], v3, s[16:19], s14 offen
    s_mov_b32 s14, 1261568
    buffer_load_dwordx4 v[104:107], v3, s[16:19], s14 offen
    s_mov_b32 s14, 1318912
    buffer_load_dwordx4 v[108:111], v3, s[16:19], s14 offen
    s_mov_b32 s14, 1376256
    buffer_load_dwordx4 v[112:115], v3, s[16:19], s14 offen
    s_mov_b32 s14, 1433600
    buffer_load_dwordx4 v[116:119], v3, s[16:19], s14 offen
    s_mov_b32 s14, 1490944
    buffer_load_dwordx4 v[120:123], v3, s[16:19], s14 offen
    s_mov_b32 s14, 1548288
    buffer_load_dwordx4 v[124:127], v3, s[16:19], s14 offen
    v_and_b32 v5, 63, v0
    v_lshrrev_b32 v6, 6, v0
    v_lshrrev_b32 v7, 5, v5
    v_lshlrev_b32 v7, 3, v7
    v_bfe_u32 v8, v5, 2, 2
    v_add_u32 v7, v7, v8
    v_mul_u32_u24 v9, 320, v7
    v_bfe_u32 v8, v5, 4, 1
    v_lshlrev_b32 v8, 5, v8
    v_and_b32 v10, 3, v5
    v_lshlrev_b32 v10, 3, v10
    v_add3_u32 v9, v9, v8, v10
    v_lshl_add_u32 v9, v6, 6, v9
    s_lshl_b32 s13, s10, 2
    v_add_u32 v11, s13, v6
    v_mul_u32_u24 v11, 28672, v11
    v_lshl_add_u32 v11, v5, 4, v11
    s_waitcnt vmcnt(27)
    ds_write_b128 v4, v[16:19] offset:0
    s_waitcnt vmcnt(26)
    ds_write_b128 v4, v[20:23] offset:5120
    s_waitcnt vmcnt(25)
    ds_write_b128 v4, v[24:27] offset:10240
    s_waitcnt vmcnt(24)
    ds_write_b128 v4, v[28:31] offset:15360
    s_waitcnt lgkmcnt(0)
    s_barrier
    ds_read_b64_tr_b16 v[132:133], v9 offset:0
    ds_read_b64_tr_b16 v[134:135], v9 offset:1280
    ds_read_b64_tr_b16 v[136:137], v9 offset:5120
    ds_read_b64_tr_b16 v[138:139], v9 offset:6400
    ds_read_b64_tr_b16 v[140:141], v9 offset:10240
    ds_read_b64_tr_b16 v[142:143], v9 offset:11520
    ds_read_b64_tr_b16 v[144:145], v9 offset:15360
    ds_read_b64_tr_b16 v[146:147], v9 offset:16640
    s_mov_b32 s14, 0
    s_waitcnt lgkmcnt(6)
    buffer_store_dwordx4 v[132:135], v11, s[20:23], s14 offen offset:0
    s_waitcnt lgkmcnt(4)
    buffer_store_dwordx4 v[136:139], v11, s[20:23], s14 offen offset:1024
    s_waitcnt lgkmcnt(2)
    buffer_store_dwordx4 v[140:143], v11, s[20:23], s14 offen offset:2048
    s_waitcnt lgkmcnt(0)
    buffer_store_dwordx4 v[144:147], v11, s[20:23], s14 offen offset:3072
    s_waitcnt lgkmcnt(0)
    s_barrier
    s_waitcnt vmcnt(27)
    ds_write_b128 v4, v[32:35] offset:0
    s_waitcnt vmcnt(26)
    ds_write_b128 v4, v[36:39] offset:5120
    s_waitcnt vmcnt(25)
    ds_write_b128 v4, v[40:43] offset:10240
    s_waitcnt vmcnt(24)
    ds_write_b128 v4, v[44:47] offset:15360
    s_waitcnt lgkmcnt(0)
    s_barrier
    ds_read_b64_tr_b16 v[132:133], v9 offset:0
    ds_read_b64_tr_b16 v[134:135], v9 offset:1280
    ds_read_b64_tr_b16 v[136:137], v9 offset:5120
    ds_read_b64_tr_b16 v[138:139], v9 offset:6400
    ds_read_b64_tr_b16 v[140:141], v9 offset:10240
    ds_read_b64_tr_b16 v[142:143], v9 offset:11520
    ds_read_b64_tr_b16 v[144:145], v9 offset:15360
    ds_read_b64_tr_b16 v[146:147], v9 offset:16640
    s_mov_b32 s14, 4096
    s_waitcnt lgkmcnt(6)
    buffer_store_dwordx4 v[132:135], v11, s[20:23], s14 offen offset:0
    s_waitcnt lgkmcnt(4)
    buffer_store_dwordx4 v[136:139], v11, s[20:23], s14 offen offset:1024
    s_waitcnt lgkmcnt(2)
    buffer_store_dwordx4 v[140:143], v11, s[20:23], s14 offen offset:2048
    s_waitcnt lgkmcnt(0)
    buffer_store_dwordx4 v[144:147], v11, s[20:23], s14 offen offset:3072
    s_waitcnt lgkmcnt(0)
    s_barrier
    s_waitcnt vmcnt(27)
    ds_write_b128 v4, v[48:51] offset:0
    s_waitcnt vmcnt(26)
    ds_write_b128 v4, v[52:55] offset:5120
    s_waitcnt vmcnt(25)
    ds_write_b128 v4, v[56:59] offset:10240
    s_waitcnt vmcnt(24)
    ds_write_b128 v4, v[60:63] offset:15360
    s_waitcnt lgkmcnt(0)
    s_barrier
    ds_read_b64_tr_b16 v[132:133], v9 offset:0
    ds_read_b64_tr_b16 v[134:135], v9 offset:1280
    ds_read_b64_tr_b16 v[136:137], v9 offset:5120
    ds_read_b64_tr_b16 v[138:139], v9 offset:6400
    ds_read_b64_tr_b16 v[140:141], v9 offset:10240
    ds_read_b64_tr_b16 v[142:143], v9 offset:11520
    ds_read_b64_tr_b16 v[144:145], v9 offset:15360
    ds_read_b64_tr_b16 v[146:147], v9 offset:16640
    s_mov_b32 s14, 8192
    s_waitcnt lgkmcnt(6)
    buffer_store_dwordx4 v[132:135], v11, s[20:23], s14 offen offset:0
    s_waitcnt lgkmcnt(4)
    buffer_store_dwordx4 v[136:139], v11, s[20:23], s14 offen offset:1024
    s_waitcnt lgkmcnt(2)
    buffer_store_dwordx4 v[140:143], v11, s[20:23], s14 offen offset:2048
    s_waitcnt lgkmcnt(0)
    buffer_store_dwordx4 v[144:147], v11, s[20:23], s14 offen offset:3072
    s_waitcnt lgkmcnt(0)
    s_barrier
    s_waitcnt vmcnt(27)
    ds_write_b128 v4, v[64:67] offset:0
    s_waitcnt vmcnt(26)
    ds_write_b128 v4, v[68:71] offset:5120
    s_waitcnt vmcnt(25)
    ds_write_b128 v4, v[72:75] offset:10240
    s_waitcnt vmcnt(24)
    ds_write_b128 v4, v[76:79] offset:15360
    s_waitcnt lgkmcnt(0)
    s_barrier
    ds_read_b64_tr_b16 v[132:133], v9 offset:0
    ds_read_b64_tr_b16 v[134:135], v9 offset:1280
    ds_read_b64_tr_b16 v[136:137], v9 offset:5120
    ds_read_b64_tr_b16 v[138:139], v9 offset:6400
    ds_read_b64_tr_b16 v[140:141], v9 offset:10240
    ds_read_b64_tr_b16 v[142:143], v9 offset:11520
    ds_read_b64_tr_b16 v[144:145], v9 offset:15360
    ds_read_b64_tr_b16 v[146:147], v9 offset:16640
    s_mov_b32 s14, 12288
    s_waitcnt lgkmcnt(6)
    buffer_store_dwordx4 v[132:135], v11, s[20:23], s14 offen offset:0
    s_waitcnt lgkmcnt(4)
    buffer_store_dwordx4 v[136:139], v11, s[20:23], s14 offen offset:1024
    s_waitcnt lgkmcnt(2)
    buffer_store_dwordx4 v[140:143], v11, s[20:23], s14 offen offset:2048
    s_waitcnt lgkmcnt(0)
    buffer_store_dwordx4 v[144:147], v11, s[20:23], s14 offen offset:3072
    s_waitcnt lgkmcnt(0)
    s_barrier
    s_waitcnt vmcnt(27)
    ds_write_b128 v4, v[80:83] offset:0
    s_waitcnt vmcnt(26)
    ds_write_b128 v4, v[84:87] offset:5120
    s_waitcnt vmcnt(25)
    ds_write_b128 v4, v[88:91] offset:10240
    s_waitcnt vmcnt(24)
    ds_write_b128 v4, v[92:95] offset:15360
    s_waitcnt lgkmcnt(0)
    s_barrier
    ds_read_b64_tr_b16 v[132:133], v9 offset:0
    ds_read_b64_tr_b16 v[134:135], v9 offset:1280
    ds_read_b64_tr_b16 v[136:137], v9 offset:5120
    ds_read_b64_tr_b16 v[138:139], v9 offset:6400
    ds_read_b64_tr_b16 v[140:141], v9 offset:10240
    ds_read_b64_tr_b16 v[142:143], v9 offset:11520
    ds_read_b64_tr_b16 v[144:145], v9 offset:15360
    ds_read_b64_tr_b16 v[146:147], v9 offset:16640
    s_mov_b32 s14, 16384
    s_waitcnt lgkmcnt(6)
    buffer_store_dwordx4 v[132:135], v11, s[20:23], s14 offen offset:0
    s_waitcnt lgkmcnt(4)
    buffer_store_dwordx4 v[136:139], v11, s[20:23], s14 offen offset:1024
    s_waitcnt lgkmcnt(2)
    buffer_store_dwordx4 v[140:143], v11, s[20:23], s14 offen offset:2048
    s_waitcnt lgkmcnt(0)
    buffer_store_dwordx4 v[144:147], v11, s[20:23], s14 offen offset:3072
    s_waitcnt lgkmcnt(0)
    s_barrier
    s_waitcnt vmcnt(27)
    ds_write_b128 v4, v[96:99] offset:0
    s_waitcnt vmcnt(26)
    ds_write_b128 v4, v[100:103] offset:5120
    s_waitcnt vmcnt(25)
    ds_write_b128 v4, v[104:107] offset:10240
    s_waitcnt vmcnt(24)
    ds_write_b128 v4, v[108:111] offset:15360
    s_waitcnt lgkmcnt(0)
    s_barrier
    ds_read_b64_tr_b16 v[132:133], v9 offset:0
    ds_read_b64_tr_b16 v[134:135], v9 offset:1280
    ds_read_b64_tr_b16 v[136:137], v9 offset:5120
    ds_read_b64_tr_b16 v[138:139], v9 offset:6400
    ds_read_b64_tr_b16 v[140:141], v9 offset:10240
    ds_read_b64_tr_b16 v[142:143], v9 offset:11520
    ds_read_b64_tr_b16 v[144:145], v9 offset:15360
    ds_read_b64_tr_b16 v[146:147], v9 offset:16640
    s_mov_b32 s14, 20480
    s_waitcnt lgkmcnt(6)
    buffer_store_dwordx4 v[132:135], v11, s[20:23], s14 offen offset:0
    s_waitcnt lgkmcnt(4)
    buffer_store_dwordx4 v[136:139], v11, s[20:23], s14 offen offset:1024
    s_waitcnt lgkmcnt(2)
    buffer_store_dwordx4 v[140:143], v11, s[20:23], s14 offen offset:2048
    s_waitcnt lgkmcnt(0)
    buffer_store_dwordx4 v[144:147], v11, s[20:23], s14 offen offset:3072
    s_waitcnt lgkmcnt(0)
    s_barrier
    s_waitcnt vmcnt(27)
    ds_write_b128 v4, v[112:115] offset:0
    s_waitcnt vmcnt(26)
    ds_write_b128 v4, v[116:119] offset:5120
    s_waitcnt vmcnt(25)
    ds_write_b128 v4, v[120:123] offset:10240
    s_waitcnt vmcnt(24)
    ds_write_b128 v4, v[124:127] offset:15360
    s_waitcnt lgkmcnt(0)
    s_barrier
    ds_read_b64_tr_b16 v[132:133], v9 offset:0
    ds_read_b64_tr_b16 v[134:135], v9 offset:1280
    ds_read_b64_tr_b16 v[136:137], v9 offset:5120
    ds_read_b64_tr_b16 v[138:139], v9 offset:6400
    ds_read_b64_tr_b16 v[140:141], v9 offset:10240
    ds_read_b64_tr_b16 v[142:143], v9 offset:11520
    ds_read_b64_tr_b16 v[144:145], v9 offset:15360
    ds_read_b64_tr_b16 v[146:147], v9 offset:16640
    s_mov_b32 s14, 24576
    s_waitcnt lgkmcnt(6)
    buffer_store_dwordx4 v[132:135], v11, s[20:23], s14 offen offset:0
    s_waitcnt lgkmcnt(4)
    buffer_store_dwordx4 v[136:139], v11, s[20:23], s14 offen offset:1024
    s_waitcnt lgkmcnt(2)
    buffer_store_dwordx4 v[140:143], v11, s[20:23], s14 offen offset:2048
    s_waitcnt lgkmcnt(0)
    buffer_store_dwordx4 v[144:147], v11, s[20:23], s14 offen offset:3072
    s_waitcnt lgkmcnt(0)
    s_barrier
L_send_g1_0_kernel:
    s_endpgm
.globl attn_0_kernel
.p2align 8
.type attn_0_kernel,@function
attn_0_kernel:
    s_load_dwordx16 s[24:39], s[0:1], 0
    s_load_dwordx4 s[40:43], s[0:1], 64
    s_cmp_ge_u32 s2, 512
    s_cbranch_scc1 L_end_attn_0_kernel
    s_and_b32 s16, s2, 7
    s_lshl_b32 s16, s16, 1
    s_bfe_u32 s18, s2, 0x10003
    s_add_u32 s16, s16, s18
    s_lshr_b32 s17, s2, 4
    s_mov_b32 s22, 0x3e8b97f6
    s_mov_b32 s23, 0x3e8b97f6
    v_and_b32 v1, 63, v0
    v_lshrrev_b32 v2, 6, v0
    v_lshrrev_b32 v3, 5, v1
    v_lshrrev_b32 v4, 1, v2
    v_and_b32 v5, 31, v1
    v_and_b32 v6, 1, v2
    v_lshl_add_u32 v5, v6, 5, v5
    s_lshl_b32 s18, s17, 6
    v_add_u32 v5, s18, v5
    v_mov_b32 v21, v5
    s_lshl_b32 s18, s16, 11
    v_add_u32 v5, s18, v5
    v_lshlrev_b32 v20, 6, v5
    v_lshl_add_u32 v20, v3, 4, v20
    v_bfe_u32 v5, v0, 2, 5
    v_and_b32 v6, 3, v0
    v_lshrrev_b32 v7, 7, v0
    v_lshl_add_u32 v8, v7, 10, v5
    v_lshlrev_b32 v22, 6, v8
    v_lshl_add_u32 v22, v6, 4, v22
    v_mul_u32_u24 v23, 80, v5
    v_lshl_add_u32 v23, v6, 4, v23
    v_mul_u32_u24 v8, 20480, v7
    v_add_u32 v23, v23, v8
    v_mul_u32_u24 v24, 64, v5
    v_lshl_add_u32 v24, v6, 4, v24
    v_mul_u32_u24 v8, 16384, v7
    v_add_u32 v24, v24, v8
    v_add_u32 v24, 40960, v24
    v_cmp_eq_u32 vcc, 3, v6
    s_nop 1
    v_cndmask_b32 v25, -1, 0, vcc
    v_mov_b32 v7, 0x3f80
    v_cndmask_b32 v26, 0, v7, vcc
    s_lshl_b32 s19, s16, 17
    s_add_u32 s20, s19, 0x400000
    s_add_u32 s19, s19, 0x200000
    v_and_b32 v5, 31, v1
    v_mul_u32_u24 v60, 80, v5
    v_lshl_add_u32 v60, v3, 4, v60
    v_mul_u32_u24 v6, 20480, v4
    v_add_u32 v60, v60, v6
    v_bfe_u32 v5, v1, 2, 2
    v_lshl_add_u32 v5, v3, 2, v5
    v_mul_u32_u24 v61, 64, v5
    v_bfe_u32 v6, v1, 4, 1
    v_lshl_add_u32 v61, v6, 5, v61
    v_and_b32 v6, 3, v1
    v_lshl_add_u32 v61, v6, 3, v61
    v_mul_u32_u24 v6, 16384, v4
    v_add_u32 v61, v61, v6
    v_add_u32 v61, 40960, v61
    v_mov_b32 v160, 0
    v_mov_b32 v161, 0
    v_mov_b32 v162, 0
    v_mov_b32 v163, 0
    v_mov_b32 v164, 0
    v_mov_b32 v165, 0
    v_mov_b32 v166, 0
    v_mov_b32 v167, 0
    v_mov_b32 v168, 0
    v_mov_b32 v169, 0
    v_mov_b32 v170, 0
    v_mov_b32 v171, 0
    v_mov_b32 v172, 0
    v_mov_b32 v173, 0
    v_mov_b32 v174, 0
    v_mov_b32 v175, 0
    v_mov_b32 v240, 0xff800000
    s_waitcnt lgkmcnt(0)
    s_mov_b32 s8, s42
    s_and_b32 s9, s43, 0xffff
    s_mov_b32 s10, 0x600000
    s_mov_b32 s11, 0x00020000
    s_add_u32 s12, s42, 0x600000
    s_addc_u32 s13, s43, 0
    s_and_b32 s13, s13, 0xffff
    s_mov_b32 s14, 0x1c0000
    s_mov_b32 s15, 0x00020000
    buffer_load_dwordx4 v[28:31], v22, s[8:11], s19 offen offset:0
    buffer_load_dwordx4 v[44:47], v22, s[8:11], s20 offen offset:0
    buffer_load_dwordx4 v[32:35], v22, s[8:11], s19 offen offset:2048
    buffer_load_dwordx4 v[48:51], v22, s[8:11], s20 offen offset:2048
    s_add_u32 s19, s19, 4096
    s_add_u32 s20, s20, 4096
    buffer_load_dwordx4 v[36:39], v22, s[8:11], s19 offen offset:0
    buffer_load_dwordx4 v[52:55], v22, s[8:11], s20 offen offset:0
    buffer_load_dwordx4 v[40:43], v22, s[8:11], s19 offen offset:2048
    buffer_load_dwordx4 v[56:59], v22, s[8:11], s20 offen offset:2048
    s_add_u32 s19, s19, 4096
    s_add_u32 s20, s20, 4096
    buffer_load_dwordx4 v[12:15], v20, s[8:11], 0 offen
    buffer_load_dwordx4 v[16:19], v20, s[8:11], 0 offen offset:32
    s_waitcnt vmcnt(9)
    v_and_b32 v30, v25, v30
    v_and_b32 v31, v25, v31
    s_waitcnt vmcnt(8)
    v_and_or_b32 v46, v46, v25, v26
    v_and_b32 v47, v25, v47
    ds_write_b128 v23, v[28:31] offset:0
    ds_write_b128 v24, v[44:47] offset:0
    s_waitcnt vmcnt(7)
    v_and_b32 v34, v25, v34
    v_and_b32 v35, v25, v35
    s_waitcnt vmcnt(6)
    v_and_or_b32 v50, v50, v25, v26
    v_and_b32 v51, v25, v51
    ds_write_b128 v23, v[32:35] offset:2560
    ds_write_b128 v24, v[48:51] offset:2048
    s_waitcnt vmcnt(5)
    v_and_b32 v38, v25, v38
    v_and_b32 v39, v25, v39
    s_waitcnt vmcnt(4)
    v_and_or_b32 v54, v54, v25, v26
    v_and_b32 v55, v25, v55
    ds_write_b128 v23, v[36:39] offset:5120
    ds_write_b128 v24, v[52:55] offset:4096
    s_waitcnt vmcnt(3)
    v_and_b32 v42, v25, v42
    v_and_b32 v43, v25, v43
    s_waitcnt vmcnt(2)
    v_and_or_b32 v58, v58, v25, v26
    v_and_b32 v59, v25, v59
    ds_write_b128 v23, v[40:43] offset:7680
    ds_write_b128 v24, v[56:59] offset:6144
    v_cmp_eq_u32 vcc, 1, v3
    s_nop 1
    v_cndmask_b32 v5, -1, 0, vcc
    s_waitcnt vmcnt(0)
    v_and_b32 v18, v5, v18
    v_and_b32 v19, v5, v19
    s_waitcnt lgkmcnt(0)
    s_barrier
    s_mov_b32 s21, 0
L_loop_attn_0_kernel:
    buffer_load_dwordx4 v[28:31], v22, s[8:11], s19 offen offset:0
    buffer_load_dwordx4 v[44:47], v22, s[8:11], s20 offen offset:0
    buffer_load_dwordx4 v[32:35], v22, s[8:11], s19 offen offset:2048
    buffer_load_dwordx4 v[48:51], v22, s[8:11], s20 offen offset:2048
    s_add_u32 s19, s19, 4096
    s_add_u32 s20, s20, 4096
    buffer_load_dwordx4 v[36:39], v22, s[8:11], s19 offen offset:0
    buffer_load_dwordx4 v[52:55], v22, s[8:11], s20 offen offset:0
    buffer_load_dwordx4 v[40:43], v22, s[8:11], s19 offen offset:2048
    buffer_load_dwordx4 v[56:59], v22, s[8:11], s20 offen offset:2048
    s_add_u32 s19, s19, 4096
    s_add_u32 s20, s20, 4096
    ds_read_b128 v[176:179], v60 offset:0
    ds_read_b128 v[180:183], v60 offset:32
    ds_read_b128 v[184:187], v60 offset:2560
    ds_read_b128 v[188:191], v60 offset:2592
    ds_read_b128 v[192:195], v60 offset:5120
    ds_read_b128 v[196:199], v60 offset:5152
    ds_read_b128 v[200:203], v60 offset:7680
    ds_read_b128 v[204:207], v60 offset:7712
    s_waitcnt lgkmcnt(7)
    v_mfma_f32_32x32x16_bf16 v[64:79], v[176:179], v[12:15], 0
    s_waitcnt lgkmcnt(6)
    v_mfma_f32_32x32x16_bf16 v[64:79], v[180:183], v[16:19], v[64:79]
    s_waitcnt lgkmcnt(5)
    v_mfma_f32_32x32x16_bf16 v[80:95], v[184:187], v[12:15], 0
    s_waitcnt lgkmcnt(4)
    v_mfma_f32_32x32x16_bf16 v[80:95], v[188:191], v[16:19], v[80:95]
    s_waitcnt lgkmcnt(3)
    v_mfma_f32_32x32x16_bf16 v[96:111], v[192:195], v[12:15], 0
    s_waitcnt lgkmcnt(2)
    v_mfma_f32_32x32x16_bf16 v[96:111], v[196:199], v[16:19], v[96:111]
    s_waitcnt lgkmcnt(1)
    v_mfma_f32_32x32x16_bf16 v[112:127], v[200:203], v[12:15], 0
    s_waitcnt lgkmcnt(0)
    v_mfma_f32_32x32x16_bf16 v[112:127], v[204:207], v[16:19], v[112:127]
    ds_read_b64_tr_b16 v[208:209], v61 offset:0
    ds_read_b64_tr_b16 v[210:211], v61 offset:512
    ds_read_b64_tr_b16 v[212:213], v61 offset:1024
    ds_read_b64_tr_b16 v[214:215], v61 offset:1536
    ds_read_b64_tr_b16 v[216:217], v61 offset:2048
    ds_read_b64_tr_b16 v[218:219], v61 offset:2560
    ds_read_b64_tr_b16 v[220:221], v61 offset:3072
    ds_read_b64_tr_b16 v[222:223], v61 offset:3584
    ds_read_b64_tr_b16 v[224:225], v61 offset:4096
    ds_read_b64_tr_b16 v[226:227], v61 offset:4608
    ds_read_b64_tr_b16 v[228:229], v61 offset:5120
    ds_read_b64_tr_b16 v[230:231], v61 offset:5632
    ds_read_b64_tr_b16 v[232:233], v61 offset:6144
    ds_read_b64_tr_b16 v[234:235], v61 offset:6656
    ds_read_b64_tr_b16 v[236:237], v61 offset:7168
    ds_read_b64_tr_b16 v[238:239], v61 offset:7680
    v_max3_f32 v241, v64, v65, v66
    v_max3_f32 v242, v96, v97, v98
    v_max3_f32 v241, v241, v67, v68
    v_max3_f32 v242, v242, v99, v100
    v_max3_f32 v241, v241, v69, v70
    v_max3_f32 v242, v242, v101, v102
    v_max3_f32 v241, v241, v71, v72
    v_max3_f32 v242, v242, v103, v104
    v_max3_f32 v241, v241, v73, v74
    v_max3_f32 v242, v242, v105, v106
    v_max3_f32 v241, v241, v75, v76
    v_max3_f32 v242, v242, v107, v108
    v_max3_f32 v241, v241, v77, v78
    v_max3_f32 v242, v242, v109, v110
    v_max3_f32 v241, v241, v79, v80
    v_max3_f32 v242, v242, v111, v112
    v_max3_f32 v241, v241, v81, v82
    v_max3_f32 v242, v242, v113, v114
    v_max3_f32 v241, v241, v83, v84
    v_max3_f32 v242, v242, v115, v116
    v_max3_f32 v241, v241, v85, v86
    v_max3_f32 v242, v242, v117, v118
    v_max3_f32 v241, v241, v87, v88
    v_max3_f32 v242, v242, v119, v120
    v_max3_f32 v241, v241, v89, v90
    v_max3_f32 v242, v242, v121, v122
    v_max3_f32 v241, v241, v91, v92
    v_max3_f32 v242, v242, v123, v124
    v_max3_f32 v241, v241, v93, v94
    v_max3_f32 v242, v242, v125, v126
    v_max3_f32 v241, v241, v95, v127
    v_max_f32 v241, v241, v242
    v_mov_b32 v5, v241
    s_nop 1
    v_permlane32_swap_b32 v241, v5
    v_max3_f32 v241, v241, v5, v240
    v_sub_f32 v244, v240, v241
    v_mul_f32 v244, s22, v244
    v_exp_f32 v244, v244
    v_mov_b32 v240, v241
    v_mul_f32 v246, s22, v241
    v_sub_f32 v246, 0, v246
    v_mov_b32 v247, v246
    v_mov_b32 v245, v244
    v_pk_fma_f32 v[64:65], v[64:65], s[22:23], v[246:247]
    v_pk_fma_f32 v[66:67], v[66:67], s[22:23], v[246:247]
    v_pk_fma_f32 v[68:69], v[68:69], s[22:23], v[246:247]
    v_pk_fma_f32 v[70:71], v[70:71], s[22:23], v[246:247]
    v_pk_fma_f32 v[72:73], v[72:73], s[22:23], v[246:247]
    v_pk_fma_f32 v[74:75], v[74:75], s[22:23], v[246:247]
    v_pk_fma_f32 v[76:77], v[76:77], s[22:23], v[246:247]
    v_pk_fma_f32 v[78:79], v[78:79], s[22:23], v[246:247]
    v_pk_fma_f32 v[80:81], v[80:81], s[22:23], v[246:247]
    v_pk_fma_f32 v[82:83], v[82:83], s[22:23], v[246:247]
    v_pk_fma_f32 v[84:85], v[84:85], s[22:23], v[246:247]
    v_pk_fma_f32 v[86:87], v[86:87], s[22:23], v[246:247]
    v_pk_fma_f32 v[88:89], v[88:89], s[22:23], v[246:247]
    v_pk_fma_f32 v[90:91], v[90:91], s[22:23], v[246:247]
    v_pk_fma_f32 v[92:93], v[92:93], s[22:23], v[246:247]
    v_pk_fma_f32 v[94:95], v[94:95], s[22:23], v[246:247]
    v_pk_fma_f32 v[96:97], v[96:97], s[22:23], v[246:247]
    v_pk_fma_f32 v[98:99], v[98:99], s[22:23], v[246:247]
    v_pk_fma_f32 v[100:101], v[100:101], s[22:23], v[246:247]
    v_pk_fma_f32 v[102:103], v[102:103], s[22:23], v[246:247]
    v_pk_fma_f32 v[104:105], v[104:105], s[22:23], v[246:247]
    v_pk_fma_f32 v[106:107], v[106:107], s[22:23], v[246:247]
    v_pk_fma_f32 v[108:109], v[108:109], s[22:23], v[246:247]
    v_pk_fma_f32 v[110:111], v[110:111], s[22:23], v[246:247]
    v_pk_fma_f32 v[112:113], v[112:113], s[22:23], v[246:247]
    v_pk_fma_f32 v[114:115], v[114:115], s[22:23], v[246:247]
    v_pk_fma_f32 v[116:117], v[116:117], s[22:23], v[246:247]
    v_pk_fma_f32 v[118:119], v[118:119], s[22:23], v[246:247]
    v_pk_fma_f32 v[120:121], v[120:121], s[22:23], v[246:247]
    v_pk_fma_f32 v[122:123], v[122:123], s[22:23], v[246:247]
    v_pk_fma_f32 v[124:125], v[124:125], s[22:23], v[246:247]
    v_pk_fma_f32 v[126:127], v[126:127], s[22:23], v[246:247]
    v_exp_f32 v64, v64
    v_exp_f32 v65, v65
    v_exp_f32 v66, v66
    v_exp_f32 v67, v67
    v_exp_f32 v68, v68
    v_exp_f32 v69, v69
    v_exp_f32 v70, v70
    v_exp_f32 v71, v71
    v_exp_f32 v72, v72
    v_exp_f32 v73, v73
    v_exp_f32 v74, v74
    v_exp_f32 v75, v75
    v_exp_f32 v76, v76
    v_exp_f32 v77, v77
    v_exp_f32 v78, v78
    v_exp_f32 v79, v79
    v_exp_f32 v80, v80
    v_exp_f32 v81, v81
    v_exp_f32 v82, v82
    v_exp_f32 v83, v83
    v_exp_f32 v84, v84
    v_exp_f32 v85, v85
    v_exp_f32 v86, v86
    v_exp_f32 v87, v87
    v_exp_f32 v88, v88
    v_exp_f32 v89, v89
    v_exp_f32 v90, v90
    v_exp_f32 v91, v91
    v_exp_f32 v92, v92
    v_exp_f32 v93, v93
    v_exp_f32 v94, v94
    v_exp_f32 v95, v95
    v_exp_f32 v96, v96
    v_exp_f32 v97, v97
    v_exp_f32 v98, v98
    v_exp_f32 v99, v99
    v_exp_f32 v100, v100
    v_exp_f32 v101, v101
    v_exp_f32 v102, v102
    v_exp_f32 v103, v103
    v_exp_f32 v104, v104
    v_exp_f32 v105, v105
    v_exp_f32 v106, v106
    v_exp_f32 v107, v107
    v_exp_f32 v108, v108
    v_exp_f32 v109, v109
    v_exp_f32 v110, v110
    v_exp_f32 v111, v111
    v_exp_f32 v112, v112
    v_exp_f32 v113, v113
    v_exp_f32 v114, v114
    v_exp_f32 v115, v115
    v_exp_f32 v116, v116
    v_exp_f32 v117, v117
    v_exp_f32 v118, v118
    v_exp_f32 v119, v119
    v_exp_f32 v120, v120
    v_exp_f32 v121, v121
    v_exp_f32 v122, v122
    v_exp_f32 v123, v123
    v_exp_f32 v124, v124
    v_exp_f32 v125, v125
    v_exp_f32 v126, v126
    v_exp_f32 v127, v127
    v_cvt_pk_bf16_f32 v128, v64, v65
    v_cvt_pk_bf16_f32 v129, v66, v67
    v_cvt_pk_bf16_f32 v130, v68, v69
    v_cvt_pk_bf16_f32 v131, v70, v71
    v_cvt_pk_bf16_f32 v132, v72, v73
    v_cvt_pk_bf16_f32 v133, v74, v75
    v_cvt_pk_bf16_f32 v134, v76, v77
    v_cvt_pk_bf16_f32 v135, v78, v79
    v_cvt_pk_bf16_f32 v136, v80, v81
    v_cvt_pk_bf16_f32 v137, v82, v83
    v_cvt_pk_bf16_f32 v138, v84, v85
    v_cvt_pk_bf16_f32 v139, v86, v87
    v_cvt_pk_bf16_f32 v140, v88, v89
    v_cvt_pk_bf16_f32 v141, v90, v91
    v_cvt_pk_bf16_f32 v142, v92, v93
    v_cvt_pk_bf16_f32 v143, v94, v95
    v_cvt_pk_bf16_f32 v144, v96, v97
    v_cvt_pk_bf16_f32 v145, v98, v99
    v_cvt_pk_bf16_f32 v146, v100, v101
    v_cvt_pk_bf16_f32 v147, v102, v103
    v_cvt_pk_bf16_f32 v148, v104, v105
    v_cvt_pk_bf16_f32 v149, v106, v107
    v_cvt_pk_bf16_f32 v150, v108, v109
    v_cvt_pk_bf16_f32 v151, v110, v111
    v_cvt_pk_bf16_f32 v152, v112, v113
    v_cvt_pk_bf16_f32 v153, v114, v115
    v_cvt_pk_bf16_f32 v154, v116, v117
    v_cvt_pk_bf16_f32 v155, v118, v119
    v_cvt_pk_bf16_f32 v156, v120, v121
    v_cvt_pk_bf16_f32 v157, v122, v123
    v_cvt_pk_bf16_f32 v158, v124, v125
    v_cvt_pk_bf16_f32 v159, v126, v127
    v_pk_mul_f32 v[160:161], v[160:161], v[244:245]
    v_pk_mul_f32 v[162:163], v[162:163], v[244:245]
    v_pk_mul_f32 v[164:165], v[164:165], v[244:245]
    v_pk_mul_f32 v[166:167], v[166:167], v[244:245]
    v_pk_mul_f32 v[168:169], v[168:169], v[244:245]
    v_pk_mul_f32 v[170:171], v[170:171], v[244:245]
    v_pk_mul_f32 v[172:173], v[172:173], v[244:245]
    v_pk_mul_f32 v[174:175], v[174:175], v[244:245]
    s_waitcnt lgkmcnt(14)
    s_nop 0
    v_mfma_f32_32x32x16_bf16 v[160:175], v[208:211], v[128:131], v[160:175]
    s_waitcnt vmcnt(7)
    v_and_b32 v30, v25, v30
    v_and_b32 v31, v25, v31
    s_waitcnt vmcnt(6)
    v_and_or_b32 v46, v46, v25, v26
    v_and_b32 v47, v25, v47
    ds_write_b128 v23, v[28:31] offset:10240
    ds_write_b128 v24, v[44:47] offset:8192
    s_waitcnt lgkmcnt(14)
    v_mfma_f32_32x32x16_bf16 v[160:175], v[212:215], v[132:135], v[160:175]
    s_waitcnt lgkmcnt(12)
    v_mfma_f32_32x32x16_bf16 v[160:175], v[216:219], v[136:139], v[160:175]
    s_waitcnt vmcnt(5)
    v_and_b32 v34, v25, v34
    v_and_b32 v35, v25, v35
    s_waitcnt vmcnt(4)
    v_and_or_b32 v50, v50, v25, v26
    v_and_b32 v51, v25, v51
    ds_write_b128 v23, v[32:35] offset:12800
    ds_write_b128 v24, v[48:51] offset:10240
    s_waitcnt lgkmcnt(12)
    v_mfma_f32_32x32x16_bf16 v[160:175], v[220:223], v[140:143], v[160:175]
    s_waitcnt lgkmcnt(10)
    v_mfma_f32_32x32x16_bf16 v[160:175], v[224:227], v[144:147], v[160:175]
    s_waitcnt vmcnt(3)
    v_and_b32 v38, v25, v38
    v_and_b32 v39, v25, v39
    s_waitcnt vmcnt(2)
    v_and_or_b32 v54, v54, v25, v26
    v_and_b32 v55, v25, v55
    ds_write_b128 v23, v[36:39] offset:15360
    ds_write_b128 v24, v[52:55] offset:12288
    s_waitcnt lgkmcnt(10)
    v_mfma_f32_32x32x16_bf16 v[160:175], v[228:231], v[148:151], v[160:175]
    s_waitcnt lgkmcnt(8)
    v_mfma_f32_32x32x16_bf16 v[160:175], v[232:235], v[152:155], v[160:175]
    s_waitcnt vmcnt(1)
    v_and_b32 v42, v25, v42
    v_and_b32 v43, v25, v43
    s_waitcnt vmcnt(0)
    v_and_or_b32 v58, v58, v25, v26
    v_and_b32 v59, v25, v59
    ds_write_b128 v23, v[40:43] offset:17920
    ds_write_b128 v24, v[56:59] offset:14336
    s_waitcnt lgkmcnt(8)
    v_mfma_f32_32x32x16_bf16 v[160:175], v[236:239], v[156:159], v[160:175]
    s_waitcnt lgkmcnt(0)
    s_barrier
    buffer_load_dwordx4 v[28:31], v22, s[8:11], s19 offen offset:0
    buffer_load_dwordx4 v[44:47], v22, s[8:11], s20 offen offset:0
    buffer_load_dwordx4 v[32:35], v22, s[8:11], s19 offen offset:2048
    buffer_load_dwordx4 v[48:51], v22, s[8:11], s20 offen offset:2048
    s_add_u32 s19, s19, 4096
    s_add_u32 s20, s20, 4096
    buffer_load_dwordx4 v[36:39], v22, s[8:11], s19 offen offset:0
    buffer_load_dwordx4 v[52:55], v22, s[8:11], s20 offen offset:0
    buffer_load_dwordx4 v[40:43], v22, s[8:11], s19 offen offset:2048
    buffer_load_dwordx4 v[56:59], v22, s[8:11], s20 offen offset:2048
    s_add_u32 s19, s19, 4096
    s_add_u32 s20, s20, 4096
    ds_read_b128 v[176:179], v60 offset:10240
    ds_read_b128 v[180:183], v60 offset:10272
    ds_read_b128 v[184:187], v60 offset:12800
    ds_read_b128 v[188:191], v60 offset:12832
    ds_read_b128 v[192:195], v60 offset:15360
    ds_read_b128 v[196:199], v60 offset:15392
    ds_read_b128 v[200:203], v60 offset:17920
    ds_read_b128 v[204:207], v60 offset:17952
    s_waitcnt lgkmcnt(7)
    v_mfma_f32_32x32x16_bf16 v[64:79], v[176:179], v[12:15], 0
    s_waitcnt lgkmcnt(6)
    v_mfma_f32_32x32x16_bf16 v[64:79], v[180:183], v[16:19], v[64:79]
    s_waitcnt lgkmcnt(5)
    v_mfma_f32_32x32x16_bf16 v[80:95], v[184:187], v[12:15], 0
    s_waitcnt lgkmcnt(4)
    v_mfma_f32_32x32x16_bf16 v[80:95], v[188:191], v[16:19], v[80:95]
    s_waitcnt lgkmcnt(3)
    v_mfma_f32_32x32x16_bf16 v[96:111], v[192:195], v[12:15], 0
    s_waitcnt lgkmcnt(2)
    v_mfma_f32_32x32x16_bf16 v[96:111], v[196:199], v[16:19], v[96:111]
    s_waitcnt lgkmcnt(1)
    v_mfma_f32_32x32x16_bf16 v[112:127], v[200:203], v[12:15], 0
    s_waitcnt lgkmcnt(0)
    v_mfma_f32_32x32x16_bf16 v[112:127], v[204:207], v[16:19], v[112:127]
    ds_read_b64_tr_b16 v[208:209], v61 offset:8192
    ds_read_b64_tr_b16 v[210:211], v61 offset:8704
    ds_read_b64_tr_b16 v[212:213], v61 offset:9216
    ds_read_b64_tr_b16 v[214:215], v61 offset:9728
    ds_read_b64_tr_b16 v[216:217], v61 offset:10240
    ds_read_b64_tr_b16 v[218:219], v61 offset:10752
    ds_read_b64_tr_b16 v[220:221], v61 offset:11264
    ds_read_b64_tr_b16 v[222:223], v61 offset:11776
    ds_read_b64_tr_b16 v[224:225], v61 offset:12288
    ds_read_b64_tr_b16 v[226:227], v61 offset:12800
    ds_read_b64_tr_b16 v[228:229], v61 offset:13312
    ds_read_b64_tr_b16 v[230:231], v61 offset:13824
    ds_read_b64_tr_b16 v[232:233], v61 offset:14336
    ds_read_b64_tr_b16 v[234:235], v61 offset:14848
    ds_read_b64_tr_b16 v[236:237], v61 offset:15360
    ds_read_b64_tr_b16 v[238:239], v61 offset:15872
    v_max3_f32 v241, v64, v65, v66
    v_max3_f32 v242, v96, v97, v98
    v_max3_f32 v241, v241, v67, v68
    v_max3_f32 v242, v242, v99, v100
    v_max3_f32 v241, v241, v69, v70
    v_max3_f32 v242, v242, v101, v102
    v_max3_f32 v241, v241, v71, v72
    v_max3_f32 v242, v242, v103, v104
    v_max3_f32 v241, v241, v73, v74
    v_max3_f32 v242, v242, v105, v106
    v_max3_f32 v241, v241, v75, v76
    v_max3_f32 v242, v242, v107, v108
    v_max3_f32 v241, v241, v77, v78
    v_max3_f32 v242, v242, v109, v110
    v_max3_f32 v241, v241, v79, v80
    v_max3_f32 v242, v242, v111, v112
    v_max3_f32 v241, v241, v81, v82
    v_max3_f32 v242, v242, v113, v114
    v_max3_f32 v241, v241, v83, v84
    v_max3_f32 v242, v242, v115, v116
    v_max3_f32 v241, v241, v85, v86
    v_max3_f32 v242, v242, v117, v118
    v_max3_f32 v241, v241, v87, v88
    v_max3_f32 v242, v242, v119, v120
    v_max3_f32 v241, v241, v89, v90
    v_max3_f32 v242, v242, v121, v122
    v_max3_f32 v241, v241, v91, v92
    v_max3_f32 v242, v242, v123, v124
    v_max3_f32 v241, v241, v93, v94
    v_max3_f32 v242, v242, v125, v126
    v_max3_f32 v241, v241, v95, v127
    v_max_f32 v241, v241, v242
    v_mov_b32 v5, v241
    s_nop 1
    v_permlane32_swap_b32 v241, v5
    v_max3_f32 v241, v241, v5, v240
    v_sub_f32 v244, v240, v241
    v_mul_f32 v244, s22, v244
    v_exp_f32 v244, v244
    v_mov_b32 v240, v241
    v_mul_f32 v246, s22, v241
    v_sub_f32 v246, 0, v246
    v_mov_b32 v247, v246
    v_mov_b32 v245, v244
    v_pk_fma_f32 v[64:65], v[64:65], s[22:23], v[246:247]
    v_pk_fma_f32 v[66:67], v[66:67], s[22:23], v[246:247]
    v_pk_fma_f32 v[68:69], v[68:69], s[22:23], v[246:247]
    v_pk_fma_f32 v[70:71], v[70:71], s[22:23], v[246:247]
    v_pk_fma_f32 v[72:73], v[72:73], s[22:23], v[246:247]
    v_pk_fma_f32 v[74:75], v[74:75], s[22:23], v[246:247]
    v_pk_fma_f32 v[76:77], v[76:77], s[22:23], v[246:247]
    v_pk_fma_f32 v[78:79], v[78:79], s[22:23], v[246:247]
    v_pk_fma_f32 v[80:81], v[80:81], s[22:23], v[246:247]
    v_pk_fma_f32 v[82:83], v[82:83], s[22:23], v[246:247]
    v_pk_fma_f32 v[84:85], v[84:85], s[22:23], v[246:247]
    v_pk_fma_f32 v[86:87], v[86:87], s[22:23], v[246:247]
    v_pk_fma_f32 v[88:89], v[88:89], s[22:23], v[246:247]
    v_pk_fma_f32 v[90:91], v[90:91], s[22:23], v[246:247]
    v_pk_fma_f32 v[92:93], v[92:93], s[22:23], v[246:247]
    v_pk_fma_f32 v[94:95], v[94:95], s[22:23], v[246:247]
    v_pk_fma_f32 v[96:97], v[96:97], s[22:23], v[246:247]
    v_pk_fma_f32 v[98:99], v[98:99], s[22:23], v[246:247]
    v_pk_fma_f32 v[100:101], v[100:101], s[22:23], v[246:247]
    v_pk_fma_f32 v[102:103], v[102:103], s[22:23], v[246:247]
    v_pk_fma_f32 v[104:105], v[104:105], s[22:23], v[246:247]
    v_pk_fma_f32 v[106:107], v[106:107], s[22:23], v[246:247]
    v_pk_fma_f32 v[108:109], v[108:109], s[22:23], v[246:247]
    v_pk_fma_f32 v[110:111], v[110:111], s[22:23], v[246:247]
    v_pk_fma_f32 v[112:113], v[112:113], s[22:23], v[246:247]
    v_pk_fma_f32 v[114:115], v[114:115], s[22:23], v[246:247]
    v_pk_fma_f32 v[116:117], v[116:117], s[22:23], v[246:247]
    v_pk_fma_f32 v[118:119], v[118:119], s[22:23], v[246:247]
    v_pk_fma_f32 v[120:121], v[120:121], s[22:23], v[246:247]
    v_pk_fma_f32 v[122:123], v[122:123], s[22:23], v[246:247]
    v_pk_fma_f32 v[124:125], v[124:125], s[22:23], v[246:247]
    v_pk_fma_f32 v[126:127], v[126:127], s[22:23], v[246:247]
    v_exp_f32 v64, v64
    v_exp_f32 v65, v65
    v_exp_f32 v66, v66
    v_exp_f32 v67, v67
    v_exp_f32 v68, v68
    v_exp_f32 v69, v69
    v_exp_f32 v70, v70
    v_exp_f32 v71, v71
    v_exp_f32 v72, v72
    v_exp_f32 v73, v73
    v_exp_f32 v74, v74
    v_exp_f32 v75, v75
    v_exp_f32 v76, v76
    v_exp_f32 v77, v77
    v_exp_f32 v78, v78
    v_exp_f32 v79, v79
    v_exp_f32 v80, v80
    v_exp_f32 v81, v81
    v_exp_f32 v82, v82
    v_exp_f32 v83, v83
    v_exp_f32 v84, v84
    v_exp_f32 v85, v85
    v_exp_f32 v86, v86
    v_exp_f32 v87, v87
    v_exp_f32 v88, v88
    v_exp_f32 v89, v89
    v_exp_f32 v90, v90
    v_exp_f32 v91, v91
    v_exp_f32 v92, v92
    v_exp_f32 v93, v93
    v_exp_f32 v94, v94
    v_exp_f32 v95, v95
    v_exp_f32 v96, v96
    v_exp_f32 v97, v97
    v_exp_f32 v98, v98
    v_exp_f32 v99, v99
    v_exp_f32 v100, v100
    v_exp_f32 v101, v101
    v_exp_f32 v102, v102
    v_exp_f32 v103, v103
    v_exp_f32 v104, v104
    v_exp_f32 v105, v105
    v_exp_f32 v106, v106
    v_exp_f32 v107, v107
    v_exp_f32 v108, v108
    v_exp_f32 v109, v109
    v_exp_f32 v110, v110
    v_exp_f32 v111, v111
    v_exp_f32 v112, v112
    v_exp_f32 v113, v113
    v_exp_f32 v114, v114
    v_exp_f32 v115, v115
    v_exp_f32 v116, v116
    v_exp_f32 v117, v117
    v_exp_f32 v118, v118
    v_exp_f32 v119, v119
    v_exp_f32 v120, v120
    v_exp_f32 v121, v121
    v_exp_f32 v122, v122
    v_exp_f32 v123, v123
    v_exp_f32 v124, v124
    v_exp_f32 v125, v125
    v_exp_f32 v126, v126
    v_exp_f32 v127, v127
    v_cvt_pk_bf16_f32 v128, v64, v65
    v_cvt_pk_bf16_f32 v129, v66, v67
    v_cvt_pk_bf16_f32 v130, v68, v69
    v_cvt_pk_bf16_f32 v131, v70, v71
    v_cvt_pk_bf16_f32 v132, v72, v73
    v_cvt_pk_bf16_f32 v133, v74, v75
    v_cvt_pk_bf16_f32 v134, v76, v77
    v_cvt_pk_bf16_f32 v135, v78, v79
    v_cvt_pk_bf16_f32 v136, v80, v81
    v_cvt_pk_bf16_f32 v137, v82, v83
    v_cvt_pk_bf16_f32 v138, v84, v85
    v_cvt_pk_bf16_f32 v139, v86, v87
    v_cvt_pk_bf16_f32 v140, v88, v89
    v_cvt_pk_bf16_f32 v141, v90, v91
    v_cvt_pk_bf16_f32 v142, v92, v93
    v_cvt_pk_bf16_f32 v143, v94, v95
    v_cvt_pk_bf16_f32 v144, v96, v97
    v_cvt_pk_bf16_f32 v145, v98, v99
    v_cvt_pk_bf16_f32 v146, v100, v101
    v_cvt_pk_bf16_f32 v147, v102, v103
    v_cvt_pk_bf16_f32 v148, v104, v105
    v_cvt_pk_bf16_f32 v149, v106, v107
    v_cvt_pk_bf16_f32 v150, v108, v109
    v_cvt_pk_bf16_f32 v151, v110, v111
    v_cvt_pk_bf16_f32 v152, v112, v113
    v_cvt_pk_bf16_f32 v153, v114, v115
    v_cvt_pk_bf16_f32 v154, v116, v117
    v_cvt_pk_bf16_f32 v155, v118, v119
    v_cvt_pk_bf16_f32 v156, v120, v121
    v_cvt_pk_bf16_f32 v157, v122, v123
    v_cvt_pk_bf16_f32 v158, v124, v125
    v_cvt_pk_bf16_f32 v159, v126, v127
    v_pk_mul_f32 v[160:161], v[160:161], v[244:245]
    v_pk_mul_f32 v[162:163], v[162:163], v[244:245]
    v_pk_mul_f32 v[164:165], v[164:165], v[244:245]
    v_pk_mul_f32 v[166:167], v[166:167], v[244:245]
    v_pk_mul_f32 v[168:169], v[168:169], v[244:245]
    v_pk_mul_f32 v[170:171], v[170:171], v[244:245]
    v_pk_mul_f32 v[172:173], v[172:173], v[244:245]
    v_pk_mul_f32 v[174:175], v[174:175], v[244:245]
    s_waitcnt lgkmcnt(14)
    s_nop 0
    v_mfma_f32_32x32x16_bf16 v[160:175], v[208:211], v[128:131], v[160:175]
    s_waitcnt vmcnt(7)
    v_and_b32 v30, v25, v30
    v_and_b32 v31, v25, v31
    s_waitcnt vmcnt(6)
    v_and_or_b32 v46, v46, v25, v26
    v_and_b32 v47, v25, v47
    ds_write_b128 v23, v[28:31] offset:0
    ds_write_b128 v24, v[44:47] offset:0
    s_waitcnt lgkmcnt(14)
    v_mfma_f32_32x32x16_bf16 v[160:175], v[212:215], v[132:135], v[160:175]
    s_waitcnt lgkmcnt(12)
    v_mfma_f32_32x32x16_bf16 v[160:175], v[216:219], v[136:139], v[160:175]
    s_waitcnt vmcnt(5)
    v_and_b32 v34, v25, v34
    v_and_b32 v35, v25, v35
    s_waitcnt vmcnt(4)
    v_and_or_b32 v50, v50, v25, v26
    v_and_b32 v51, v25, v51
    ds_write_b128 v23, v[32:35] offset:2560
    ds_write_b128 v24, v[48:51] offset:2048
    s_waitcnt lgkmcnt(12)
    v_mfma_f32_32x32x16_bf16 v[160:175], v[220:223], v[140:143], v[160:175]
    s_waitcnt lgkmcnt(10)
    v_mfma_f32_32x32x16_bf16 v[160:175], v[224:227], v[144:147], v[160:175]
    s_waitcnt vmcnt(3)
    v_and_b32 v38, v25, v38
    v_and_b32 v39, v25, v39
    s_waitcnt vmcnt(2)
    v_and_or_b32 v54, v54, v25, v26
    v_and_b32 v55, v25, v55
    ds_write_b128 v23, v[36:39] offset:5120
    ds_write_b128 v24, v[52:55] offset:4096
    s_waitcnt lgkmcnt(10)
    v_mfma_f32_32x32x16_bf16 v[160:175], v[228:231], v[148:151], v[160:175]
    s_waitcnt lgkmcnt(8)
    v_mfma_f32_32x32x16_bf16 v[160:175], v[232:235], v[152:155], v[160:175]
    s_waitcnt vmcnt(1)
    v_and_b32 v42, v25, v42
    v_and_b32 v43, v25, v43
    s_waitcnt vmcnt(0)
    v_and_or_b32 v58, v58, v25, v26
    v_and_b32 v59, v25, v59
    ds_write_b128 v23, v[40:43] offset:7680
    ds_write_b128 v24, v[56:59] offset:6144
    s_waitcnt lgkmcnt(8)
    v_mfma_f32_32x32x16_bf16 v[160:175], v[236:239], v[156:159], v[160:175]
    s_waitcnt lgkmcnt(0)
    s_barrier
    s_add_u32 s21, s21, 1
    s_cmp_lt_u32 s21, 4
    s_nop 7
    s_cbranch_scc1 L_loop_attn_0_kernel
    v_and_b32 v5, 1, v2
    v_mul_u32_u24 v5, 4352, v5
    v_lshl_add_u32 v248, v1, 2, v5
    v_cmp_eq_u32 vcc, 1, v4
    s_nop 0
    s_and_saveexec_b64 s[4:5], vcc
    s_nop 2
    s_cbranch_execz L_skipw_attn_0_kernel
    ds_write_b32 v248, v160 offset:0
    ds_write_b32 v248, v161 offset:256
    ds_write_b32 v248, v162 offset:512
    ds_write_b32 v248, v163 offset:768
    ds_write_b32 v248, v164 offset:1024
    ds_write_b32 v248, v165 offset:1280
    ds_write_b32 v248, v166 offset:1536
    ds_write_b32 v248, v167 offset:1792
    ds_write_b32 v248, v168 offset:2048
    ds_write_b32 v248, v169 offset:2304
    ds_write_b32 v248, v170 offset:2560
    ds_write_b32 v248, v171 offset:2816
    ds_write_b32 v248, v172 offset:3072
    ds_write_b32 v248, v173 offset:3328
    ds_write_b32 v248, v174 offset:3584
    ds_write_b32 v248, v175 offset:3840
    ds_write_b32 v248, v240 offset:4096
L_skipw_attn_0_kernel:
    s_mov_b64 exec, s[4:5]
    s_waitcnt lgkmcnt(0)
    s_barrier
    v_cmp_eq_u32 vcc, 0, v4
    s_nop 0
    s_and_saveexec_b64 s[4:5], vcc
    s_nop 2
    s_cbranch_execz L_end_attn_0_kernel
    ds_read_b32 v64, v248 offset:0
    ds_read_b32 v65, v248 offset:256
    ds_read_b32 v66, v248 offset:512
    ds_read_b32 v67, v248 offset:768
    ds_read_b32 v68, v248 offset:1024
    ds_read_b32 v69, v248 offset:1280
    ds_read_b32 v70, v248 offset:1536
    ds_read_b32 v71, v248 offset:1792
    ds_read_b32 v72, v248 offset:2048
    ds_read_b32 v73, v248 offset:2304
    ds_read_b32 v74, v248 offset:2560
    ds_read_b32 v75, v248 offset:2816
    ds_read_b32 v76, v248 offset:3072
    ds_read_b32 v77, v248 offset:3328
    ds_read_b32 v78, v248 offset:3584
    ds_read_b32 v79, v248 offset:3840
    ds_read_b32 v7, v248 offset:4096
    s_waitcnt lgkmcnt(0)
    v_max_f32 v241, v240, v7
    v_sub_f32 v5, v240, v241
    v_sub_f32 v6, v7, v241
    v_mul_f32 v5, s22, v5
    v_mul_f32 v6, s22, v6
    v_exp_f32 v5, v5
    v_exp_f32 v6, v6
    v_mul_f32 v160, v5, v160
    v_fmac_f32 v160, v6, v64
    v_mul_f32 v161, v5, v161
    v_fmac_f32 v161, v6, v65
    v_mul_f32 v162, v5, v162
    v_fmac_f32 v162, v6, v66
    v_mul_f32 v163, v5, v163
    v_fmac_f32 v163, v6, v67
    v_mul_f32 v164, v5, v164
    v_fmac_f32 v164, v6, v68
    v_mul_f32 v165, v5, v165
    v_fmac_f32 v165, v6, v69
    v_mul_f32 v166, v5, v166
    v_fmac_f32 v166, v6, v70
    v_mul_f32 v167, v5, v167
    v_fmac_f32 v167, v6, v71
    v_mul_f32 v168, v5, v168
    v_fmac_f32 v168, v6, v72
    v_mul_f32 v169, v5, v169
    v_fmac_f32 v169, v6, v73
    v_mul_f32 v170, v5, v170
    v_fmac_f32 v170, v6, v74
    v_mul_f32 v171, v5, v171
    v_fmac_f32 v171, v6, v75
    v_mul_f32 v172, v5, v172
    v_fmac_f32 v172, v6, v76
    v_mul_f32 v173, v5, v173
    v_fmac_f32 v173, v6, v77
    v_mul_f32 v174, v5, v174
    v_fmac_f32 v174, v6, v78
    v_mul_f32 v175, v5, v175
    v_fmac_f32 v175, v6, v79
    v_mov_b32 v5, v172
    v_mov_b32 v6, v172
    s_nop 1
    v_permlane32_swap_b32 v5, v6
    v_rcp_f32 v6, v6
    v_mul_u32_u24 v249, 896, v21
    s_mul_i32 s18, s16, 56
    v_add_u32 v249, s18, v249
    v_lshl_add_u32 v249, v3, 3, v249
    v_mul_f32 v160, v6, v160
    v_mul_f32 v161, v6, v161
    v_mul_f32 v162, v6, v162
    v_mul_f32 v163, v6, v163
    v_mul_f32 v164, v6, v164
    v_mul_f32 v165, v6, v165
    v_mul_f32 v166, v6, v166
    v_mul_f32 v167, v6, v167
    v_mul_f32 v168, v6, v168
    v_mul_f32 v169, v6, v169
    v_mul_f32 v170, v6, v170
    v_mul_f32 v171, v6, v171
    v_mul_f32 v172, v6, v172
    v_mul_f32 v173, v6, v173
    v_mul_f32 v174, v6, v174
    v_mul_f32 v175, v6, v175
    v_cvt_pk_bf16_f32 v128, v160, v161
    v_cvt_pk_bf16_f32 v129, v162, v163
    v_cvt_pk_bf16_f32 v130, v164, v165
    v_cvt_pk_bf16_f32 v131, v166, v167
    v_cvt_pk_bf16_f32 v132, v168, v169
    v_cvt_pk_bf16_f32 v133, v170, v171
    v_cvt_pk_bf16_f32 v134, v172, v173
    v_cvt_pk_bf16_f32 v135, v174, v175
    buffer_store_dwordx2 v[128:129], v249, s[12:15], 0 offen offset:0
    buffer_store_dwordx2 v[130:131], v249, s[12:15], 0 offen offset:16
    buffer_store_dwordx2 v[132:133], v249, s[12:15], 0 offen offset:32
    s_mov_b32 exec_hi, 0
    buffer_store_dwordx2 v[134:135], v249, s[12:15], 0 offen offset:48
L_end_attn_0_kernel:
    s_endpgm
.globl g3_0_kernel
.p2align 8
.type g3_0_kernel,@function
g3_0_kernel:
    s_load_dwordx16 s[32:47], s[0:1], 0
    s_load_dwordx4 s[48:51], s[0:1], 64
    s_cmp_ge_u32 s2, 224
    s_cbranch_scc1 L_end_g3_0_kernel
    s_lshr_b32 s28, s2, 3
    s_and_b32 s29, s2, 7
    s_mul_hi_u32 s24, s28, 0x24924925
    s_mul_i32 s27, s24, 7
    s_sub_u32 s25, s28, s27
    s_and_b32 s27, s29, 7
    s_mul_i32 s27, s27, 4
    s_add_u32 s24, s24, s27
    s_lshr_b32 s27, s29, 3
    s_mul_i32 s27, s27, 7
    s_add_u32 s25, s25, s27
    s_mov_b32 s30, 0
    s_mov_b32 s31, 28672
    v_and_b32 v1, 63, v0
    v_lshrrev_b32 v2, 6, v0
    v_lshrrev_b32 v3, 3, v0
    v_and_b32 v4, 7, v0
    v_lshlrev_b32 v4, 4, v4
    s_mul_i32 s27, s24, 57344
    v_mul_u32_u24 v7, 896, v3
    v_add3_u32 v7, v7, v4, s27
    v_mul_u32_u24 v8, 144, v3
    v_add_u32 v8, v8, v4
    s_mul_i32 s27, s25, 128
    v_lshrrev_b32 v3, 3, v0
    v_and_b32 v4, 7, v0
    v_lshlrev_b32 v4, 4, v4
    v_mul_u32_u24 v9, 896, v3
    v_add3_u32 v9, v9, v4, s27
    v_mul_u32_u24 v10, 192, v3
    v_add_u32 v10, v10, v4
    v_add_u32 v10, 9216, v10
    v_and_b32 v5, 31, v1
    v_mul_u32_u24 v11, 144, v5
    v_lshrrev_b32 v6, 5, v1
    v_lshlrev_b32 v6, 4, v6
    v_add_u32 v11, v11, v6
    v_lshl_add_u32 v11, v2, 5, v11
    v_lshrrev_b32 v3, 5, v1
    v_lshlrev_b32 v3, 3, v3
    v_bfe_u32 v5, v1, 2, 2
    v_add_u32 v3, v3, v5
    v_lshl_add_u32 v3, v2, 4, v3
    v_mul_u32_u24 v12, 192, v3
    v_bfe_u32 v5, v1, 4, 1
    v_lshlrev_b32 v5, 5, v5
    v_and_b32 v6, 3, v1
    v_lshlrev_b32 v6, 3, v6
    v_add3_u32 v12, v12, v5, v6
    v_add_u32 v12, 9216, v12
    v_add_u32 v13, 21504, v11
    v_add_u32 v14, 43008, v11
    v_add_u32 v15, 21504, v12
    v_add_u32 v16, 43008, v12
    v_add_u32 v17, 21504, v8
    v_add_u32 v18, 43008, v8
    v_add_u32 v19, 21504, v10
    v_add_u32 v20, 43008, v10
    s_waitcnt lgkmcnt(0)
    s_add_u32 s8, s50, 0x600000
    s_addc_u32 s9, s51, 0
    s_and_b32 s9, s9, 0xffff
    s_mov_b32 s10, 0x1c0000
    s_mov_b32 s11, 0x00020000
    s_mov_b32 s12, s36
    s_and_b32 s13, s37, 0xffff
    s_mov_b32 s14, 0x62000
    s_mov_b32 s15, 0x00020000
    buffer_load_dwordx4 v[24:27], v7, s[8:11], s30 offen offset:0
    buffer_load_dwordx4 v[28:31], v7, s[8:11], s31 offen offset:0
    buffer_load_dwordx4 v[32:35], v7, s[8:11], s30 offen offset:128
    buffer_load_dwordx4 v[36:39], v7, s[8:11], s31 offen offset:128
    buffer_load_dwordx4 v[40:43], v7, s[8:11], s30 offen offset:256
    buffer_load_dwordx4 v[44:47], v7, s[8:11], s31 offen offset:256
    buffer_load_dwordx4 v[48:51], v7, s[8:11], s30 offen offset:384
    buffer_load_dwordx4 v[52:55], v7, s[8:11], s31 offen offset:384
    s_mov_b32 s26, 0
    buffer_load_dwordx4 v[56:59], v9, s[12:15], s26 offen
    s_mov_b32 s26, 28672
    buffer_load_dwordx4 v[60:63], v9, s[12:15], s26 offen
    s_mov_b32 s26, 57344
    buffer_load_dwordx4 v[64:67], v9, s[12:15], s26 offen
    s_mov_b32 s26, 86016
    buffer_load_dwordx4 v[68:71], v9, s[12:15], s26 offen
    s_mov_b32 s26, 114688
    buffer_load_dwordx4 v[72:75], v9, s[12:15], s26 offen
    s_mov_b32 s26, 143360
    buffer_load_dwordx4 v[76:79], v9, s[12:15], s26 offen
    s_mov_b32 s26, 172032
    buffer_load_dwordx4 v[80:83], v9, s[12:15], s26 offen
    s_mov_b32 s26, 200704
    buffer_load_dwordx4 v[84:87], v9, s[12:15], s26 offen
    s_waitcnt vmcnt(15)
    ds_write_b128 v8, v[24:27] offset:0
    s_waitcnt vmcnt(14)
    ds_write_b128 v8, v[28:31] offset:4608
    s_waitcnt vmcnt(7)
    ds_write_b128 v10, v[56:59] offset:0
    s_waitcnt vmcnt(6)
    ds_write_b128 v10, v[60:63] offset:6144
    buffer_load_dwordx4 v[24:27], v7, s[8:11], s30 offen offset:512
    buffer_load_dwordx4 v[28:31], v7, s[8:11], s31 offen offset:512
    s_mov_b32 s26, 229376
    buffer_load_dwordx4 v[56:59], v9, s[12:15], s26 offen
    s_mov_b32 s26, 258048
    buffer_load_dwordx4 v[60:63], v9, s[12:15], s26 offen
    ds_write_b128 v17, v[32:35] offset:0
    ds_write_b128 v17, v[36:39] offset:4608
    s_waitcnt vmcnt(9)
    ds_write_b128 v19, v[64:67] offset:0
    s_waitcnt vmcnt(8)
    ds_write_b128 v19, v[68:71] offset:6144
    buffer_load_dwordx4 v[32:35], v7, s[8:11], s30 offen offset:640
    buffer_load_dwordx4 v[36:39], v7, s[8:11], s31 offen offset:640
    s_mov_b32 s26, 286720
    buffer_load_dwordx4 v[64:67], v9, s[12:15], s26 offen
    s_mov_b32 s26, 315392
    buffer_load_dwordx4 v[68:71], v9, s[12:15], s26 offen
    s_waitcnt lgkmcnt(0)
    s_barrier
    ds_read_b128 v[88:91], v11 offset:0
    ds_read_b128 v[92:95], v11 offset:4608
    ds_read_b64_tr_b16 v[104:105], v12 offset:0
    ds_read_b64_tr_b16 v[106:107], v12 offset:768
    ds_read_b64_tr_b16 v[108:109], v12 offset:64
    ds_read_b64_tr_b16 v[110:111], v12 offset:832
    s_waitcnt lgkmcnt(2)
    v_mfma_f32_32x32x16_bf16 v[120:135], v[104:107], v[88:91], 0
    ds_read_b128 v[96:99], v13 offset:0
    ds_read_b128 v[100:103], v13 offset:4608
    ds_write_b128 v18, v[40:43] offset:0
    ds_write_b128 v18, v[44:47] offset:4608
    s_waitcnt vmcnt(11)
    ds_write_b128 v20, v[72:75] offset:0
    v_mfma_f32_32x32x16_bf16 v[136:151], v[104:107], v[92:95], 0
    ds_read_b64_tr_b16 v[112:113], v15 offset:0
    ds_read_b64_tr_b16 v[114:115], v15 offset:768
    s_waitcnt vmcnt(10)
    ds_write_b128 v20, v[76:79] offset:6144
    buffer_load_dwordx4 v[40:43], v7, s[8:11], s30 offen offset:768
    s_waitcnt lgkmcnt(8)
    v_mfma_f32_32x32x16_bf16 v[152:167], v[108:111], v[88:91], 0
    ds_read_b64_tr_b16 v[116:117], v15 offset:64
    ds_read_b64_tr_b16 v[118:119], v15 offset:832
    buffer_load_dwordx4 v[44:47], v7, s[8:11], s31 offen offset:768
    s_mov_b32 s26, 344064
    buffer_load_dwordx4 v[72:75], v9, s[12:15], s26 offen
    s_mov_b32 s26, 372736
    buffer_load_dwordx4 v[76:79], v9, s[12:15], s26 offen
    v_mfma_f32_32x32x16_bf16 v[168:183], v[108:111], v[92:95], 0
    s_waitcnt lgkmcnt(2)
    s_barrier
    v_mfma_f32_32x32x16_bf16 v[120:135], v[112:115], v[96:99], v[120:135]
    ds_read_b128 v[88:91], v14 offset:0
    ds_read_b128 v[92:95], v14 offset:4608
    ds_write_b128 v8, v[48:51] offset:0
    ds_write_b128 v8, v[52:55] offset:4608
    v_mfma_f32_32x32x16_bf16 v[136:151], v[112:115], v[100:103], v[136:151]
    ds_read_b64_tr_b16 v[104:105], v16 offset:0
    ds_read_b64_tr_b16 v[106:107], v16 offset:768
    s_waitcnt vmcnt(13)
    ds_write_b128 v10, v[80:83] offset:0
    s_waitcnt lgkmcnt(7)
    v_mfma_f32_32x32x16_bf16 v[152:167], v[116:119], v[96:99], v[152:167]
    ds_read_b64_tr_b16 v[108:109], v16 offset:64
    ds_read_b64_tr_b16 v[110:111], v16 offset:832
    s_waitcnt vmcnt(12)
    ds_write_b128 v10, v[84:87] offset:6144
    v_mfma_f32_32x32x16_bf16 v[168:183], v[116:119], v[100:103], v[168:183]
    s_waitcnt lgkmcnt(0)
    s_barrier
    v_mfma_f32_32x32x16_bf16 v[120:135], v[104:107], v[88:91], v[120:135]
    ds_read_b128 v[96:99], v11 offset:0
    ds_read_b128 v[100:103], v11 offset:4608
    s_waitcnt vmcnt(11)
    ds_write_b128 v17, v[24:27] offset:0
    s_waitcnt vmcnt(10)
    ds_write_b128 v17, v[28:31] offset:4608
    v_mfma_f32_32x32x16_bf16 v[136:151], v[104:107], v[92:95], v[136:151]
    ds_read_b64_tr_b16 v[112:113], v12 offset:0
    ds_read_b64_tr_b16 v[114:115], v12 offset:768
    s_waitcnt vmcnt(9)
    ds_write_b128 v19, v[56:59] offset:0
    v_mfma_f32_32x32x16_bf16 v[152:167], v[108:111], v[88:91], v[152:167]
    ds_read_b64_tr_b16 v[116:117], v12 offset:64
    ds_read_b64_tr_b16 v[118:119], v12 offset:832
    s_waitcnt vmcnt(8)
    ds_write_b128 v19, v[60:63] offset:6144
    v_mfma_f32_32x32x16_bf16 v[168:183], v[108:111], v[92:95], v[168:183]
    s_waitcnt lgkmcnt(0)
    s_barrier
    v_mfma_f32_32x32x16_bf16 v[120:135], v[112:115], v[96:99], v[120:135]
    ds_read_b128 v[88:91], v13 offset:0
    ds_read_b128 v[92:95], v13 offset:4608
    s_waitcnt vmcnt(7)
    ds_write_b128 v18, v[32:35] offset:0
    s_waitcnt vmcnt(6)
    ds_write_b128 v18, v[36:39] offset:4608
    v_mfma_f32_32x32x16_bf16 v[136:151], v[112:115], v[100:103], v[136:151]
    ds_read_b64_tr_b16 v[104:105], v15 offset:0
    ds_read_b64_tr_b16 v[106:107], v15 offset:768
    s_waitcnt vmcnt(5)
    ds_write_b128 v20, v[64:67] offset:0
    v_mfma_f32_32x32x16_bf16 v[152:167], v[116:119], v[96:99], v[152:167]
    ds_read_b64_tr_b16 v[108:109], v15 offset:64
    ds_read_b64_tr_b16 v[110:111], v15 offset:832
    s_waitcnt vmcnt(4)
    ds_write_b128 v20, v[68:71] offset:6144
    v_mfma_f32_32x32x16_bf16 v[168:183], v[116:119], v[100:103], v[168:183]
    s_waitcnt lgkmcnt(0)
    s_barrier
    v_mfma_f32_32x32x16_bf16 v[120:135], v[104:107], v[88:91], v[120:135]
    ds_read_b128 v[96:99], v14 offset:0
    ds_read_b128 v[100:103], v14 offset:4608
    s_waitcnt vmcnt(3)
    ds_write_b128 v8, v[40:43] offset:0
    s_waitcnt vmcnt(2)
    ds_write_b128 v8, v[44:47] offset:4608
    v_mfma_f32_32x32x16_bf16 v[136:151], v[104:107], v[92:95], v[136:151]
    ds_read_b64_tr_b16 v[112:113], v16 offset:0
    ds_read_b64_tr_b16 v[114:115], v16 offset:768
    s_waitcnt vmcnt(1)
    ds_write_b128 v10, v[72:75] offset:0
    v_mfma_f32_32x32x16_bf16 v[152:167], v[108:111], v[88:91], v[152:167]
    ds_read_b64_tr_b16 v[116:117], v16 offset:64
    ds_read_b64_tr_b16 v[118:119], v16 offset:832
    s_waitcnt vmcnt(0)
    ds_write_b128 v10, v[76:79] offset:6144
    v_mfma_f32_32x32x16_bf16 v[168:183], v[108:111], v[92:95], v[168:183]
    s_waitcnt lgkmcnt(0)
    s_barrier
    v_mfma_f32_32x32x16_bf16 v[120:135], v[112:115], v[96:99], v[120:135]
    ds_read_b128 v[88:91], v11 offset:0
    ds_read_b128 v[92:95], v11 offset:4608
    v_mfma_f32_32x32x16_bf16 v[136:151], v[112:115], v[100:103], v[136:151]
    ds_read_b64_tr_b16 v[104:105], v12 offset:0
    ds_read_b64_tr_b16 v[106:107], v12 offset:768
    v_mfma_f32_32x32x16_bf16 v[152:167], v[116:119], v[96:99], v[152:167]
    ds_read_b64_tr_b16 v[108:109], v12 offset:64
    ds_read_b64_tr_b16 v[110:111], v12 offset:832
    v_mfma_f32_32x32x16_bf16 v[168:183], v[116:119], v[100:103], v[168:183]
    s_waitcnt lgkmcnt(2)
    v_mfma_f32_32x32x16_bf16 v[120:135], v[104:107], v[88:91], v[120:135]
    v_mfma_f32_32x32x16_bf16 v[136:151], v[104:107], v[92:95], v[136:151]
    s_waitcnt lgkmcnt(0)
    v_mfma_f32_32x32x16_bf16 v[152:167], v[108:111], v[88:91], v[152:167]
    v_mfma_f32_32x32x16_bf16 v[168:183], v[108:111], v[92:95], v[168:183]
    s_mul_i32 s27, s24, 64
    s_mul_i32 s28, s25, 64
    v_and_b32 v5, 31, v1
    v_lshrrev_b32 v6, 5, v1
    v_lshlrev_b32 v6, 2, v6
    v_and_b32 v3, 1, v2
    v_lshrrev_b32 v4, 1, v2
    v_lshlrev_b32 v3, 5, v3
    v_lshlrev_b32 v4, 5, v4
    v_add3_u32 v24, v3, v5, s27
    v_add3_u32 v25, v4, v6, s28
    s_add_u32 s16, s50, 0x800000
    s_addc_u32 s17, s51, 0
    s_and_b32 s17, s17, 0xffff
    s_mov_b32 s18, 0x1c0000
    s_mov_b32 s19, 0x00020000
    s_mov_b32 s20, s32
    s_and_b32 s21, s33, 0xffff
    s_mov_b32 s22, 0x1c0000
    s_mov_b32 s23, 0x00020000
    v_lshrrev_b32 v3, 5, v1
    v_lshl_add_u32 v3, v3, 2, v25
    v_mul_u32_u24 v26, 896, v24
    v_lshl_add_u32 v26, v3, 1, v26
    buffer_load_dwordx4 v[28:31], v26, s[20:23], 0 offen offset:0
    buffer_load_dwordx4 v[32:35], v26, s[20:23], 0 offen offset:32
    s_waitcnt lgkmcnt(0)
    s_barrier
    v_lshlrev_b32 v3, 4, v1
    v_lshl_add_u32 v36, v2, 14, v3
    v_lshl_add_u32 v37, v2, 12, v3
    ds_write_b128 v36, v[120:123] offset:0
    ds_write_b128 v36, v[124:127] offset:1024
    ds_write_b128 v36, v[128:131] offset:2048
    ds_write_b128 v36, v[132:135] offset:3072
    ds_write_b128 v36, v[136:139] offset:4096
    ds_write_b128 v36, v[140:143] offset:5120
    ds_write_b128 v36, v[144:147] offset:6144
    ds_write_b128 v36, v[148:151] offset:7168
    ds_write_b128 v36, v[152:155] offset:8192
    ds_write_b128 v36, v[156:159] offset:9216
    ds_write_b128 v36, v[160:163] offset:10240
    ds_write_b128 v36, v[164:167] offset:11264
    ds_write_b128 v36, v[168:171] offset:12288
    ds_write_b128 v36, v[172:175] offset:13312
    ds_write_b128 v36, v[176:179] offset:14336
    ds_write_b128 v36, v[180:183] offset:15360
    s_waitcnt lgkmcnt(0)
    s_barrier
    ds_read_b128 v[184:187], v37 offset:0
    ds_read_b128 v[188:191], v37 offset:1024
    ds_read_b128 v[192:195], v37 offset:2048
    ds_read_b128 v[196:199], v37 offset:3072
    ds_read_b128 v[200:203], v37 offset:16384
    ds_read_b128 v[204:207], v37 offset:17408
    ds_read_b128 v[208:211], v37 offset:18432
    ds_read_b128 v[212:215], v37 offset:19456
    ds_read_b128 v[216:219], v37 offset:32768
    ds_read_b128 v[220:223], v37 offset:33792
    ds_read_b128 v[224:227], v37 offset:34816
    ds_read_b128 v[228:231], v37 offset:35840
    ds_read_b128 v[232:235], v37 offset:49152
    ds_read_b128 v[236:239], v37 offset:50176
    ds_read_b128 v[240:243], v37 offset:51200
    ds_read_b128 v[244:247], v37 offset:52224
    s_waitcnt lgkmcnt(11)
    v_pk_add_f32 v[184:185], v[184:185], v[200:201]
    s_waitcnt lgkmcnt(3)
    v_pk_add_f32 v[216:217], v[216:217], v[232:233]
    v_pk_add_f32 v[184:185], v[184:185], v[216:217]
    v_pk_add_f32 v[186:187], v[186:187], v[202:203]
    v_pk_add_f32 v[218:219], v[218:219], v[234:235]
    v_pk_add_f32 v[186:187], v[186:187], v[218:219]
    v_pk_add_f32 v[188:189], v[188:189], v[204:205]
    s_waitcnt lgkmcnt(2)
    v_pk_add_f32 v[220:221], v[220:221], v[236:237]
    v_pk_add_f32 v[188:189], v[188:189], v[220:221]
    v_pk_add_f32 v[190:191], v[190:191], v[206:207]
    v_pk_add_f32 v[222:223], v[222:223], v[238:239]
    v_pk_add_f32 v[190:191], v[190:191], v[222:223]
    v_pk_add_f32 v[192:193], v[192:193], v[208:209]
    s_waitcnt lgkmcnt(1)
    v_pk_add_f32 v[224:225], v[224:225], v[240:241]
    v_pk_add_f32 v[192:193], v[192:193], v[224:225]
    v_pk_add_f32 v[194:195], v[194:195], v[210:211]
    v_pk_add_f32 v[226:227], v[226:227], v[242:243]
    v_pk_add_f32 v[194:195], v[194:195], v[226:227]
    v_pk_add_f32 v[196:197], v[196:197], v[212:213]
    s_waitcnt lgkmcnt(0)
    v_pk_add_f32 v[228:229], v[228:229], v[244:245]
    v_pk_add_f32 v[196:197], v[196:197], v[228:229]
    v_pk_add_f32 v[198:199], v[198:199], v[214:215]
    v_pk_add_f32 v[230:231], v[230:231], v[246:247]
    v_pk_add_f32 v[198:199], v[198:199], v[230:231]
    v_cvt_pk_bf16_f32 v40, v184, v185
    v_cvt_pk_bf16_f32 v41, v186, v187
    v_cvt_pk_bf16_f32 v42, v188, v189
    v_cvt_pk_bf16_f32 v43, v190, v191
    s_nop 0
    v_permlane32_swap_b32 v40, v42
    v_permlane32_swap_b32 v41, v43
    v_lshlrev_b32 v4, 16, v40
    v_and_b32 v3, 0xffff0000, v40
    s_waitcnt vmcnt(1)
    v_lshlrev_b32 v5, 16, v28
    v_and_b32 v6, 0xffff0000, v28
    v_add_f32 v4, v4, v5
    v_add_f32 v3, v3, v6
    v_cvt_pk_bf16_f32 v28, v4, v3
    v_lshlrev_b32 v4, 16, v41
    v_and_b32 v3, 0xffff0000, v41
    v_lshlrev_b32 v5, 16, v29
    v_and_b32 v6, 0xffff0000, v29
    v_add_f32 v4, v4, v5
    v_add_f32 v3, v3, v6
    v_cvt_pk_bf16_f32 v29, v4, v3
    v_lshlrev_b32 v4, 16, v42
    v_and_b32 v3, 0xffff0000, v42
    v_lshlrev_b32 v5, 16, v30
    v_and_b32 v6, 0xffff0000, v30
    v_add_f32 v4, v4, v5
    v_add_f32 v3, v3, v6
    v_cvt_pk_bf16_f32 v30, v4, v3
    v_lshlrev_b32 v4, 16, v43
    v_and_b32 v3, 0xffff0000, v43
    v_lshlrev_b32 v5, 16, v31
    v_and_b32 v6, 0xffff0000, v31
    v_add_f32 v4, v4, v5
    v_add_f32 v3, v3, v6
    v_cvt_pk_bf16_f32 v31, v4, v3
    buffer_store_dwordx4 v[28:31], v26, s[16:19], 0 offen offset:0
    v_cvt_pk_bf16_f32 v40, v192, v193
    v_cvt_pk_bf16_f32 v41, v194, v195
    v_cvt_pk_bf16_f32 v42, v196, v197
    v_cvt_pk_bf16_f32 v43, v198, v199
    s_nop 0
    v_permlane32_swap_b32 v40, v42
    v_permlane32_swap_b32 v41, v43
    v_lshlrev_b32 v4, 16, v40
    v_and_b32 v3, 0xffff0000, v40
    s_waitcnt vmcnt(1)
    v_lshlrev_b32 v5, 16, v32
    v_and_b32 v6, 0xffff0000, v32
    v_add_f32 v4, v4, v5
    v_add_f32 v3, v3, v6
    v_cvt_pk_bf16_f32 v32, v4, v3
    v_lshlrev_b32 v4, 16, v41
    v_and_b32 v3, 0xffff0000, v41
    v_lshlrev_b32 v5, 16, v33
    v_and_b32 v6, 0xffff0000, v33
    v_add_f32 v4, v4, v5
    v_add_f32 v3, v3, v6
    v_cvt_pk_bf16_f32 v33, v4, v3
    v_lshlrev_b32 v4, 16, v42
    v_and_b32 v3, 0xffff0000, v42
    v_lshlrev_b32 v5, 16, v34
    v_and_b32 v6, 0xffff0000, v34
    v_add_f32 v4, v4, v5
    v_add_f32 v3, v3, v6
    v_cvt_pk_bf16_f32 v34, v4, v3
    v_lshlrev_b32 v4, 16, v43
    v_and_b32 v3, 0xffff0000, v43
    v_lshlrev_b32 v5, 16, v35
    v_and_b32 v6, 0xffff0000, v35
    v_add_f32 v4, v4, v5
    v_add_f32 v3, v3, v6
    v_cvt_pk_bf16_f32 v35, v4, v3
    buffer_store_dwordx4 v[32:35], v26, s[16:19], 0 offen offset:32
L_end_g3_0_kernel:
    s_endpgm
.globl g4_0_kernel
.p2align 8
.type g4_0_kernel,@function
g4_0_kernel:
    s_load_dwordx16 s[40:55], s[0:1], 0
    s_load_dwordx4 s[56:59], s[0:1], 64
    s_cmp_ge_u32 s2, 224
    s_cbranch_scc1 L_side_g4_0_kernel
    s_lshr_b32 s32, s2, 3
    s_and_b32 s33, s2, 7
    s_mul_hi_u32 s28, s32, 0x24924925
    s_mul_i32 s31, s28, 7
    s_sub_u32 s29, s32, s31
    s_and_b32 s31, s33, 3
    s_mul_i32 s31, s31, 4
    s_add_u32 s28, s28, s31
    s_lshr_b32 s31, s33, 2
    s_mul_i32 s31, s31, 7
    s_add_u32 s29, s29, s31
    s_mov_b32 s34, 0
    s_mov_b32 s35, 28672
    s_mov_b32 s36, 57344
    s_mov_b32 s37, 86016
    v_and_b32 v1, 63, v0
    v_lshrrev_b32 v2, 6, v0
    v_lshrrev_b32 v3, 3, v0
    v_and_b32 v4, 7, v0
    v_lshlrev_b32 v4, 4, v4
    s_mul_i32 s31, s28, 114688
    v_mul_u32_u24 v7, 896, v3
    v_add3_u32 v7, v7, v4, s31
    v_mul_u32_u24 v8, 144, v3
    v_add_u32 v8, v8, v4
    s_lshl_b32 s31, s29, 2
    v_add_u32 v3, s31, v2
    v_mul_u32_u24 v124, 28672, v3
    v_lshl_add_u32 v124, v1, 4, v124
    v_and_b32 v5, 31, v1
    v_mul_u32_u24 v176, 144, v5
    v_lshrrev_b32 v6, 5, v1
    v_lshlrev_b32 v6, 4, v6
    v_add_u32 v176, v176, v6
    v_add_u32 v177, 18432, v176
    v_add_u32 v178, 36864, v176
    v_add_u32 v179, 18432, v8
    v_add_u32 v180, 36864, v8
    s_waitcnt lgkmcnt(0)
    s_add_u32 s8, s58, 0x800000
    s_addc_u32 s9, s59, 0
    s_and_b32 s9, s9, 0xffff
    s_mov_b32 s10, 0x1c0000
    s_mov_b32 s11, 0x00020000
    s_add_u32 s12, s58, 0x1500000
    s_addc_u32 s13, s59, 0
    s_and_b32 s13, s13, 0xffff
    s_mov_b32 s14, 0x188000
    s_mov_b32 s15, 0x00020000
    s_add_u32 s16, s58, 0x1690000
    s_addc_u32 s17, s59, 0
    s_and_b32 s17, s17, 0xffff
    s_mov_b32 s18, 0x188000
    s_mov_b32 s19, 0x00020000
    buffer_load_dwordx4 v[12:15], v7, s[8:11], s34 offen offset:0
    buffer_load_dwordx4 v[16:19], v7, s[8:11], s35 offen offset:0
    buffer_load_dwordx4 v[20:23], v7, s[8:11], s36 offen offset:0
    buffer_load_dwordx4 v[24:27], v7, s[8:11], s37 offen offset:0
    buffer_load_dwordx4 v[28:31], v7, s[8:11], s34 offen offset:128
    buffer_load_dwordx4 v[32:35], v7, s[8:11], s35 offen offset:128
    buffer_load_dwordx4 v[36:39], v7, s[8:11], s36 offen offset:128
    buffer_load_dwordx4 v[40:43], v7, s[8:11], s37 offen offset:128
    buffer_load_dwordx4 v[44:47], v7, s[8:11], s34 offen offset:256
    buffer_load_dwordx4 v[48:51], v7, s[8:11], s35 offen offset:256
    buffer_load_dwordx4 v[52:55], v7, s[8:11], s36 offen offset:256
    buffer_load_dwordx4 v[56:59], v7, s[8:11], s37 offen offset:256
    buffer_load_dwordx4 v[60:63], v7, s[8:11], s34 offen offset:384
    buffer_load_dwordx4 v[64:67], v7, s[8:11], s35 offen offset:384
    buffer_load_dwordx4 v[68:71], v7, s[8:11], s36 offen offset:384
    buffer_load_dwordx4 v[72:75], v7, s[8:11], s37 offen offset:384
    buffer_load_dwordx4 v[76:79], v7, s[8:11], s34 offen offset:512
    buffer_load_dwordx4 v[80:83], v7, s[8:11], s35 offen offset:512
    buffer_load_dwordx4 v[84:87], v7, s[8:11], s36 offen offset:512
    buffer_load_dwordx4 v[88:91], v7, s[8:11], s37 offen offset:512
    buffer_load_dwordx4 v[92:95], v7, s[8:11], s34 offen offset:640
    buffer_load_dwordx4 v[96:99], v7, s[8:11], s35 offen offset:640
    buffer_load_dwordx4 v[100:103], v7, s[8:11], s36 offen offset:640
    buffer_load_dwordx4 v[104:107], v7, s[8:11], s37 offen offset:640
    buffer_load_dwordx4 v[108:111], v7, s[8:11], s34 offen offset:768
    buffer_load_dwordx4 v[112:115], v7, s[8:11], s35 offen offset:768
    buffer_load_dwordx4 v[116:119], v7, s[8:11], s36 offen offset:768
    buffer_load_dwordx4 v[120:123], v7, s[8:11], s37 offen offset:768
    s_mov_b32 s30, 0
    buffer_load_dwordx4 v[128:131], v124, s[12:15], s30 offen offset:0
    buffer_load_dwordx4 v[132:135], v124, s[16:19], s30 offen offset:0
    buffer_load_dwordx4 v[136:139], v124, s[12:15], s30 offen offset:1024
    buffer_load_dwordx4 v[140:143], v124, s[16:19], s30 offen offset:1024
    buffer_load_dwordx4 v[144:147], v124, s[12:15], s30 offen offset:2048
    buffer_load_dwordx4 v[148:151], v124, s[16:19], s30 offen offset:2048
    buffer_load_dwordx4 v[152:155], v124, s[12:15], s30 offen offset:3072
    buffer_load_dwordx4 v[156:159], v124, s[16:19], s30 offen offset:3072
    s_mov_b32 s30, 4096
    buffer_load_dwordx4 v[160:163], v124, s[12:15], s30 offen offset:0
    buffer_load_dwordx4 v[164:167], v124, s[16:19], s30 offen offset:0
    buffer_load_dwordx4 v[168:171], v124, s[12:15], s30 offen offset:1024
    buffer_load_dwordx4 v[172:175], v124, s[16:19], s30 offen offset:1024
    v_mov_b32 v224, 0x3f803f80
    v_mov_b32 v216, 0
    v_mov_b32 v220, 0
    v_mov_b32 v217, 0
    v_mov_b32 v221, 0
    v_mov_b32 v218, 0
    v_mov_b32 v222, 0
    v_mov_b32 v219, 0
    v_mov_b32 v223, 0
    s_waitcnt vmcnt(39)
    v_dot2_f32_bf16 v216, v12, v224, v216
    v_dot2_f32_bf16 v220, v12, v12, v220
    v_dot2_f32_bf16 v216, v13, v224, v216
    v_dot2_f32_bf16 v220, v13, v13, v220
    v_dot2_f32_bf16 v216, v14, v224, v216
    v_dot2_f32_bf16 v220, v14, v14, v220
    v_dot2_f32_bf16 v216, v15, v224, v216
    v_dot2_f32_bf16 v220, v15, v15, v220
    s_waitcnt vmcnt(38)
    v_dot2_f32_bf16 v217, v16, v224, v217
    v_dot2_f32_bf16 v221, v16, v16, v221
    v_dot2_f32_bf16 v217, v17, v224, v217
    v_dot2_f32_bf16 v221, v17, v17, v221
    v_dot2_f32_bf16 v217, v18, v224, v217
    v_dot2_f32_bf16 v221, v18, v18, v221
    v_dot2_f32_bf16 v217, v19, v224, v217
    v_dot2_f32_bf16 v221, v19, v19, v221
    s_waitcnt vmcnt(37)
    v_dot2_f32_bf16 v218, v20, v224, v218
    v_dot2_f32_bf16 v222, v20, v20, v222
    v_dot2_f32_bf16 v218, v21, v224, v218
    v_dot2_f32_bf16 v222, v21, v21, v222
    v_dot2_f32_bf16 v218, v22, v224, v218
    v_dot2_f32_bf16 v222, v22, v22, v222
    v_dot2_f32_bf16 v218, v23, v224, v218
    v_dot2_f32_bf16 v222, v23, v23, v222
    s_waitcnt vmcnt(36)
    v_dot2_f32_bf16 v219, v24, v224, v219
    v_dot2_f32_bf16 v223, v24, v24, v223
    v_dot2_f32_bf16 v219, v25, v224, v219
    v_dot2_f32_bf16 v223, v25, v25, v223
    v_dot2_f32_bf16 v219, v26, v224, v219
    v_dot2_f32_bf16 v223, v26, v26, v223
    v_dot2_f32_bf16 v219, v27, v224, v219
    v_dot2_f32_bf16 v223, v27, v27, v223
    s_waitcnt vmcnt(35)
    v_dot2_f32_bf16 v216, v28, v224, v216
    v_dot2_f32_bf16 v220, v28, v28, v220
    v_dot2_f32_bf16 v216, v29, v224, v216
    v_dot2_f32_bf16 v220, v29, v29, v220
    v_dot2_f32_bf16 v216, v30, v224, v216
    v_dot2_f32_bf16 v220, v30, v30, v220
    v_dot2_f32_bf16 v216, v31, v224, v216
    v_dot2_f32_bf16 v220, v31, v31, v220
    s_waitcnt vmcnt(34)
    v_dot2_f32_bf16 v217, v32, v224, v217
    v_dot2_f32_bf16 v221, v32, v32, v221
    v_dot2_f32_bf16 v217, v33, v224, v217
    v_dot2_f32_bf16 v221, v33, v33, v221
    v_dot2_f32_bf16 v217, v34, v224, v217
    v_dot2_f32_bf16 v221, v34, v34, v221
    v_dot2_f32_bf16 v217, v35, v224, v217
    v_dot2_f32_bf16 v221, v35, v35, v221
    s_waitcnt vmcnt(33)
    v_dot2_f32_bf16 v218, v36, v224, v218
    v_dot2_f32_bf16 v222, v36, v36, v222
    v_dot2_f32_bf16 v218, v37, v224, v218
    v_dot2_f32_bf16 v222, v37, v37, v222
    v_dot2_f32_bf16 v218, v38, v224, v218
    v_dot2_f32_bf16 v222, v38, v38, v222
    v_dot2_f32_bf16 v218, v39, v224, v218
    v_dot2_f32_bf16 v222, v39, v39, v222
    s_waitcnt vmcnt(32)
    v_dot2_f32_bf16 v219, v40, v224, v219
    v_dot2_f32_bf16 v223, v40, v40, v223
    v_dot2_f32_bf16 v219, v41, v224, v219
    v_dot2_f32_bf16 v223, v41, v41, v223
    v_dot2_f32_bf16 v219, v42, v224, v219
    v_dot2_f32_bf16 v223, v42, v42, v223
    v_dot2_f32_bf16 v219, v43, v224, v219
    v_dot2_f32_bf16 v223, v43, v43, v223
    s_waitcnt vmcnt(31)
    v_dot2_f32_bf16 v216, v44, v224, v216
    v_dot2_f32_bf16 v220, v44, v44, v220
    v_dot2_f32_bf16 v216, v45, v224, v216
    v_dot2_f32_bf16 v220, v45, v45, v220
    v_dot2_f32_bf16 v216, v46, v224, v216
    v_dot2_f32_bf16 v220, v46, v46, v220
    v_dot2_f32_bf16 v216, v47, v224, v216
    v_dot2_f32_bf16 v220, v47, v47, v220
    s_waitcnt vmcnt(30)
    v_dot2_f32_bf16 v217, v48, v224, v217
    v_dot2_f32_bf16 v221, v48, v48, v221
    v_dot2_f32_bf16 v217, v49, v224, v217
    v_dot2_f32_bf16 v221, v49, v49, v221
    v_dot2_f32_bf16 v217, v50, v224, v217
    v_dot2_f32_bf16 v221, v50, v50, v221
    v_dot2_f32_bf16 v217, v51, v224, v217
    v_dot2_f32_bf16 v221, v51, v51, v221
    s_waitcnt vmcnt(29)
    v_dot2_f32_bf16 v218, v52, v224, v218
    v_dot2_f32_bf16 v222, v52, v52, v222
    v_dot2_f32_bf16 v218, v53, v224, v218
    v_dot2_f32_bf16 v222, v53, v53, v222
    v_dot2_f32_bf16 v218, v54, v224, v218
    v_dot2_f32_bf16 v222, v54, v54, v222
    v_dot2_f32_bf16 v218, v55, v224, v218
    v_dot2_f32_bf16 v222, v55, v55, v222
    s_waitcnt vmcnt(28)
    v_dot2_f32_bf16 v219, v56, v224, v219
    v_dot2_f32_bf16 v223, v56, v56, v223
    v_dot2_f32_bf16 v219, v57, v224, v219
    v_dot2_f32_bf16 v223, v57, v57, v223
    v_dot2_f32_bf16 v219, v58, v224, v219
    v_dot2_f32_bf16 v223, v58, v58, v223
    v_dot2_f32_bf16 v219, v59, v224, v219
    v_dot2_f32_bf16 v223, v59, v59, v223
    s_waitcnt vmcnt(27)
    v_dot2_f32_bf16 v216, v60, v224, v216
    v_dot2_f32_bf16 v220, v60, v60, v220
    v_dot2_f32_bf16 v216, v61, v224, v216
    v_dot2_f32_bf16 v220, v61, v61, v220
    v_dot2_f32_bf16 v216, v62, v224, v216
    v_dot2_f32_bf16 v220, v62, v62, v220
    v_dot2_f32_bf16 v216, v63, v224, v216
    v_dot2_f32_bf16 v220, v63, v63, v220
    s_waitcnt vmcnt(26)
    v_dot2_f32_bf16 v217, v64, v224, v217
    v_dot2_f32_bf16 v221, v64, v64, v221
    v_dot2_f32_bf16 v217, v65, v224, v217
    v_dot2_f32_bf16 v221, v65, v65, v221
    v_dot2_f32_bf16 v217, v66, v224, v217
    v_dot2_f32_bf16 v221, v66, v66, v221
    v_dot2_f32_bf16 v217, v67, v224, v217
    v_dot2_f32_bf16 v221, v67, v67, v221
    s_waitcnt vmcnt(25)
    v_dot2_f32_bf16 v218, v68, v224, v218
    v_dot2_f32_bf16 v222, v68, v68, v222
    v_dot2_f32_bf16 v218, v69, v224, v218
    v_dot2_f32_bf16 v222, v69, v69, v222
    v_dot2_f32_bf16 v218, v70, v224, v218
    v_dot2_f32_bf16 v222, v70, v70, v222
    v_dot2_f32_bf16 v218, v71, v224, v218
    v_dot2_f32_bf16 v222, v71, v71, v222
    s_waitcnt vmcnt(24)
    v_dot2_f32_bf16 v219, v72, v224, v219
    v_dot2_f32_bf16 v223, v72, v72, v223
    v_dot2_f32_bf16 v219, v73, v224, v219
    v_dot2_f32_bf16 v223, v73, v73, v223
    v_dot2_f32_bf16 v219, v74, v224, v219
    v_dot2_f32_bf16 v223, v74, v74, v223
    v_dot2_f32_bf16 v219, v75, v224, v219
    v_dot2_f32_bf16 v223, v75, v75, v223
    s_waitcnt vmcnt(23)
    v_dot2_f32_bf16 v216, v76, v224, v216
    v_dot2_f32_bf16 v220, v76, v76, v220
    v_dot2_f32_bf16 v216, v77, v224, v216
    v_dot2_f32_bf16 v220, v77, v77, v220
    v_dot2_f32_bf16 v216, v78, v224, v216
    v_dot2_f32_bf16 v220, v78, v78, v220
    v_dot2_f32_bf16 v216, v79, v224, v216
    v_dot2_f32_bf16 v220, v79, v79, v220
    s_waitcnt vmcnt(22)
    v_dot2_f32_bf16 v217, v80, v224, v217
    v_dot2_f32_bf16 v221, v80, v80, v221
    v_dot2_f32_bf16 v217, v81, v224, v217
    v_dot2_f32_bf16 v221, v81, v81, v221
    v_dot2_f32_bf16 v217, v82, v224, v217
    v_dot2_f32_bf16 v221, v82, v82, v221
    v_dot2_f32_bf16 v217, v83, v224, v217
    v_dot2_f32_bf16 v221, v83, v83, v221
    s_waitcnt vmcnt(21)
    v_dot2_f32_bf16 v218, v84, v224, v218
    v_dot2_f32_bf16 v222, v84, v84, v222
    v_dot2_f32_bf16 v218, v85, v224, v218
    v_dot2_f32_bf16 v222, v85, v85, v222
    v_dot2_f32_bf16 v218, v86, v224, v218
    v_dot2_f32_bf16 v222, v86, v86, v222
    v_dot2_f32_bf16 v218, v87, v224, v218
    v_dot2_f32_bf16 v222, v87, v87, v222
    s_waitcnt vmcnt(20)
    v_dot2_f32_bf16 v219, v88, v224, v219
    v_dot2_f32_bf16 v223, v88, v88, v223
    v_dot2_f32_bf16 v219, v89, v224, v219
    v_dot2_f32_bf16 v223, v89, v89, v223
    v_dot2_f32_bf16 v219, v90, v224, v219
    v_dot2_f32_bf16 v223, v90, v90, v223
    v_dot2_f32_bf16 v219, v91, v224, v219
    v_dot2_f32_bf16 v223, v91, v91, v223
    s_waitcnt vmcnt(19)
    v_dot2_f32_bf16 v216, v92, v224, v216
    v_dot2_f32_bf16 v220, v92, v92, v220
    v_dot2_f32_bf16 v216, v93, v224, v216
    v_dot2_f32_bf16 v220, v93, v93, v220
    v_dot2_f32_bf16 v216, v94, v224, v216
    v_dot2_f32_bf16 v220, v94, v94, v220
    v_dot2_f32_bf16 v216, v95, v224, v216
    v_dot2_f32_bf16 v220, v95, v95, v220
    s_waitcnt vmcnt(18)
    v_dot2_f32_bf16 v217, v96, v224, v217
    v_dot2_f32_bf16 v221, v96, v96, v221
    v_dot2_f32_bf16 v217, v97, v224, v217
    v_dot2_f32_bf16 v221, v97, v97, v221
    v_dot2_f32_bf16 v217, v98, v224, v217
    v_dot2_f32_bf16 v221, v98, v98, v221
    v_dot2_f32_bf16 v217, v99, v224, v217
    v_dot2_f32_bf16 v221, v99, v99, v221
    s_waitcnt vmcnt(17)
    v_dot2_f32_bf16 v218, v100, v224, v218
    v_dot2_f32_bf16 v222, v100, v100, v222
    v_dot2_f32_bf16 v218, v101, v224, v218
    v_dot2_f32_bf16 v222, v101, v101, v222
    v_dot2_f32_bf16 v218, v102, v224, v218
    v_dot2_f32_bf16 v222, v102, v102, v222
    v_dot2_f32_bf16 v218, v103, v224, v218
    v_dot2_f32_bf16 v222, v103, v103, v222
    s_waitcnt vmcnt(16)
    v_dot2_f32_bf16 v219, v104, v224, v219
    v_dot2_f32_bf16 v223, v104, v104, v223
    v_dot2_f32_bf16 v219, v105, v224, v219
    v_dot2_f32_bf16 v223, v105, v105, v223
    v_dot2_f32_bf16 v219, v106, v224, v219
    v_dot2_f32_bf16 v223, v106, v106, v223
    v_dot2_f32_bf16 v219, v107, v224, v219
    v_dot2_f32_bf16 v223, v107, v107, v223
    s_waitcnt vmcnt(15)
    v_dot2_f32_bf16 v216, v108, v224, v216
    v_dot2_f32_bf16 v220, v108, v108, v220
    v_dot2_f32_bf16 v216, v109, v224, v216
    v_dot2_f32_bf16 v220, v109, v109, v220
    v_dot2_f32_bf16 v216, v110, v224, v216
    v_dot2_f32_bf16 v220, v110, v110, v220
    v_dot2_f32_bf16 v216, v111, v224, v216
    v_dot2_f32_bf16 v220, v111, v111, v220
    s_waitcnt vmcnt(14)
    v_dot2_f32_bf16 v217, v112, v224, v217
    v_dot2_f32_bf16 v221, v112, v112, v221
    v_dot2_f32_bf16 v217, v113, v224, v217
    v_dot2_f32_bf16 v221, v113, v113, v221
    v_dot2_f32_bf16 v217, v114, v224, v217
    v_dot2_f32_bf16 v221, v114, v114, v221
    v_dot2_f32_bf16 v217, v115, v224, v217
    v_dot2_f32_bf16 v221, v115, v115, v221
    s_waitcnt vmcnt(13)
    v_dot2_f32_bf16 v218, v116, v224, v218
    v_dot2_f32_bf16 v222, v116, v116, v222
    v_dot2_f32_bf16 v218, v117, v224, v218
    v_dot2_f32_bf16 v222, v117, v117, v222
    v_dot2_f32_bf16 v218, v118, v224, v218
    v_dot2_f32_bf16 v222, v118, v118, v222
    v_dot2_f32_bf16 v218, v119, v224, v218
    v_dot2_f32_bf16 v222, v119, v119, v222
    s_waitcnt vmcnt(12)
    v_dot2_f32_bf16 v219, v120, v224, v219
    v_dot2_f32_bf16 v223, v120, v120, v223
    v_dot2_f32_bf16 v219, v121, v224, v219
    v_dot2_f32_bf16 v223, v121, v121, v223
    v_dot2_f32_bf16 v219, v122, v224, v219
    v_dot2_f32_bf16 v223, v122, v122, v223
    v_dot2_f32_bf16 v219, v123, v224, v219
    v_dot2_f32_bf16 v223, v123, v123, v223
    v_add_f32_dpp v3, v216, v216 quad_perm:[1,0,3,2] row_mask:0xf bank_mask:0xf
    v_add_f32_dpp v4, v220, v220 quad_perm:[1,0,3,2] row_mask:0xf bank_mask:0xf
    v_mov_b32 v216, v3
    v_mov_b32 v220, v4
    s_nop 0
    v_add_f32_dpp v3, v216, v216 quad_perm:[2,3,0,1] row_mask:0xf bank_mask:0xf
    v_add_f32_dpp v4, v220, v220 quad_perm:[2,3,0,1] row_mask:0xf bank_mask:0xf
    v_mov_b32 v216, v3
    v_mov_b32 v220, v4
    s_nop 0
    v_add_f32_dpp v3, v216, v216 row_half_mirror row_mask:0xf bank_mask:0xf
    v_add_f32_dpp v4, v220, v220 row_half_mirror row_mask:0xf bank_mask:0xf
    v_mov_b32 v216, v3
    v_mov_b32 v220, v4
    v_mul_f32 v216, 0x3b124925, v216
    v_mul_f32 v220, 0x3b124925, v220
    v_fma_f32 v220, -v216, v216, v220
    v_max_f32 v220, 0, v220
    v_cvt_pk_bf16_f32 v3, v216, v220
    v_lshlrev_b32 v216, 16, v3
    v_and_b32 v220, 0xffff0000, v3
    v_add_f32 v220, 0x3727c5ac, v220
    v_cvt_pk_bf16_f32 v3, v220, v220
    v_lshlrev_b32 v220, 16, v3
    v_sqrt_f32 v220, v220
    s_nop 0
    v_cvt_pk_bf16_f32 v3, v220, v220
    v_lshlrev_b32 v220, 16, v3
    v_rcp_f32 v225, v220
    s_nop 0
    v_mul_f32 v229, v216, v225
    v_sub_f32 v229, 0, v229
    v_add_f32_dpp v3, v217, v217 quad_perm:[1,0,3,2] row_mask:0xf bank_mask:0xf
    v_add_f32_dpp v4, v221, v221 quad_perm:[1,0,3,2] row_mask:0xf bank_mask:0xf
    v_mov_b32 v217, v3
    v_mov_b32 v221, v4
    s_nop 0
    v_add_f32_dpp v3, v217, v217 quad_perm:[2,3,0,1] row_mask:0xf bank_mask:0xf
    v_add_f32_dpp v4, v221, v221 quad_perm:[2,3,0,1] row_mask:0xf bank_mask:0xf
    v_mov_b32 v217, v3
    v_mov_b32 v221, v4
    s_nop 0
    v_add_f32_dpp v3, v217, v217 row_half_mirror row_mask:0xf bank_mask:0xf
    v_add_f32_dpp v4, v221, v221 row_half_mirror row_mask:0xf bank_mask:0xf
    v_mov_b32 v217, v3
    v_mov_b32 v221, v4
    v_mul_f32 v217, 0x3b124925, v217
    v_mul_f32 v221, 0x3b124925, v221
    v_fma_f32 v221, -v217, v217, v221
    v_max_f32 v221, 0, v221
    v_cvt_pk_bf16_f32 v3, v217, v221
    v_lshlrev_b32 v217, 16, v3
    v_and_b32 v221, 0xffff0000, v3
    v_add_f32 v221, 0x3727c5ac, v221
    v_cvt_pk_bf16_f32 v3, v221, v221
    v_lshlrev_b32 v221, 16, v3
    v_sqrt_f32 v221, v221
    s_nop 0
    v_cvt_pk_bf16_f32 v3, v221, v221
    v_lshlrev_b32 v221, 16, v3
    v_rcp_f32 v226, v221
    s_nop 0
    v_mul_f32 v230, v217, v226
    v_sub_f32 v230, 0, v230
    v_add_f32_dpp v3, v218, v218 quad_perm:[1,0,3,2] row_mask:0xf bank_mask:0xf
    v_add_f32_dpp v4, v222, v222 quad_perm:[1,0,3,2] row_mask:0xf bank_mask:0xf
    v_mov_b32 v218, v3
    v_mov_b32 v222, v4
    s_nop 0
    v_add_f32_dpp v3, v218, v218 quad_perm:[2,3,0,1] row_mask:0xf bank_mask:0xf
    v_add_f32_dpp v4, v222, v222 quad_perm:[2,3,0,1] row_mask:0xf bank_mask:0xf
    v_mov_b32 v218, v3
    v_mov_b32 v222, v4
    s_nop 0
    v_add_f32_dpp v3, v218, v218 row_half_mirror row_mask:0xf bank_mask:0xf
    v_add_f32_dpp v4, v222, v222 row_half_mirror row_mask:0xf bank_mask:0xf
    v_mov_b32 v218, v3
    v_mov_b32 v222, v4
    v_mul_f32 v218, 0x3b124925, v218
    v_mul_f32 v222, 0x3b124925, v222
    v_fma_f32 v222, -v218, v218, v222
    v_max_f32 v222, 0, v222
    v_cvt_pk_bf16_f32 v3, v218, v222
    v_lshlrev_b32 v218, 16, v3
    v_and_b32 v222, 0xffff0000, v3
    v_add_f32 v222, 0x3727c5ac, v222
    v_cvt_pk_bf16_f32 v3, v222, v222
    v_lshlrev_b32 v222, 16, v3
    v_sqrt_f32 v222, v222
    s_nop 0
    v_cvt_pk_bf16_f32 v3, v222, v222
    v_lshlrev_b32 v222, 16, v3
    v_rcp_f32 v227, v222
    s_nop 0
    v_mul_f32 v231, v218, v227
    v_sub_f32 v231, 0, v231
    v_add_f32_dpp v3, v219, v219 quad_perm:[1,0,3,2] row_mask:0xf bank_mask:0xf
    v_add_f32_dpp v4, v223, v223 quad_perm:[1,0,3,2] row_mask:0xf bank_mask:0xf
    v_mov_b32 v219, v3
    v_mov_b32 v223, v4
    s_nop 0
    v_add_f32_dpp v3, v219, v219 quad_perm:[2,3,0,1] row_mask:0xf bank_mask:0xf
    v_add_f32_dpp v4, v223, v223 quad_perm:[2,3,0,1] row_mask:0xf bank_mask:0xf
    v_mov_b32 v219, v3
    v_mov_b32 v223, v4
    s_nop 0
    v_add_f32_dpp v3, v219, v219 row_half_mirror row_mask:0xf bank_mask:0xf
    v_add_f32_dpp v4, v223, v223 row_half_mirror row_mask:0xf bank_mask:0xf
    v_mov_b32 v219, v3
    v_mov_b32 v223, v4
    v_mul_f32 v219, 0x3b124925, v219
    v_mul_f32 v223, 0x3b124925, v223
    v_fma_f32 v223, -v219, v219, v223
    v_max_f32 v223, 0, v223
    v_cvt_pk_bf16_f32 v3, v219, v223
    v_lshlrev_b32 v219, 16, v3
    v_and_b32 v223, 0xffff0000, v3
    v_add_f32 v223, 0x3727c5ac, v223
    v_cvt_pk_bf16_f32 v3, v223, v223
    v_lshlrev_b32 v223, 16, v3
    v_sqrt_f32 v223, v223
    s_nop 0
    v_cvt_pk_bf16_f32 v3, v223, v223
    v_lshlrev_b32 v223, 16, v3
    v_rcp_f32 v228, v223
    s_nop 0
    v_mul_f32 v232, v219, v228
    v_sub_f32 v232, 0, v232
    v_lshlrev_b32 v234, 16, v12
    v_and_b32 v235, 0xffff0000, v12
    v_fma_f32 v234, v234, v225, v229
    v_fma_f32 v235, v235, v225, v229
    v_cvt_pk_bf16_f32 v12, v234, v235
    v_lshlrev_b32 v234, 16, v13
    v_and_b32 v235, 0xffff0000, v13
    v_fma_f32 v234, v234, v225, v229
    v_fma_f32 v235, v235, v225, v229
    v_cvt_pk_bf16_f32 v13, v234, v235
    v_lshlrev_b32 v234, 16, v14
    v_and_b32 v235, 0xffff0000, v14
    v_fma_f32 v234, v234, v225, v229
    v_fma_f32 v235, v235, v225, v229
    v_cvt_pk_bf16_f32 v14, v234, v235
    v_lshlrev_b32 v234, 16, v15
    v_and_b32 v235, 0xffff0000, v15
    v_fma_f32 v234, v234, v225, v229
    v_fma_f32 v235, v235, v225, v229
    v_cvt_pk_bf16_f32 v15, v234, v235
    ds_write_b128 v8, v[12:15] offset:0
    v_lshlrev_b32 v234, 16, v16
    v_and_b32 v235, 0xffff0000, v16
    v_fma_f32 v234, v234, v226, v230
    v_fma_f32 v235, v235, v226, v230
    v_cvt_pk_bf16_f32 v16, v234, v235
    v_lshlrev_b32 v234, 16, v17
    v_and_b32 v235, 0xffff0000, v17
    v_fma_f32 v234, v234, v226, v230
    v_fma_f32 v235, v235, v226, v230
    v_cvt_pk_bf16_f32 v17, v234, v235
    v_lshlrev_b32 v234, 16, v18
    v_and_b32 v235, 0xffff0000, v18
    v_fma_f32 v234, v234, v226, v230
    v_fma_f32 v235, v235, v226, v230
    v_cvt_pk_bf16_f32 v18, v234, v235
    v_lshlrev_b32 v234, 16, v19
    v_and_b32 v235, 0xffff0000, v19
    v_fma_f32 v234, v234, v226, v230
    v_fma_f32 v235, v235, v226, v230
    v_cvt_pk_bf16_f32 v19, v234, v235
    ds_write_b128 v8, v[16:19] offset:4608
    v_lshlrev_b32 v234, 16, v20
    v_and_b32 v235, 0xffff0000, v20
    v_fma_f32 v234, v234, v227, v231
    v_fma_f32 v235, v235, v227, v231
    v_cvt_pk_bf16_f32 v20, v234, v235
    v_lshlrev_b32 v234, 16, v21
    v_and_b32 v235, 0xffff0000, v21
    v_fma_f32 v234, v234, v227, v231
    v_fma_f32 v235, v235, v227, v231
    v_cvt_pk_bf16_f32 v21, v234, v235
    v_lshlrev_b32 v234, 16, v22
    v_and_b32 v235, 0xffff0000, v22
    v_fma_f32 v234, v234, v227, v231
    v_fma_f32 v235, v235, v227, v231
    v_cvt_pk_bf16_f32 v22, v234, v235
    v_lshlrev_b32 v234, 16, v23
    v_and_b32 v235, 0xffff0000, v23
    v_fma_f32 v234, v234, v227, v231
    v_fma_f32 v235, v235, v227, v231
    v_cvt_pk_bf16_f32 v23, v234, v235
    ds_write_b128 v8, v[20:23] offset:9216
    v_lshlrev_b32 v234, 16, v24
    v_and_b32 v235, 0xffff0000, v24
    v_fma_f32 v234, v234, v228, v232
    v_fma_f32 v235, v235, v228, v232
    v_cvt_pk_bf16_f32 v24, v234, v235
    v_lshlrev_b32 v234, 16, v25
    v_and_b32 v235, 0xffff0000, v25
    v_fma_f32 v234, v234, v228, v232
    v_fma_f32 v235, v235, v228, v232
    v_cvt_pk_bf16_f32 v25, v234, v235
    v_lshlrev_b32 v234, 16, v26
    v_and_b32 v235, 0xffff0000, v26
    v_fma_f32 v234, v234, v228, v232
    v_fma_f32 v235, v235, v228, v232
    v_cvt_pk_bf16_f32 v26, v234, v235
    v_lshlrev_b32 v234, 16, v27
    v_and_b32 v235, 0xffff0000, v27
    v_fma_f32 v234, v234, v228, v232
    v_fma_f32 v235, v235, v228, v232
    v_cvt_pk_bf16_f32 v27, v234, v235
    ds_write_b128 v8, v[24:27] offset:13824
    v_lshlrev_b32 v234, 16, v28
    v_and_b32 v235, 0xffff0000, v28
    v_fma_f32 v234, v234, v225, v229
    v_fma_f32 v235, v235, v225, v229
    v_cvt_pk_bf16_f32 v28, v234, v235
    v_lshlrev_b32 v234, 16, v29
    v_and_b32 v235, 0xffff0000, v29
    v_fma_f32 v234, v234, v225, v229
    v_fma_f32 v235, v235, v225, v229
    v_cvt_pk_bf16_f32 v29, v234, v235
    v_lshlrev_b32 v234, 16, v30
    v_and_b32 v235, 0xffff0000, v30
    v_fma_f32 v234, v234, v225, v229
    v_fma_f32 v235, v235, v225, v229
    v_cvt_pk_bf16_f32 v30, v234, v235
    v_lshlrev_b32 v234, 16, v31
    v_and_b32 v235, 0xffff0000, v31
    v_fma_f32 v234, v234, v225, v229
    v_fma_f32 v235, v235, v225, v229
    v_cvt_pk_bf16_f32 v31, v234, v235
    ds_write_b128 v179, v[28:31] offset:0
    v_lshlrev_b32 v234, 16, v32
    v_and_b32 v235, 0xffff0000, v32
    v_fma_f32 v234, v234, v226, v230
    v_fma_f32 v235, v235, v226, v230
    v_cvt_pk_bf16_f32 v32, v234, v235
    v_lshlrev_b32 v234, 16, v33
    v_and_b32 v235, 0xffff0000, v33
    v_fma_f32 v234, v234, v226, v230
    v_fma_f32 v235, v235, v226, v230
    v_cvt_pk_bf16_f32 v33, v234, v235
    v_lshlrev_b32 v234, 16, v34
    v_and_b32 v235, 0xffff0000, v34
    v_fma_f32 v234, v234, v226, v230
    v_fma_f32 v235, v235, v226, v230
    v_cvt_pk_bf16_f32 v34, v234, v235
    v_lshlrev_b32 v234, 16, v35
    v_and_b32 v235, 0xffff0000, v35
    v_fma_f32 v234, v234, v226, v230
    v_fma_f32 v235, v235, v226, v230
    v_cvt_pk_bf16_f32 v35, v234, v235
    ds_write_b128 v179, v[32:35] offset:4608
    v_lshlrev_b32 v234, 16, v36
    v_and_b32 v235, 0xffff0000, v36
    v_fma_f32 v234, v234, v227, v231
    v_fma_f32 v235, v235, v227, v231
    v_cvt_pk_bf16_f32 v36, v234, v235
    v_lshlrev_b32 v234, 16, v37
    v_and_b32 v235, 0xffff0000, v37
    v_fma_f32 v234, v234, v227, v231
    v_fma_f32 v235, v235, v227, v231
    v_cvt_pk_bf16_f32 v37, v234, v235
    v_lshlrev_b32 v234, 16, v38
    v_and_b32 v235, 0xffff0000, v38
    v_fma_f32 v234, v234, v227, v231
    v_fma_f32 v235, v235, v227, v231
    v_cvt_pk_bf16_f32 v38, v234, v235
    v_lshlrev_b32 v234, 16, v39
    v_and_b32 v235, 0xffff0000, v39
    v_fma_f32 v234, v234, v227, v231
    v_fma_f32 v235, v235, v227, v231
    v_cvt_pk_bf16_f32 v39, v234, v235
    ds_write_b128 v179, v[36:39] offset:9216
    v_lshlrev_b32 v234, 16, v40
    v_and_b32 v235, 0xffff0000, v40
    v_fma_f32 v234, v234, v228, v232
    v_fma_f32 v235, v235, v228, v232
    v_cvt_pk_bf16_f32 v40, v234, v235
    v_lshlrev_b32 v234, 16, v41
    v_and_b32 v235, 0xffff0000, v41
    v_fma_f32 v234, v234, v228, v232
    v_fma_f32 v235, v235, v228, v232
    v_cvt_pk_bf16_f32 v41, v234, v235
    v_lshlrev_b32 v234, 16, v42
    v_and_b32 v235, 0xffff0000, v42
    v_fma_f32 v234, v234, v228, v232
    v_fma_f32 v235, v235, v228, v232
    v_cvt_pk_bf16_f32 v42, v234, v235
    v_lshlrev_b32 v234, 16, v43
    v_and_b32 v235, 0xffff0000, v43
    v_fma_f32 v234, v234, v228, v232
    v_fma_f32 v235, v235, v228, v232
    v_cvt_pk_bf16_f32 v43, v234, v235
    ds_write_b128 v179, v[40:43] offset:13824
    s_waitcnt lgkmcnt(0)
    s_barrier
    ds_read_b128 v[184:187], v176 offset:0
    ds_read_b128 v[188:191], v176 offset:4608
    ds_read_b128 v[192:195], v176 offset:9216
    ds_read_b128 v[196:199], v176 offset:13824
    s_waitcnt vmcnt(11) lgkmcnt(3)
    v_mfma_f32_32x32x16_bf16 a[0:15], v[128:131], v[184:187], 0
    v_lshlrev_b32 v234, 16, v44
    v_and_b32 v235, 0xffff0000, v44
    v_fma_f32 v234, v234, v225, v229
    v_fma_f32 v235, v235, v225, v229
    s_waitcnt lgkmcnt(2)
    v_mfma_f32_32x32x16_bf16 a[16:31], v[128:131], v[188:191], 0
    ds_read_b128 v[200:203], v176 offset:32
    v_cvt_pk_bf16_f32 v44, v234, v235
    v_lshlrev_b32 v234, 16, v45
    v_and_b32 v235, 0xffff0000, v45
    v_fma_f32 v234, v234, v225, v229
    s_waitcnt lgkmcnt(2)
    v_mfma_f32_32x32x16_bf16 a[32:47], v[128:131], v[192:195], 0
    ds_read_b128 v[204:207], v176 offset:4640
    v_fma_f32 v235, v235, v225, v229
    v_cvt_pk_bf16_f32 v45, v234, v235
    v_lshlrev_b32 v234, 16, v46
    s_waitcnt lgkmcnt(2)
    v_mfma_f32_32x32x16_bf16 a[48:63], v[128:131], v[196:199], 0
    buffer_load_dwordx4 v[128:131], v124, s[12:15], s30 offen offset:2048
    v_and_b32 v235, 0xffff0000, v46
    v_fma_f32 v234, v234, v225, v229
    v_fma_f32 v235, v235, v225, v229
    v_cvt_pk_bf16_f32 v46, v234, v235
    s_waitcnt vmcnt(11)
    v_mfma_f32_32x32x16_bf16 a[64:79], v[132:135], v[184:187], 0
    ds_read_b128 v[208:211], v176 offset:9248
    v_lshlrev_b32 v234, 16, v47
    v_and_b32 v235, 0xffff0000, v47
    v_fma_f32 v234, v234, v225, v229
    v_fma_f32 v235, v235, v225, v229
    v_mfma_f32_32x32x16_bf16 a[80:95], v[132:135], v[188:191], 0
    ds_read_b128 v[212:215], v176 offset:13856
    v_cvt_pk_bf16_f32 v47, v234, v235
    ds_write_b128 v180, v[44:47] offset:0
    v_mfma_f32_32x32x16_bf16 a[96:111], v[132:135], v[192:195], 0
    v_lshlrev_b32 v234, 16, v48
    v_and_b32 v235, 0xffff0000, v48
    v_fma_f32 v234, v234, v226, v230
    v_mfma_f32_32x32x16_bf16 a[112:127], v[132:135], v[196:199], 0
    buffer_load_dwordx4 v[132:135], v124, s[16:19], s30 offen offset:2048
    v_fma_f32 v235, v235, v226, v230
    v_cvt_pk_bf16_f32 v48, v234, v235
    v_lshlrev_b32 v234, 16, v49
    s_waitcnt vmcnt(11) lgkmcnt(4)
    v_mfma_f32_32x32x16_bf16 a[0:15], v[136:139], v[200:203], a[0:15]
    v_and_b32 v235, 0xffff0000, v49
    v_fma_f32 v234, v234, v226, v230
    v_fma_f32 v235, v235, v226, v230
    v_cvt_pk_bf16_f32 v49, v234, v235
    s_waitcnt lgkmcnt(3)
    v_mfma_f32_32x32x16_bf16 a[16:31], v[136:139], v[204:207], a[16:31]
    ds_read_b128 v[184:187], v176 offset:64
    v_lshlrev_b32 v234, 16, v50
    v_and_b32 v235, 0xffff0000, v50
    v_fma_f32 v234, v234, v226, v230
    v_fma_f32 v235, v235, v226, v230
    s_waitcnt lgkmcnt(3)
    v_mfma_f32_32x32x16_bf16 a[32:47], v[136:139], v[208:211], a[32:47]
    ds_read_b128 v[188:191], v176 offset:4672
    v_cvt_pk_bf16_f32 v50, v234, v235
    v_lshlrev_b32 v234, 16, v51
    v_and_b32 v235, 0xffff0000, v51
    s_waitcnt lgkmcnt(3)
    v_mfma_f32_32x32x16_bf16 a[48:63], v[136:139], v[212:215], a[48:63]
    buffer_load_dwordx4 v[136:139], v124, s[12:15], s30 offen offset:3072
    v_fma_f32 v234, v234, v226, v230
    v_fma_f32 v235, v235, v226, v230
    v_cvt_pk_bf16_f32 v51, v234, v235
    ds_write_b128 v180, v[48:51] offset:4608
    s_waitcnt vmcnt(11)
    v_mfma_f32_32x32x16_bf16 a[64:79], v[140:143], v[200:203], a[64:79]
    ds_read_b128 v[192:195], v176 offset:9280
    v_lshlrev_b32 v234, 16, v52
    v_mfma_f32_32x32x16_bf16 a[80:95], v[140:143], v[204:207], a[80:95]
    ds_read_b128 v[196:199], v176 offset:13888
    v_and_b32 v235, 0xffff0000, v52
    v_fma_f32 v234, v234, v227, v231
    v_fma_f32 v235, v235, v227, v231
    v_cvt_pk_bf16_f32 v52, v234, v235
    v_mfma_f32_32x32x16_bf16 a[96:111], v[140:143], v[208:211], a[96:111]
    v_lshlrev_b32 v234, 16, v53
    v_and_b32 v235, 0xffff0000, v53
    v_fma_f32 v234, v234, v227, v231
    v_mfma_f32_32x32x16_bf16 a[112:127], v[140:143], v[212:215], a[112:127]
    buffer_load_dwordx4 v[140:143], v124, s[16:19], s30 offen offset:3072
    v_fma_f32 v235, v235, v227, v231
    v_cvt_pk_bf16_f32 v53, v234, v235
    v_lshlrev_b32 v234, 16, v54
    v_and_b32 v235, 0xffff0000, v54
    s_waitcnt vmcnt(11) lgkmcnt(4)
    v_mfma_f32_32x32x16_bf16 a[0:15], v[144:147], v[184:187], a[0:15]
    v_fma_f32 v234, v234, v227, v231
    v_fma_f32 v235, v235, v227, v231
    v_cvt_pk_bf16_f32 v54, v234, v235
    v_lshlrev_b32 v234, 16, v55
    s_waitcnt lgkmcnt(3)
    v_mfma_f32_32x32x16_bf16 a[16:31], v[144:147], v[188:191], a[16:31]
    ds_read_b128 v[200:203], v176 offset:96
    v_and_b32 v235, 0xffff0000, v55
    v_fma_f32 v234, v234, v227, v231
    v_fma_f32 v235, v235, v227, v231
    s_waitcnt lgkmcnt(2)
    v_mfma_f32_32x32x16_bf16 a[32:47], v[144:147], v[192:195], a[32:47]
    ds_read_b128 v[204:207], v176 offset:4704
    v_cvt_pk_bf16_f32 v55, v234, v235
    ds_write_b128 v180, v[52:55] offset:9216
    s_waitcnt lgkmcnt(3)
    v_mfma_f32_32x32x16_bf16 a[48:63], v[144:147], v[196:199], a[48:63]
    s_mov_b32 s30, 8192
    buffer_load_dwordx4 v[144:147], v124, s[12:15], s30 offen offset:0
    v_lshlrev_b32 v234, 16, v56
    v_and_b32 v235, 0xffff0000, v56
    v_fma_f32 v234, v234, v228, v232
    s_waitcnt vmcnt(11)
    v_mfma_f32_32x32x16_bf16 a[64:79], v[148:151], v[184:187], a[64:79]
    ds_read_b128 v[208:211], v176 offset:9312
    v_fma_f32 v235, v235, v228, v232
    v_cvt_pk_bf16_f32 v56, v234, v235
    v_lshlrev_b32 v234, 16, v57
    v_and_b32 v235, 0xffff0000, v57
    v_mfma_f32_32x32x16_bf16 a[80:95], v[148:151], v[188:191], a[80:95]
    ds_read_b128 v[212:215], v176 offset:13920
    v_fma_f32 v234, v234, v228, v232
    v_fma_f32 v235, v235, v228, v232
    v_cvt_pk_bf16_f32 v57, v234, v235
    v_lshlrev_b32 v234, 16, v58
    v_mfma_f32_32x32x16_bf16 a[96:111], v[148:151], v[192:195], a[96:111]
    v_and_b32 v235, 0xffff0000, v58
    v_fma_f32 v234, v234, v228, v232
    v_fma_f32 v235, v235, v228, v232
    v_mfma_f32_32x32x16_bf16 a[112:127], v[148:151], v[196:199], a[112:127]
    buffer_load_dwordx4 v[148:151], v124, s[16:19], s30 offen offset:0
    v_cvt_pk_bf16_f32 v58, v234, v235
    v_lshlrev_b32 v234, 16, v59
    v_and_b32 v235, 0xffff0000, v59
    v_fma_f32 v234, v234, v228, v232
    s_waitcnt vmcnt(11) lgkmcnt(4)
    v_mfma_f32_32x32x16_bf16 a[0:15], v[152:155], v[200:203], a[0:15]
    v_fma_f32 v235, v235, v228, v232
    v_cvt_pk_bf16_f32 v59, v234, v235
    ds_write_b128 v180, v[56:59] offset:13824
    s_waitcnt lgkmcnt(4)
    v_mfma_f32_32x32x16_bf16 a[16:31], v[152:155], v[204:207], a[16:31]
    ds_read_b128 v[184:187], v177 offset:0
    s_waitcnt lgkmcnt(3)
    v_mfma_f32_32x32x16_bf16 a[32:47], v[152:155], v[208:211], a[32:47]
    ds_read_b128 v[188:191], v177 offset:4608
    s_waitcnt lgkmcnt(3)
    v_mfma_f32_32x32x16_bf16 a[48:63], v[152:155], v[212:215], a[48:63]
    buffer_load_dwordx4 v[152:155], v124, s[12:15], s30 offen offset:1024
    s_waitcnt vmcnt(11)
    v_mfma_f32_32x32x16_bf16 a[64:79], v[156:159], v[200:203], a[64:79]
    ds_read_b128 v[192:195], v177 offset:9216
    v_mfma_f32_32x32x16_bf16 a[80:95], v[156:159], v[204:207], a[80:95]
    ds_read_b128 v[196:199], v177 offset:13824
    v_mfma_f32_32x32x16_bf16 a[96:111], v[156:159], v[208:211], a[96:111]
    v_mfma_f32_32x32x16_bf16 a[112:127], v[156:159], v[212:215], a[112:127]
    buffer_load_dwordx4 v[156:159], v124, s[16:19], s30 offen offset:1024
    s_waitcnt lgkmcnt(4)
    s_barrier
    s_waitcnt vmcnt(11) lgkmcnt(3)
    v_mfma_f32_32x32x16_bf16 a[0:15], v[160:163], v[184:187], a[0:15]
    v_lshlrev_b32 v234, 16, v60
    v_and_b32 v235, 0xffff0000, v60
    v_fma_f32 v234, v234, v225, v229
    v_fma_f32 v235, v235, v225, v229
    s_waitcnt lgkmcnt(2)
    v_mfma_f32_32x32x16_bf16 a[16:31], v[160:163], v[188:191], a[16:31]
    ds_read_b128 v[200:203], v177 offset:32
    v_cvt_pk_bf16_f32 v60, v234, v235
    v_lshlrev_b32 v234, 16, v61
    v_and_b32 v235, 0xffff0000, v61
    v_fma_f32 v234, v234, v225, v229
    s_waitcnt lgkmcnt(2)
    v_mfma_f32_32x32x16_bf16 a[32:47], v[160:163], v[192:195], a[32:47]
    ds_read_b128 v[204:207], v177 offset:4640
    v_fma_f32 v235, v235, v225, v229
    v_cvt_pk_bf16_f32 v61, v234, v235
    v_lshlrev_b32 v234, 16, v62
    s_waitcnt lgkmcnt(2)
    v_mfma_f32_32x32x16_bf16 a[48:63], v[160:163], v[196:199], a[48:63]
    buffer_load_dwordx4 v[160:163], v124, s[12:15], s30 offen offset:2048
    v_and_b32 v235, 0xffff0000, v62
    v_fma_f32 v234, v234, v225, v229
    v_fma_f32 v235, v235, v225, v229
    v_cvt_pk_bf16_f32 v62, v234, v235
    s_waitcnt vmcnt(11)
    v_mfma_f32_32x32x16_bf16 a[64:79], v[164:167], v[184:187], a[64:79]
    ds_read_b128 v[208:211], v177 offset:9248
    v_lshlrev_b32 v234, 16, v63
    v_and_b32 v235, 0xffff0000, v63
    v_fma_f32 v234, v234, v225, v229
    v_fma_f32 v235, v235, v225, v229
    v_mfma_f32_32x32x16_bf16 a[80:95], v[164:167], v[188:191], a[80:95]
    ds_read_b128 v[212:215], v177 offset:13856
    v_cvt_pk_bf16_f32 v63, v234, v235
    ds_write_b128 v8, v[60:63] offset:0
    v_mfma_f32_32x32x16_bf16 a[96:111], v[164:167], v[192:195], a[96:111]
    v_lshlrev_b32 v234, 16, v64
    v_and_b32 v235, 0xffff0000, v64
    v_fma_f32 v234, v234, v226, v230
    v_mfma_f32_32x32x16_bf16 a[112:127], v[164:167], v[196:199], a[112:127]
    buffer_load_dwordx4 v[164:167], v124, s[16:19], s30 offen offset:2048
    v_fma_f32 v235, v235, v226, v230
    v_cvt_pk_bf16_f32 v64, v234, v235
    v_lshlrev_b32 v234, 16, v65
    s_waitcnt vmcnt(11) lgkmcnt(4)
    v_mfma_f32_32x32x16_bf16 a[0:15], v[168:171], v[200:203], a[0:15]
    v_and_b32 v235, 0xffff0000, v65
    v_fma_f32 v234, v234, v226, v230
    v_fma_f32 v235, v235, v226, v230
    v_cvt_pk_bf16_f32 v65, v234, v235
    s_waitcnt lgkmcnt(3)
    v_mfma_f32_32x32x16_bf16 a[16:31], v[168:171], v[204:207], a[16:31]
    ds_read_b128 v[184:187], v177 offset:64
    v_lshlrev_b32 v234, 16, v66
    v_and_b32 v235, 0xffff0000, v66
    v_fma_f32 v234, v234, v226, v230
    v_fma_f32 v235, v235, v226, v230
    s_waitcnt lgkmcnt(3)
    v_mfma_f32_32x32x16_bf16 a[32:47], v[168:171], v[208:211], a[32:47]
    ds_read_b128 v[188:191], v177 offset:4672
    v_cvt_pk_bf16_f32 v66, v234, v235
    v_lshlrev_b32 v234, 16, v67
    v_and_b32 v235, 0xffff0000, v67
    s_waitcnt lgkmcnt(3)
    v_mfma_f32_32x32x16_bf16 a[48:63], v[168:171], v[212:215], a[48:63]
    buffer_load_dwordx4 v[168:171], v124, s[12:15], s30 offen offset:3072
    v_fma_f32 v234, v234, v226, v230
    v_fma_f32 v235, v235, v226, v230
    v_cvt_pk_bf16_f32 v67, v234, v235
    ds_write_b128 v8, v[64:67] offset:4608
    s_waitcnt vmcnt(11)
    v_mfma_f32_32x32x16_bf16 a[64:79], v[172:175], v[200:203], a[64:79]
    ds_read_b128 v[192:195], v177 offset:9280
    v_lshlrev_b32 v234, 16, v68
    v_mfma_f32_32x32x16_bf16 a[80:95], v[172:175], v[204:207], a[80:95]
    ds_read_b128 v[196:199], v177 offset:13888
    v_and_b32 v235, 0xffff0000, v68
    v_fma_f32 v234, v234, v227, v231
    v_fma_f32 v235, v235, v227, v231
    v_cvt_pk_bf16_f32 v68, v234, v235
    v_mfma_f32_32x32x16_bf16 a[96:111], v[172:175], v[208:211], a[96:111]
    v_lshlrev_b32 v234, 16, v69
    v_and_b32 v235, 0xffff0000, v69
    v_fma_f32 v234, v234, v227, v231
    v_mfma_f32_32x32x16_bf16 a[112:127], v[172:175], v[212:215], a[112:127]
    buffer_load_dwordx4 v[172:175], v124, s[16:19], s30 offen offset:3072
    v_fma_f32 v235, v235, v227, v231
    v_cvt_pk_bf16_f32 v69, v234, v235
    v_lshlrev_b32 v234, 16, v70
    v_and_b32 v235, 0xffff0000, v70
    s_waitcnt vmcnt(11) lgkmcnt(4)
    v_mfma_f32_32x32x16_bf16 a[0:15], v[128:131], v[184:187], a[0:15]
    v_fma_f32 v234, v234, v227, v231
    v_fma_f32 v235, v235, v227, v231
    v_cvt_pk_bf16_f32 v70, v234, v235
    v_lshlrev_b32 v234, 16, v71
    s_waitcnt lgkmcnt(3)
    v_mfma_f32_32x32x16_bf16 a[16:31], v[128:131], v[188:191], a[16:31]
    ds_read_b128 v[200:203], v177 offset:96
    v_and_b32 v235, 0xffff0000, v71
    v_fma_f32 v234, v234, v227, v231
    v_fma_f32 v235, v235, v227, v231
    s_waitcnt lgkmcnt(2)
    v_mfma_f32_32x32x16_bf16 a[32:47], v[128:131], v[192:195], a[32:47]
    ds_read_b128 v[204:207], v177 offset:4704
    v_cvt_pk_bf16_f32 v71, v234, v235
    ds_write_b128 v8, v[68:71] offset:9216
    s_waitcnt lgkmcnt(3)
    v_mfma_f32_32x32x16_bf16 a[48:63], v[128:131], v[196:199], a[48:63]
    s_mov_b32 s30, 12288
    buffer_load_dwordx4 v[128:131], v124, s[12:15], s30 offen offset:0
    v_lshlrev_b32 v234, 16, v72
    v_and_b32 v235, 0xffff0000, v72
    v_fma_f32 v234, v234, v228, v232
    s_waitcnt vmcnt(11)
    v_mfma_f32_32x32x16_bf16 a[64:79], v[132:135], v[184:187], a[64:79]
    ds_read_b128 v[208:211], v177 offset:9312
    v_fma_f32 v235, v235, v228, v232
    v_cvt_pk_bf16_f32 v72, v234, v235
    v_lshlrev_b32 v234, 16, v73
    v_and_b32 v235, 0xffff0000, v73
    v_mfma_f32_32x32x16_bf16 a[80:95], v[132:135], v[188:191], a[80:95]
    ds_read_b128 v[212:215], v177 offset:13920
    v_fma_f32 v234, v234, v228, v232
    v_fma_f32 v235, v235, v228, v232
    v_cvt_pk_bf16_f32 v73, v234, v235
    v_lshlrev_b32 v234, 16, v74
    v_mfma_f32_32x32x16_bf16 a[96:111], v[132:135], v[192:195], a[96:111]
    v_and_b32 v235, 0xffff0000, v74
    v_fma_f32 v234, v234, v228, v232
    v_fma_f32 v235, v235, v228, v232
    v_mfma_f32_32x32x16_bf16 a[112:127], v[132:135], v[196:199], a[112:127]
    buffer_load_dwordx4 v[132:135], v124, s[16:19], s30 offen offset:0
    v_cvt_pk_bf16_f32 v74, v234, v235
    v_lshlrev_b32 v234, 16, v75
    v_and_b32 v235, 0xffff0000, v75
    v_fma_f32 v234, v234, v228, v232
    s_waitcnt vmcnt(11) lgkmcnt(4)
    v_mfma_f32_32x32x16_bf16 a[0:15], v[136:139], v[200:203], a[0:15]
    v_fma_f32 v235, v235, v228, v232
    v_cvt_pk_bf16_f32 v75, v234, v235
    ds_write_b128 v8, v[72:75] offset:13824
    s_waitcnt lgkmcnt(4)
    v_mfma_f32_32x32x16_bf16 a[16:31], v[136:139], v[204:207], a[16:31]
    ds_read_b128 v[184:187], v178 offset:0
    s_waitcnt lgkmcnt(3)
    v_mfma_f32_32x32x16_bf16 a[32:47], v[136:139], v[208:211], a[32:47]
    ds_read_b128 v[188:191], v178 offset:4608
    s_waitcnt lgkmcnt(3)
    v_mfma_f32_32x32x16_bf16 a[48:63], v[136:139], v[212:215], a[48:63]
    buffer_load_dwordx4 v[136:139], v124, s[12:15], s30 offen offset:1024
    s_waitcnt vmcnt(11)
    v_mfma_f32_32x32x16_bf16 a[64:79], v[140:143], v[200:203], a[64:79]
    ds_read_b128 v[192:195], v178 offset:9216
    v_mfma_f32_32x32x16_bf16 a[80:95], v[140:143], v[204:207], a[80:95]
    ds_read_b128 v[196:199], v178 offset:13824
    v_mfma_f32_32x32x16_bf16 a[96:111], v[140:143], v[208:211], a[96:111]
    v_mfma_f32_32x32x16_bf16 a[112:127], v[140:143], v[212:215], a[112:127]
    buffer_load_dwordx4 v[140:143], v124, s[16:19], s30 offen offset:1024
    s_waitcnt lgkmcnt(4)
    s_barrier
    s_waitcnt vmcnt(11) lgkmcnt(3)
    v_mfma_f32_32x32x16_bf16 a[0:15], v[144:147], v[184:187], a[0:15]
    v_lshlrev_b32 v234, 16, v76
    v_and_b32 v235, 0xffff0000, v76
    v_fma_f32 v234, v234, v225, v229
    v_fma_f32 v235, v235, v225, v229
    s_waitcnt lgkmcnt(2)
    v_mfma_f32_32x32x16_bf16 a[16:31], v[144:147], v[188:191], a[16:31]
    ds_read_b128 v[200:203], v178 offset:32
    v_cvt_pk_bf16_f32 v76, v234, v235
    v_lshlrev_b32 v234, 16, v77
    v_and_b32 v235, 0xffff0000, v77
    v_fma_f32 v234, v234, v225, v229
    s_waitcnt lgkmcnt(2)
    v_mfma_f32_32x32x16_bf16 a[32:47], v[144:147], v[192:195], a[32:47]
    ds_read_b128 v[204:207], v178 offset:4640
    v_fma_f32 v235, v235, v225, v229
    v_cvt_pk_bf16_f32 v77, v234, v235
    v_lshlrev_b32 v234, 16, v78
    s_waitcnt lgkmcnt(2)
    v_mfma_f32_32x32x16_bf16 a[48:63], v[144:147], v[196:199], a[48:63]
    buffer_load_dwordx4 v[144:147], v124, s[12:15], s30 offen offset:2048
    v_and_b32 v235, 0xffff0000, v78
    v_fma_f32 v234, v234, v225, v229
    v_fma_f32 v235, v235, v225, v229
    v_cvt_pk_bf16_f32 v78, v234, v235
    s_waitcnt vmcnt(11)
    v_mfma_f32_32x32x16_bf16 a[64:79], v[148:151], v[184:187], a[64:79]
    ds_read_b128 v[208:211], v178 offset:9248
    v_lshlrev_b32 v234, 16, v79
    v_and_b32 v235, 0xffff0000, v79
    v_fma_f32 v234, v234, v225, v229
    v_fma_f32 v235, v235, v225, v229
    v_mfma_f32_32x32x16_bf16 a[80:95], v[148:151], v[188:191], a[80:95]
    ds_read_b128 v[212:215], v178 offset:13856
    v_cvt_pk_bf16_f32 v79, v234, v235
    ds_write_b128 v179, v[76:79] offset:0
    v_mfma_f32_32x32x16_bf16 a[96:111], v[148:151], v[192:195], a[96:111]
    v_lshlrev_b32 v234, 16, v80
    v_and_b32 v235, 0xffff0000, v80
    v_fma_f32 v234, v234, v226, v230
    v_mfma_f32_32x32x16_bf16 a[112:127], v[148:151], v[196:199], a[112:127]
    buffer_load_dwordx4 v[148:151], v124, s[16:19], s30 offen offset:2048
    v_fma_f32 v235, v235, v226, v230
    v_cvt_pk_bf16_f32 v80, v234, v235
    v_lshlrev_b32 v234, 16, v81
    s_waitcnt vmcnt(11) lgkmcnt(4)
    v_mfma_f32_32x32x16_bf16 a[0:15], v[152:155], v[200:203], a[0:15]
    v_and_b32 v235, 0xffff0000, v81
    v_fma_f32 v234, v234, v226, v230
    v_fma_f32 v235, v235, v226, v230
    v_cvt_pk_bf16_f32 v81, v234, v235
    s_waitcnt lgkmcnt(3)
    v_mfma_f32_32x32x16_bf16 a[16:31], v[152:155], v[204:207], a[16:31]
    ds_read_b128 v[184:187], v178 offset:64
    v_lshlrev_b32 v234, 16, v82
    v_and_b32 v235, 0xffff0000, v82
    v_fma_f32 v234, v234, v226, v230
    v_fma_f32 v235, v235, v226, v230
    s_waitcnt lgkmcnt(3)
    v_mfma_f32_32x32x16_bf16 a[32:47], v[152:155], v[208:211], a[32:47]
    ds_read_b128 v[188:191], v178 offset:4672
    v_cvt_pk_bf16_f32 v82, v234, v235
    v_lshlrev_b32 v234, 16, v83
    v_and_b32 v235, 0xffff0000, v83
    s_waitcnt lgkmcnt(3)
    v_mfma_f32_32x32x16_bf16 a[48:63], v[152:155], v[212:215], a[48:63]
    buffer_load_dwordx4 v[152:155], v124, s[12:15], s30 offen offset:3072
    v_fma_f32 v234, v234, v226, v230
    v_fma_f32 v235, v235, v226, v230
    v_cvt_pk_bf16_f32 v83, v234, v235
    ds_write_b128 v179, v[80:83] offset:4608
    s_waitcnt vmcnt(11)
    v_mfma_f32_32x32x16_bf16 a[64:79], v[156:159], v[200:203], a[64:79]
    ds_read_b128 v[192:195], v178 offset:9280
    v_lshlrev_b32 v234, 16, v84
    v_mfma_f32_32x32x16_bf16 a[80:95], v[156:159], v[204:207], a[80:95]
    ds_read_b128 v[196:199], v178 offset:13888
    v_and_b32 v235, 0xffff0000, v84
    v_fma_f32 v234, v234, v227, v231
    v_fma_f32 v235, v235, v227, v231
    v_cvt_pk_bf16_f32 v84, v234, v235
    v_mfma_f32_32x32x16_bf16 a[96:111], v[156:159], v[208:211], a[96:111]
    v_lshlrev_b32 v234, 16, v85
    v_and_b32 v235, 0xffff0000, v85
    v_fma_f32 v234, v234, v227, v231
    v_mfma_f32_32x32x16_bf16 a[112:127], v[156:159], v[212:215], a[112:127]
    buffer_load_dwordx4 v[156:159], v124, s[16:19], s30 offen offset:3072
    v_fma_f32 v235, v235, v227, v231
    v_cvt_pk_bf16_f32 v85, v234, v235
    v_lshlrev_b32 v234, 16, v86
    v_and_b32 v235, 0xffff0000, v86
    s_waitcnt vmcnt(11) lgkmcnt(4)
    v_mfma_f32_32x32x16_bf16 a[0:15], v[160:163], v[184:187], a[0:15]
    v_fma_f32 v234, v234, v227, v231
    v_fma_f32 v235, v235, v227, v231
    v_cvt_pk_bf16_f32 v86, v234, v235
    v_lshlrev_b32 v234, 16, v87
    s_waitcnt lgkmcnt(3)
    v_mfma_f32_32x32x16_bf16 a[16:31], v[160:163], v[188:191], a[16:31]
    ds_read_b128 v[200:203], v178 offset:96
    v_and_b32 v235, 0xffff0000, v87
    v_fma_f32 v234, v234, v227, v231
    v_fma_f32 v235, v235, v227, v231
    s_waitcnt lgkmcnt(2)
    v_mfma_f32_32x32x16_bf16 a[32:47], v[160:163], v[192:195], a[32:47]
    ds_read_b128 v[204:207], v178 offset:4704
    v_cvt_pk_bf16_f32 v87, v234, v235
    ds_write_b128 v179, v[84:87] offset:9216
    s_waitcnt lgkmcnt(3)
    v_mfma_f32_32x32x16_bf16 a[48:63], v[160:163], v[196:199], a[48:63]
    s_mov_b32 s30, 16384
    buffer_load_dwordx4 v[160:163], v124, s[12:15], s30 offen offset:0
    v_lshlrev_b32 v234, 16, v88
    v_and_b32 v235, 0xffff0000, v88
    v_fma_f32 v234, v234, v228, v232
    s_waitcnt vmcnt(11)
    v_mfma_f32_32x32x16_bf16 a[64:79], v[164:167], v[184:187], a[64:79]
    ds_read_b128 v[208:211], v178 offset:9312
    v_fma_f32 v235, v235, v228, v232
    v_cvt_pk_bf16_f32 v88, v234, v235
    v_lshlrev_b32 v234, 16, v89
    v_and_b32 v235, 0xffff0000, v89
    v_mfma_f32_32x32x16_bf16 a[80:95], v[164:167], v[188:191], a[80:95]
    ds_read_b128 v[212:215], v178 offset:13920
    v_fma_f32 v234, v234, v228, v232
    v_fma_f32 v235, v235, v228, v232
    v_cvt_pk_bf16_f32 v89, v234, v235
    v_lshlrev_b32 v234, 16, v90
    v_mfma_f32_32x32x16_bf16 a[96:111], v[164:167], v[192:195], a[96:111]
    v_and_b32 v235, 0xffff0000, v90
    v_fma_f32 v234, v234, v228, v232
    v_fma_f32 v235, v235, v228, v232
    v_mfma_f32_32x32x16_bf16 a[112:127], v[164:167], v[196:199], a[112:127]
    buffer_load_dwordx4 v[164:167], v124, s[16:19], s30 offen offset:0
    v_cvt_pk_bf16_f32 v90, v234, v235
    v_lshlrev_b32 v234, 16, v91
    v_and_b32 v235, 0xffff0000, v91
    v_fma_f32 v234, v234, v228, v232
    s_waitcnt vmcnt(11) lgkmcnt(4)
    v_mfma_f32_32x32x16_bf16 a[0:15], v[168:171], v[200:203], a[0:15]
    v_fma_f32 v235, v235, v228, v232
    v_cvt_pk_bf16_f32 v91, v234, v235
    ds_write_b128 v179, v[88:91] offset:13824
    s_waitcnt lgkmcnt(4)
    v_mfma_f32_32x32x16_bf16 a[16:31], v[168:171], v[204:207], a[16:31]
    ds_read_b128 v[184:187], v176 offset:0
    s_waitcnt lgkmcnt(3)
    v_mfma_f32_32x32x16_bf16 a[32:47], v[168:171], v[208:211], a[32:47]
    ds_read_b128 v[188:191], v176 offset:4608
    s_waitcnt lgkmcnt(3)
    v_mfma_f32_32x32x16_bf16 a[48:63], v[168:171], v[212:215], a[48:63]
    buffer_load_dwordx4 v[168:171], v124, s[12:15], s30 offen offset:1024
    s_waitcnt vmcnt(11)
    v_mfma_f32_32x32x16_bf16 a[64:79], v[172:175], v[200:203], a[64:79]
    ds_read_b128 v[192:195], v176 offset:9216
    v_mfma_f32_32x32x16_bf16 a[80:95], v[172:175], v[204:207], a[80:95]
    ds_read_b128 v[196:199], v176 offset:13824
    v_mfma_f32_32x32x16_bf16 a[96:111], v[172:175], v[208:211], a[96:111]
    v_mfma_f32_32x32x16_bf16 a[112:127], v[172:175], v[212:215], a[112:127]
    buffer_load_dwordx4 v[172:175], v124, s[16:19], s30 offen offset:1024
    s_waitcnt lgkmcnt(4)
    s_barrier
    s_waitcnt vmcnt(11) lgkmcnt(3)
    v_mfma_f32_32x32x16_bf16 a[0:15], v[128:131], v[184:187], a[0:15]
    v_lshlrev_b32 v234, 16, v92
    v_and_b32 v235, 0xffff0000, v92
    v_fma_f32 v234, v234, v225, v229
    v_fma_f32 v235, v235, v225, v229
    s_waitcnt lgkmcnt(2)
    v_mfma_f32_32x32x16_bf16 a[16:31], v[128:131], v[188:191], a[16:31]
    ds_read_b128 v[200:203], v176 offset:32
    v_cvt_pk_bf16_f32 v92, v234, v235
    v_lshlrev_b32 v234, 16, v93
    v_and_b32 v235, 0xffff0000, v93
    v_fma_f32 v234, v234, v225, v229
    s_waitcnt lgkmcnt(2)
    v_mfma_f32_32x32x16_bf16 a[32:47], v[128:131], v[192:195], a[32:47]
    ds_read_b128 v[204:207], v176 offset:4640
    v_fma_f32 v235, v235, v225, v229
    v_cvt_pk_bf16_f32 v93, v234, v235
    v_lshlrev_b32 v234, 16, v94
    s_waitcnt lgkmcnt(2)
    v_mfma_f32_32x32x16_bf16 a[48:63], v[128:131], v[196:199], a[48:63]
    buffer_load_dwordx4 v[128:131], v124, s[12:15], s30 offen offset:2048
    v_and_b32 v235, 0xffff0000, v94
    v_fma_f32 v234, v234, v225, v229
    v_fma_f32 v235, v235, v225, v229
    v_cvt_pk_bf16_f32 v94, v234, v235
    s_waitcnt vmcnt(11)
    v_mfma_f32_32x32x16_bf16 a[64:79], v[132:135], v[184:187], a[64:79]
    ds_read_b128 v[208:211], v176 offset:9248
    v_lshlrev_b32 v234, 16, v95
    v_and_b32 v235, 0xffff0000, v95
    v_fma_f32 v234, v234, v225, v229
    v_fma_f32 v235, v235, v225, v229
    v_mfma_f32_32x32x16_bf16 a[80:95], v[132:135], v[188:191], a[80:95]
    ds_read_b128 v[212:215], v176 offset:13856
    v_cvt_pk_bf16_f32 v95, v234, v235
    ds_write_b128 v180, v[92:95] offset:0
    v_mfma_f32_32x32x16_bf16 a[96:111], v[132:135], v[192:195], a[96:111]
    v_lshlrev_b32 v234, 16, v96
    v_and_b32 v235, 0xffff0000, v96
    v_fma_f32 v234, v234, v226, v230
    v_mfma_f32_32x32x16_bf16 a[112:127], v[132:135], v[196:199], a[112:127]
    buffer_load_dwordx4 v[132:135], v124, s[16:19], s30 offen offset:2048
    v_fma_f32 v235, v235, v226, v230
    v_cvt_pk_bf16_f32 v96, v234, v235
    v_lshlrev_b32 v234, 16, v97
    s_waitcnt vmcnt(11) lgkmcnt(4)
    v_mfma_f32_32x32x16_bf16 a[0:15], v[136:139], v[200:203], a[0:15]
    v_and_b32 v235, 0xffff0000, v97
    v_fma_f32 v234, v234, v226, v230
    v_fma_f32 v235, v235, v226, v230
    v_cvt_pk_bf16_f32 v97, v234, v235
    s_waitcnt lgkmcnt(3)
    v_mfma_f32_32x32x16_bf16 a[16:31], v[136:139], v[204:207], a[16:31]
    ds_read_b128 v[184:187], v176 offset:64
    v_lshlrev_b32 v234, 16, v98
    v_and_b32 v235, 0xffff0000, v98
    v_fma_f32 v234, v234, v226, v230
    v_fma_f32 v235, v235, v226, v230
    s_waitcnt lgkmcnt(3)
    v_mfma_f32_32x32x16_bf16 a[32:47], v[136:139], v[208:211], a[32:47]
    ds_read_b128 v[188:191], v176 offset:4672
    v_cvt_pk_bf16_f32 v98, v234, v235
    v_lshlrev_b32 v234, 16, v99
    v_and_b32 v235, 0xffff0000, v99
    s_waitcnt lgkmcnt(3)
    v_mfma_f32_32x32x16_bf16 a[48:63], v[136:139], v[212:215], a[48:63]
    buffer_load_dwordx4 v[136:139], v124, s[12:15], s30 offen offset:3072
    v_fma_f32 v234, v234, v226, v230
    v_fma_f32 v235, v235, v226, v230
    v_cvt_pk_bf16_f32 v99, v234, v235
    ds_write_b128 v180, v[96:99] offset:4608
    s_waitcnt vmcnt(11)
    v_mfma_f32_32x32x16_bf16 a[64:79], v[140:143], v[200:203], a[64:79]
    ds_read_b128 v[192:195], v176 offset:9280
    v_lshlrev_b32 v234, 16, v100
    v_mfma_f32_32x32x16_bf16 a[80:95], v[140:143], v[204:207], a[80:95]
    ds_read_b128 v[196:199], v176 offset:13888
    v_and_b32 v235, 0xffff0000, v100
    v_fma_f32 v234, v234, v227, v231
    v_fma_f32 v235, v235, v227, v231
    v_cvt_pk_bf16_f32 v100, v234, v235
    v_mfma_f32_32x32x16_bf16 a[96:111], v[140:143], v[208:211], a[96:111]
    v_lshlrev_b32 v234, 16, v101
    v_and_b32 v235, 0xffff0000, v101
    v_fma_f32 v234, v234, v227, v231
    v_mfma_f32_32x32x16_bf16 a[112:127], v[140:143], v[212:215], a[112:127]
    buffer_load_dwordx4 v[140:143], v124, s[16:19], s30 offen offset:3072
    v_fma_f32 v235, v235, v227, v231
    v_cvt_pk_bf16_f32 v101, v234, v235
    v_lshlrev_b32 v234, 16, v102
    v_and_b32 v235, 0xffff0000, v102
    s_waitcnt vmcnt(11) lgkmcnt(4)
    v_mfma_f32_32x32x16_bf16 a[0:15], v[144:147], v[184:187], a[0:15]
    v_fma_f32 v234, v234, v227, v231
    v_fma_f32 v235, v235, v227, v231
    v_cvt_pk_bf16_f32 v102, v234, v235
    v_lshlrev_b32 v234, 16, v103
    s_waitcnt lgkmcnt(3)
    v_mfma_f32_32x32x16_bf16 a[16:31], v[144:147], v[188:191], a[16:31]
    ds_read_b128 v[200:203], v176 offset:96
    v_and_b32 v235, 0xffff0000, v103
    v_fma_f32 v234, v234, v227, v231
    v_fma_f32 v235, v235, v227, v231
    s_waitcnt lgkmcnt(2)
    v_mfma_f32_32x32x16_bf16 a[32:47], v[144:147], v[192:195], a[32:47]
    ds_read_b128 v[204:207], v176 offset:4704
    v_cvt_pk_bf16_f32 v103, v234, v235
    ds_write_b128 v180, v[100:103] offset:9216
    s_waitcnt lgkmcnt(3)
    v_mfma_f32_32x32x16_bf16 a[48:63], v[144:147], v[196:199], a[48:63]
    s_mov_b32 s30, 20480
    buffer_load_dwordx4 v[144:147], v124, s[12:15], s30 offen offset:0
    v_lshlrev_b32 v234, 16, v104
    v_and_b32 v235, 0xffff0000, v104
    v_fma_f32 v234, v234, v228, v232
    s_waitcnt vmcnt(11)
    v_mfma_f32_32x32x16_bf16 a[64:79], v[148:151], v[184:187], a[64:79]
    ds_read_b128 v[208:211], v176 offset:9312
    v_fma_f32 v235, v235, v228, v232
    v_cvt_pk_bf16_f32 v104, v234, v235
    v_lshlrev_b32 v234, 16, v105
    v_and_b32 v235, 0xffff0000, v105
    v_mfma_f32_32x32x16_bf16 a[80:95], v[148:151], v[188:191], a[80:95]
    ds_read_b128 v[212:215], v176 offset:13920
    v_fma_f32 v234, v234, v228, v232
    v_fma_f32 v235, v235, v228, v232
    v_cvt_pk_bf16_f32 v105, v234, v235
    v_lshlrev_b32 v234, 16, v106
    v_mfma_f32_32x32x16_bf16 a[96:111], v[148:151], v[192:195], a[96:111]
    v_and_b32 v235, 0xffff0000, v106
    v_fma_f32 v234, v234, v228, v232
    v_fma_f32 v235, v235, v228, v232
    v_mfma_f32_32x32x16_bf16 a[112:127], v[148:151], v[196:199], a[112:127]
    buffer_load_dwordx4 v[148:151], v124, s[16:19], s30 offen offset:0
    v_cvt_pk_bf16_f32 v106, v234, v235
    v_lshlrev_b32 v234, 16, v107
    v_and_b32 v235, 0xffff0000, v107
    v_fma_f32 v234, v234, v228, v232
    s_waitcnt vmcnt(11) lgkmcnt(4)
    v_mfma_f32_32x32x16_bf16 a[0:15], v[152:155], v[200:203], a[0:15]
    v_fma_f32 v235, v235, v228, v232
    v_cvt_pk_bf16_f32 v107, v234, v235
    ds_write_b128 v180, v[104:107] offset:13824
    s_waitcnt lgkmcnt(4)
    v_mfma_f32_32x32x16_bf16 a[16:31], v[152:155], v[204:207], a[16:31]
    ds_read_b128 v[184:187], v177 offset:0
    s_waitcnt lgkmcnt(3)
    v_mfma_f32_32x32x16_bf16 a[32:47], v[152:155], v[208:211], a[32:47]
    ds_read_b128 v[188:191], v177 offset:4608
    s_waitcnt lgkmcnt(3)
    v_mfma_f32_32x32x16_bf16 a[48:63], v[152:155], v[212:215], a[48:63]
    buffer_load_dwordx4 v[152:155], v124, s[12:15], s30 offen offset:1024
    s_waitcnt vmcnt(11)
    v_mfma_f32_32x32x16_bf16 a[64:79], v[156:159], v[200:203], a[64:79]
    ds_read_b128 v[192:195], v177 offset:9216
    v_mfma_f32_32x32x16_bf16 a[80:95], v[156:159], v[204:207], a[80:95]
    ds_read_b128 v[196:199], v177 offset:13824
    v_mfma_f32_32x32x16_bf16 a[96:111], v[156:159], v[208:211], a[96:111]
    v_mfma_f32_32x32x16_bf16 a[112:127], v[156:159], v[212:215], a[112:127]
    buffer_load_dwordx4 v[156:159], v124, s[16:19], s30 offen offset:1024
    s_waitcnt lgkmcnt(4)
    s_barrier
    s_waitcnt vmcnt(11) lgkmcnt(3)
    v_mfma_f32_32x32x16_bf16 a[0:15], v[160:163], v[184:187], a[0:15]
    v_lshlrev_b32 v234, 16, v108
    v_and_b32 v235, 0xffff0000, v108
    v_fma_f32 v234, v234, v225, v229
    v_fma_f32 v235, v235, v225, v229
    s_waitcnt lgkmcnt(2)
    v_mfma_f32_32x32x16_bf16 a[16:31], v[160:163], v[188:191], a[16:31]
    ds_read_b128 v[200:203], v177 offset:32
    v_cvt_pk_bf16_f32 v108, v234, v235
    v_lshlrev_b32 v234, 16, v109
    v_and_b32 v235, 0xffff0000, v109
    v_fma_f32 v234, v234, v225, v229
    s_waitcnt lgkmcnt(2)
    v_mfma_f32_32x32x16_bf16 a[32:47], v[160:163], v[192:195], a[32:47]
    ds_read_b128 v[204:207], v177 offset:4640
    v_fma_f32 v235, v235, v225, v229
    v_cvt_pk_bf16_f32 v109, v234, v235
    v_lshlrev_b32 v234, 16, v110
    s_waitcnt lgkmcnt(2)
    v_mfma_f32_32x32x16_bf16 a[48:63], v[160:163], v[196:199], a[48:63]
    buffer_load_dwordx4 v[160:163], v124, s[12:15], s30 offen offset:2048
    v_and_b32 v235, 0xffff0000, v110
    v_fma_f32 v234, v234, v225, v229
    v_fma_f32 v235, v235, v225, v229
    v_cvt_pk_bf16_f32 v110, v234, v235
    s_waitcnt vmcnt(11)
    v_mfma_f32_32x32x16_bf16 a[64:79], v[164:167], v[184:187], a[64:79]
    ds_read_b128 v[208:211], v177 offset:9248
    v_lshlrev_b32 v234, 16, v111
    v_and_b32 v235, 0xffff0000, v111
    v_fma_f32 v234, v234, v225, v229
    v_fma_f32 v235, v235, v225, v229
    v_mfma_f32_32x32x16_bf16 a[80:95], v[164:167], v[188:191], a[80:95]
    ds_read_b128 v[212:215], v177 offset:13856
    v_cvt_pk_bf16_f32 v111, v234, v235
    ds_write_b128 v8, v[108:111] offset:0
    v_mfma_f32_32x32x16_bf16 a[96:111], v[164:167], v[192:195], a[96:111]
    v_lshlrev_b32 v234, 16, v112
    v_and_b32 v235, 0xffff0000, v112
    v_fma_f32 v234, v234, v226, v230
    v_mfma_f32_32x32x16_bf16 a[112:127], v[164:167], v[196:199], a[112:127]
    buffer_load_dwordx4 v[164:167], v124, s[16:19], s30 offen offset:2048
    v_fma_f32 v235, v235, v226, v230
    v_cvt_pk_bf16_f32 v112, v234, v235
    v_lshlrev_b32 v234, 16, v113
    s_waitcnt vmcnt(11) lgkmcnt(4)
    v_mfma_f32_32x32x16_bf16 a[0:15], v[168:171], v[200:203], a[0:15]
    v_and_b32 v235, 0xffff0000, v113
    v_fma_f32 v234, v234, v226, v230
    v_fma_f32 v235, v235, v226, v230
    v_cvt_pk_bf16_f32 v113, v234, v235
    s_waitcnt lgkmcnt(3)
    v_mfma_f32_32x32x16_bf16 a[16:31], v[168:171], v[204:207], a[16:31]
    ds_read_b128 v[184:187], v177 offset:64
    v_lshlrev_b32 v234, 16, v114
    v_and_b32 v235, 0xffff0000, v114
    v_fma_f32 v234, v234, v226, v230
    v_fma_f32 v235, v235, v226, v230
    s_waitcnt lgkmcnt(3)
    v_mfma_f32_32x32x16_bf16 a[32:47], v[168:171], v[208:211], a[32:47]
    ds_read_b128 v[188:191], v177 offset:4672
    v_cvt_pk_bf16_f32 v114, v234, v235
    v_lshlrev_b32 v234, 16, v115
    v_and_b32 v235, 0xffff0000, v115
    s_waitcnt lgkmcnt(3)
    v_mfma_f32_32x32x16_bf16 a[48:63], v[168:171], v[212:215], a[48:63]
    buffer_load_dwordx4 v[168:171], v124, s[12:15], s30 offen offset:3072
    v_fma_f32 v234, v234, v226, v230
    v_fma_f32 v235, v235, v226, v230
    v_cvt_pk_bf16_f32 v115, v234, v235
    ds_write_b128 v8, v[112:115] offset:4608
    s_waitcnt vmcnt(11)
    v_mfma_f32_32x32x16_bf16 a[64:79], v[172:175], v[200:203], a[64:79]
    ds_read_b128 v[192:195], v177 offset:9280
    v_lshlrev_b32 v234, 16, v116
    v_mfma_f32_32x32x16_bf16 a[80:95], v[172:175], v[204:207], a[80:95]
    ds_read_b128 v[196:199], v177 offset:13888
    v_and_b32 v235, 0xffff0000, v116
    v_fma_f32 v234, v234, v227, v231
    v_fma_f32 v235, v235, v227, v231
    v_cvt_pk_bf16_f32 v116, v234, v235
    v_mfma_f32_32x32x16_bf16 a[96:111], v[172:175], v[208:211], a[96:111]
    v_lshlrev_b32 v234, 16, v117
    v_and_b32 v235, 0xffff0000, v117
    v_fma_f32 v234, v234, v227, v231
    v_mfma_f32_32x32x16_bf16 a[112:127], v[172:175], v[212:215], a[112:127]
    buffer_load_dwordx4 v[172:175], v124, s[16:19], s30 offen offset:3072
    v_fma_f32 v235, v235, v227, v231
    v_cvt_pk_bf16_f32 v117, v234, v235
    v_lshlrev_b32 v234, 16, v118
    v_and_b32 v235, 0xffff0000, v118
    s_waitcnt vmcnt(11) lgkmcnt(4)
    v_mfma_f32_32x32x16_bf16 a[0:15], v[128:131], v[184:187], a[0:15]
    v_fma_f32 v234, v234, v227, v231
    v_fma_f32 v235, v235, v227, v231
    v_cvt_pk_bf16_f32 v118, v234, v235
    v_lshlrev_b32 v234, 16, v119
    s_waitcnt lgkmcnt(3)
    v_mfma_f32_32x32x16_bf16 a[16:31], v[128:131], v[188:191], a[16:31]
    ds_read_b128 v[200:203], v177 offset:96
    v_and_b32 v235, 0xffff0000, v119
    v_fma_f32 v234, v234, v227, v231
    v_fma_f32 v235, v235, v227, v231
    s_waitcnt lgkmcnt(2)
    v_mfma_f32_32x32x16_bf16 a[32:47], v[128:131], v[192:195], a[32:47]
    ds_read_b128 v[204:207], v177 offset:4704
    v_cvt_pk_bf16_f32 v119, v234, v235
    ds_write_b128 v8, v[116:119] offset:9216
    s_waitcnt lgkmcnt(3)
    v_mfma_f32_32x32x16_bf16 a[48:63], v[128:131], v[196:199], a[48:63]
    s_mov_b32 s30, 24576
    buffer_load_dwordx4 v[128:131], v124, s[12:15], s30 offen offset:0
    v_lshlrev_b32 v234, 16, v120
    v_and_b32 v235, 0xffff0000, v120
    v_fma_f32 v234, v234, v228, v232
    s_waitcnt vmcnt(11)
    v_mfma_f32_32x32x16_bf16 a[64:79], v[132:135], v[184:187], a[64:79]
    ds_read_b128 v[208:211], v177 offset:9312
    v_fma_f32 v235, v235, v228, v232
    v_cvt_pk_bf16_f32 v120, v234, v235
    v_lshlrev_b32 v234, 16, v121
    v_and_b32 v235, 0xffff0000, v121
    v_mfma_f32_32x32x16_bf16 a[80:95], v[132:135], v[188:191], a[80:95]
    ds_read_b128 v[212:215], v177 offset:13920
    v_fma_f32 v234, v234, v228, v232
    v_fma_f32 v235, v235, v228, v232
    v_cvt_pk_bf16_f32 v121, v234, v235
    v_lshlrev_b32 v234, 16, v122
    v_mfma_f32_32x32x16_bf16 a[96:111], v[132:135], v[192:195], a[96:111]
    v_and_b32 v235, 0xffff0000, v122
    v_fma_f32 v234, v234, v228, v232
    v_fma_f32 v235, v235, v228, v232
    v_mfma_f32_32x32x16_bf16 a[112:127], v[132:135], v[196:199], a[112:127]
    buffer_load_dwordx4 v[132:135], v124, s[16:19], s30 offen offset:0
    v_cvt_pk_bf16_f32 v122, v234, v235
    v_lshlrev_b32 v234, 16, v123
    v_and_b32 v235, 0xffff0000, v123
    v_fma_f32 v234, v234, v228, v232
    s_waitcnt vmcnt(11) lgkmcnt(4)
    v_mfma_f32_32x32x16_bf16 a[0:15], v[136:139], v[200:203], a[0:15]
    v_fma_f32 v235, v235, v228, v232
    v_cvt_pk_bf16_f32 v123, v234, v235
    ds_write_b128 v8, v[120:123] offset:13824
    s_waitcnt lgkmcnt(4)
    v_mfma_f32_32x32x16_bf16 a[16:31], v[136:139], v[204:207], a[16:31]
    ds_read_b128 v[184:187], v178 offset:0
    s_waitcnt lgkmcnt(3)
    v_mfma_f32_32x32x16_bf16 a[32:47], v[136:139], v[208:211], a[32:47]
    ds_read_b128 v[188:191], v178 offset:4608
    s_waitcnt lgkmcnt(3)
    v_mfma_f32_32x32x16_bf16 a[48:63], v[136:139], v[212:215], a[48:63]
    buffer_load_dwordx4 v[136:139], v124, s[12:15], s30 offen offset:1024
    s_waitcnt vmcnt(11)
    v_mfma_f32_32x32x16_bf16 a[64:79], v[140:143], v[200:203], a[64:79]
    ds_read_b128 v[192:195], v178 offset:9216
    v_mfma_f32_32x32x16_bf16 a[80:95], v[140:143], v[204:207], a[80:95]
    ds_read_b128 v[196:199], v178 offset:13824
    v_mfma_f32_32x32x16_bf16 a[96:111], v[140:143], v[208:211], a[96:111]
    v_mfma_f32_32x32x16_bf16 a[112:127], v[140:143], v[212:215], a[112:127]
    buffer_load_dwordx4 v[140:143], v124, s[16:19], s30 offen offset:1024
    s_waitcnt lgkmcnt(4)
    s_barrier
    s_waitcnt vmcnt(11) lgkmcnt(3)
    v_mfma_f32_32x32x16_bf16 a[0:15], v[144:147], v[184:187], a[0:15]
    s_waitcnt lgkmcnt(2)
    v_mfma_f32_32x32x16_bf16 a[16:31], v[144:147], v[188:191], a[16:31]
    ds_read_b128 v[200:203], v178 offset:32
    s_waitcnt lgkmcnt(2)
    v_mfma_f32_32x32x16_bf16 a[32:47], v[144:147], v[192:195], a[32:47]
    ds_read_b128 v[204:207], v178 offset:4640
    s_waitcnt lgkmcnt(2)
    v_mfma_f32_32x32x16_bf16 a[48:63], v[144:147], v[196:199], a[48:63]
    buffer_load_dwordx4 v[144:147], v124, s[12:15], s30 offen offset:2048
    s_waitcnt vmcnt(11)
    v_mfma_f32_32x32x16_bf16 a[64:79], v[148:151], v[184:187], a[64:79]
    ds_read_b128 v[208:211], v178 offset:9248
    v_mfma_f32_32x32x16_bf16 a[80:95], v[148:151], v[188:191], a[80:95]
    ds_read_b128 v[212:215], v178 offset:13856
    v_mfma_f32_32x32x16_bf16 a[96:111], v[148:151], v[192:195], a[96:111]
    v_mfma_f32_32x32x16_bf16 a[112:127], v[148:151], v[196:199], a[112:127]
    buffer_load_dwordx4 v[148:151], v124, s[16:19], s30 offen offset:2048
    s_waitcnt vmcnt(11) lgkmcnt(3)
    v_mfma_f32_32x32x16_bf16 a[0:15], v[152:155], v[200:203], a[0:15]
    s_waitcnt lgkmcnt(2)
    v_mfma_f32_32x32x16_bf16 a[16:31], v[152:155], v[204:207], a[16:31]
    ds_read_b128 v[184:187], v178 offset:64
    s_waitcnt lgkmcnt(2)
    v_mfma_f32_32x32x16_bf16 a[32:47], v[152:155], v[208:211], a[32:47]
    ds_read_b128 v[188:191], v178 offset:4672
    s_waitcnt lgkmcnt(2)
    v_mfma_f32_32x32x16_bf16 a[48:63], v[152:155], v[212:215], a[48:63]
    buffer_load_dwordx4 v[152:155], v124, s[12:15], s30 offen offset:3072
    s_waitcnt vmcnt(11)
    v_mfma_f32_32x32x16_bf16 a[64:79], v[156:159], v[200:203], a[64:79]
    ds_read_b128 v[192:195], v178 offset:9280
    v_mfma_f32_32x32x16_bf16 a[80:95], v[156:159], v[204:207], a[80:95]
    ds_read_b128 v[196:199], v178 offset:13888
    v_mfma_f32_32x32x16_bf16 a[96:111], v[156:159], v[208:211], a[96:111]
    v_mfma_f32_32x32x16_bf16 a[112:127], v[156:159], v[212:215], a[112:127]
    buffer_load_dwordx4 v[156:159], v124, s[16:19], s30 offen offset:3072
    s_waitcnt vmcnt(11) lgkmcnt(3)
    v_mfma_f32_32x32x16_bf16 a[0:15], v[160:163], v[184:187], a[0:15]
    s_waitcnt lgkmcnt(2)
    v_mfma_f32_32x32x16_bf16 a[16:31], v[160:163], v[188:191], a[16:31]
    ds_read_b128 v[200:203], v178 offset:96
    s_waitcnt lgkmcnt(2)
    v_mfma_f32_32x32x16_bf16 a[32:47], v[160:163], v[192:195], a[32:47]
    ds_read_b128 v[204:207], v178 offset:4704
    s_waitcnt lgkmcnt(2)
    v_mfma_f32_32x32x16_bf16 a[48:63], v[160:163], v[196:199], a[48:63]
    s_waitcnt vmcnt(10)
    v_mfma_f32_32x32x16_bf16 a[64:79], v[164:167], v[184:187], a[64:79]
    ds_read_b128 v[208:211], v178 offset:9312
    v_mfma_f32_32x32x16_bf16 a[80:95], v[164:167], v[188:191], a[80:95]
    ds_read_b128 v[212:215], v178 offset:13920
    v_mfma_f32_32x32x16_bf16 a[96:111], v[164:167], v[192:195], a[96:111]
    v_mfma_f32_32x32x16_bf16 a[112:127], v[164:167], v[196:199], a[112:127]
    s_waitcnt vmcnt(9) lgkmcnt(3)
    v_mfma_f32_32x32x16_bf16 a[0:15], v[168:171], v[200:203], a[0:15]
    s_waitcnt lgkmcnt(2)
    v_mfma_f32_32x32x16_bf16 a[16:31], v[168:171], v[204:207], a[16:31]
    ds_read_b128 v[184:187], v176 offset:0
    s_waitcnt lgkmcnt(2)
    v_mfma_f32_32x32x16_bf16 a[32:47], v[168:171], v[208:211], a[32:47]
    ds_read_b128 v[188:191], v176 offset:4608
    s_waitcnt lgkmcnt(2)
    v_mfma_f32_32x32x16_bf16 a[48:63], v[168:171], v[212:215], a[48:63]
    s_waitcnt vmcnt(8)
    v_mfma_f32_32x32x16_bf16 a[64:79], v[172:175], v[200:203], a[64:79]
    ds_read_b128 v[192:195], v176 offset:9216
    v_mfma_f32_32x32x16_bf16 a[80:95], v[172:175], v[204:207], a[80:95]
    ds_read_b128 v[196:199], v176 offset:13824
    v_mfma_f32_32x32x16_bf16 a[96:111], v[172:175], v[208:211], a[96:111]
    v_mfma_f32_32x32x16_bf16 a[112:127], v[172:175], v[212:215], a[112:127]
    s_waitcnt vmcnt(7) lgkmcnt(3)
    v_mfma_f32_32x32x16_bf16 a[0:15], v[128:131], v[184:187], a[0:15]
    s_waitcnt lgkmcnt(2)
    v_mfma_f32_32x32x16_bf16 a[16:31], v[128:131], v[188:191], a[16:31]
    ds_read_b128 v[200:203], v176 offset:32
    s_waitcnt lgkmcnt(2)
    v_mfma_f32_32x32x16_bf16 a[32:47], v[128:131], v[192:195], a[32:47]
    ds_read_b128 v[204:207], v176 offset:4640
    s_waitcnt lgkmcnt(2)
    v_mfma_f32_32x32x16_bf16 a[48:63], v[128:131], v[196:199], a[48:63]
    s_waitcnt vmcnt(6)
    v_mfma_f32_32x32x16_bf16 a[64:79], v[132:135], v[184:187], a[64:79]
    ds_read_b128 v[208:211], v176 offset:9248
    v_mfma_f32_32x32x16_bf16 a[80:95], v[132:135], v[188:191], a[80:95]
    ds_read_b128 v[212:215], v176 offset:13856
    v_mfma_f32_32x32x16_bf16 a[96:111], v[132:135], v[192:195], a[96:111]
    v_mfma_f32_32x32x16_bf16 a[112:127], v[132:135], v[196:199], a[112:127]
    s_waitcnt vmcnt(5) lgkmcnt(3)
    v_mfma_f32_32x32x16_bf16 a[0:15], v[136:139], v[200:203], a[0:15]
    s_waitcnt lgkmcnt(2)
    v_mfma_f32_32x32x16_bf16 a[16:31], v[136:139], v[204:207], a[16:31]
    ds_read_b128 v[184:187], v176 offset:64
    s_waitcnt lgkmcnt(2)
    v_mfma_f32_32x32x16_bf16 a[32:47], v[136:139], v[208:211], a[32:47]
    ds_read_b128 v[188:191], v176 offset:4672
    s_waitcnt lgkmcnt(2)
    v_mfma_f32_32x32x16_bf16 a[48:63], v[136:139], v[212:215], a[48:63]
    s_waitcnt vmcnt(4)
    v_mfma_f32_32x32x16_bf16 a[64:79], v[140:143], v[200:203], a[64:79]
    ds_read_b128 v[192:195], v176 offset:9280
    v_mfma_f32_32x32x16_bf16 a[80:95], v[140:143], v[204:207], a[80:95]
    ds_read_b128 v[196:199], v176 offset:13888
    v_mfma_f32_32x32x16_bf16 a[96:111], v[140:143], v[208:211], a[96:111]
    v_mfma_f32_32x32x16_bf16 a[112:127], v[140:143], v[212:215], a[112:127]
    s_waitcnt vmcnt(3) lgkmcnt(3)
    v_mfma_f32_32x32x16_bf16 a[0:15], v[144:147], v[184:187], a[0:15]
    s_waitcnt lgkmcnt(2)
    v_mfma_f32_32x32x16_bf16 a[16:31], v[144:147], v[188:191], a[16:31]
    ds_read_b128 v[200:203], v176 offset:96
    s_waitcnt lgkmcnt(2)
    v_mfma_f32_32x32x16_bf16 a[32:47], v[144:147], v[192:195], a[32:47]
    ds_read_b128 v[204:207], v176 offset:4704
    s_waitcnt lgkmcnt(2)
    v_mfma_f32_32x32x16_bf16 a[48:63], v[144:147], v[196:199], a[48:63]
    s_waitcnt vmcnt(2)
    v_mfma_f32_32x32x16_bf16 a[64:79], v[148:151], v[184:187], a[64:79]
    ds_read_b128 v[208:211], v176 offset:9312
    v_mfma_f32_32x32x16_bf16 a[80:95], v[148:151], v[188:191], a[80:95]
    ds_read_b128 v[212:215], v176 offset:13920
    v_mfma_f32_32x32x16_bf16 a[96:111], v[148:151], v[192:195], a[96:111]
    v_mfma_f32_32x32x16_bf16 a[112:127], v[148:151], v[196:199], a[112:127]
    s_waitcnt vmcnt(1) lgkmcnt(3)
    v_mfma_f32_32x32x16_bf16 a[0:15], v[152:155], v[200:203], a[0:15]
    s_waitcnt lgkmcnt(2)
    v_mfma_f32_32x32x16_bf16 a[16:31], v[152:155], v[204:207], a[16:31]
    s_waitcnt lgkmcnt(1)
    v_mfma_f32_32x32x16_bf16 a[32:47], v[152:155], v[208:211], a[32:47]
    s_waitcnt lgkmcnt(0)
    v_mfma_f32_32x32x16_bf16 a[48:63], v[152:155], v[212:215], a[48:63]
    s_waitcnt vmcnt(0)
    v_mfma_f32_32x32x16_bf16 a[64:79], v[156:159], v[200:203], a[64:79]
    v_mfma_f32_32x32x16_bf16 a[80:95], v[156:159], v[204:207], a[80:95]
    v_mfma_f32_32x32x16_bf16 a[96:111], v[156:159], v[208:211], a[96:111]
    v_mfma_f32_32x32x16_bf16 a[112:127], v[156:159], v[212:215], a[112:127]
    s_mul_i32 s31, s28, 128
    s_mul_i32 s32, s29, 128
    v_and_b32 v5, 31, v1
    v_lshrrev_b32 v6, 5, v1
    v_lshlrev_b32 v6, 2, v6
    v_lshlrev_b32 v4, 5, v2
    v_add_u32 v12, s31, v5
    v_add3_u32 v13, v4, v6, s32
    s_add_u32 s20, s58, 0xc00000
    s_addc_u32 s21, s59, 0
    s_and_b32 s21, s21, 0xffff
    s_mov_b32 s22, 0x700000
    s_mov_b32 s23, 0x00020000
    v_mul_u32_u24 v14, 3584, v12
    v_lshl_add_u32 v14, v13, 1, v14
    v_add_u32 v15, 114688, v14
    v_add_u32 v16, 229376, v14
    v_add_u32 v17, 344064, v14
    v_mov_b32 v18, 0xbfb8aa3b
    v_mov_b32 v19, 0xbfb8aa3b
    v_mov_b32 v20, 1.0
    v_mov_b32 v21, 1.0
    v_lshrrev_b32 v3, 5, v1
    v_lshlrev_b32 v3, 3, v3
    v_add_u32 v14, v14, v3
    v_add_u32 v15, v15, v3
    v_add_u32 v16, v16, v3
    v_add_u32 v17, v17, v3
    v_accvgpr_read_b32 v22, a0
    v_accvgpr_read_b32 v23, a1
    v_accvgpr_read_b32 v24, a2
    v_accvgpr_read_b32 v25, a3
    v_accvgpr_read_b32 v26, a64
    v_accvgpr_read_b32 v27, a65
    v_accvgpr_read_b32 v28, a66
    v_accvgpr_read_b32 v29, a67
    v_pk_mul_f32 v[30:31], v[22:23], v[18:19]
    v_pk_mul_f32 v[32:33], v[24:25], v[18:19]
    v_exp_f32 v30, v30
    v_exp_f32 v31, v31
    v_exp_f32 v32, v32
    v_exp_f32 v33, v33
    v_pk_add_f32 v[30:31], v[30:31], v[20:21]
    v_pk_add_f32 v[32:33], v[32:33], v[20:21]
    v_pk_mul_f32 v[26:27], v[22:23], v[26:27]
    v_pk_mul_f32 v[28:29], v[24:25], v[28:29]
    v_rcp_f32 v30, v30
    v_rcp_f32 v31, v31
    v_rcp_f32 v32, v32
    v_rcp_f32 v33, v33
    v_pk_mul_f32 v[26:27], v[26:27], v[30:31]
    v_pk_mul_f32 v[28:29], v[28:29], v[32:33]
    v_cvt_pk_bf16_f32 v48, v26, v27
    v_cvt_pk_bf16_f32 v49, v28, v29
    v_accvgpr_read_b32 v34, a4
    v_accvgpr_read_b32 v35, a5
    v_accvgpr_read_b32 v36, a6
    v_accvgpr_read_b32 v37, a7
    v_accvgpr_read_b32 v38, a68
    v_accvgpr_read_b32 v39, a69
    v_accvgpr_read_b32 v40, a70
    v_accvgpr_read_b32 v41, a71
    v_pk_mul_f32 v[42:43], v[34:35], v[18:19]
    v_pk_mul_f32 v[44:45], v[36:37], v[18:19]
    v_exp_f32 v42, v42
    v_exp_f32 v43, v43
    v_exp_f32 v44, v44
    v_exp_f32 v45, v45
    v_pk_add_f32 v[42:43], v[42:43], v[20:21]
    v_pk_add_f32 v[44:45], v[44:45], v[20:21]
    v_pk_mul_f32 v[38:39], v[34:35], v[38:39]
    v_pk_mul_f32 v[40:41], v[36:37], v[40:41]
    v_rcp_f32 v42, v42
    v_rcp_f32 v43, v43
    v_rcp_f32 v44, v44
    v_rcp_f32 v45, v45
    v_pk_mul_f32 v[38:39], v[38:39], v[42:43]
    v_pk_mul_f32 v[40:41], v[40:41], v[44:45]
    v_cvt_pk_bf16_f32 v50, v38, v39
    v_cvt_pk_bf16_f32 v51, v40, v41
    s_nop 0
    v_permlane32_swap_b32 v48, v50
    v_permlane32_swap_b32 v49, v51
    buffer_store_dwordx4 v[48:51], v14, s[20:23], 0 offen offset:0
    v_accvgpr_read_b32 v22, a8
    v_accvgpr_read_b32 v23, a9
    v_accvgpr_read_b32 v24, a10
    v_accvgpr_read_b32 v25, a11
    v_accvgpr_read_b32 v26, a72
    v_accvgpr_read_b32 v27, a73
    v_accvgpr_read_b32 v28, a74
    v_accvgpr_read_b32 v29, a75
    v_pk_mul_f32 v[30:31], v[22:23], v[18:19]
    v_pk_mul_f32 v[32:33], v[24:25], v[18:19]
    v_exp_f32 v30, v30
    v_exp_f32 v31, v31
    v_exp_f32 v32, v32
    v_exp_f32 v33, v33
    v_pk_add_f32 v[30:31], v[30:31], v[20:21]
    v_pk_add_f32 v[32:33], v[32:33], v[20:21]
    v_pk_mul_f32 v[26:27], v[22:23], v[26:27]
    v_pk_mul_f32 v[28:29], v[24:25], v[28:29]
    v_rcp_f32 v30, v30
    v_rcp_f32 v31, v31
    v_rcp_f32 v32, v32
    v_rcp_f32 v33, v33
    v_pk_mul_f32 v[26:27], v[26:27], v[30:31]
    v_pk_mul_f32 v[28:29], v[28:29], v[32:33]
    v_cvt_pk_bf16_f32 v52, v26, v27
    v_cvt_pk_bf16_f32 v53, v28, v29
    v_accvgpr_read_b32 v34, a12
    v_accvgpr_read_b32 v35, a13
    v_accvgpr_read_b32 v36, a14
    v_accvgpr_read_b32 v37, a15
    v_accvgpr_read_b32 v38, a76
    v_accvgpr_read_b32 v39, a77
    v_accvgpr_read_b32 v40, a78
    v_accvgpr_read_b32 v41, a79
    v_pk_mul_f32 v[42:43], v[34:35], v[18:19]
    v_pk_mul_f32 v[44:45], v[36:37], v[18:19]
    v_exp_f32 v42, v42
    v_exp_f32 v43, v43
    v_exp_f32 v44, v44
    v_exp_f32 v45, v45
    v_pk_add_f32 v[42:43], v[42:43], v[20:21]
    v_pk_add_f32 v[44:45], v[44:45], v[20:21]
    v_pk_mul_f32 v[38:39], v[34:35], v[38:39]
    v_pk_mul_f32 v[40:41], v[36:37], v[40:41]
    v_rcp_f32 v42, v42
    v_rcp_f32 v43, v43
    v_rcp_f32 v44, v44
    v_rcp_f32 v45, v45
    v_pk_mul_f32 v[38:39], v[38:39], v[42:43]
    v_pk_mul_f32 v[40:41], v[40:41], v[44:45]
    v_cvt_pk_bf16_f32 v54, v38, v39
    v_cvt_pk_bf16_f32 v55, v40, v41
    s_nop 0
    v_permlane32_swap_b32 v52, v54
    v_permlane32_swap_b32 v53, v55
    buffer_store_dwordx4 v[52:55], v14, s[20:23], 0 offen offset:32
    v_accvgpr_read_b32 v22, a16
    v_accvgpr_read_b32 v23, a17
    v_accvgpr_read_b32 v24, a18
    v_accvgpr_read_b32 v25, a19
    v_accvgpr_read_b32 v26, a80
    v_accvgpr_read_b32 v27, a81
    v_accvgpr_read_b32 v28, a82
    v_accvgpr_read_b32 v29, a83
    v_pk_mul_f32 v[30:31], v[22:23], v[18:19]
    v_pk_mul_f32 v[32:33], v[24:25], v[18:19]
    v_exp_f32 v30, v30
    v_exp_f32 v31, v31
    v_exp_f32 v32, v32
    v_exp_f32 v33, v33
    v_pk_add_f32 v[30:31], v[30:31], v[20:21]
    v_pk_add_f32 v[32:33], v[32:33], v[20:21]
    v_pk_mul_f32 v[26:27], v[22:23], v[26:27]
    v_pk_mul_f32 v[28:29], v[24:25], v[28:29]
    v_rcp_f32 v30, v30
    v_rcp_f32 v31, v31
    v_rcp_f32 v32, v32
    v_rcp_f32 v33, v33
    v_pk_mul_f32 v[26:27], v[26:27], v[30:31]
    v_pk_mul_f32 v[28:29], v[28:29], v[32:33]
    v_cvt_pk_bf16_f32 v48, v26, v27
    v_cvt_pk_bf16_f32 v49, v28, v29
    v_accvgpr_read_b32 v34, a20
    v_accvgpr_read_b32 v35, a21
    v_accvgpr_read_b32 v36, a22
    v_accvgpr_read_b32 v37, a23
    v_accvgpr_read_b32 v38, a84
    v_accvgpr_read_b32 v39, a85
    v_accvgpr_read_b32 v40, a86
    v_accvgpr_read_b32 v41, a87
    v_pk_mul_f32 v[42:43], v[34:35], v[18:19]
    v_pk_mul_f32 v[44:45], v[36:37], v[18:19]
    v_exp_f32 v42, v42
    v_exp_f32 v43, v43
    v_exp_f32 v44, v44
    v_exp_f32 v45, v45
    v_pk_add_f32 v[42:43], v[42:43], v[20:21]
    v_pk_add_f32 v[44:45], v[44:45], v[20:21]
    v_pk_mul_f32 v[38:39], v[34:35], v[38:39]
    v_pk_mul_f32 v[40:41], v[36:37], v[40:41]
    v_rcp_f32 v42, v42
    v_rcp_f32 v43, v43
    v_rcp_f32 v44, v44
    v_rcp_f32 v45, v45
    v_pk_mul_f32 v[38:39], v[38:39], v[42:43]
    v_pk_mul_f32 v[40:41], v[40:41], v[44:45]
    v_cvt_pk_bf16_f32 v50, v38, v39
    v_cvt_pk_bf16_f32 v51, v40, v41
    s_nop 0
    v_permlane32_swap_b32 v48, v50
    v_permlane32_swap_b32 v49, v51
    buffer_store_dwordx4 v[48:51], v15, s[20:23], 0 offen offset:0
    v_accvgpr_read_b32 v22, a24
    v_accvgpr_read_b32 v23, a25
    v_accvgpr_read_b32 v24, a26
    v_accvgpr_read_b32 v25, a27
    v_accvgpr_read_b32 v26, a88
    v_accvgpr_read_b32 v27, a89
    v_accvgpr_read_b32 v28, a90
    v_accvgpr_read_b32 v29, a91
    v_pk_mul_f32 v[30:31], v[22:23], v[18:19]
    v_pk_mul_f32 v[32:33], v[24:25], v[18:19]
    v_exp_f32 v30, v30
    v_exp_f32 v31, v31
    v_exp_f32 v32, v32
    v_exp_f32 v33, v33
    v_pk_add_f32 v[30:31], v[30:31], v[20:21]
    v_pk_add_f32 v[32:33], v[32:33], v[20:21]
    v_pk_mul_f32 v[26:27], v[22:23], v[26:27]
    v_pk_mul_f32 v[28:29], v[24:25], v[28:29]
    v_rcp_f32 v30, v30
    v_rcp_f32 v31, v31
    v_rcp_f32 v32, v32
    v_rcp_f32 v33, v33
    v_pk_mul_f32 v[26:27], v[26:27], v[30:31]
    v_pk_mul_f32 v[28:29], v[28:29], v[32:33]
    v_cvt_pk_bf16_f32 v52, v26, v27
    v_cvt_pk_bf16_f32 v53, v28, v29
    v_accvgpr_read_b32 v34, a28
    v_accvgpr_read_b32 v35, a29
    v_accvgpr_read_b32 v36, a30
    v_accvgpr_read_b32 v37, a31
    v_accvgpr_read_b32 v38, a92
    v_accvgpr_read_b32 v39, a93
    v_accvgpr_read_b32 v40, a94
    v_accvgpr_read_b32 v41, a95
    v_pk_mul_f32 v[42:43], v[34:35], v[18:19]
    v_pk_mul_f32 v[44:45], v[36:37], v[18:19]
    v_exp_f32 v42, v42
    v_exp_f32 v43, v43
    v_exp_f32 v44, v44
    v_exp_f32 v45, v45
    v_pk_add_f32 v[42:43], v[42:43], v[20:21]
    v_pk_add_f32 v[44:45], v[44:45], v[20:21]
    v_pk_mul_f32 v[38:39], v[34:35], v[38:39]
    v_pk_mul_f32 v[40:41], v[36:37], v[40:41]
    v_rcp_f32 v42, v42
    v_rcp_f32 v43, v43
    v_rcp_f32 v44, v44
    v_rcp_f32 v45, v45
    v_pk_mul_f32 v[38:39], v[38:39], v[42:43]
    v_pk_mul_f32 v[40:41], v[40:41], v[44:45]
    v_cvt_pk_bf16_f32 v54, v38, v39
    v_cvt_pk_bf16_f32 v55, v40, v41
    s_nop 0
    v_permlane32_swap_b32 v52, v54
    v_permlane32_swap_b32 v53, v55
    buffer_store_dwordx4 v[52:55], v15, s[20:23], 0 offen offset:32
    v_accvgpr_read_b32 v22, a32
    v_accvgpr_read_b32 v23, a33
    v_accvgpr_read_b32 v24, a34
    v_accvgpr_read_b32 v25, a35
    v_accvgpr_read_b32 v26, a96
    v_accvgpr_read_b32 v27, a97
    v_accvgpr_read_b32 v28, a98
    v_accvgpr_read_b32 v29, a99
    v_pk_mul_f32 v[30:31], v[22:23], v[18:19]
    v_pk_mul_f32 v[32:33], v[24:25], v[18:19]
    v_exp_f32 v30, v30
    v_exp_f32 v31, v31
    v_exp_f32 v32, v32
    v_exp_f32 v33, v33
    v_pk_add_f32 v[30:31], v[30:31], v[20:21]
    v_pk_add_f32 v[32:33], v[32:33], v[20:21]
    v_pk_mul_f32 v[26:27], v[22:23], v[26:27]
    v_pk_mul_f32 v[28:29], v[24:25], v[28:29]
    v_rcp_f32 v30, v30
    v_rcp_f32 v31, v31
    v_rcp_f32 v32, v32
    v_rcp_f32 v33, v33
    v_pk_mul_f32 v[26:27], v[26:27], v[30:31]
    v_pk_mul_f32 v[28:29], v[28:29], v[32:33]
    v_cvt_pk_bf16_f32 v48, v26, v27
    v_cvt_pk_bf16_f32 v49, v28, v29
    v_accvgpr_read_b32 v34, a36
    v_accvgpr_read_b32 v35, a37
    v_accvgpr_read_b32 v36, a38
    v_accvgpr_read_b32 v37, a39
    v_accvgpr_read_b32 v38, a100
    v_accvgpr_read_b32 v39, a101
    v_accvgpr_read_b32 v40, a102
    v_accvgpr_read_b32 v41, a103
    v_pk_mul_f32 v[42:43], v[34:35], v[18:19]
    v_pk_mul_f32 v[44:45], v[36:37], v[18:19]
    v_exp_f32 v42, v42
    v_exp_f32 v43, v43
    v_exp_f32 v44, v44
    v_exp_f32 v45, v45
    v_pk_add_f32 v[42:43], v[42:43], v[20:21]
    v_pk_add_f32 v[44:45], v[44:45], v[20:21]
    v_pk_mul_f32 v[38:39], v[34:35], v[38:39]
    v_pk_mul_f32 v[40:41], v[36:37], v[40:41]
    v_rcp_f32 v42, v42
    v_rcp_f32 v43, v43
    v_rcp_f32 v44, v44
    v_rcp_f32 v45, v45
    v_pk_mul_f32 v[38:39], v[38:39], v[42:43]
    v_pk_mul_f32 v[40:41], v[40:41], v[44:45]
    v_cvt_pk_bf16_f32 v50, v38, v39
    v_cvt_pk_bf16_f32 v51, v40, v41
    s_nop 0
    v_permlane32_swap_b32 v48, v50
    v_permlane32_swap_b32 v49, v51
    buffer_store_dwordx4 v[48:51], v16, s[20:23], 0 offen offset:0
    v_accvgpr_read_b32 v22, a40
    v_accvgpr_read_b32 v23, a41
    v_accvgpr_read_b32 v24, a42
    v_accvgpr_read_b32 v25, a43
    v_accvgpr_read_b32 v26, a104
    v_accvgpr_read_b32 v27, a105
    v_accvgpr_read_b32 v28, a106
    v_accvgpr_read_b32 v29, a107
    v_pk_mul_f32 v[30:31], v[22:23], v[18:19]
    v_pk_mul_f32 v[32:33], v[24:25], v[18:19]
    v_exp_f32 v30, v30
    v_exp_f32 v31, v31
    v_exp_f32 v32, v32
    v_exp_f32 v33, v33
    v_pk_add_f32 v[30:31], v[30:31], v[20:21]
    v_pk_add_f32 v[32:33], v[32:33], v[20:21]
    v_pk_mul_f32 v[26:27], v[22:23], v[26:27]
    v_pk_mul_f32 v[28:29], v[24:25], v[28:29]
    v_rcp_f32 v30, v30
    v_rcp_f32 v31, v31
    v_rcp_f32 v32, v32
    v_rcp_f32 v33, v33
    v_pk_mul_f32 v[26:27], v[26:27], v[30:31]
    v_pk_mul_f32 v[28:29], v[28:29], v[32:33]
    v_cvt_pk_bf16_f32 v52, v26, v27
    v_cvt_pk_bf16_f32 v53, v28, v29
    v_accvgpr_read_b32 v34, a44
    v_accvgpr_read_b32 v35, a45
    v_accvgpr_read_b32 v36, a46
    v_accvgpr_read_b32 v37, a47
    v_accvgpr_read_b32 v38, a108
    v_accvgpr_read_b32 v39, a109
    v_accvgpr_read_b32 v40, a110
    v_accvgpr_read_b32 v41, a111
    v_pk_mul_f32 v[42:43], v[34:35], v[18:19]
    v_pk_mul_f32 v[44:45], v[36:37], v[18:19]
    v_exp_f32 v42, v42
    v_exp_f32 v43, v43
    v_exp_f32 v44, v44
    v_exp_f32 v45, v45
    v_pk_add_f32 v[42:43], v[42:43], v[20:21]
    v_pk_add_f32 v[44:45], v[44:45], v[20:21]
    v_pk_mul_f32 v[38:39], v[34:35], v[38:39]
    v_pk_mul_f32 v[40:41], v[36:37], v[40:41]
    v_rcp_f32 v42, v42
    v_rcp_f32 v43, v43
    v_rcp_f32 v44, v44
    v_rcp_f32 v45, v45
    v_pk_mul_f32 v[38:39], v[38:39], v[42:43]
    v_pk_mul_f32 v[40:41], v[40:41], v[44:45]
    v_cvt_pk_bf16_f32 v54, v38, v39
    v_cvt_pk_bf16_f32 v55, v40, v41
    s_nop 0
    v_permlane32_swap_b32 v52, v54
    v_permlane32_swap_b32 v53, v55
    buffer_store_dwordx4 v[52:55], v16, s[20:23], 0 offen offset:32
    v_accvgpr_read_b32 v22, a48
    v_accvgpr_read_b32 v23, a49
    v_accvgpr_read_b32 v24, a50
    v_accvgpr_read_b32 v25, a51
    v_accvgpr_read_b32 v26, a112
    v_accvgpr_read_b32 v27, a113
    v_accvgpr_read_b32 v28, a114
    v_accvgpr_read_b32 v29, a115
    v_pk_mul_f32 v[30:31], v[22:23], v[18:19]
    v_pk_mul_f32 v[32:33], v[24:25], v[18:19]
    v_exp_f32 v30, v30
    v_exp_f32 v31, v31
    v_exp_f32 v32, v32
    v_exp_f32 v33, v33
    v_pk_add_f32 v[30:31], v[30:31], v[20:21]
    v_pk_add_f32 v[32:33], v[32:33], v[20:21]
    v_pk_mul_f32 v[26:27], v[22:23], v[26:27]
    v_pk_mul_f32 v[28:29], v[24:25], v[28:29]
    v_rcp_f32 v30, v30
    v_rcp_f32 v31, v31
    v_rcp_f32 v32, v32
    v_rcp_f32 v33, v33
    v_pk_mul_f32 v[26:27], v[26:27], v[30:31]
    v_pk_mul_f32 v[28:29], v[28:29], v[32:33]
    v_cvt_pk_bf16_f32 v48, v26, v27
    v_cvt_pk_bf16_f32 v49, v28, v29
    v_accvgpr_read_b32 v34, a52
    v_accvgpr_read_b32 v35, a53
    v_accvgpr_read_b32 v36, a54
    v_accvgpr_read_b32 v37, a55
    v_accvgpr_read_b32 v38, a116
    v_accvgpr_read_b32 v39, a117
    v_accvgpr_read_b32 v40, a118
    v_accvgpr_read_b32 v41, a119
    v_pk_mul_f32 v[42:43], v[34:35], v[18:19]
    v_pk_mul_f32 v[44:45], v[36:37], v[18:19]
    v_exp_f32 v42, v42
    v_exp_f32 v43, v43
    v_exp_f32 v44, v44
    v_exp_f32 v45, v45
    v_pk_add_f32 v[42:43], v[42:43], v[20:21]
    v_pk_add_f32 v[44:45], v[44:45], v[20:21]
    v_pk_mul_f32 v[38:39], v[34:35], v[38:39]
    v_pk_mul_f32 v[40:41], v[36:37], v[40:41]
    v_rcp_f32 v42, v42
    v_rcp_f32 v43, v43
    v_rcp_f32 v44, v44
    v_rcp_f32 v45, v45
    v_pk_mul_f32 v[38:39], v[38:39], v[42:43]
    v_pk_mul_f32 v[40:41], v[40:41], v[44:45]
    v_cvt_pk_bf16_f32 v50, v38, v39
    v_cvt_pk_bf16_f32 v51, v40, v41
    s_nop 0
    v_permlane32_swap_b32 v48, v50
    v_permlane32_swap_b32 v49, v51
    buffer_store_dwordx4 v[48:51], v17, s[20:23], 0 offen offset:0
    v_accvgpr_read_b32 v22, a56
    v_accvgpr_read_b32 v23, a57
    v_accvgpr_read_b32 v24, a58
    v_accvgpr_read_b32 v25, a59
    v_accvgpr_read_b32 v26, a120
    v_accvgpr_read_b32 v27, a121
    v_accvgpr_read_b32 v28, a122
    v_accvgpr_read_b32 v29, a123
    v_pk_mul_f32 v[30:31], v[22:23], v[18:19]
    v_pk_mul_f32 v[32:33], v[24:25], v[18:19]
    v_exp_f32 v30, v30
    v_exp_f32 v31, v31
    v_exp_f32 v32, v32
    v_exp_f32 v33, v33
    v_pk_add_f32 v[30:31], v[30:31], v[20:21]
    v_pk_add_f32 v[32:33], v[32:33], v[20:21]
    v_pk_mul_f32 v[26:27], v[22:23], v[26:27]
    v_pk_mul_f32 v[28:29], v[24:25], v[28:29]
    v_rcp_f32 v30, v30
    v_rcp_f32 v31, v31
    v_rcp_f32 v32, v32
    v_rcp_f32 v33, v33
    v_pk_mul_f32 v[26:27], v[26:27], v[30:31]
    v_pk_mul_f32 v[28:29], v[28:29], v[32:33]
    v_cvt_pk_bf16_f32 v52, v26, v27
    v_cvt_pk_bf16_f32 v53, v28, v29
    v_accvgpr_read_b32 v34, a60
    v_accvgpr_read_b32 v35, a61
    v_accvgpr_read_b32 v36, a62
    v_accvgpr_read_b32 v37, a63
    v_accvgpr_read_b32 v38, a124
    v_accvgpr_read_b32 v39, a125
    v_accvgpr_read_b32 v40, a126
    v_accvgpr_read_b32 v41, a127
    v_pk_mul_f32 v[42:43], v[34:35], v[18:19]
    v_pk_mul_f32 v[44:45], v[36:37], v[18:19]
    v_exp_f32 v42, v42
    v_exp_f32 v43, v43
    v_exp_f32 v44, v44
    v_exp_f32 v45, v45
    v_pk_add_f32 v[42:43], v[42:43], v[20:21]
    v_pk_add_f32 v[44:45], v[44:45], v[20:21]
    v_pk_mul_f32 v[38:39], v[34:35], v[38:39]
    v_pk_mul_f32 v[40:41], v[36:37], v[40:41]
    v_rcp_f32 v42, v42
    v_rcp_f32 v43, v43
    v_rcp_f32 v44, v44
    v_rcp_f32 v45, v45
    v_pk_mul_f32 v[38:39], v[38:39], v[42:43]
    v_pk_mul_f32 v[40:41], v[40:41], v[44:45]
    v_cvt_pk_bf16_f32 v54, v38, v39
    v_cvt_pk_bf16_f32 v55, v40, v41
    s_nop 0
    v_permlane32_swap_b32 v52, v54
    v_permlane32_swap_b32 v53, v55
    buffer_store_dwordx4 v[52:55], v17, s[20:23], 0 offen offset:32
L_end_g4_0_kernel:
    s_endpgm
L_side_g4_0_kernel:
    s_waitcnt lgkmcnt(0)
    s_sub_u32 s3, s2, 224
    s_cmp_ge_u32 s3, 32
    s_cbranch_scc1 L_send_g4_0_kernel
    s_load_dwordx2 s[4:5], s[0:1], 48
    s_waitcnt lgkmcnt(0)
    s_mov_b32 s16, s4
    s_and_b32 s17, s5, 0xffff
    s_mov_b32 s18, 1605632
    s_mov_b32 s19, 0x00020000
    s_mul_i32 s13, s3, 53248
    v_lshlrev_b32 v1, 4, v0
    v_add_u32 v1, s13, v1
    s_mov_b32 s14, 0
    buffer_load_dwordx4 v[4:7], v1, s[16:19], s14 offen
    s_mov_b32 s14, 4096
    buffer_load_dwordx4 v[8:11], v1, s[16:19], s14 offen
    s_mov_b32 s14, 8192
    buffer_load_dwordx4 v[12:15], v1, s[16:19], s14 offen
    s_mov_b32 s14, 12288
    buffer_load_dwordx4 v[16:19], v1, s[16:19], s14 offen
    s_mov_b32 s14, 16384
    buffer_load_dwordx4 v[20:23], v1, s[16:19], s14 offen
    s_mov_b32 s14, 20480
    buffer_load_dwordx4 v[24:27], v1, s[16:19], s14 offen
    s_mov_b32 s14, 24576
    buffer_load_dwordx4 v[28:31], v1, s[16:19], s14 offen
    s_mov_b32 s14, 28672
    buffer_load_dwordx4 v[32:35], v1, s[16:19], s14 offen
    s_mov_b32 s14, 32768
    buffer_load_dwordx4 v[36:39], v1, s[16:19], s14 offen
    s_mov_b32 s14, 36864
    buffer_load_dwordx4 v[40:43], v1, s[16:19], s14 offen
    s_mov_b32 s14, 40960
    buffer_load_dwordx4 v[44:47], v1, s[16:19], s14 offen
    s_mov_b32 s14, 45056
    buffer_load_dwordx4 v[48:51], v1, s[16:19], s14 offen
    s_mov_b32 s14, 49152
    buffer_load_dwordx4 v[52:55], v1, s[16:19], s14 offen
    s_waitcnt vmcnt(0)
L_send_g4_0_kernel:
    s_endpgm
.globl g5_0_kernel
.p2align 8
.type g5_0_kernel,@function
g5_0_kernel:
    s_load_dwordx16 s[32:47], s[0:1], 0
    s_load_dwordx4 s[48:51], s[0:1], 64
    s_cmp_ge_u32 s2, 224
    s_cbranch_scc1 L_end_g5_0_kernel
    s_lshr_b32 s28, s2, 3
    s_and_b32 s29, s2, 7
    s_mul_hi_u32 s24, s28, 0x24924925
    s_mul_i32 s27, s24, 7
    s_sub_u32 s25, s28, s27
    s_and_b32 s27, s29, 7
    s_mul_i32 s27, s27, 4
    s_add_u32 s24, s24, s27
    s_lshr_b32 s27, s29, 3
    s_mul_i32 s27, s27, 7
    s_add_u32 s25, s25, s27
    s_mov_b32 s30, 0
    s_mov_b32 s31, 114688
    v_and_b32 v1, 63, v0
    v_lshrrev_b32 v2, 6, v0
    v_lshrrev_b32 v3, 3, v0
    v_and_b32 v4, 7, v0
    v_lshlrev_b32 v4, 4, v4
    s_mul_i32 s27, s24, 229376
    v_mul_u32_u24 v7, 3584, v3
    v_add3_u32 v7, v7, v4, s27
    v_mul_u32_u24 v8, 144, v3
    v_add_u32 v8, v8, v4
    s_mul_i32 s27, s25, 128
    v_lshrrev_b32 v3, 3, v0
    v_and_b32 v4, 7, v0
    v_lshlrev_b32 v4, 4, v4
    v_mul_u32_u24 v9, 896, v3
    v_add3_u32 v9, v9, v4, s27
    v_mul_u32_u24 v10, 192, v3
    v_add_u32 v10, v10, v4
    v_add_u32 v10, 9216, v10
    v_and_b32 v5, 31, v1
    v_mul_u32_u24 v11, 144, v5
    v_lshrrev_b32 v6, 5, v1
    v_lshlrev_b32 v6, 4, v6
    v_add_u32 v11, v11, v6
    v_lshl_add_u32 v11, v2, 5, v11
    v_lshrrev_b32 v3, 5, v1
    v_lshlrev_b32 v3, 3, v3
    v_bfe_u32 v5, v1, 2, 2
    v_add_u32 v3, v3, v5
    v_lshl_add_u32 v3, v2, 4, v3
    v_mul_u32_u24 v12, 192, v3
    v_bfe_u32 v5, v1, 4, 1
    v_lshlrev_b32 v5, 5, v5
    v_and_b32 v6, 3, v1
    v_lshlrev_b32 v6, 3, v6
    v_add3_u32 v12, v12, v5, v6
    v_add_u32 v12, 9216, v12
    v_add_u32 v13, 21504, v11
    v_add_u32 v14, 43008, v11
    v_add_u32 v15, 21504, v12
    v_add_u32 v16, 43008, v12
    v_add_u32 v17, 21504, v8
    v_add_u32 v18, 43008, v8
    v_add_u32 v19, 21504, v10
    v_add_u32 v20, 43008, v10
    s_waitcnt lgkmcnt(0)
    s_add_u32 s8, s50, 0xc00000
    s_addc_u32 s9, s51, 0
    s_and_b32 s9, s9, 0xffff
    s_mov_b32 s10, 0x700000
    s_mov_b32 s11, 0x00020000
    s_mov_b32 s12, s44
    s_and_b32 s13, s45, 0xffff
    s_mov_b32 s14, 0x188000
    s_mov_b32 s15, 0x00020000
    buffer_load_dwordx4 v[24:27], v7, s[8:11], s30 offen offset:0
    buffer_load_dwordx4 v[28:31], v7, s[8:11], s31 offen offset:0
    buffer_load_dwordx4 v[32:35], v7, s[8:11], s30 offen offset:128
    buffer_load_dwordx4 v[36:39], v7, s[8:11], s31 offen offset:128
    buffer_load_dwordx4 v[40:43], v7, s[8:11], s30 offen offset:256
    buffer_load_dwordx4 v[44:47], v7, s[8:11], s31 offen offset:256
    buffer_load_dwordx4 v[48:51], v7, s[8:11], s30 offen offset:384
    buffer_load_dwordx4 v[52:55], v7, s[8:11], s31 offen offset:384
    s_mov_b32 s26, 0
    buffer_load_dwordx4 v[56:59], v9, s[12:15], s26 offen
    s_mov_b32 s26, 28672
    buffer_load_dwordx4 v[60:63], v9, s[12:15], s26 offen
    s_mov_b32 s26, 57344
    buffer_load_dwordx4 v[64:67], v9, s[12:15], s26 offen
    s_mov_b32 s26, 86016
    buffer_load_dwordx4 v[68:71], v9, s[12:15], s26 offen
    s_mov_b32 s26, 114688
    buffer_load_dwordx4 v[72:75], v9, s[12:15], s26 offen
    s_mov_b32 s26, 143360
    buffer_load_dwordx4 v[76:79], v9, s[12:15], s26 offen
    s_mov_b32 s26, 172032
    buffer_load_dwordx4 v[80:83], v9, s[12:15], s26 offen
    s_mov_b32 s26, 200704
    buffer_load_dwordx4 v[84:87], v9, s[12:15], s26 offen
    s_waitcnt vmcnt(15)
    ds_write_b128 v8, v[24:27] offset:0
    s_waitcnt vmcnt(14)
    ds_write_b128 v8, v[28:31] offset:4608
    s_waitcnt vmcnt(7)
    ds_write_b128 v10, v[56:59] offset:0
    s_waitcnt vmcnt(6)
    ds_write_b128 v10, v[60:63] offset:6144
    buffer_load_dwordx4 v[24:27], v7, s[8:11], s30 offen offset:512
    buffer_load_dwordx4 v[28:31], v7, s[8:11], s31 offen offset:512
    s_mov_b32 s26, 229376
    buffer_load_dwordx4 v[56:59], v9, s[12:15], s26 offen
    s_mov_b32 s26, 258048
    buffer_load_dwordx4 v[60:63], v9, s[12:15], s26 offen
    ds_write_b128 v17, v[32:35] offset:0
    ds_write_b128 v17, v[36:39] offset:4608
    s_waitcnt vmcnt(9)
    ds_write_b128 v19, v[64:67] offset:0
    s_waitcnt vmcnt(8)
    ds_write_b128 v19, v[68:71] offset:6144
    buffer_load_dwordx4 v[32:35], v7, s[8:11], s30 offen offset:640
    buffer_load_dwordx4 v[36:39], v7, s[8:11], s31 offen offset:640
    s_mov_b32 s26, 286720
    buffer_load_dwordx4 v[64:67], v9, s[12:15], s26 offen
    s_mov_b32 s26, 315392
    buffer_load_dwordx4 v[68:71], v9, s[12:15], s26 offen
    s_waitcnt lgkmcnt(0)
    s_barrier
    ds_read_b128 v[88:91], v11 offset:0
    ds_read_b128 v[92:95], v11 offset:4608
    ds_read_b64_tr_b16 v[104:105], v12 offset:0
    ds_read_b64_tr_b16 v[106:107], v12 offset:768
    ds_read_b64_tr_b16 v[108:109], v12 offset:64
    ds_read_b64_tr_b16 v[110:111], v12 offset:832
    s_waitcnt lgkmcnt(2)
    v_mfma_f32_32x32x16_bf16 v[120:135], v[104:107], v[88:91], 0
    ds_read_b128 v[96:99], v13 offset:0
    ds_read_b128 v[100:103], v13 offset:4608
    ds_write_b128 v18, v[40:43] offset:0
    ds_write_b128 v18, v[44:47] offset:4608
    s_waitcnt vmcnt(11)
    ds_write_b128 v20, v[72:75] offset:0
    v_mfma_f32_32x32x16_bf16 v[136:151], v[104:107], v[92:95], 0
    ds_read_b64_tr_b16 v[112:113], v15 offset:0
    ds_read_b64_tr_b16 v[114:115], v15 offset:768
    s_waitcnt vmcnt(10)
    ds_write_b128 v20, v[76:79] offset:6144
    buffer_load_dwordx4 v[40:43], v7, s[8:11], s30 offen offset:768
    s_waitcnt lgkmcnt(8)
    v_mfma_f32_32x32x16_bf16 v[152:167], v[108:111], v[88:91], 0
    ds_read_b64_tr_b16 v[116:117], v15 offset:64
    ds_read_b64_tr_b16 v[118:119], v15 offset:832
    buffer_load_dwordx4 v[44:47], v7, s[8:11], s31 offen offset:768
    s_mov_b32 s26, 344064
    buffer_load_dwordx4 v[72:75], v9, s[12:15], s26 offen
    s_mov_b32 s26, 372736
    buffer_load_dwordx4 v[76:79], v9, s[12:15], s26 offen
    v_mfma_f32_32x32x16_bf16 v[168:183], v[108:111], v[92:95], 0
    s_waitcnt lgkmcnt(2)
    s_barrier
    v_mfma_f32_32x32x16_bf16 v[120:135], v[112:115], v[96:99], v[120:135]
    ds_read_b128 v[88:91], v14 offset:0
    ds_read_b128 v[92:95], v14 offset:4608
    ds_write_b128 v8, v[48:51] offset:0
    ds_write_b128 v8, v[52:55] offset:4608
    s_waitcnt vmcnt(13)
    ds_write_b128 v10, v[80:83] offset:0
    v_mfma_f32_32x32x16_bf16 v[136:151], v[112:115], v[100:103], v[136:151]
    ds_read_b64_tr_b16 v[104:105], v16 offset:0
    ds_read_b64_tr_b16 v[106:107], v16 offset:768
    s_waitcnt vmcnt(12)
    ds_write_b128 v10, v[84:87] offset:6144
    buffer_load_dwordx4 v[48:51], v7, s[8:11], s30 offen offset:896
    s_waitcnt lgkmcnt(8)
    v_mfma_f32_32x32x16_bf16 v[152:167], v[116:119], v[96:99], v[152:167]
    ds_read_b64_tr_b16 v[108:109], v16 offset:64
    ds_read_b64_tr_b16 v[110:111], v16 offset:832
    buffer_load_dwordx4 v[52:55], v7, s[8:11], s31 offen offset:896
    s_mov_b32 s26, 401408
    buffer_load_dwordx4 v[80:83], v9, s[12:15], s26 offen
    s_mov_b32 s26, 430080
    buffer_load_dwordx4 v[84:87], v9, s[12:15], s26 offen
    v_mfma_f32_32x32x16_bf16 v[168:183], v[116:119], v[100:103], v[168:183]
    s_waitcnt lgkmcnt(2)
    s_barrier
    v_mfma_f32_32x32x16_bf16 v[120:135], v[104:107], v[88:91], v[120:135]
    ds_read_b128 v[96:99], v11 offset:0
    ds_read_b128 v[100:103], v11 offset:4608
    s_waitcnt vmcnt(15)
    ds_write_b128 v17, v[24:27] offset:0
    s_waitcnt vmcnt(14)
    ds_write_b128 v17, v[28:31] offset:4608
    s_waitcnt vmcnt(13)
    ds_write_b128 v19, v[56:59] offset:0
    v_mfma_f32_32x32x16_bf16 v[136:151], v[104:107], v[92:95], v[136:151]
    ds_read_b64_tr_b16 v[112:113], v12 offset:0
    ds_read_b64_tr_b16 v[114:115], v12 offset:768
    s_waitcnt vmcnt(12)
    ds_write_b128 v19, v[60:63] offset:6144
    buffer_load_dwordx4 v[24:27], v7, s[8:11], s30 offen offset:1024
    s_waitcnt lgkmcnt(8)
    v_mfma_f32_32x32x16_bf16 v[152:167], v[108:111], v[88:91], v[152:167]
    ds_read_b64_tr_b16 v[116:117], v12 offset:64
    ds_read_b64_tr_b16 v[118:119], v12 offset:832
    buffer_load_dwordx4 v[28:31], v7, s[8:11], s31 offen offset:1024
    s_mov_b32 s26, 458752
    buffer_load_dwordx4 v[56:59], v9, s[12:15], s26 offen
    s_mov_b32 s26, 487424
    buffer_load_dwordx4 v[60:63], v9, s[12:15], s26 offen
    v_mfma_f32_32x32x16_bf16 v[168:183], v[108:111], v[92:95], v[168:183]
    s_waitcnt lgkmcnt(2)
    s_barrier
    v_mfma_f32_32x32x16_bf16 v[120:135], v[112:115], v[96:99], v[120:135]
    ds_read_b128 v[88:91], v13 offset:0
    ds_read_b128 v[92:95], v13 offset:4608
    s_waitcnt vmcnt(15)
    ds_write_b128 v18, v[32:35] offset:0
    s_waitcnt vmcnt(14)
    ds_write_b128 v18, v[36:39] offset:4608
    s_waitcnt vmcnt(13)
    ds_write_b128 v20, v[64:67] offset:0
    v_mfma_f32_32x32x16_bf16 v[136:151], v[112:115], v[100:103], v[136:151]
    ds_read_b64_tr_b16 v[104:105], v15 offset:0
    ds_read_b64_tr_b16 v[106:107], v15 offset:768
    s_waitcnt vmcnt(12)
    ds_write_b128 v20, v[68:71] offset:6144
    buffer_load_dwordx4 v[32:35], v7, s[8:11], s30 offen offset:1152
    s_waitcnt lgkmcnt(8)
    v_mfma_f32_32x32x16_bf16 v[152:167], v[116:119], v[96:99], v[152:167]
    ds_read_b64_tr_b16 v[108:109], v15 offset:64
    ds_read_b64_tr_b16 v[110:111], v15 offset:832
    buffer_load_dwordx4 v[36:39], v7, s[8:11], s31 offen offset:1152
    s_mov_b32 s26, 516096
    buffer_load_dwordx4 v[64:67], v9, s[12:15], s26 offen
    s_mov_b32 s26, 544768
    buffer_load_dwordx4 v[68:71], v9, s[12:15], s26 offen
    v_mfma_f32_32x32x16_bf16 v[168:183], v[116:119], v[100:103], v[168:183]
    s_waitcnt lgkmcnt(2)
    s_barrier
    v_mfma_f32_32x32x16_bf16 v[120:135], v[104:107], v[88:91], v[120:135]
    ds_read_b128 v[96:99], v14 offset:0
    ds_read_b128 v[100:103], v14 offset:4608
    s_waitcnt vmcnt(15)
    ds_write_b128 v8, v[40:43] offset:0
    s_waitcnt vmcnt(14)
    ds_write_b128 v8, v[44:47] offset:4608
    s_waitcnt vmcnt(13)
    ds_write_b128 v10, v[72:75] offset:0
    v_mfma_f32_32x32x16_bf16 v[136:151], v[104:107], v[92:95], v[136:151]
    ds_read_b64_tr_b16 v[112:113], v16 offset:0
    ds_read_b64_tr_b16 v[114:115], v16 offset:768
    s_waitcnt vmcnt(12)
    ds_write_b128 v10, v[76:79] offset:6144
    buffer_load_dwordx4 v[40:43], v7, s[8:11], s30 offen offset:1280
    s_waitcnt lgkmcnt(8)
    v_mfma_f32_32x32x16_bf16 v[152:167], v[108:111], v[88:91], v[152:167]
    ds_read_b64_tr_b16 v[116:117], v16 offset:64
    ds_read_b64_tr_b16 v[118:119], v16 offset:832
    buffer_load_dwordx4 v[44:47], v7, s[8:11], s31 offen offset:1280
    s_mov_b32 s26, 573440
    buffer_load_dwordx4 v[72:75], v9, s[12:15], s26 offen
    s_mov_b32 s26, 602112
    buffer_load_dwordx4 v[76:79], v9, s[12:15], s26 offen
    v_mfma_f32_32x32x16_bf16 v[168:183], v[108:111], v[92:95], v[168:183]
    s_waitcnt lgkmcnt(2)
    s_barrier
    v_mfma_f32_32x32x16_bf16 v[120:135], v[112:115], v[96:99], v[120:135]
    ds_read_b128 v[88:91], v11 offset:0
    ds_read_b128 v[92:95], v11 offset:4608
    s_waitcnt vmcnt(15)
    ds_write_b128 v17, v[48:51] offset:0
    s_waitcnt vmcnt(14)
    ds_write_b128 v17, v[52:55] offset:4608
    s_waitcnt vmcnt(13)
    ds_write_b128 v19, v[80:83] offset:0
    v_mfma_f32_32x32x16_bf16 v[136:151], v[112:115], v[100:103], v[136:151]
    ds_read_b64_tr_b16 v[104:105], v12 offset:0
    ds_read_b64_tr_b16 v[106:107], v12 offset:768
    s_waitcnt vmcnt(12)
    ds_write_b128 v19, v[84:87] offset:6144
    buffer_load_dwordx4 v[48:51], v7, s[8:11], s30 offen offset:1408
    s_waitcnt lgkmcnt(8)
    v_mfma_f32_32x32x16_bf16 v[152:167], v[116:119], v[96:99], v[152:167]
    ds_read_b64_tr_b16 v[108:109], v12 offset:64
    ds_read_b64_tr_b16 v[110:111], v12 offset:832
    buffer_load_dwordx4 v[52:55], v7, s[8:11], s31 offen offset:1408
    s_mov_b32 s26, 630784
    buffer_load_dwordx4 v[80:83], v9, s[12:15], s26 offen
    s_mov_b32 s26, 659456
    buffer_load_dwordx4 v[84:87], v9, s[12:15], s26 offen
    v_mfma_f32_32x32x16_bf16 v[168:183], v[116:119], v[100:103], v[168:183]
    s_waitcnt lgkmcnt(2)
    s_barrier
    v_mfma_f32_32x32x16_bf16 v[120:135], v[104:107], v[88:91], v[120:135]
    ds_read_b128 v[96:99], v13 offset:0
    ds_read_b128 v[100:103], v13 offset:4608
    s_waitcnt vmcnt(15)
    ds_write_b128 v18, v[24:27] offset:0
    s_waitcnt vmcnt(14)
    ds_write_b128 v18, v[28:31] offset:4608
    s_waitcnt vmcnt(13)
    ds_write_b128 v20, v[56:59] offset:0
    v_mfma_f32_32x32x16_bf16 v[136:151], v[104:107], v[92:95], v[136:151]
    ds_read_b64_tr_b16 v[112:113], v15 offset:0
    ds_read_b64_tr_b16 v[114:115], v15 offset:768
    s_waitcnt vmcnt(12)
    ds_write_b128 v20, v[60:63] offset:6144
    buffer_load_dwordx4 v[24:27], v7, s[8:11], s30 offen offset:1536
    s_waitcnt lgkmcnt(8)
    v_mfma_f32_32x32x16_bf16 v[152:167], v[108:111], v[88:91], v[152:167]
    ds_read_b64_tr_b16 v[116:117], v15 offset:64
    ds_read_b64_tr_b16 v[118:119], v15 offset:832
    buffer_load_dwordx4 v[28:31], v7, s[8:11], s31 offen offset:1536
    s_mov_b32 s26, 688128
    buffer_load_dwordx4 v[56:59], v9, s[12:15], s26 offen
    s_mov_b32 s26, 716800
    buffer_load_dwordx4 v[60:63], v9, s[12:15], s26 offen
    v_mfma_f32_32x32x16_bf16 v[168:183], v[108:111], v[92:95], v[168:183]
    s_waitcnt lgkmcnt(2)
    s_barrier
    v_mfma_f32_32x32x16_bf16 v[120:135], v[112:115], v[96:99], v[120:135]
    ds_read_b128 v[88:91], v14 offset:0
    ds_read_b128 v[92:95], v14 offset:4608
    s_waitcnt vmcnt(15)
    ds_write_b128 v8, v[32:35] offset:0
    s_waitcnt vmcnt(14)
    ds_write_b128 v8, v[36:39] offset:4608
    s_waitcnt vmcnt(13)
    ds_write_b128 v10, v[64:67] offset:0
    v_mfma_f32_32x32x16_bf16 v[136:151], v[112:115], v[100:103], v[136:151]
    ds_read_b64_tr_b16 v[104:105], v16 offset:0
    ds_read_b64_tr_b16 v[106:107], v16 offset:768
    s_waitcnt vmcnt(12)
    ds_write_b128 v10, v[68:71] offset:6144
    buffer_load_dwordx4 v[32:35], v7, s[8:11], s30 offen offset:1664
    s_waitcnt lgkmcnt(8)
    v_mfma_f32_32x32x16_bf16 v[152:167], v[116:119], v[96:99], v[152:167]
    ds_read_b64_tr_b16 v[108:109], v16 offset:64
    ds_read_b64_tr_b16 v[110:111], v16 offset:832
    buffer_load_dwordx4 v[36:39], v7, s[8:11], s31 offen offset:1664
    s_mov_b32 s26, 745472
    buffer_load_dwordx4 v[64:67], v9, s[12:15], s26 offen
    s_mov_b32 s26, 774144
    buffer_load_dwordx4 v[68:71], v9, s[12:15], s26 offen
    v_mfma_f32_32x32x16_bf16 v[168:183], v[116:119], v[100:103], v[168:183]
    s_waitcnt lgkmcnt(2)
    s_barrier
    v_mfma_f32_32x32x16_bf16 v[120:135], v[104:107], v[88:91], v[120:135]
    ds_read_b128 v[96:99], v11 offset:0
    ds_read_b128 v[100:103], v11 offset:4608
    s_waitcnt vmcnt(15)
    ds_write_b128 v17, v[40:43] offset:0
    s_waitcnt vmcnt(14)
    ds_write_b128 v17, v[44:47] offset:4608
    s_waitcnt vmcnt(13)
    ds_write_b128 v19, v[72:75] offset:0
    v_mfma_f32_32x32x16_bf16 v[136:151], v[104:107], v[92:95], v[136:151]
    ds_read_b64_tr_b16 v[112:113], v12 offset:0
    ds_read_b64_tr_b16 v[114:115], v12 offset:768
    s_waitcnt vmcnt(12)
    ds_write_b128 v19, v[76:79] offset:6144
    buffer_load_dwordx4 v[40:43], v7, s[8:11], s30 offen offset:1792
    s_waitcnt lgkmcnt(8)
    v_mfma_f32_32x32x16_bf16 v[152:167], v[108:111], v[88:91], v[152:167]
    ds_read_b64_tr_b16 v[116:117], v12 offset:64
    ds_read_b64_tr_b16 v[118:119], v12 offset:832
    buffer_load_dwordx4 v[44:47], v7, s[8:11], s31 offen offset:1792
    s_mov_b32 s26, 802816
    buffer_load_dwordx4 v[72:75], v9, s[12:15], s26 offen
    s_mov_b32 s26, 831488
    buffer_load_dwordx4 v[76:79], v9, s[12:15], s26 offen
    v_mfma_f32_32x32x16_bf16 v[168:183], v[108:111], v[92:95], v[168:183]
    s_waitcnt lgkmcnt(2)
    s_barrier
    v_mfma_f32_32x32x16_bf16 v[120:135], v[112:115], v[96:99], v[120:135]
    ds_read_b128 v[88:91], v13 offset:0
    ds_read_b128 v[92:95], v13 offset:4608
    s_waitcnt vmcnt(15)
    ds_write_b128 v18, v[48:51] offset:0
    s_waitcnt vmcnt(14)
    ds_write_b128 v18, v[52:55] offset:4608
    s_waitcnt vmcnt(13)
    ds_write_b128 v20, v[80:83] offset:0
    v_mfma_f32_32x32x16_bf16 v[136:151], v[112:115], v[100:103], v[136:151]
    ds_read_b64_tr_b16 v[104:105], v15 offset:0
    ds_read_b64_tr_b16 v[106:107], v15 offset:768
    s_waitcnt vmcnt(12)
    ds_write_b128 v20, v[84:87] offset:6144
    buffer_load_dwordx4 v[48:51], v7, s[8:11], s30 offen offset:1920
    s_waitcnt lgkmcnt(8)
    v_mfma_f32_32x32x16_bf16 v[152:167], v[116:119], v[96:99], v[152:167]
    ds_read_b64_tr_b16 v[108:109], v15 offset:64
    ds_read_b64_tr_b16 v[110:111], v15 offset:832
    buffer_load_dwordx4 v[52:55], v7, s[8:11], s31 offen offset:1920
    s_mov_b32 s26, 860160
    buffer_load_dwordx4 v[80:83], v9, s[12:15], s26 offen
    s_mov_b32 s26, 888832
    buffer_load_dwordx4 v[84:87], v9, s[12:15], s26 offen
    v_mfma_f32_32x32x16_bf16 v[168:183], v[116:119], v[100:103], v[168:183]
    s_waitcnt lgkmcnt(2)
    s_barrier
    v_mfma_f32_32x32x16_bf16 v[120:135], v[104:107], v[88:91], v[120:135]
    ds_read_b128 v[96:99], v14 offset:0
    ds_read_b128 v[100:103], v14 offset:4608
    s_waitcnt vmcnt(15)
    ds_write_b128 v8, v[24:27] offset:0
    s_waitcnt vmcnt(14)
    ds_write_b128 v8, v[28:31] offset:4608
    s_waitcnt vmcnt(13)
    ds_write_b128 v10, v[56:59] offset:0
    v_mfma_f32_32x32x16_bf16 v[136:151], v[104:107], v[92:95], v[136:151]
    ds_read_b64_tr_b16 v[112:113], v16 offset:0
    ds_read_b64_tr_b16 v[114:115], v16 offset:768
    s_waitcnt vmcnt(12)
    ds_write_b128 v10, v[60:63] offset:6144
    buffer_load_dwordx4 v[24:27], v7, s[8:11], s30 offen offset:2048
    s_waitcnt lgkmcnt(8)
    v_mfma_f32_32x32x16_bf16 v[152:167], v[108:111], v[88:91], v[152:167]
    ds_read_b64_tr_b16 v[116:117], v16 offset:64
    ds_read_b64_tr_b16 v[118:119], v16 offset:832
    buffer_load_dwordx4 v[28:31], v7, s[8:11], s31 offen offset:2048
    s_mov_b32 s26, 917504
    buffer_load_dwordx4 v[56:59], v9, s[12:15], s26 offen
    s_mov_b32 s26, 946176
    buffer_load_dwordx4 v[60:63], v9, s[12:15], s26 offen
    v_mfma_f32_32x32x16_bf16 v[168:183], v[108:111], v[92:95], v[168:183]
    s_waitcnt lgkmcnt(2)
    s_barrier
    v_mfma_f32_32x32x16_bf16 v[120:135], v[112:115], v[96:99], v[120:135]
    ds_read_b128 v[88:91], v11 offset:0
    ds_read_b128 v[92:95], v11 offset:4608
    s_waitcnt vmcnt(15)
    ds_write_b128 v17, v[32:35] offset:0
    s_waitcnt vmcnt(14)
    ds_write_b128 v17, v[36:39] offset:4608
    s_waitcnt vmcnt(13)
    ds_write_b128 v19, v[64:67] offset:0
    v_mfma_f32_32x32x16_bf16 v[136:151], v[112:115], v[100:103], v[136:151]
    ds_read_b64_tr_b16 v[104:105], v12 offset:0
    ds_read_b64_tr_b16 v[106:107], v12 offset:768
    s_waitcnt vmcnt(12)
    ds_write_b128 v19, v[68:71] offset:6144
    buffer_load_dwordx4 v[32:35], v7, s[8:11], s30 offen offset:2176
    s_waitcnt lgkmcnt(8)
    v_mfma_f32_32x32x16_bf16 v[152:167], v[116:119], v[96:99], v[152:167]
    ds_read_b64_tr_b16 v[108:109], v12 offset:64
    ds_read_b64_tr_b16 v[110:111], v12 offset:832
    buffer_load_dwordx4 v[36:39], v7, s[8:11], s31 offen offset:2176
    s_mov_b32 s26, 974848
    buffer_load_dwordx4 v[64:67], v9, s[12:15], s26 offen
    s_mov_b32 s26, 1003520
    buffer_load_dwordx4 v[68:71], v9, s[12:15], s26 offen
    v_mfma_f32_32x32x16_bf16 v[168:183], v[116:119], v[100:103], v[168:183]
    s_waitcnt lgkmcnt(2)
    s_barrier
    v_mfma_f32_32x32x16_bf16 v[120:135], v[104:107], v[88:91], v[120:135]
    ds_read_b128 v[96:99], v13 offset:0
    ds_read_b128 v[100:103], v13 offset:4608
    s_waitcnt vmcnt(15)
    ds_write_b128 v18, v[40:43] offset:0
    s_waitcnt vmcnt(14)
    ds_write_b128 v18, v[44:47] offset:4608
    s_waitcnt vmcnt(13)
    ds_write_b128 v20, v[72:75] offset:0
    v_mfma_f32_32x32x16_bf16 v[136:151], v[104:107], v[92:95], v[136:151]
    ds_read_b64_tr_b16 v[112:113], v15 offset:0
    ds_read_b64_tr_b16 v[114:115], v15 offset:768
    s_waitcnt vmcnt(12)
    ds_write_b128 v20, v[76:79] offset:6144
    buffer_load_dwordx4 v[40:43], v7, s[8:11], s30 offen offset:2304
    s_waitcnt lgkmcnt(8)
    v_mfma_f32_32x32x16_bf16 v[152:167], v[108:111], v[88:91], v[152:167]
    ds_read_b64_tr_b16 v[116:117], v15 offset:64
    ds_read_b64_tr_b16 v[118:119], v15 offset:832
    buffer_load_dwordx4 v[44:47], v7, s[8:11], s31 offen offset:2304
    s_mov_b32 s26, 1032192
    buffer_load_dwordx4 v[72:75], v9, s[12:15], s26 offen
    s_mov_b32 s26, 1060864
    buffer_load_dwordx4 v[76:79], v9, s[12:15], s26 offen
    v_mfma_f32_32x32x16_bf16 v[168:183], v[108:111], v[92:95], v[168:183]
    s_waitcnt lgkmcnt(2)
    s_barrier
    v_mfma_f32_32x32x16_bf16 v[120:135], v[112:115], v[96:99], v[120:135]
    ds_read_b128 v[88:91], v14 offset:0
    ds_read_b128 v[92:95], v14 offset:4608
    s_waitcnt vmcnt(15)
    ds_write_b128 v8, v[48:51] offset:0
    s_waitcnt vmcnt(14)
    ds_write_b128 v8, v[52:55] offset:4608
    s_waitcnt vmcnt(13)
    ds_write_b128 v10, v[80:83] offset:0
    v_mfma_f32_32x32x16_bf16 v[136:151], v[112:115], v[100:103], v[136:151]
    ds_read_b64_tr_b16 v[104:105], v16 offset:0
    ds_read_b64_tr_b16 v[106:107], v16 offset:768
    s_waitcnt vmcnt(12)
    ds_write_b128 v10, v[84:87] offset:6144
    buffer_load_dwordx4 v[48:51], v7, s[8:11], s30 offen offset:2432
    s_waitcnt lgkmcnt(8)
    v_mfma_f32_32x32x16_bf16 v[152:167], v[116:119], v[96:99], v[152:167]
    ds_read_b64_tr_b16 v[108:109], v16 offset:64
    ds_read_b64_tr_b16 v[110:111], v16 offset:832
    buffer_load_dwordx4 v[52:55], v7, s[8:11], s31 offen offset:2432
    s_mov_b32 s26, 1089536
    buffer_load_dwordx4 v[80:83], v9, s[12:15], s26 offen
    s_mov_b32 s26, 1118208
    buffer_load_dwordx4 v[84:87], v9, s[12:15], s26 offen
    v_mfma_f32_32x32x16_bf16 v[168:183], v[116:119], v[100:103], v[168:183]
    s_waitcnt lgkmcnt(2)
    s_barrier
    v_mfma_f32_32x32x16_bf16 v[120:135], v[104:107], v[88:91], v[120:135]
    ds_read_b128 v[96:99], v11 offset:0
    ds_read_b128 v[100:103], v11 offset:4608
    s_waitcnt vmcnt(15)
    ds_write_b128 v17, v[24:27] offset:0
    s_waitcnt vmcnt(14)
    ds_write_b128 v17, v[28:31] offset:4608
    s_waitcnt vmcnt(13)
    ds_write_b128 v19, v[56:59] offset:0
    v_mfma_f32_32x32x16_bf16 v[136:151], v[104:107], v[92:95], v[136:151]
    ds_read_b64_tr_b16 v[112:113], v12 offset:0
    ds_read_b64_tr_b16 v[114:115], v12 offset:768
    s_waitcnt vmcnt(12)
    ds_write_b128 v19, v[60:63] offset:6144
    buffer_load_dwordx4 v[24:27], v7, s[8:11], s30 offen offset:2560
    s_waitcnt lgkmcnt(8)
    v_mfma_f32_32x32x16_bf16 v[152:167], v[108:111], v[88:91], v[152:167]
    ds_read_b64_tr_b16 v[116:117], v12 offset:64
    ds_read_b64_tr_b16 v[118:119], v12 offset:832
    buffer_load_dwordx4 v[28:31], v7, s[8:11], s31 offen offset:2560
    s_mov_b32 s26, 1146880
    buffer_load_dwordx4 v[56:59], v9, s[12:15], s26 offen
    s_mov_b32 s26, 1175552
    buffer_load_dwordx4 v[60:63], v9, s[12:15], s26 offen
    v_mfma_f32_32x32x16_bf16 v[168:183], v[108:111], v[92:95], v[168:183]
    s_waitcnt lgkmcnt(2)
    s_barrier
    v_mfma_f32_32x32x16_bf16 v[120:135], v[112:115], v[96:99], v[120:135]
    ds_read_b128 v[88:91], v13 offset:0
    ds_read_b128 v[92:95], v13 offset:4608
    s_waitcnt vmcnt(15)
    ds_write_b128 v18, v[32:35] offset:0
    s_waitcnt vmcnt(14)
    ds_write_b128 v18, v[36:39] offset:4608
    s_waitcnt vmcnt(13)
    ds_write_b128 v20, v[64:67] offset:0
    v_mfma_f32_32x32x16_bf16 v[136:151], v[112:115], v[100:103], v[136:151]
    ds_read_b64_tr_b16 v[104:105], v15 offset:0
    ds_read_b64_tr_b16 v[106:107], v15 offset:768
    s_waitcnt vmcnt(12)
    ds_write_b128 v20, v[68:71] offset:6144
    buffer_load_dwordx4 v[32:35], v7, s[8:11], s30 offen offset:2688
    s_waitcnt lgkmcnt(8)
    v_mfma_f32_32x32x16_bf16 v[152:167], v[116:119], v[96:99], v[152:167]
    ds_read_b64_tr_b16 v[108:109], v15 offset:64
    ds_read_b64_tr_b16 v[110:111], v15 offset:832
    buffer_load_dwordx4 v[36:39], v7, s[8:11], s31 offen offset:2688
    s_mov_b32 s26, 1204224
    buffer_load_dwordx4 v[64:67], v9, s[12:15], s26 offen
    s_mov_b32 s26, 1232896
    buffer_load_dwordx4 v[68:71], v9, s[12:15], s26 offen
    v_mfma_f32_32x32x16_bf16 v[168:183], v[116:119], v[100:103], v[168:183]
    s_waitcnt lgkmcnt(2)
    s_barrier
    v_mfma_f32_32x32x16_bf16 v[120:135], v[104:107], v[88:91], v[120:135]
    ds_read_b128 v[96:99], v14 offset:0
    ds_read_b128 v[100:103], v14 offset:4608
    s_waitcnt vmcnt(15)
    ds_write_b128 v8, v[40:43] offset:0
    s_waitcnt vmcnt(14)
    ds_write_b128 v8, v[44:47] offset:4608
    s_waitcnt vmcnt(13)
    ds_write_b128 v10, v[72:75] offset:0
    v_mfma_f32_32x32x16_bf16 v[136:151], v[104:107], v[92:95], v[136:151]
    ds_read_b64_tr_b16 v[112:113], v16 offset:0
    ds_read_b64_tr_b16 v[114:115], v16 offset:768
    s_waitcnt vmcnt(12)
    ds_write_b128 v10, v[76:79] offset:6144
    buffer_load_dwordx4 v[40:43], v7, s[8:11], s30 offen offset:2816
    s_waitcnt lgkmcnt(8)
    v_mfma_f32_32x32x16_bf16 v[152:167], v[108:111], v[88:91], v[152:167]
    ds_read_b64_tr_b16 v[116:117], v16 offset:64
    ds_read_b64_tr_b16 v[118:119], v16 offset:832
    buffer_load_dwordx4 v[44:47], v7, s[8:11], s31 offen offset:2816
    s_mov_b32 s26, 1261568
    buffer_load_dwordx4 v[72:75], v9, s[12:15], s26 offen
    s_mov_b32 s26, 1290240
    buffer_load_dwordx4 v[76:79], v9, s[12:15], s26 offen
    v_mfma_f32_32x32x16_bf16 v[168:183], v[108:111], v[92:95], v[168:183]
    s_waitcnt lgkmcnt(2)
    s_barrier
    v_mfma_f32_32x32x16_bf16 v[120:135], v[112:115], v[96:99], v[120:135]
    ds_read_b128 v[88:91], v11 offset:0
    ds_read_b128 v[92:95], v11 offset:4608
    s_waitcnt vmcnt(15)
    ds_write_b128 v17, v[48:51] offset:0
    s_waitcnt vmcnt(14)
    ds_write_b128 v17, v[52:55] offset:4608
    s_waitcnt vmcnt(13)
    ds_write_b128 v19, v[80:83] offset:0
    v_mfma_f32_32x32x16_bf16 v[136:151], v[112:115], v[100:103], v[136:151]
    ds_read_b64_tr_b16 v[104:105], v12 offset:0
    ds_read_b64_tr_b16 v[106:107], v12 offset:768
    s_waitcnt vmcnt(12)
    ds_write_b128 v19, v[84:87] offset:6144
    buffer_load_dwordx4 v[48:51], v7, s[8:11], s30 offen offset:2944
    s_waitcnt lgkmcnt(8)
    v_mfma_f32_32x32x16_bf16 v[152:167], v[116:119], v[96:99], v[152:167]
    ds_read_b64_tr_b16 v[108:109], v12 offset:64
    ds_read_b64_tr_b16 v[110:111], v12 offset:832
    buffer_load_dwordx4 v[52:55], v7, s[8:11], s31 offen offset:2944
    s_mov_b32 s26, 1318912
    buffer_load_dwordx4 v[80:83], v9, s[12:15], s26 offen
    s_mov_b32 s26, 1347584
    buffer_load_dwordx4 v[84:87], v9, s[12:15], s26 offen
    v_mfma_f32_32x32x16_bf16 v[168:183], v[116:119], v[100:103], v[168:183]
    s_waitcnt lgkmcnt(2)
    s_barrier
    v_mfma_f32_32x32x16_bf16 v[120:135], v[104:107], v[88:91], v[120:135]
    ds_read_b128 v[96:99], v13 offset:0
    ds_read_b128 v[100:103], v13 offset:4608
    s_waitcnt vmcnt(15)
    ds_write_b128 v18, v[24:27] offset:0
    s_waitcnt vmcnt(14)
    ds_write_b128 v18, v[28:31] offset:4608
    s_waitcnt vmcnt(13)
    ds_write_b128 v20, v[56:59] offset:0
    v_mfma_f32_32x32x16_bf16 v[136:151], v[104:107], v[92:95], v[136:151]
    ds_read_b64_tr_b16 v[112:113], v15 offset:0
    ds_read_b64_tr_b16 v[114:115], v15 offset:768
    s_waitcnt vmcnt(12)
    ds_write_b128 v20, v[60:63] offset:6144
    buffer_load_dwordx4 v[24:27], v7, s[8:11], s30 offen offset:3072
    s_waitcnt lgkmcnt(8)
    v_mfma_f32_32x32x16_bf16 v[152:167], v[108:111], v[88:91], v[152:167]
    ds_read_b64_tr_b16 v[116:117], v15 offset:64
    ds_read_b64_tr_b16 v[118:119], v15 offset:832
    buffer_load_dwordx4 v[28:31], v7, s[8:11], s31 offen offset:3072
    s_mov_b32 s26, 1376256
    buffer_load_dwordx4 v[56:59], v9, s[12:15], s26 offen
    s_mov_b32 s26, 1404928
    buffer_load_dwordx4 v[60:63], v9, s[12:15], s26 offen
    v_mfma_f32_32x32x16_bf16 v[168:183], v[108:111], v[92:95], v[168:183]
    s_waitcnt lgkmcnt(2)
    s_barrier
    v_mfma_f32_32x32x16_bf16 v[120:135], v[112:115], v[96:99], v[120:135]
    ds_read_b128 v[88:91], v14 offset:0
    ds_read_b128 v[92:95], v14 offset:4608
    s_waitcnt vmcnt(15)
    ds_write_b128 v8, v[32:35] offset:0
    s_waitcnt vmcnt(14)
    ds_write_b128 v8, v[36:39] offset:4608
    s_waitcnt vmcnt(13)
    ds_write_b128 v10, v[64:67] offset:0
    v_mfma_f32_32x32x16_bf16 v[136:151], v[112:115], v[100:103], v[136:151]
    ds_read_b64_tr_b16 v[104:105], v16 offset:0
    ds_read_b64_tr_b16 v[106:107], v16 offset:768
    s_waitcnt vmcnt(12)
    ds_write_b128 v10, v[68:71] offset:6144
    buffer_load_dwordx4 v[32:35], v7, s[8:11], s30 offen offset:3200
    s_waitcnt lgkmcnt(8)
    v_mfma_f32_32x32x16_bf16 v[152:167], v[116:119], v[96:99], v[152:167]
    ds_read_b64_tr_b16 v[108:109], v16 offset:64
    ds_read_b64_tr_b16 v[110:111], v16 offset:832
    buffer_load_dwordx4 v[36:39], v7, s[8:11], s31 offen offset:3200
    s_mov_b32 s26, 1433600
    buffer_load_dwordx4 v[64:67], v9, s[12:15], s26 offen
    s_mov_b32 s26, 1462272
    buffer_load_dwordx4 v[68:71], v9, s[12:15], s26 offen
    v_mfma_f32_32x32x16_bf16 v[168:183], v[116:119], v[100:103], v[168:183]
    s_waitcnt lgkmcnt(2)
    s_barrier
    v_mfma_f32_32x32x16_bf16 v[120:135], v[104:107], v[88:91], v[120:135]
    ds_read_b128 v[96:99], v11 offset:0
    ds_read_b128 v[100:103], v11 offset:4608
    s_waitcnt vmcnt(15)
    ds_write_b128 v17, v[40:43] offset:0
    s_waitcnt vmcnt(14)
    ds_write_b128 v17, v[44:47] offset:4608
    s_waitcnt vmcnt(13)
    ds_write_b128 v19, v[72:75] offset:0
    v_mfma_f32_32x32x16_bf16 v[136:151], v[104:107], v[92:95], v[136:151]
    ds_read_b64_tr_b16 v[112:113], v12 offset:0
    ds_read_b64_tr_b16 v[114:115], v12 offset:768
    s_waitcnt vmcnt(12)
    ds_write_b128 v19, v[76:79] offset:6144
    buffer_load_dwordx4 v[40:43], v7, s[8:11], s30 offen offset:3328
    s_waitcnt lgkmcnt(8)
    v_mfma_f32_32x32x16_bf16 v[152:167], v[108:111], v[88:91], v[152:167]
    ds_read_b64_tr_b16 v[116:117], v12 offset:64
    ds_read_b64_tr_b16 v[118:119], v12 offset:832
    buffer_load_dwordx4 v[44:47], v7, s[8:11], s31 offen offset:3328
    s_mov_b32 s26, 1490944
    buffer_load_dwordx4 v[72:75], v9, s[12:15], s26 offen
    s_mov_b32 s26, 1519616
    buffer_load_dwordx4 v[76:79], v9, s[12:15], s26 offen
    v_mfma_f32_32x32x16_bf16 v[168:183], v[108:111], v[92:95], v[168:183]
    s_waitcnt lgkmcnt(2)
    s_barrier
    v_mfma_f32_32x32x16_bf16 v[120:135], v[112:115], v[96:99], v[120:135]
    ds_read_b128 v[88:91], v13 offset:0
    ds_read_b128 v[92:95], v13 offset:4608
    s_waitcnt vmcnt(15)
    ds_write_b128 v18, v[48:51] offset:0
    s_waitcnt vmcnt(14)
    ds_write_b128 v18, v[52:55] offset:4608
    s_waitcnt vmcnt(13)
    ds_write_b128 v20, v[80:83] offset:0
    v_mfma_f32_32x32x16_bf16 v[136:151], v[112:115], v[100:103], v[136:151]
    ds_read_b64_tr_b16 v[104:105], v15 offset:0
    ds_read_b64_tr_b16 v[106:107], v15 offset:768
    s_waitcnt vmcnt(12)
    ds_write_b128 v20, v[84:87] offset:6144
    buffer_load_dwordx4 v[48:51], v7, s[8:11], s30 offen offset:3456
    s_waitcnt lgkmcnt(8)
    v_mfma_f32_32x32x16_bf16 v[152:167], v[116:119], v[96:99], v[152:167]
    ds_read_b64_tr_b16 v[108:109], v15 offset:64
    ds_read_b64_tr_b16 v[110:111], v15 offset:832
    buffer_load_dwordx4 v[52:55], v7, s[8:11], s31 offen offset:3456
    s_mov_b32 s26, 1548288
    buffer_load_dwordx4 v[80:83], v9, s[12:15], s26 offen
    s_mov_b32 s26, 1576960
    buffer_load_dwordx4 v[84:87], v9, s[12:15], s26 offen
    v_mfma_f32_32x32x16_bf16 v[168:183], v[116:119], v[100:103], v[168:183]
    s_waitcnt lgkmcnt(2)
    s_barrier
    v_mfma_f32_32x32x16_bf16 v[120:135], v[104:107], v[88:91], v[120:135]
    ds_read_b128 v[96:99], v14 offset:0
    ds_read_b128 v[100:103], v14 offset:4608
    s_waitcnt vmcnt(15)
    ds_write_b128 v8, v[24:27] offset:0
    s_waitcnt vmcnt(14)
    ds_write_b128 v8, v[28:31] offset:4608
    v_mfma_f32_32x32x16_bf16 v[136:151], v[104:107], v[92:95], v[136:151]
    ds_read_b64_tr_b16 v[112:113], v16 offset:0
    ds_read_b64_tr_b16 v[114:115], v16 offset:768
    s_waitcnt vmcnt(13)
    ds_write_b128 v10, v[56:59] offset:0
    s_waitcnt lgkmcnt(7)
    v_mfma_f32_32x32x16_bf16 v[152:167], v[108:111], v[88:91], v[152:167]
    ds_read_b64_tr_b16 v[116:117], v16 offset:64
    ds_read_b64_tr_b16 v[118:119], v16 offset:832
    s_waitcnt vmcnt(12)
    ds_write_b128 v10, v[60:63] offset:6144
    v_mfma_f32_32x32x16_bf16 v[168:183], v[108:111], v[92:95], v[168:183]
    s_waitcnt lgkmcnt(0)
    s_barrier
    v_mfma_f32_32x32x16_bf16 v[120:135], v[112:115], v[96:99], v[120:135]
    ds_read_b128 v[88:91], v11 offset:0
    ds_read_b128 v[92:95], v11 offset:4608
    s_waitcnt vmcnt(11)
    ds_write_b128 v17, v[32:35] offset:0
    s_waitcnt vmcnt(10)
    ds_write_b128 v17, v[36:39] offset:4608
    v_mfma_f32_32x32x16_bf16 v[136:151], v[112:115], v[100:103], v[136:151]
    ds_read_b64_tr_b16 v[104:105], v12 offset:0
    ds_read_b64_tr_b16 v[106:107], v12 offset:768
    s_waitcnt vmcnt(9)
    ds_write_b128 v19, v[64:67] offset:0
    v_mfma_f32_32x32x16_bf16 v[152:167], v[116:119], v[96:99], v[152:167]
    ds_read_b64_tr_b16 v[108:109], v12 offset:64
    ds_read_b64_tr_b16 v[110:111], v12 offset:832
    s_waitcnt vmcnt(8)
    ds_write_b128 v19, v[68:71] offset:6144
    v_mfma_f32_32x32x16_bf16 v[168:183], v[116:119], v[100:103], v[168:183]
    s_waitcnt lgkmcnt(0)
    s_barrier
    v_mfma_f32_32x32x16_bf16 v[120:135], v[104:107], v[88:91], v[120:135]
    ds_read_b128 v[96:99], v13 offset:0
    ds_read_b128 v[100:103], v13 offset:4608
    s_waitcnt vmcnt(7)
    ds_write_b128 v18, v[40:43] offset:0
    s_waitcnt vmcnt(6)
    ds_write_b128 v18, v[44:47] offset:4608
    v_mfma_f32_32x32x16_bf16 v[136:151], v[104:107], v[92:95], v[136:151]
    ds_read_b64_tr_b16 v[112:113], v15 offset:0
    ds_read_b64_tr_b16 v[114:115], v15 offset:768
    s_waitcnt vmcnt(5)
    ds_write_b128 v20, v[72:75] offset:0
    v_mfma_f32_32x32x16_bf16 v[152:167], v[108:111], v[88:91], v[152:167]
    ds_read_b64_tr_b16 v[116:117], v15 offset:64
    ds_read_b64_tr_b16 v[118:119], v15 offset:832
    s_waitcnt vmcnt(4)
    ds_write_b128 v20, v[76:79] offset:6144
    v_mfma_f32_32x32x16_bf16 v[168:183], v[108:111], v[92:95], v[168:183]
    s_waitcnt lgkmcnt(0)
    s_barrier
    v_mfma_f32_32x32x16_bf16 v[120:135], v[112:115], v[96:99], v[120:135]
    ds_read_b128 v[88:91], v14 offset:0
    ds_read_b128 v[92:95], v14 offset:4608
    s_waitcnt vmcnt(3)
    ds_write_b128 v8, v[48:51] offset:0
    s_waitcnt vmcnt(2)
    ds_write_b128 v8, v[52:55] offset:4608
    v_mfma_f32_32x32x16_bf16 v[136:151], v[112:115], v[100:103], v[136:151]
    ds_read_b64_tr_b16 v[104:105], v16 offset:0
    ds_read_b64_tr_b16 v[106:107], v16 offset:768
    s_waitcnt vmcnt(1)
    ds_write_b128 v10, v[80:83] offset:0
    v_mfma_f32_32x32x16_bf16 v[152:167], v[116:119], v[96:99], v[152:167]
    ds_read_b64_tr_b16 v[108:109], v16 offset:64
    ds_read_b64_tr_b16 v[110:111], v16 offset:832
    s_waitcnt vmcnt(0)
    ds_write_b128 v10, v[84:87] offset:6144
    v_mfma_f32_32x32x16_bf16 v[168:183], v[116:119], v[100:103], v[168:183]
    s_waitcnt lgkmcnt(0)
    s_barrier
    v_mfma_f32_32x32x16_bf16 v[120:135], v[104:107], v[88:91], v[120:135]
    ds_read_b128 v[96:99], v11 offset:0
    ds_read_b128 v[100:103], v11 offset:4608
    v_mfma_f32_32x32x16_bf16 v[136:151], v[104:107], v[92:95], v[136:151]
    ds_read_b64_tr_b16 v[112:113], v12 offset:0
    ds_read_b64_tr_b16 v[114:115], v12 offset:768
    v_mfma_f32_32x32x16_bf16 v[152:167], v[108:111], v[88:91], v[152:167]
    ds_read_b64_tr_b16 v[116:117], v12 offset:64
    ds_read_b64_tr_b16 v[118:119], v12 offset:832
    v_mfma_f32_32x32x16_bf16 v[168:183], v[108:111], v[92:95], v[168:183]
    s_waitcnt lgkmcnt(2)
    v_mfma_f32_32x32x16_bf16 v[120:135], v[112:115], v[96:99], v[120:135]
    v_mfma_f32_32x32x16_bf16 v[136:151], v[112:115], v[100:103], v[136:151]
    s_waitcnt lgkmcnt(0)
    v_mfma_f32_32x32x16_bf16 v[152:167], v[116:119], v[96:99], v[152:167]
    v_mfma_f32_32x32x16_bf16 v[168:183], v[116:119], v[100:103], v[168:183]
    s_mul_i32 s27, s24, 64
    s_mul_i32 s28, s25, 64
    v_and_b32 v5, 31, v1
    v_lshrrev_b32 v6, 5, v1
    v_lshlrev_b32 v6, 2, v6
    v_and_b32 v3, 1, v2
    v_lshrrev_b32 v4, 1, v2
    v_lshlrev_b32 v3, 5, v3
    v_lshlrev_b32 v4, 5, v4
    v_add3_u32 v24, v3, v5, s27
    v_add3_u32 v25, v4, v6, s28
    s_add_u32 s16, s50, 0xa00000
    s_addc_u32 s17, s51, 0
    s_and_b32 s17, s17, 0xffff
    s_mov_b32 s18, 0x1c0000
    s_mov_b32 s19, 0x00020000
    s_add_u32 s20, s50, 0x800000
    s_addc_u32 s21, s51, 0
    s_and_b32 s21, s21, 0xffff
    s_mov_b32 s22, 0x1c0000
    s_mov_b32 s23, 0x00020000
    v_lshrrev_b32 v3, 5, v1
    v_lshl_add_u32 v3, v3, 2, v25
    v_mul_u32_u24 v26, 896, v24
    v_lshl_add_u32 v26, v3, 1, v26
    buffer_load_dwordx4 v[28:31], v26, s[20:23], 0 offen offset:0
    buffer_load_dwordx4 v[32:35], v26, s[20:23], 0 offen offset:32
    s_waitcnt lgkmcnt(0)
    s_barrier
    v_lshlrev_b32 v3, 4, v1
    v_lshl_add_u32 v36, v2, 14, v3
    v_lshl_add_u32 v37, v2, 12, v3
    ds_write_b128 v36, v[120:123] offset:0
    ds_write_b128 v36, v[124:127] offset:1024
    ds_write_b128 v36, v[128:131] offset:2048
    ds_write_b128 v36, v[132:135] offset:3072
    ds_write_b128 v36, v[136:139] offset:4096
    ds_write_b128 v36, v[140:143] offset:5120
    ds_write_b128 v36, v[144:147] offset:6144
    ds_write_b128 v36, v[148:151] offset:7168
    ds_write_b128 v36, v[152:155] offset:8192
    ds_write_b128 v36, v[156:159] offset:9216
    ds_write_b128 v36, v[160:163] offset:10240
    ds_write_b128 v36, v[164:167] offset:11264
    ds_write_b128 v36, v[168:171] offset:12288
    ds_write_b128 v36, v[172:175] offset:13312
    ds_write_b128 v36, v[176:179] offset:14336
    ds_write_b128 v36, v[180:183] offset:15360
    s_waitcnt lgkmcnt(0)
    s_barrier
    ds_read_b128 v[184:187], v37 offset:0
    ds_read_b128 v[188:191], v37 offset:1024
    ds_read_b128 v[192:195], v37 offset:2048
    ds_read_b128 v[196:199], v37 offset:3072
    ds_read_b128 v[200:203], v37 offset:16384
    ds_read_b128 v[204:207], v37 offset:17408
    ds_read_b128 v[208:211], v37 offset:18432
    ds_read_b128 v[212:215], v37 offset:19456
    ds_read_b128 v[216:219], v37 offset:32768
    ds_read_b128 v[220:223], v37 offset:33792
    ds_read_b128 v[224:227], v37 offset:34816
    ds_read_b128 v[228:231], v37 offset:35840
    ds_read_b128 v[232:235], v37 offset:49152
    ds_read_b128 v[236:239], v37 offset:50176
    ds_read_b128 v[240:243], v37 offset:51200
    ds_read_b128 v[244:247], v37 offset:52224
    s_waitcnt lgkmcnt(11)
    v_pk_add_f32 v[184:185], v[184:185], v[200:201]
    s_waitcnt lgkmcnt(3)
    v_pk_add_f32 v[216:217], v[216:217], v[232:233]
    v_pk_add_f32 v[184:185], v[184:185], v[216:217]
    v_pk_add_f32 v[186:187], v[186:187], v[202:203]
    v_pk_add_f32 v[218:219], v[218:219], v[234:235]
    v_pk_add_f32 v[186:187], v[186:187], v[218:219]
    v_pk_add_f32 v[188:189], v[188:189], v[204:205]
    s_waitcnt lgkmcnt(2)
    v_pk_add_f32 v[220:221], v[220:221], v[236:237]
    v_pk_add_f32 v[188:189], v[188:189], v[220:221]
    v_pk_add_f32 v[190:191], v[190:191], v[206:207]
    v_pk_add_f32 v[222:223], v[222:223], v[238:239]
    v_pk_add_f32 v[190:191], v[190:191], v[222:223]
    v_pk_add_f32 v[192:193], v[192:193], v[208:209]
    s_waitcnt lgkmcnt(1)
    v_pk_add_f32 v[224:225], v[224:225], v[240:241]
    v_pk_add_f32 v[192:193], v[192:193], v[224:225]
    v_pk_add_f32 v[194:195], v[194:195], v[210:211]
    v_pk_add_f32 v[226:227], v[226:227], v[242:243]
    v_pk_add_f32 v[194:195], v[194:195], v[226:227]
    v_pk_add_f32 v[196:197], v[196:197], v[212:213]
    s_waitcnt lgkmcnt(0)
    v_pk_add_f32 v[228:229], v[228:229], v[244:245]
    v_pk_add_f32 v[196:197], v[196:197], v[228:229]
    v_pk_add_f32 v[198:199], v[198:199], v[214:215]
    v_pk_add_f32 v[230:231], v[230:231], v[246:247]
    v_pk_add_f32 v[198:199], v[198:199], v[230:231]
    v_cvt_pk_bf16_f32 v40, v184, v185
    v_cvt_pk_bf16_f32 v41, v186, v187
    v_cvt_pk_bf16_f32 v42, v188, v189
    v_cvt_pk_bf16_f32 v43, v190, v191
    s_nop 0
    v_permlane32_swap_b32 v40, v42
    v_permlane32_swap_b32 v41, v43
    v_lshlrev_b32 v4, 16, v40
    v_and_b32 v3, 0xffff0000, v40
    s_waitcnt vmcnt(1)
    v_lshlrev_b32 v5, 16, v28
    v_and_b32 v6, 0xffff0000, v28
    v_add_f32 v4, v4, v5
    v_add_f32 v3, v3, v6
    v_cvt_pk_bf16_f32 v28, v4, v3
    v_lshlrev_b32 v4, 16, v41
    v_and_b32 v3, 0xffff0000, v41
    v_lshlrev_b32 v5, 16, v29
    v_and_b32 v6, 0xffff0000, v29
    v_add_f32 v4, v4, v5
    v_add_f32 v3, v3, v6
    v_cvt_pk_bf16_f32 v29, v4, v3
    v_lshlrev_b32 v4, 16, v42
    v_and_b32 v3, 0xffff0000, v42
    v_lshlrev_b32 v5, 16, v30
    v_and_b32 v6, 0xffff0000, v30
    v_add_f32 v4, v4, v5
    v_add_f32 v3, v3, v6
    v_cvt_pk_bf16_f32 v30, v4, v3
    v_lshlrev_b32 v4, 16, v43
    v_and_b32 v3, 0xffff0000, v43
    v_lshlrev_b32 v5, 16, v31
    v_and_b32 v6, 0xffff0000, v31
    v_add_f32 v4, v4, v5
    v_add_f32 v3, v3, v6
    v_cvt_pk_bf16_f32 v31, v4, v3
    buffer_store_dwordx4 v[28:31], v26, s[16:19], 0 offen offset:0
    v_cvt_pk_bf16_f32 v40, v192, v193
    v_cvt_pk_bf16_f32 v41, v194, v195
    v_cvt_pk_bf16_f32 v42, v196, v197
    v_cvt_pk_bf16_f32 v43, v198, v199
    s_nop 0
    v_permlane32_swap_b32 v40, v42
    v_permlane32_swap_b32 v41, v43
    v_lshlrev_b32 v4, 16, v40
    v_and_b32 v3, 0xffff0000, v40
    s_waitcnt vmcnt(1)
    v_lshlrev_b32 v5, 16, v32
    v_and_b32 v6, 0xffff0000, v32
    v_add_f32 v4, v4, v5
    v_add_f32 v3, v3, v6
    v_cvt_pk_bf16_f32 v32, v4, v3
    v_lshlrev_b32 v4, 16, v41
    v_and_b32 v3, 0xffff0000, v41
    v_lshlrev_b32 v5, 16, v33
    v_and_b32 v6, 0xffff0000, v33
    v_add_f32 v4, v4, v5
    v_add_f32 v3, v3, v6
    v_cvt_pk_bf16_f32 v33, v4, v3
    v_lshlrev_b32 v4, 16, v42
    v_and_b32 v3, 0xffff0000, v42
    v_lshlrev_b32 v5, 16, v34
    v_and_b32 v6, 0xffff0000, v34
    v_add_f32 v4, v4, v5
    v_add_f32 v3, v3, v6
    v_cvt_pk_bf16_f32 v34, v4, v3
    v_lshlrev_b32 v4, 16, v43
    v_and_b32 v3, 0xffff0000, v43
    v_lshlrev_b32 v5, 16, v35
    v_and_b32 v6, 0xffff0000, v35
    v_add_f32 v4, v4, v5
    v_add_f32 v3, v3, v6
    v_cvt_pk_bf16_f32 v35, v4, v3
    buffer_store_dwordx4 v[32:35], v26, s[16:19], 0 offen offset:32
L_end_g5_0_kernel:
    s_endpgm
.globl g1_1_kernel
.p2align 8
.type g1_1_kernel,@function
g1_1_kernel:
    s_load_dwordx16 s[32:47], s[0:1], 0
    s_load_dwordx4 s[48:51], s[0:1], 64
    s_cmp_ge_u32 s2, 224
    s_cbranch_scc1 L_end_g1_1_kernel
    s_lshr_b32 s28, s2, 3
    s_and_b32 s29, s2, 7
    s_mul_hi_u32 s24, s28, 0x24924925
    s_mul_i32 s27, s24, 7
    s_sub_u32 s25, s28, s27
    s_and_b32 s27, s29, 7
    s_mul_i32 s27, s27, 4
    s_add_u32 s24, s24, s27
    s_lshr_b32 s27, s29, 3
    s_mul_i32 s27, s27, 7
    s_add_u32 s25, s25, s27
    s_mov_b32 s30, 0
    s_mov_b32 s31, 28672
    v_and_b32 v1, 63, v0
    v_lshrrev_b32 v2, 6, v0
    v_lshrrev_b32 v3, 3, v0
    v_and_b32 v4, 7, v0
    v_lshlrev_b32 v4, 4, v4
    s_mul_i32 s27, s24, 57344
    v_mul_u32_u24 v7, 896, v3
    v_add3_u32 v7, v7, v4, s27
    v_mul_u32_u24 v8, 144, v3
    v_add_u32 v8, v8, v4
    s_mul_i32 s27, s25, 384
    v_add_u32 v5, 0, v0
    v_mul_u32_u24 v3, 0xaaab, v5
    v_lshrrev_b32 v3, 20, v3
    v_mul_u32_u24 v4, 24, v3
    v_sub_u32 v4, v5, v4
    v_lshlrev_b32 v4, 4, v4
    v_mul_u32_u24 v9, 2688, v3
    v_add3_u32 v9, v9, v4, s27
    v_mul_u32_u24 v15, 448, v3
    v_add_u32 v15, v15, v4
    v_add_u32 v15, 9216, v15
    v_add_u32 v5, 256, v0
    v_mul_u32_u24 v3, 0xaaab, v5
    v_lshrrev_b32 v3, 20, v3
    v_mul_u32_u24 v4, 24, v3
    v_sub_u32 v4, v5, v4
    v_lshlrev_b32 v4, 4, v4
    v_mul_u32_u24 v10, 2688, v3
    v_add3_u32 v10, v10, v4, s27
    v_mul_u32_u24 v16, 448, v3
    v_add_u32 v16, v16, v4
    v_add_u32 v16, 9216, v16
    v_add_u32 v5, 512, v0
    v_mul_u32_u24 v3, 0xaaab, v5
    v_lshrrev_b32 v3, 20, v3
    v_mul_u32_u24 v4, 24, v3
    v_sub_u32 v4, v5, v4
    v_lshlrev_b32 v4, 4, v4
    v_mul_u32_u24 v11, 2688, v3
    v_add3_u32 v11, v11, v4, s27
    v_mul_u32_u24 v17, 448, v3
    v_add_u32 v17, v17, v4
    v_add_u32 v17, 9216, v17
    v_add_u32 v5, 768, v0
    v_mul_u32_u24 v3, 0xaaab, v5
    v_lshrrev_b32 v3, 20, v3
    v_mul_u32_u24 v4, 24, v3
    v_sub_u32 v4, v5, v4
    v_lshlrev_b32 v4, 4, v4
    v_mul_u32_u24 v12, 2688, v3
    v_add3_u32 v12, v12, v4, s27
    v_mul_u32_u24 v18, 448, v3
    v_add_u32 v18, v18, v4
    v_add_u32 v18, 9216, v18
    v_add_u32 v5, 1024, v0
    v_mul_u32_u24 v3, 0xaaab, v5
    v_lshrrev_b32 v3, 20, v3
    v_mul_u32_u24 v4, 24, v3
    v_sub_u32 v4, v5, v4
    v_lshlrev_b32 v4, 4, v4
    v_mul_u32_u24 v13, 2688, v3
    v_add3_u32 v13, v13, v4, s27
    v_mul_u32_u24 v19, 448, v3
    v_add_u32 v19, v19, v4
    v_add_u32 v19, 9216, v19
    v_add_u32 v5, 1280, v0
    v_mul_u32_u24 v3, 0xaaab, v5
    v_lshrrev_b32 v3, 20, v3
    v_mul_u32_u24 v4, 24, v3
    v_sub_u32 v4, v5, v4
    v_lshlrev_b32 v4, 4, v4
    v_mul_u32_u24 v14, 2688, v3
    v_add3_u32 v14, v14, v4, s27
    v_mul_u32_u24 v20, 448, v3
    v_add_u32 v20, v20, v4
    v_add_u32 v20, 9216, v20
    v_lshrrev_b32 v3, 1, v2
    v_and_b32 v4, 1, v2
    v_mul_u32_u24 v3, 32, v3
    v_and_b32 v5, 31, v1
    v_add_u32 v5, v5, v3
    v_mul_u32_u24 v21, 144, v5
    v_lshrrev_b32 v6, 5, v1
    v_lshlrev_b32 v6, 4, v6
    v_add_u32 v21, v21, v6
    v_lshrrev_b32 v3, 5, v1
    v_lshlrev_b32 v3, 3, v3
    v_bfe_u32 v5, v1, 2, 2
    v_add_u32 v3, v3, v5
    v_mul_u32_u24 v22, 448, v3
    v_bfe_u32 v5, v1, 4, 1
    v_lshlrev_b32 v5, 5, v5
    v_and_b32 v6, 3, v1
    v_lshlrev_b32 v6, 3, v6
    v_add3_u32 v22, v22, v5, v6
    v_mul_u32_u24 v4, 192, v4
    v_add_u32 v22, v22, v4
    v_add_u32 v22, 9216, v22
    v_add_u32 v23, 37888, v21
    v_add_u32 v24, 75776, v21
    v_add_u32 v25, 37888, v22
    v_add_u32 v26, 75776, v22
    v_add_u32 v27, 37888, v8
    v_add_u32 v28, 75776, v8
    v_add_u32 v29, 37888, v15
    v_add_u32 v30, 75776, v15
    v_add_u32 v31, 37888, v16
    v_add_u32 v32, 75776, v16
    v_add_u32 v33, 37888, v17
    v_add_u32 v34, 75776, v17
    v_add_u32 v35, 37888, v18
    v_add_u32 v36, 75776, v18
    v_add_u32 v37, 37888, v19
    v_add_u32 v38, 75776, v19
    v_add_u32 v39, 37888, v20
    v_add_u32 v40, 75776, v20
    s_waitcnt lgkmcnt(0)
    s_add_u32 s8, s50, 0xa00000
    s_addc_u32 s9, s51, 0
    s_and_b32 s9, s9, 0xffff
    s_mov_b32 s10, 0x1c0000
    s_mov_b32 s11, 0x00020000
    s_mov_b32 s12, s34
    s_and_b32 s13, s35, 0xffff
    s_mov_b32 s14, 0x126000
    s_mov_b32 s15, 0x00020000
    buffer_load_dwordx4 v[44:47], v7, s[8:11], s30 offen offset:0
    buffer_load_dwordx4 v[48:51], v7, s[8:11], s31 offen offset:0
    buffer_load_dwordx4 v[52:55], v7, s[8:11], s30 offen offset:128
    buffer_load_dwordx4 v[56:59], v7, s[8:11], s31 offen offset:128
    buffer_load_dwordx4 v[60:63], v7, s[8:11], s30 offen offset:256
    buffer_load_dwordx4 v[64:67], v7, s[8:11], s31 offen offset:256
    buffer_load_dwordx4 v[68:71], v7, s[8:11], s30 offen offset:384
    buffer_load_dwordx4 v[72:75], v7, s[8:11], s31 offen offset:384
    buffer_load_dwordx4 v[76:79], v7, s[8:11], s30 offen offset:512
    buffer_load_dwordx4 v[80:83], v7, s[8:11], s31 offen offset:512
    buffer_load_dwordx4 v[84:87], v7, s[8:11], s30 offen offset:640
    buffer_load_dwordx4 v[88:91], v7, s[8:11], s31 offen offset:640
    buffer_load_dwordx4 v[92:95], v7, s[8:11], s30 offen offset:768
    buffer_load_dwordx4 v[96:99], v7, s[8:11], s31 offen offset:768
    s_mov_b32 s26, 0
    buffer_load_dwordx4 v[100:103], v9, s[12:15], s26 offen
    buffer_load_dwordx4 v[104:107], v10, s[12:15], s26 offen
    buffer_load_dwordx4 v[108:111], v11, s[12:15], s26 offen
    buffer_load_dwordx4 v[112:115], v12, s[12:15], s26 offen
    buffer_load_dwordx4 v[116:119], v13, s[12:15], s26 offen
    buffer_load_dwordx4 v[120:123], v14, s[12:15], s26 offen
    s_mov_b32 s26, 172032
    buffer_load_dwordx4 v[124:127], v9, s[12:15], s26 offen
    buffer_load_dwordx4 v[128:131], v10, s[12:15], s26 offen
    buffer_load_dwordx4 v[132:135], v11, s[12:15], s26 offen
    buffer_load_dwordx4 v[136:139], v12, s[12:15], s26 offen
    buffer_load_dwordx4 v[140:143], v13, s[12:15], s26 offen
    buffer_load_dwordx4 v[144:147], v14, s[12:15], s26 offen
    v_mov_b32 v232, 0x3f803f80
    v_mov_b32 v228, 0
    v_mov_b32 v230, 0
    v_mov_b32 v229, 0
    v_mov_b32 v231, 0
    s_waitcnt vmcnt(25)
    v_dot2_f32_bf16 v228, v44, v232, v228
    v_dot2_f32_bf16 v230, v44, v44, v230
    v_dot2_f32_bf16 v228, v45, v232, v228
    v_dot2_f32_bf16 v230, v45, v45, v230
    v_dot2_f32_bf16 v228, v46, v232, v228
    v_dot2_f32_bf16 v230, v46, v46, v230
    v_dot2_f32_bf16 v228, v47, v232, v228
    v_dot2_f32_bf16 v230, v47, v47, v230
    s_waitcnt vmcnt(24)
    v_dot2_f32_bf16 v229, v48, v232, v229
    v_dot2_f32_bf16 v231, v48, v48, v231
    v_dot2_f32_bf16 v229, v49, v232, v229
    v_dot2_f32_bf16 v231, v49, v49, v231
    v_dot2_f32_bf16 v229, v50, v232, v229
    v_dot2_f32_bf16 v231, v50, v50, v231
    v_dot2_f32_bf16 v229, v51, v232, v229
    v_dot2_f32_bf16 v231, v51, v51, v231
    s_waitcnt vmcnt(23)
    v_dot2_f32_bf16 v228, v52, v232, v228
    v_dot2_f32_bf16 v230, v52, v52, v230
    v_dot2_f32_bf16 v228, v53, v232, v228
    v_dot2_f32_bf16 v230, v53, v53, v230
    v_dot2_f32_bf16 v228, v54, v232, v228
    v_dot2_f32_bf16 v230, v54, v54, v230
    v_dot2_f32_bf16 v228, v55, v232, v228
    v_dot2_f32_bf16 v230, v55, v55, v230
    s_waitcnt vmcnt(22)
    v_dot2_f32_bf16 v229, v56, v232, v229
    v_dot2_f32_bf16 v231, v56, v56, v231
    v_dot2_f32_bf16 v229, v57, v232, v229
    v_dot2_f32_bf16 v231, v57, v57, v231
    v_dot2_f32_bf16 v229, v58, v232, v229
    v_dot2_f32_bf16 v231, v58, v58, v231
    v_dot2_f32_bf16 v229, v59, v232, v229
    v_dot2_f32_bf16 v231, v59, v59, v231
    s_waitcnt vmcnt(21)
    v_dot2_f32_bf16 v228, v60, v232, v228
    v_dot2_f32_bf16 v230, v60, v60, v230
    v_dot2_f32_bf16 v228, v61, v232, v228
    v_dot2_f32_bf16 v230, v61, v61, v230
    v_dot2_f32_bf16 v228, v62, v232, v228
    v_dot2_f32_bf16 v230, v62, v62, v230
    v_dot2_f32_bf16 v228, v63, v232, v228
    v_dot2_f32_bf16 v230, v63, v63, v230
    s_waitcnt vmcnt(20)
    v_dot2_f32_bf16 v229, v64, v232, v229
    v_dot2_f32_bf16 v231, v64, v64, v231
    v_dot2_f32_bf16 v229, v65, v232, v229
    v_dot2_f32_bf16 v231, v65, v65, v231
    v_dot2_f32_bf16 v229, v66, v232, v229
    v_dot2_f32_bf16 v231, v66, v66, v231
    v_dot2_f32_bf16 v229, v67, v232, v229
    v_dot2_f32_bf16 v231, v67, v67, v231
    s_waitcnt vmcnt(19)
    v_dot2_f32_bf16 v228, v68, v232, v228
    v_dot2_f32_bf16 v230, v68, v68, v230
    v_dot2_f32_bf16 v228, v69, v232, v228
    v_dot2_f32_bf16 v230, v69, v69, v230
    v_dot2_f32_bf16 v228, v70, v232, v228
    v_dot2_f32_bf16 v230, v70, v70, v230
    v_dot2_f32_bf16 v228, v71, v232, v228
    v_dot2_f32_bf16 v230, v71, v71, v230
    s_waitcnt vmcnt(18)
    v_dot2_f32_bf16 v229, v72, v232, v229
    v_dot2_f32_bf16 v231, v72, v72, v231
    v_dot2_f32_bf16 v229, v73, v232, v229
    v_dot2_f32_bf16 v231, v73, v73, v231
    v_dot2_f32_bf16 v229, v74, v232, v229
    v_dot2_f32_bf16 v231, v74, v74, v231
    v_dot2_f32_bf16 v229, v75, v232, v229
    v_dot2_f32_bf16 v231, v75, v75, v231
    s_waitcnt vmcnt(17)
    v_dot2_f32_bf16 v228, v76, v232, v228
    v_dot2_f32_bf16 v230, v76, v76, v230
    v_dot2_f32_bf16 v228, v77, v232, v228
    v_dot2_f32_bf16 v230, v77, v77, v230
    v_dot2_f32_bf16 v228, v78, v232, v228
    v_dot2_f32_bf16 v230, v78, v78, v230
    v_dot2_f32_bf16 v228, v79, v232, v228
    v_dot2_f32_bf16 v230, v79, v79, v230
    s_waitcnt vmcnt(16)
    v_dot2_f32_bf16 v229, v80, v232, v229
    v_dot2_f32_bf16 v231, v80, v80, v231
    v_dot2_f32_bf16 v229, v81, v232, v229
    v_dot2_f32_bf16 v231, v81, v81, v231
    v_dot2_f32_bf16 v229, v82, v232, v229
    v_dot2_f32_bf16 v231, v82, v82, v231
    v_dot2_f32_bf16 v229, v83, v232, v229
    v_dot2_f32_bf16 v231, v83, v83, v231
    s_waitcnt vmcnt(15)
    v_dot2_f32_bf16 v228, v84, v232, v228
    v_dot2_f32_bf16 v230, v84, v84, v230
    v_dot2_f32_bf16 v228, v85, v232, v228
    v_dot2_f32_bf16 v230, v85, v85, v230
    v_dot2_f32_bf16 v228, v86, v232, v228
    v_dot2_f32_bf16 v230, v86, v86, v230
    v_dot2_f32_bf16 v228, v87, v232, v228
    v_dot2_f32_bf16 v230, v87, v87, v230
    s_waitcnt vmcnt(14)
    v_dot2_f32_bf16 v229, v88, v232, v229
    v_dot2_f32_bf16 v231, v88, v88, v231
    v_dot2_f32_bf16 v229, v89, v232, v229
    v_dot2_f32_bf16 v231, v89, v89, v231
    v_dot2_f32_bf16 v229, v90, v232, v229
    v_dot2_f32_bf16 v231, v90, v90, v231
    v_dot2_f32_bf16 v229, v91, v232, v229
    v_dot2_f32_bf16 v231, v91, v91, v231
    s_waitcnt vmcnt(13)
    v_dot2_f32_bf16 v228, v92, v232, v228
    v_dot2_f32_bf16 v230, v92, v92, v230
    v_dot2_f32_bf16 v228, v93, v232, v228
    v_dot2_f32_bf16 v230, v93, v93, v230
    v_dot2_f32_bf16 v228, v94, v232, v228
    v_dot2_f32_bf16 v230, v94, v94, v230
    v_dot2_f32_bf16 v228, v95, v232, v228
    v_dot2_f32_bf16 v230, v95, v95, v230
    s_waitcnt vmcnt(12)
    v_dot2_f32_bf16 v229, v96, v232, v229
    v_dot2_f32_bf16 v231, v96, v96, v231
    v_dot2_f32_bf16 v229, v97, v232, v229
    v_dot2_f32_bf16 v231, v97, v97, v231
    v_dot2_f32_bf16 v229, v98, v232, v229
    v_dot2_f32_bf16 v231, v98, v98, v231
    v_dot2_f32_bf16 v229, v99, v232, v229
    v_dot2_f32_bf16 v231, v99, v99, v231
    v_add_f32_dpp v3, v228, v228 quad_perm:[1,0,3,2] row_mask:0xf bank_mask:0xf
    v_add_f32_dpp v4, v230, v230 quad_perm:[1,0,3,2] row_mask:0xf bank_mask:0xf
    v_mov_b32 v228, v3
    v_mov_b32 v230, v4
    s_nop 0
    v_add_f32_dpp v3, v228, v228 quad_perm:[2,3,0,1] row_mask:0xf bank_mask:0xf
    v_add_f32_dpp v4, v230, v230 quad_perm:[2,3,0,1] row_mask:0xf bank_mask:0xf
    v_mov_b32 v228, v3
    v_mov_b32 v230, v4
    s_nop 0
    v_add_f32_dpp v3, v228, v228 row_half_mirror row_mask:0xf bank_mask:0xf
    v_add_f32_dpp v4, v230, v230 row_half_mirror row_mask:0xf bank_mask:0xf
    v_mov_b32 v228, v3
    v_mov_b32 v230, v4
    v_mul_f32 v228, 0x3b124925, v228
    v_mul_f32 v230, 0x3b124925, v230
    v_fma_f32 v230, -v228, v228, v230
    v_max_f32 v230, 0, v230
    v_cvt_pk_bf16_f32 v3, v228, v230
    v_lshlrev_b32 v228, 16, v3
    v_and_b32 v230, 0xffff0000, v3
    v_add_f32 v230, 0x3727c5ac, v230
    v_cvt_pk_bf16_f32 v3, v230, v230
    v_lshlrev_b32 v230, 16, v3
    v_sqrt_f32 v230, v230
    s_nop 0
    v_cvt_pk_bf16_f32 v3, v230, v230
    v_lshlrev_b32 v230, 16, v3
    v_rcp_f32 v230, v230
    s_nop 0
    v_mov_b32 v234, v230
    v_mov_b32 v235, v230
    v_mul_f32 v238, v228, v230
    v_sub_f32 v238, 0, v238
    v_mov_b32 v239, v238
    v_add_f32_dpp v3, v229, v229 quad_perm:[1,0,3,2] row_mask:0xf bank_mask:0xf
    v_add_f32_dpp v4, v231, v231 quad_perm:[1,0,3,2] row_mask:0xf bank_mask:0xf
    v_mov_b32 v229, v3
    v_mov_b32 v231, v4
    s_nop 0
    v_add_f32_dpp v3, v229, v229 quad_perm:[2,3,0,1] row_mask:0xf bank_mask:0xf
    v_add_f32_dpp v4, v231, v231 quad_perm:[2,3,0,1] row_mask:0xf bank_mask:0xf
    v_mov_b32 v229, v3
    v_mov_b32 v231, v4
    s_nop 0
    v_add_f32_dpp v3, v229, v229 row_half_mirror row_mask:0xf bank_mask:0xf
    v_add_f32_dpp v4, v231, v231 row_half_mirror row_mask:0xf bank_mask:0xf
    v_mov_b32 v229, v3
    v_mov_b32 v231, v4
    v_mul_f32 v229, 0x3b124925, v229
    v_mul_f32 v231, 0x3b124925, v231
    v_fma_f32 v231, -v229, v229, v231
    v_max_f32 v231, 0, v231
    v_cvt_pk_bf16_f32 v3, v229, v231
    v_lshlrev_b32 v229, 16, v3
    v_and_b32 v231, 0xffff0000, v3
    v_add_f32 v231, 0x3727c5ac, v231
    v_cvt_pk_bf16_f32 v3, v231, v231
    v_lshlrev_b32 v231, 16, v3
    v_sqrt_f32 v231, v231
    s_nop 0
    v_cvt_pk_bf16_f32 v3, v231, v231
    v_lshlrev_b32 v231, 16, v3
    v_rcp_f32 v231, v231
    s_nop 0
    v_mov_b32 v236, v231
    v_mov_b32 v237, v231
    v_mul_f32 v240, v229, v231
    v_sub_f32 v240, 0, v240
    v_mov_b32 v241, v240
    v_lshlrev_b32 v242, 16, v44
    v_and_b32 v243, 0xffff0000, v44
    v_fma_f32 v242, v242, v234, v238
    v_fma_f32 v243, v243, v234, v238
    v_cvt_pk_bf16_f32 v44, v242, v243
    v_lshlrev_b32 v242, 16, v45
    v_and_b32 v243, 0xffff0000, v45
    v_fma_f32 v242, v242, v234, v238
    v_fma_f32 v243, v243, v234, v238
    v_cvt_pk_bf16_f32 v45, v242, v243
    v_lshlrev_b32 v242, 16, v46
    v_and_b32 v243, 0xffff0000, v46
    v_fma_f32 v242, v242, v234, v238
    v_fma_f32 v243, v243, v234, v238
    v_cvt_pk_bf16_f32 v46, v242, v243
    v_lshlrev_b32 v242, 16, v47
    v_and_b32 v243, 0xffff0000, v47
    v_fma_f32 v242, v242, v234, v238
    v_fma_f32 v243, v243, v234, v238
    v_cvt_pk_bf16_f32 v47, v242, v243
    ds_write_b128 v8, v[44:47] offset:0
    v_lshlrev_b32 v242, 16, v48
    v_and_b32 v243, 0xffff0000, v48
    v_fma_f32 v242, v242, v236, v240
    v_fma_f32 v243, v243, v236, v240
    v_cvt_pk_bf16_f32 v48, v242, v243
    v_lshlrev_b32 v242, 16, v49
    v_and_b32 v243, 0xffff0000, v49
    v_fma_f32 v242, v242, v236, v240
    v_fma_f32 v243, v243, v236, v240
    v_cvt_pk_bf16_f32 v49, v242, v243
    v_lshlrev_b32 v242, 16, v50
    v_and_b32 v243, 0xffff0000, v50
    v_fma_f32 v242, v242, v236, v240
    v_fma_f32 v243, v243, v236, v240
    v_cvt_pk_bf16_f32 v50, v242, v243
    v_lshlrev_b32 v242, 16, v51
    v_and_b32 v243, 0xffff0000, v51
    v_fma_f32 v242, v242, v236, v240
    v_fma_f32 v243, v243, v236, v240
    v_cvt_pk_bf16_f32 v51, v242, v243
    ds_write_b128 v8, v[48:51] offset:4608
    s_waitcnt vmcnt(11)
    ds_write_b128 v15, v[100:103] offset:0
    s_waitcnt vmcnt(10)
    ds_write_b128 v16, v[104:107] offset:0
    s_waitcnt vmcnt(9)
    ds_write_b128 v17, v[108:111] offset:0
    s_waitcnt vmcnt(8)
    ds_write_b128 v18, v[112:115] offset:0
    s_waitcnt vmcnt(7)
    ds_write_b128 v19, v[116:119] offset:0
    s_waitcnt vmcnt(6)
    ds_write_b128 v20, v[120:123] offset:0
    s_mov_b32 s26, 344064
    buffer_load_dwordx4 v[100:103], v9, s[12:15], s26 offen
    buffer_load_dwordx4 v[104:107], v10, s[12:15], s26 offen
    buffer_load_dwordx4 v[108:111], v11, s[12:15], s26 offen
    buffer_load_dwordx4 v[112:115], v12, s[12:15], s26 offen
    buffer_load_dwordx4 v[116:119], v13, s[12:15], s26 offen
    buffer_load_dwordx4 v[120:123], v14, s[12:15], s26 offen
    v_lshlrev_b32 v242, 16, v52
    v_and_b32 v243, 0xffff0000, v52
    v_fma_f32 v242, v242, v234, v238
    v_fma_f32 v243, v243, v234, v238
    v_cvt_pk_bf16_f32 v52, v242, v243
    v_lshlrev_b32 v242, 16, v53
    v_and_b32 v243, 0xffff0000, v53
    v_fma_f32 v242, v242, v234, v238
    v_fma_f32 v243, v243, v234, v238
    v_cvt_pk_bf16_f32 v53, v242, v243
    v_lshlrev_b32 v242, 16, v54
    v_and_b32 v243, 0xffff0000, v54
    v_fma_f32 v242, v242, v234, v238
    v_fma_f32 v243, v243, v234, v238
    v_cvt_pk_bf16_f32 v54, v242, v243
    v_lshlrev_b32 v242, 16, v55
    v_and_b32 v243, 0xffff0000, v55
    v_fma_f32 v242, v242, v234, v238
    v_fma_f32 v243, v243, v234, v238
    v_cvt_pk_bf16_f32 v55, v242, v243
    ds_write_b128 v27, v[52:55] offset:0
    v_lshlrev_b32 v242, 16, v56
    v_and_b32 v243, 0xffff0000, v56
    v_fma_f32 v242, v242, v236, v240
    v_fma_f32 v243, v243, v236, v240
    v_cvt_pk_bf16_f32 v56, v242, v243
    v_lshlrev_b32 v242, 16, v57
    v_and_b32 v243, 0xffff0000, v57
    v_fma_f32 v242, v242, v236, v240
    v_fma_f32 v243, v243, v236, v240
    v_cvt_pk_bf16_f32 v57, v242, v243
    v_lshlrev_b32 v242, 16, v58
    v_and_b32 v243, 0xffff0000, v58
    v_fma_f32 v242, v242, v236, v240
    v_fma_f32 v243, v243, v236, v240
    v_cvt_pk_bf16_f32 v58, v242, v243
    v_lshlrev_b32 v242, 16, v59
    v_and_b32 v243, 0xffff0000, v59
    v_fma_f32 v242, v242, v236, v240
    v_fma_f32 v243, v243, v236, v240
    v_cvt_pk_bf16_f32 v59, v242, v243
    ds_write_b128 v27, v[56:59] offset:4608
    s_waitcnt vmcnt(11)
    ds_write_b128 v29, v[124:127] offset:0
    s_waitcnt vmcnt(10)
    ds_write_b128 v31, v[128:131] offset:0
    s_waitcnt vmcnt(9)
    ds_write_b128 v33, v[132:135] offset:0
    s_waitcnt vmcnt(8)
    ds_write_b128 v35, v[136:139] offset:0
    s_waitcnt vmcnt(7)
    ds_write_b128 v37, v[140:143] offset:0
    s_waitcnt vmcnt(6)
    ds_write_b128 v39, v[144:147] offset:0
    s_mov_b32 s26, 516096
    buffer_load_dwordx4 v[124:127], v9, s[12:15], s26 offen
    buffer_load_dwordx4 v[128:131], v10, s[12:15], s26 offen
    buffer_load_dwordx4 v[132:135], v11, s[12:15], s26 offen
    buffer_load_dwordx4 v[136:139], v12, s[12:15], s26 offen
    buffer_load_dwordx4 v[140:143], v13, s[12:15], s26 offen
    buffer_load_dwordx4 v[144:147], v14, s[12:15], s26 offen
    s_waitcnt lgkmcnt(0)
    s_barrier
    ds_read_b128 v[148:151], v21 offset:0
    ds_read_b64_tr_b16 v[156:157], v22 offset:0
    ds_read_b64_tr_b16 v[158:159], v22 offset:1792
    ds_read_b64_tr_b16 v[160:161], v22 offset:64
    ds_read_b64_tr_b16 v[162:163], v22 offset:1856
    ds_read_b64_tr_b16 v[164:165], v22 offset:128
    ds_read_b64_tr_b16 v[166:167], v22 offset:1920
    s_waitcnt lgkmcnt(4)
    v_mfma_f32_32x32x16_bf16 v[180:195], v[156:159], v[148:151], 0
    ds_read_b128 v[152:155], v21 offset:32
    ds_read_b64_tr_b16 v[168:169], v22 offset:7168
    ds_read_b64_tr_b16 v[170:171], v22 offset:8960
    v_lshlrev_b32 v242, 16, v60
    v_and_b32 v243, 0xffff0000, v60
    v_fma_f32 v242, v242, v234, v238
    v_fma_f32 v243, v243, v234, v238
    v_cvt_pk_bf16_f32 v60, v242, v243
    v_lshlrev_b32 v242, 16, v61
    v_and_b32 v243, 0xffff0000, v61
    v_fma_f32 v242, v242, v234, v238
    v_fma_f32 v243, v243, v234, v238
    s_waitcnt lgkmcnt(5)
    v_mfma_f32_32x32x16_bf16 v[196:211], v[160:163], v[148:151], 0
    ds_read_b64_tr_b16 v[172:173], v22 offset:7232
    ds_read_b64_tr_b16 v[174:175], v22 offset:9024
    ds_read_b64_tr_b16 v[176:177], v22 offset:7296
    ds_read_b64_tr_b16 v[178:179], v22 offset:9088
    v_cvt_pk_bf16_f32 v61, v242, v243
    v_lshlrev_b32 v242, 16, v62
    v_and_b32 v243, 0xffff0000, v62
    v_fma_f32 v242, v242, v234, v238
    v_fma_f32 v243, v243, v234, v238
    v_cvt_pk_bf16_f32 v62, v242, v243
    v_lshlrev_b32 v242, 16, v63
    v_and_b32 v243, 0xffff0000, v63
    v_fma_f32 v242, v242, v234, v238
    s_waitcnt lgkmcnt(7)
    v_mfma_f32_32x32x16_bf16 v[212:227], v[164:167], v[148:151], 0
    v_fma_f32 v243, v243, v234, v238
    v_cvt_pk_bf16_f32 v63, v242, v243
    ds_write_b128 v28, v[60:63] offset:0
    v_lshlrev_b32 v242, 16, v64
    v_and_b32 v243, 0xffff0000, v64
    v_fma_f32 v242, v242, v236, v240
    v_fma_f32 v243, v243, v236, v240
    s_waitcnt lgkmcnt(5)
    v_mfma_f32_32x32x16_bf16 v[180:195], v[168:171], v[152:155], v[180:195]
    ds_read_b128 v[148:151], v21 offset:64
    ds_read_b64_tr_b16 v[156:157], v22 offset:14336
    ds_read_b64_tr_b16 v[158:159], v22 offset:16128
    v_cvt_pk_bf16_f32 v64, v242, v243
    v_lshlrev_b32 v242, 16, v65
    v_and_b32 v243, 0xffff0000, v65
    v_fma_f32 v242, v242, v236, v240
    v_fma_f32 v243, v243, v236, v240
    v_cvt_pk_bf16_f32 v65, v242, v243
    v_lshlrev_b32 v242, 16, v66
    v_and_b32 v243, 0xffff0000, v66
    s_waitcnt lgkmcnt(6)
    v_mfma_f32_32x32x16_bf16 v[196:211], v[172:175], v[152:155], v[196:211]
    ds_read_b64_tr_b16 v[160:161], v22 offset:14400
    ds_read_b64_tr_b16 v[162:163], v22 offset:16192
    ds_read_b64_tr_b16 v[164:165], v22 offset:14464
    ds_read_b64_tr_b16 v[166:167], v22 offset:16256
    v_fma_f32 v242, v242, v236, v240
    v_fma_f32 v243, v243, v236, v240
    v_cvt_pk_bf16_f32 v66, v242, v243
    v_lshlrev_b32 v242, 16, v67
    v_and_b32 v243, 0xffff0000, v67
    v_fma_f32 v242, v242, v236, v240
    v_fma_f32 v243, v243, v236, v240
    v_cvt_pk_bf16_f32 v67, v242, v243
    ds_write_b128 v28, v[64:67] offset:4608
    s_waitcnt lgkmcnt(9)
    v_mfma_f32_32x32x16_bf16 v[212:227], v[176:179], v[152:155], v[212:227]
    s_waitcnt vmcnt(11)
    ds_write_b128 v30, v[100:103] offset:0
    s_waitcnt vmcnt(10)
    ds_write_b128 v32, v[104:107] offset:0
    s_waitcnt lgkmcnt(7)
    v_mfma_f32_32x32x16_bf16 v[180:195], v[156:159], v[148:151], v[180:195]
    ds_read_b128 v[152:155], v21 offset:96
    ds_read_b64_tr_b16 v[168:169], v22 offset:21504
    ds_read_b64_tr_b16 v[170:171], v22 offset:23296
    s_waitcnt vmcnt(9)
    ds_write_b128 v34, v[108:111] offset:0
    s_waitcnt vmcnt(8)
    ds_write_b128 v36, v[112:115] offset:0
    s_waitcnt vmcnt(7)
    ds_write_b128 v38, v[116:119] offset:0
    s_waitcnt lgkmcnt(11)
    v_mfma_f32_32x32x16_bf16 v[196:211], v[160:163], v[148:151], v[196:211]
    ds_read_b64_tr_b16 v[172:173], v22 offset:21568
    ds_read_b64_tr_b16 v[174:175], v22 offset:23360
    ds_read_b64_tr_b16 v[176:177], v22 offset:21632
    ds_read_b64_tr_b16 v[178:179], v22 offset:23424
    s_waitcnt vmcnt(6)
    ds_write_b128 v40, v[120:123] offset:0
    s_mov_b32 s26, 688128
    buffer_load_dwordx4 v[100:103], v9, s[12:15], s26 offen
    buffer_load_dwordx4 v[104:107], v10, s[12:15], s26 offen
    s_waitcnt lgkmcnt(14)
    v_mfma_f32_32x32x16_bf16 v[212:227], v[164:167], v[148:151], v[212:227]
    buffer_load_dwordx4 v[108:111], v11, s[12:15], s26 offen
    buffer_load_dwordx4 v[112:115], v12, s[12:15], s26 offen
    buffer_load_dwordx4 v[116:119], v13, s[12:15], s26 offen
    s_waitcnt lgkmcnt(8)
    v_mfma_f32_32x32x16_bf16 v[180:195], v[168:171], v[152:155], v[180:195]
    ds_read_b128 v[148:151], v23 offset:0
    ds_read_b64_tr_b16 v[156:157], v25 offset:0
    ds_read_b64_tr_b16 v[158:159], v25 offset:1792
    buffer_load_dwordx4 v[120:123], v14, s[12:15], s26 offen
    s_waitcnt lgkmcnt(6)
    v_mfma_f32_32x32x16_bf16 v[196:211], v[172:175], v[152:155], v[196:211]
    ds_read_b64_tr_b16 v[160:161], v25 offset:64
    ds_read_b64_tr_b16 v[162:163], v25 offset:1856
    ds_read_b64_tr_b16 v[164:165], v25 offset:128
    ds_read_b64_tr_b16 v[166:167], v25 offset:1920
    s_waitcnt lgkmcnt(8)
    v_mfma_f32_32x32x16_bf16 v[212:227], v[176:179], v[152:155], v[212:227]
    s_waitcnt lgkmcnt(7)
    s_barrier
    s_waitcnt lgkmcnt(4)
    v_mfma_f32_32x32x16_bf16 v[180:195], v[156:159], v[148:151], v[180:195]
    ds_read_b128 v[152:155], v23 offset:32
    ds_read_b64_tr_b16 v[168:169], v25 offset:7168
    ds_read_b64_tr_b16 v[170:171], v25 offset:8960
    v_lshlrev_b32 v242, 16, v68
    v_and_b32 v243, 0xffff0000, v68
    v_fma_f32 v242, v242, v234, v238
    v_fma_f32 v243, v243, v234, v238
    v_cvt_pk_bf16_f32 v68, v242, v243
    v_lshlrev_b32 v242, 16, v69
    v_and_b32 v243, 0xffff0000, v69
    v_fma_f32 v242, v242, v234, v238
    v_fma_f32 v243, v243, v234, v238
    s_waitcnt lgkmcnt(5)
    v_mfma_f32_32x32x16_bf16 v[196:211], v[160:163], v[148:151], v[196:211]
    ds_read_b64_tr_b16 v[172:173], v25 offset:7232
    ds_read_b64_tr_b16 v[174:175], v25 offset:9024
    ds_read_b64_tr_b16 v[176:177], v25 offset:7296
    ds_read_b64_tr_b16 v[178:179], v25 offset:9088
    v_cvt_pk_bf16_f32 v69, v242, v243
    v_lshlrev_b32 v242, 16, v70
    v_and_b32 v243, 0xffff0000, v70
    v_fma_f32 v242, v242, v234, v238
    v_fma_f32 v243, v243, v234, v238
    v_cvt_pk_bf16_f32 v70, v242, v243
    v_lshlrev_b32 v242, 16, v71
    v_and_b32 v243, 0xffff0000, v71
    v_fma_f32 v242, v242, v234, v238
    s_waitcnt lgkmcnt(7)
    v_mfma_f32_32x32x16_bf16 v[212:227], v[164:167], v[148:151], v[212:227]
    v_fma_f32 v243, v243, v234, v238
    v_cvt_pk_bf16_f32 v71, v242, v243
    ds_write_b128 v8, v[68:71] offset:0
    v_lshlrev_b32 v242, 16, v72
    v_and_b32 v243, 0xffff0000, v72
    v_fma_f32 v242, v242, v236, v240
    v_fma_f32 v243, v243, v236, v240
    s_waitcnt lgkmcnt(5)
    v_mfma_f32_32x32x16_bf16 v[180:195], v[168:171], v[152:155], v[180:195]
    ds_read_b128 v[148:151], v23 offset:64
    ds_read_b64_tr_b16 v[156:157], v25 offset:14336
    ds_read_b64_tr_b16 v[158:159], v25 offset:16128
    v_cvt_pk_bf16_f32 v72, v242, v243
    v_lshlrev_b32 v242, 16, v73
    v_and_b32 v243, 0xffff0000, v73
    v_fma_f32 v242, v242, v236, v240
    v_fma_f32 v243, v243, v236, v240
    v_cvt_pk_bf16_f32 v73, v242, v243
    v_lshlrev_b32 v242, 16, v74
    v_and_b32 v243, 0xffff0000, v74
    s_waitcnt lgkmcnt(6)
    v_mfma_f32_32x32x16_bf16 v[196:211], v[172:175], v[152:155], v[196:211]
    ds_read_b64_tr_b16 v[160:161], v25 offset:14400
    ds_read_b64_tr_b16 v[162:163], v25 offset:16192
    ds_read_b64_tr_b16 v[164:165], v25 offset:14464
    ds_read_b64_tr_b16 v[166:167], v25 offset:16256
    v_fma_f32 v242, v242, v236, v240
    v_fma_f32 v243, v243, v236, v240
    v_cvt_pk_bf16_f32 v74, v242, v243
    v_lshlrev_b32 v242, 16, v75
    v_and_b32 v243, 0xffff0000, v75
    v_fma_f32 v242, v242, v236, v240
    v_fma_f32 v243, v243, v236, v240
    v_cvt_pk_bf16_f32 v75, v242, v243
    ds_write_b128 v8, v[72:75] offset:4608
    s_waitcnt lgkmcnt(9)
    v_mfma_f32_32x32x16_bf16 v[212:227], v[176:179], v[152:155], v[212:227]
    s_waitcnt vmcnt(11)
    ds_write_b128 v15, v[124:127] offset:0
    s_waitcnt vmcnt(10)
    ds_write_b128 v16, v[128:131] offset:0
    s_waitcnt lgkmcnt(7)
    v_mfma_f32_32x32x16_bf16 v[180:195], v[156:159], v[148:151], v[180:195]
    ds_read_b128 v[152:155], v23 offset:96
    ds_read_b64_tr_b16 v[168:169], v25 offset:21504
    ds_read_b64_tr_b16 v[170:171], v25 offset:23296
    s_waitcnt vmcnt(9)
    ds_write_b128 v17, v[132:135] offset:0
    s_waitcnt vmcnt(8)
    ds_write_b128 v18, v[136:139] offset:0
    s_waitcnt vmcnt(7)
    ds_write_b128 v19, v[140:143] offset:0
    s_waitcnt lgkmcnt(11)
    v_mfma_f32_32x32x16_bf16 v[196:211], v[160:163], v[148:151], v[196:211]
    ds_read_b64_tr_b16 v[172:173], v25 offset:21568
    ds_read_b64_tr_b16 v[174:175], v25 offset:23360
    ds_read_b64_tr_b16 v[176:177], v25 offset:21632
    ds_read_b64_tr_b16 v[178:179], v25 offset:23424
    s_waitcnt vmcnt(6)
    ds_write_b128 v20, v[144:147] offset:0
    s_mov_b32 s26, 860160
    buffer_load_dwordx4 v[124:127], v9, s[12:15], s26 offen
    buffer_load_dwordx4 v[128:131], v10, s[12:15], s26 offen
    s_waitcnt lgkmcnt(14)
    v_mfma_f32_32x32x16_bf16 v[212:227], v[164:167], v[148:151], v[212:227]
    buffer_load_dwordx4 v[132:135], v11, s[12:15], s26 offen
    buffer_load_dwordx4 v[136:139], v12, s[12:15], s26 offen
    buffer_load_dwordx4 v[140:143], v13, s[12:15], s26 offen
    s_waitcnt lgkmcnt(8)
    v_mfma_f32_32x32x16_bf16 v[180:195], v[168:171], v[152:155], v[180:195]
    ds_read_b128 v[148:151], v24 offset:0
    ds_read_b64_tr_b16 v[156:157], v26 offset:0
    ds_read_b64_tr_b16 v[158:159], v26 offset:1792
    buffer_load_dwordx4 v[144:147], v14, s[12:15], s26 offen
    s_waitcnt lgkmcnt(6)
    v_mfma_f32_32x32x16_bf16 v[196:211], v[172:175], v[152:155], v[196:211]
    ds_read_b64_tr_b16 v[160:161], v26 offset:64
    ds_read_b64_tr_b16 v[162:163], v26 offset:1856
    ds_read_b64_tr_b16 v[164:165], v26 offset:128
    ds_read_b64_tr_b16 v[166:167], v26 offset:1920
    s_waitcnt lgkmcnt(8)
    v_mfma_f32_32x32x16_bf16 v[212:227], v[176:179], v[152:155], v[212:227]
    s_waitcnt lgkmcnt(7)
    s_barrier
    s_waitcnt lgkmcnt(4)
    v_mfma_f32_32x32x16_bf16 v[180:195], v[156:159], v[148:151], v[180:195]
    ds_read_b128 v[152:155], v24 offset:32
    ds_read_b64_tr_b16 v[168:169], v26 offset:7168
    ds_read_b64_tr_b16 v[170:171], v26 offset:8960
    v_lshlrev_b32 v242, 16, v76
    v_and_b32 v243, 0xffff0000, v76
    v_fma_f32 v242, v242, v234, v238
    v_fma_f32 v243, v243, v234, v238
    v_cvt_pk_bf16_f32 v76, v242, v243
    v_lshlrev_b32 v242, 16, v77
    v_and_b32 v243, 0xffff0000, v77
    v_fma_f32 v242, v242, v234, v238
    v_fma_f32 v243, v243, v234, v238
    s_waitcnt lgkmcnt(5)
    v_mfma_f32_32x32x16_bf16 v[196:211], v[160:163], v[148:151], v[196:211]
    ds_read_b64_tr_b16 v[172:173], v26 offset:7232
    ds_read_b64_tr_b16 v[174:175], v26 offset:9024
    ds_read_b64_tr_b16 v[176:177], v26 offset:7296
    ds_read_b64_tr_b16 v[178:179], v26 offset:9088
    v_cvt_pk_bf16_f32 v77, v242, v243
    v_lshlrev_b32 v242, 16, v78
    v_and_b32 v243, 0xffff0000, v78
    v_fma_f32 v242, v242, v234, v238
    v_fma_f32 v243, v243, v234, v238
    v_cvt_pk_bf16_f32 v78, v242, v243
    v_lshlrev_b32 v242, 16, v79
    v_and_b32 v243, 0xffff0000, v79
    v_fma_f32 v242, v242, v234, v238
    s_waitcnt lgkmcnt(7)
    v_mfma_f32_32x32x16_bf16 v[212:227], v[164:167], v[148:151], v[212:227]
    v_fma_f32 v243, v243, v234, v238
    v_cvt_pk_bf16_f32 v79, v242, v243
    ds_write_b128 v27, v[76:79] offset:0
    v_lshlrev_b32 v242, 16, v80
    v_and_b32 v243, 0xffff0000, v80
    v_fma_f32 v242, v242, v236, v240
    v_fma_f32 v243, v243, v236, v240
    s_waitcnt lgkmcnt(5)
    v_mfma_f32_32x32x16_bf16 v[180:195], v[168:171], v[152:155], v[180:195]
    ds_read_b128 v[148:151], v24 offset:64
    ds_read_b64_tr_b16 v[156:157], v26 offset:14336
    ds_read_b64_tr_b16 v[158:159], v26 offset:16128
    v_cvt_pk_bf16_f32 v80, v242, v243
    v_lshlrev_b32 v242, 16, v81
    v_and_b32 v243, 0xffff0000, v81
    v_fma_f32 v242, v242, v236, v240
    v_fma_f32 v243, v243, v236, v240
    v_cvt_pk_bf16_f32 v81, v242, v243
    v_lshlrev_b32 v242, 16, v82
    v_and_b32 v243, 0xffff0000, v82
    s_waitcnt lgkmcnt(6)
    v_mfma_f32_32x32x16_bf16 v[196:211], v[172:175], v[152:155], v[196:211]
    ds_read_b64_tr_b16 v[160:161], v26 offset:14400
    ds_read_b64_tr_b16 v[162:163], v26 offset:16192
    ds_read_b64_tr_b16 v[164:165], v26 offset:14464
    ds_read_b64_tr_b16 v[166:167], v26 offset:16256
    v_fma_f32 v242, v242, v236, v240
    v_fma_f32 v243, v243, v236, v240
    v_cvt_pk_bf16_f32 v82, v242, v243
    v_lshlrev_b32 v242, 16, v83
    v_and_b32 v243, 0xffff0000, v83
    v_fma_f32 v242, v242, v236, v240
    v_fma_f32 v243, v243, v236, v240
    v_cvt_pk_bf16_f32 v83, v242, v243
    ds_write_b128 v27, v[80:83] offset:4608
    s_waitcnt lgkmcnt(9)
    v_mfma_f32_32x32x16_bf16 v[212:227], v[176:179], v[152:155], v[212:227]
    s_waitcnt vmcnt(11)
    ds_write_b128 v29, v[100:103] offset:0
    s_waitcnt vmcnt(10)
    ds_write_b128 v31, v[104:107] offset:0
    s_waitcnt lgkmcnt(7)
    v_mfma_f32_32x32x16_bf16 v[180:195], v[156:159], v[148:151], v[180:195]
    ds_read_b128 v[152:155], v24 offset:96
    ds_read_b64_tr_b16 v[168:169], v26 offset:21504
    ds_read_b64_tr_b16 v[170:171], v26 offset:23296
    s_waitcnt vmcnt(9)
    ds_write_b128 v33, v[108:111] offset:0
    s_waitcnt vmcnt(8)
    ds_write_b128 v35, v[112:115] offset:0
    s_waitcnt vmcnt(7)
    ds_write_b128 v37, v[116:119] offset:0
    s_waitcnt lgkmcnt(11)
    v_mfma_f32_32x32x16_bf16 v[196:211], v[160:163], v[148:151], v[196:211]
    ds_read_b64_tr_b16 v[172:173], v26 offset:21568
    ds_read_b64_tr_b16 v[174:175], v26 offset:23360
    ds_read_b64_tr_b16 v[176:177], v26 offset:21632
    ds_read_b64_tr_b16 v[178:179], v26 offset:23424
    s_waitcnt vmcnt(6)
    ds_write_b128 v39, v[120:123] offset:0
    s_mov_b32 s26, 1032192
    buffer_load_dwordx4 v[100:103], v9, s[12:15], s26 offen
    buffer_load_dwordx4 v[104:107], v10, s[12:15], s26 offen
    s_waitcnt lgkmcnt(14)
    v_mfma_f32_32x32x16_bf16 v[212:227], v[164:167], v[148:151], v[212:227]
    buffer_load_dwordx4 v[108:111], v11, s[12:15], s26 offen
    buffer_load_dwordx4 v[112:115], v12, s[12:15], s26 offen
    buffer_load_dwordx4 v[116:119], v13, s[12:15], s26 offen
    s_waitcnt lgkmcnt(8)
    v_mfma_f32_32x32x16_bf16 v[180:195], v[168:171], v[152:155], v[180:195]
    ds_read_b128 v[148:151], v21 offset:0
    ds_read_b64_tr_b16 v[156:157], v22 offset:0
    ds_read_b64_tr_b16 v[158:159], v22 offset:1792
    buffer_load_dwordx4 v[120:123], v14, s[12:15], s26 offen
    s_waitcnt lgkmcnt(6)
    v_mfma_f32_32x32x16_bf16 v[196:211], v[172:175], v[152:155], v[196:211]
    ds_read_b64_tr_b16 v[160:161], v22 offset:64
    ds_read_b64_tr_b16 v[162:163], v22 offset:1856
    ds_read_b64_tr_b16 v[164:165], v22 offset:128
    ds_read_b64_tr_b16 v[166:167], v22 offset:1920
    s_waitcnt lgkmcnt(8)
    v_mfma_f32_32x32x16_bf16 v[212:227], v[176:179], v[152:155], v[212:227]
    s_waitcnt lgkmcnt(7)
    s_barrier
    s_waitcnt lgkmcnt(4)
    v_mfma_f32_32x32x16_bf16 v[180:195], v[156:159], v[148:151], v[180:195]
    ds_read_b128 v[152:155], v21 offset:32
    ds_read_b64_tr_b16 v[168:169], v22 offset:7168
    ds_read_b64_tr_b16 v[170:171], v22 offset:8960
    v_lshlrev_b32 v242, 16, v84
    v_and_b32 v243, 0xffff0000, v84
    v_fma_f32 v242, v242, v234, v238
    v_fma_f32 v243, v243, v234, v238
    v_cvt_pk_bf16_f32 v84, v242, v243
    v_lshlrev_b32 v242, 16, v85
    v_and_b32 v243, 0xffff0000, v85
    s_waitcnt lgkmcnt(5)
    v_mfma_f32_32x32x16_bf16 v[196:211], v[160:163], v[148:151], v[196:211]
    ds_read_b64_tr_b16 v[172:173], v22 offset:7232
    ds_read_b64_tr_b16 v[174:175], v22 offset:9024
    ds_read_b64_tr_b16 v[176:177], v22 offset:7296
    ds_read_b64_tr_b16 v[178:179], v22 offset:9088
    v_fma_f32 v242, v242, v234, v238
    v_fma_f32 v243, v243, v234, v238
    v_cvt_pk_bf16_f32 v85, v242, v243
    v_lshlrev_b32 v242, 16, v86
    v_and_b32 v243, 0xffff0000, v86
    v_fma_f32 v242, v242, v234, v238
    v_fma_f32 v243, v243, v234, v238
    s_waitcnt lgkmcnt(7)
    v_mfma_f32_32x32x16_bf16 v[212:227], v[164:167], v[148:151], v[212:227]
    v_cvt_pk_bf16_f32 v86, v242, v243
    v_lshlrev_b32 v242, 16, v87
    v_and_b32 v243, 0xffff0000, v87
    v_fma_f32 v242, v242, v234, v238
    v_fma_f32 v243, v243, v234, v238
    v_cvt_pk_bf16_f32 v87, v242, v243
    ds_write_b128 v28, v[84:87] offset:0
    s_waitcnt lgkmcnt(5)
    v_mfma_f32_32x32x16_bf16 v[180:195], v[168:171], v[152:155], v[180:195]
    ds_read_b128 v[148:151], v21 offset:64
    ds_read_b64_tr_b16 v[156:157], v22 offset:14336
    ds_read_b64_tr_b16 v[158:159], v22 offset:16128
    v_lshlrev_b32 v242, 16, v88
    v_and_b32 v243, 0xffff0000, v88
    v_fma_f32 v242, v242, v236, v240
    v_fma_f32 v243, v243, v236, v240
    v_cvt_pk_bf16_f32 v88, v242, v243
    s_waitcnt lgkmcnt(6)
    v_mfma_f32_32x32x16_bf16 v[196:211], v[172:175], v[152:155], v[196:211]
    ds_read_b64_tr_b16 v[160:161], v22 offset:14400
    ds_read_b64_tr_b16 v[162:163], v22 offset:16192
    ds_read_b64_tr_b16 v[164:165], v22 offset:14464
    ds_read_b64_tr_b16 v[166:167], v22 offset:16256
    v_lshlrev_b32 v242, 16, v89
    v_and_b32 v243, 0xffff0000, v89
    v_fma_f32 v242, v242, v236, v240
    v_fma_f32 v243, v243, v236, v240
    v_cvt_pk_bf16_f32 v89, v242, v243
    v_lshlrev_b32 v242, 16, v90
    v_and_b32 v243, 0xffff0000, v90
    s_waitcnt lgkmcnt(8)
    v_mfma_f32_32x32x16_bf16 v[212:227], v[176:179], v[152:155], v[212:227]
    v_fma_f32 v242, v242, v236, v240
    v_fma_f32 v243, v243, v236, v240
    v_cvt_pk_bf16_f32 v90, v242, v243
    v_lshlrev_b32 v242, 16, v91
    v_and_b32 v243, 0xffff0000, v91
    v_fma_f32 v242, v242, v236, v240
    s_waitcnt lgkmcnt(4)
    v_mfma_f32_32x32x16_bf16 v[180:195], v[156:159], v[148:151], v[180:195]
    ds_read_b128 v[152:155], v21 offset:96
    ds_read_b64_tr_b16 v[168:169], v22 offset:21504
    ds_read_b64_tr_b16 v[170:171], v22 offset:23296
    v_fma_f32 v243, v243, v236, v240
    v_cvt_pk_bf16_f32 v91, v242, v243
    ds_write_b128 v28, v[88:91] offset:4608
    s_waitcnt vmcnt(11)
    ds_write_b128 v30, v[124:127] offset:0
    s_waitcnt lgkmcnt(7)
    v_mfma_f32_32x32x16_bf16 v[196:211], v[160:163], v[148:151], v[196:211]
    ds_read_b64_tr_b16 v[172:173], v22 offset:21568
    ds_read_b64_tr_b16 v[174:175], v22 offset:23360
    ds_read_b64_tr_b16 v[176:177], v22 offset:21632
    ds_read_b64_tr_b16 v[178:179], v22 offset:23424
    s_waitcnt vmcnt(10)
    ds_write_b128 v32, v[128:131] offset:0
    s_waitcnt vmcnt(9)
    ds_write_b128 v34, v[132:135] offset:0
    s_waitcnt lgkmcnt(11)
    v_mfma_f32_32x32x16_bf16 v[212:227], v[164:167], v[148:151], v[212:227]
    s_waitcnt vmcnt(8)
    ds_write_b128 v36, v[136:139] offset:0
    s_waitcnt vmcnt(7)
    ds_write_b128 v38, v[140:143] offset:0
    s_waitcnt lgkmcnt(10)
    v_mfma_f32_32x32x16_bf16 v[180:195], v[168:171], v[152:155], v[180:195]
    ds_read_b128 v[148:151], v23 offset:0
    ds_read_b64_tr_b16 v[156:157], v25 offset:0
    ds_read_b64_tr_b16 v[158:159], v25 offset:1792
    s_waitcnt vmcnt(6)
    ds_write_b128 v40, v[144:147] offset:0
    s_waitcnt lgkmcnt(10)
    v_mfma_f32_32x32x16_bf16 v[196:211], v[172:175], v[152:155], v[196:211]
    ds_read_b64_tr_b16 v[160:161], v25 offset:64
    ds_read_b64_tr_b16 v[162:163], v25 offset:1856
    ds_read_b64_tr_b16 v[164:165], v25 offset:128
    ds_read_b64_tr_b16 v[166:167], v25 offset:1920
    s_waitcnt lgkmcnt(12)
    v_mfma_f32_32x32x16_bf16 v[212:227], v[176:179], v[152:155], v[212:227]
    s_waitcnt lgkmcnt(4)
    s_barrier
    v_mfma_f32_32x32x16_bf16 v[180:195], v[156:159], v[148:151], v[180:195]
    ds_read_b128 v[152:155], v23 offset:32
    ds_read_b64_tr_b16 v[168:169], v25 offset:7168
    ds_read_b64_tr_b16 v[170:171], v25 offset:8960
    v_lshlrev_b32 v242, 16, v92
    v_and_b32 v243, 0xffff0000, v92
    v_fma_f32 v242, v242, v234, v238
    v_fma_f32 v243, v243, v234, v238
    v_cvt_pk_bf16_f32 v92, v242, v243
    v_lshlrev_b32 v242, 16, v93
    v_and_b32 v243, 0xffff0000, v93
    s_waitcnt lgkmcnt(5)
    v_mfma_f32_32x32x16_bf16 v[196:211], v[160:163], v[148:151], v[196:211]
    ds_read_b64_tr_b16 v[172:173], v25 offset:7232
    ds_read_b64_tr_b16 v[174:175], v25 offset:9024
    ds_read_b64_tr_b16 v[176:177], v25 offset:7296
    ds_read_b64_tr_b16 v[178:179], v25 offset:9088
    v_fma_f32 v242, v242, v234, v238
    v_fma_f32 v243, v243, v234, v238
    v_cvt_pk_bf16_f32 v93, v242, v243
    v_lshlrev_b32 v242, 16, v94
    v_and_b32 v243, 0xffff0000, v94
    v_fma_f32 v242, v242, v234, v238
    v_fma_f32 v243, v243, v234, v238
    s_waitcnt lgkmcnt(7)
    v_mfma_f32_32x32x16_bf16 v[212:227], v[164:167], v[148:151], v[212:227]
    v_cvt_pk_bf16_f32 v94, v242, v243
    v_lshlrev_b32 v242, 16, v95
    v_and_b32 v243, 0xffff0000, v95
    v_fma_f32 v242, v242, v234, v238
    v_fma_f32 v243, v243, v234, v238
    v_cvt_pk_bf16_f32 v95, v242, v243
    ds_write_b128 v8, v[92:95] offset:0
    s_waitcnt lgkmcnt(5)
    v_mfma_f32_32x32x16_bf16 v[180:195], v[168:171], v[152:155], v[180:195]
    ds_read_b128 v[148:151], v23 offset:64
    ds_read_b64_tr_b16 v[156:157], v25 offset:14336
    ds_read_b64_tr_b16 v[158:159], v25 offset:16128
    v_lshlrev_b32 v242, 16, v96
    v_and_b32 v243, 0xffff0000, v96
    v_fma_f32 v242, v242, v236, v240
    v_fma_f32 v243, v243, v236, v240
    v_cvt_pk_bf16_f32 v96, v242, v243
    s_waitcnt lgkmcnt(6)
    v_mfma_f32_32x32x16_bf16 v[196:211], v[172:175], v[152:155], v[196:211]
    ds_read_b64_tr_b16 v[160:161], v25 offset:14400
    ds_read_b64_tr_b16 v[162:163], v25 offset:16192
    ds_read_b64_tr_b16 v[164:165], v25 offset:14464
    ds_read_b64_tr_b16 v[166:167], v25 offset:16256
    v_lshlrev_b32 v242, 16, v97
    v_and_b32 v243, 0xffff0000, v97
    v_fma_f32 v242, v242, v236, v240
    v_fma_f32 v243, v243, v236, v240
    v_cvt_pk_bf16_f32 v97, v242, v243
    v_lshlrev_b32 v242, 16, v98
    v_and_b32 v243, 0xffff0000, v98
    s_waitcnt lgkmcnt(8)
    v_mfma_f32_32x32x16_bf16 v[212:227], v[176:179], v[152:155], v[212:227]
    v_fma_f32 v242, v242, v236, v240
    v_fma_f32 v243, v243, v236, v240
    v_cvt_pk_bf16_f32 v98, v242, v243
    v_lshlrev_b32 v242, 16, v99
    v_and_b32 v243, 0xffff0000, v99
    v_fma_f32 v242, v242, v236, v240
    s_waitcnt lgkmcnt(4)
    v_mfma_f32_32x32x16_bf16 v[180:195], v[156:159], v[148:151], v[180:195]
    ds_read_b128 v[152:155], v23 offset:96
    ds_read_b64_tr_b16 v[168:169], v25 offset:21504
    ds_read_b64_tr_b16 v[170:171], v25 offset:23296
    v_fma_f32 v243, v243, v236, v240
    v_cvt_pk_bf16_f32 v99, v242, v243
    ds_write_b128 v8, v[96:99] offset:4608
    s_waitcnt vmcnt(5)
    ds_write_b128 v15, v[100:103] offset:0
    s_waitcnt lgkmcnt(7)
    v_mfma_f32_32x32x16_bf16 v[196:211], v[160:163], v[148:151], v[196:211]
    ds_read_b64_tr_b16 v[172:173], v25 offset:21568
    ds_read_b64_tr_b16 v[174:175], v25 offset:23360
    ds_read_b64_tr_b16 v[176:177], v25 offset:21632
    ds_read_b64_tr_b16 v[178:179], v25 offset:23424
    s_waitcnt vmcnt(4)
    ds_write_b128 v16, v[104:107] offset:0
    s_waitcnt vmcnt(3)
    ds_write_b128 v17, v[108:111] offset:0
    s_waitcnt lgkmcnt(11)
    v_mfma_f32_32x32x16_bf16 v[212:227], v[164:167], v[148:151], v[212:227]
    s_waitcnt vmcnt(2)
    ds_write_b128 v18, v[112:115] offset:0
    s_waitcnt vmcnt(1)
    ds_write_b128 v19, v[116:119] offset:0
    s_waitcnt lgkmcnt(10)
    v_mfma_f32_32x32x16_bf16 v[180:195], v[168:171], v[152:155], v[180:195]
    ds_read_b128 v[148:151], v24 offset:0
    ds_read_b64_tr_b16 v[156:157], v26 offset:0
    ds_read_b64_tr_b16 v[158:159], v26 offset:1792
    s_waitcnt vmcnt(0)
    ds_write_b128 v20, v[120:123] offset:0
    s_waitcnt lgkmcnt(10)
    v_mfma_f32_32x32x16_bf16 v[196:211], v[172:175], v[152:155], v[196:211]
    ds_read_b64_tr_b16 v[160:161], v26 offset:64
    ds_read_b64_tr_b16 v[162:163], v26 offset:1856
    ds_read_b64_tr_b16 v[164:165], v26 offset:128
    ds_read_b64_tr_b16 v[166:167], v26 offset:1920
    s_waitcnt lgkmcnt(12)
    v_mfma_f32_32x32x16_bf16 v[212:227], v[176:179], v[152:155], v[212:227]
    s_waitcnt lgkmcnt(4)
    s_barrier
    v_mfma_f32_32x32x16_bf16 v[180:195], v[156:159], v[148:151], v[180:195]
    ds_read_b128 v[152:155], v24 offset:32
    ds_read_b64_tr_b16 v[168:169], v26 offset:7168
    ds_read_b64_tr_b16 v[170:171], v26 offset:8960
    s_waitcnt lgkmcnt(5)
    v_mfma_f32_32x32x16_bf16 v[196:211], v[160:163], v[148:151], v[196:211]
    ds_read_b64_tr_b16 v[172:173], v26 offset:7232
    ds_read_b64_tr_b16 v[174:175], v26 offset:9024
    ds_read_b64_tr_b16 v[176:177], v26 offset:7296
    ds_read_b64_tr_b16 v[178:179], v26 offset:9088
    s_waitcnt lgkmcnt(7)
    v_mfma_f32_32x32x16_bf16 v[212:227], v[164:167], v[148:151], v[212:227]
    s_waitcnt lgkmcnt(4)
    v_mfma_f32_32x32x16_bf16 v[180:195], v[168:171], v[152:155], v[180:195]
    ds_read_b128 v[148:151], v24 offset:64
    ds_read_b64_tr_b16 v[156:157], v26 offset:14336
    ds_read_b64_tr_b16 v[158:159], v26 offset:16128
    s_waitcnt lgkmcnt(5)
    v_mfma_f32_32x32x16_bf16 v[196:211], v[172:175], v[152:155], v[196:211]
    ds_read_b64_tr_b16 v[160:161], v26 offset:14400
    ds_read_b64_tr_b16 v[162:163], v26 offset:16192
    ds_read_b64_tr_b16 v[164:165], v26 offset:14464
    ds_read_b64_tr_b16 v[166:167], v26 offset:16256
    s_waitcnt lgkmcnt(7)
    v_mfma_f32_32x32x16_bf16 v[212:227], v[176:179], v[152:155], v[212:227]
    s_waitcnt lgkmcnt(4)
    v_mfma_f32_32x32x16_bf16 v[180:195], v[156:159], v[148:151], v[180:195]
    ds_read_b128 v[152:155], v24 offset:96
    ds_read_b64_tr_b16 v[168:169], v26 offset:21504
    ds_read_b64_tr_b16 v[170:171], v26 offset:23296
    s_waitcnt lgkmcnt(5)
    v_mfma_f32_32x32x16_bf16 v[196:211], v[160:163], v[148:151], v[196:211]
    ds_read_b64_tr_b16 v[172:173], v26 offset:21568
    ds_read_b64_tr_b16 v[174:175], v26 offset:23360
    ds_read_b64_tr_b16 v[176:177], v26 offset:21632
    ds_read_b64_tr_b16 v[178:179], v26 offset:23424
    s_waitcnt lgkmcnt(7)
    v_mfma_f32_32x32x16_bf16 v[212:227], v[164:167], v[148:151], v[212:227]
    s_waitcnt lgkmcnt(4)
    v_mfma_f32_32x32x16_bf16 v[180:195], v[168:171], v[152:155], v[180:195]
    ds_read_b128 v[148:151], v21 offset:0
    ds_read_b64_tr_b16 v[156:157], v22 offset:0
    ds_read_b64_tr_b16 v[158:159], v22 offset:1792
    s_waitcnt lgkmcnt(5)
    v_mfma_f32_32x32x16_bf16 v[196:211], v[172:175], v[152:155], v[196:211]
    ds_read_b64_tr_b16 v[160:161], v22 offset:64
    ds_read_b64_tr_b16 v[162:163], v22 offset:1856
    ds_read_b64_tr_b16 v[164:165], v22 offset:128
    ds_read_b64_tr_b16 v[166:167], v22 offset:1920
    s_waitcnt lgkmcnt(7)
    v_mfma_f32_32x32x16_bf16 v[212:227], v[176:179], v[152:155], v[212:227]
    s_waitcnt lgkmcnt(4)
    v_mfma_f32_32x32x16_bf16 v[180:195], v[156:159], v[148:151], v[180:195]
    ds_read_b128 v[152:155], v21 offset:32
    ds_read_b64_tr_b16 v[168:169], v22 offset:7168
    ds_read_b64_tr_b16 v[170:171], v22 offset:8960
    s_waitcnt lgkmcnt(5)
    v_mfma_f32_32x32x16_bf16 v[196:211], v[160:163], v[148:151], v[196:211]
    ds_read_b64_tr_b16 v[172:173], v22 offset:7232
    ds_read_b64_tr_b16 v[174:175], v22 offset:9024
    ds_read_b64_tr_b16 v[176:177], v22 offset:7296
    ds_read_b64_tr_b16 v[178:179], v22 offset:9088
    s_waitcnt lgkmcnt(7)
    v_mfma_f32_32x32x16_bf16 v[212:227], v[164:167], v[148:151], v[212:227]
    s_waitcnt lgkmcnt(4)
    v_mfma_f32_32x32x16_bf16 v[180:195], v[168:171], v[152:155], v[180:195]
    ds_read_b128 v[148:151], v21 offset:64
    ds_read_b64_tr_b16 v[156:157], v22 offset:14336
    ds_read_b64_tr_b16 v[158:159], v22 offset:16128
    s_waitcnt lgkmcnt(5)
    v_mfma_f32_32x32x16_bf16 v[196:211], v[172:175], v[152:155], v[196:211]
    ds_read_b64_tr_b16 v[160:161], v22 offset:14400
    ds_read_b64_tr_b16 v[162:163], v22 offset:16192
    ds_read_b64_tr_b16 v[164:165], v22 offset:14464
    ds_read_b64_tr_b16 v[166:167], v22 offset:16256
    s_waitcnt lgkmcnt(7)
    v_mfma_f32_32x32x16_bf16 v[212:227], v[176:179], v[152:155], v[212:227]
    s_waitcnt lgkmcnt(4)
    v_mfma_f32_32x32x16_bf16 v[180:195], v[156:159], v[148:151], v[180:195]
    ds_read_b128 v[152:155], v21 offset:96
    ds_read_b64_tr_b16 v[168:169], v22 offset:21504
    ds_read_b64_tr_b16 v[170:171], v22 offset:23296
    s_waitcnt lgkmcnt(5)
    v_mfma_f32_32x32x16_bf16 v[196:211], v[160:163], v[148:151], v[196:211]
    ds_read_b64_tr_b16 v[172:173], v22 offset:21568
    ds_read_b64_tr_b16 v[174:175], v22 offset:23360
    ds_read_b64_tr_b16 v[176:177], v22 offset:21632
    ds_read_b64_tr_b16 v[178:179], v22 offset:23424
    s_waitcnt lgkmcnt(7)
    v_mfma_f32_32x32x16_bf16 v[212:227], v[164:167], v[148:151], v[212:227]
    s_waitcnt lgkmcnt(4)
    v_mfma_f32_32x32x16_bf16 v[180:195], v[168:171], v[152:155], v[180:195]
    s_waitcnt lgkmcnt(2)
    v_mfma_f32_32x32x16_bf16 v[196:211], v[172:175], v[152:155], v[196:211]
    s_waitcnt lgkmcnt(0)
    v_mfma_f32_32x32x16_bf16 v[212:227], v[176:179], v[152:155], v[212:227]
    s_mul_i32 s27, s24, 64
    s_mul_i32 s28, s25, 192
    v_and_b32 v5, 31, v1
    v_lshrrev_b32 v6, 5, v1
    v_lshlrev_b32 v6, 2, v6
    v_lshrrev_b32 v3, 1, v2
    v_and_b32 v4, 1, v2
    v_mul_u32_u24 v3, 32, v3
    v_mul_u32_u24 v4, 96, v4
    v_add3_u32 v44, v3, v5, s27
    v_add3_u32 v45, v4, v6, s28
    s_mov_b32 s16, s50
    s_and_b32 s17, s51, 0xffff
    s_mov_b32 s18, 0x600000
    s_mov_b32 s19, 0x00020000
    v_lshrrev_b32 v59, 2, v45
    v_lshrrev_b32 v3, 5, v1
    v_add_u32 v59, v59, v3
    v_cvt_pk_bf16_f32 v48, v180, v181
    v_cvt_pk_bf16_f32 v49, v182, v183
    v_cvt_pk_bf16_f32 v50, v184, v185
    v_cvt_pk_bf16_f32 v51, v186, v187
    v_add_u32 v3, 0, v59
    v_mul_u32_u24 v4, 0x2493, v3
    v_lshrrev_b32 v4, 16, v4
    v_mul_u32_u24 v5, 7, v4
    v_sub_u32 v5, v3, v5
    v_lshlrev_b32 v4, 17, v4
    v_lshl_add_u32 v4, v44, 6, v4
    v_lshl_add_u32 v56, v5, 3, v4
    v_permlane32_swap_b32 v48, v50
    v_permlane32_swap_b32 v49, v51
    buffer_store_dwordx4 v[48:51], v56, s[16:19], 0 offen
    v_add_u32 v58, 0x20000, v4
    v_cmp_eq_u32 vcc, 6, v5
    s_nop 0
    s_and_saveexec_b64 s[52:53], vcc
    s_nop 2
    s_cbranch_execz L_q1_g1_1_kernel
    buffer_store_dwordx2 v[50:51], v58, s[16:19], 0 offen
L_q1_g1_1_kernel:
    s_mov_b64 exec, s[52:53]
    v_cvt_pk_bf16_f32 v52, v188, v189
    v_cvt_pk_bf16_f32 v53, v190, v191
    v_cvt_pk_bf16_f32 v54, v192, v193
    v_cvt_pk_bf16_f32 v55, v194, v195
    v_add_u32 v3, 4, v59
    v_mul_u32_u24 v4, 0x2493, v3
    v_lshrrev_b32 v4, 16, v4
    v_mul_u32_u24 v5, 7, v4
    v_sub_u32 v5, v3, v5
    v_lshlrev_b32 v4, 17, v4
    v_lshl_add_u32 v4, v44, 6, v4
    v_lshl_add_u32 v57, v5, 3, v4
    v_permlane32_swap_b32 v52, v54
    v_permlane32_swap_b32 v53, v55
    buffer_store_dwordx4 v[52:55], v57, s[16:19], 0 offen
    v_add_u32 v58, 0x20000, v4
    v_cmp_eq_u32 vcc, 6, v5
    s_nop 0
    s_and_saveexec_b64 s[52:53], vcc
    s_nop 2
    s_cbranch_execz L_q2_g1_1_kernel
    buffer_store_dwordx2 v[54:55], v58, s[16:19], 0 offen
L_q2_g1_1_kernel:
    s_mov_b64 exec, s[52:53]
    v_cvt_pk_bf16_f32 v48, v196, v197
    v_cvt_pk_bf16_f32 v49, v198, v199
    v_cvt_pk_bf16_f32 v50, v200, v201
    v_cvt_pk_bf16_f32 v51, v202, v203
    v_add_u32 v3, 8, v59
    v_mul_u32_u24 v4, 0x2493, v3
    v_lshrrev_b32 v4, 16, v4
    v_mul_u32_u24 v5, 7, v4
    v_sub_u32 v5, v3, v5
    v_lshlrev_b32 v4, 17, v4
    v_lshl_add_u32 v4, v44, 6, v4
    v_lshl_add_u32 v56, v5, 3, v4
    v_permlane32_swap_b32 v48, v50
    v_permlane32_swap_b32 v49, v51
    buffer_store_dwordx4 v[48:51], v56, s[16:19], 0 offen
    v_add_u32 v58, 0x20000, v4
    v_cmp_eq_u32 vcc, 6, v5
    s_nop 0
    s_and_saveexec_b64 s[52:53], vcc
    s_nop 2
    s_cbranch_execz L_q3_g1_1_kernel
    buffer_store_dwordx2 v[50:51], v58, s[16:19], 0 offen
L_q3_g1_1_kernel:
    s_mov_b64 exec, s[52:53]
    v_cvt_pk_bf16_f32 v52, v204, v205
    v_cvt_pk_bf16_f32 v53, v206, v207
    v_cvt_pk_bf16_f32 v54, v208, v209
    v_cvt_pk_bf16_f32 v55, v210, v211
    v_add_u32 v3, 12, v59
    v_mul_u32_u24 v4, 0x2493, v3
    v_lshrrev_b32 v4, 16, v4
    v_mul_u32_u24 v5, 7, v4
    v_sub_u32 v5, v3, v5
    v_lshlrev_b32 v4, 17, v4
    v_lshl_add_u32 v4, v44, 6, v4
    v_lshl_add_u32 v57, v5, 3, v4
    v_permlane32_swap_b32 v52, v54
    v_permlane32_swap_b32 v53, v55
    buffer_store_dwordx4 v[52:55], v57, s[16:19], 0 offen
    v_add_u32 v58, 0x20000, v4
    v_cmp_eq_u32 vcc, 6, v5
    s_nop 0
    s_and_saveexec_b64 s[52:53], vcc
    s_nop 2
    s_cbranch_execz L_q4_g1_1_kernel
    buffer_store_dwordx2 v[54:55], v58, s[16:19], 0 offen
L_q4_g1_1_kernel:
    s_mov_b64 exec, s[52:53]
    v_cvt_pk_bf16_f32 v48, v212, v213
    v_cvt_pk_bf16_f32 v49, v214, v215
    v_cvt_pk_bf16_f32 v50, v216, v217
    v_cvt_pk_bf16_f32 v51, v218, v219
    v_add_u32 v3, 16, v59
    v_mul_u32_u24 v4, 0x2493, v3
    v_lshrrev_b32 v4, 16, v4
    v_mul_u32_u24 v5, 7, v4
    v_sub_u32 v5, v3, v5
    v_lshlrev_b32 v4, 17, v4
    v_lshl_add_u32 v4, v44, 6, v4
    v_lshl_add_u32 v56, v5, 3, v4
    v_permlane32_swap_b32 v48, v50
    v_permlane32_swap_b32 v49, v51
    buffer_store_dwordx4 v[48:51], v56, s[16:19], 0 offen
    v_add_u32 v58, 0x20000, v4
    v_cmp_eq_u32 vcc, 6, v5
    s_nop 0
    s_and_saveexec_b64 s[52:53], vcc
    s_nop 2
    s_cbranch_execz L_q5_g1_1_kernel
    buffer_store_dwordx2 v[50:51], v58, s[16:19], 0 offen
L_q5_g1_1_kernel:
    s_mov_b64 exec, s[52:53]
    v_cvt_pk_bf16_f32 v52, v220, v221
    v_cvt_pk_bf16_f32 v53, v222, v223
    v_cvt_pk_bf16_f32 v54, v224, v225
    v_cvt_pk_bf16_f32 v55, v226, v227
    v_add_u32 v3, 20, v59
    v_mul_u32_u24 v4, 0x2493, v3
    v_lshrrev_b32 v4, 16, v4
    v_mul_u32_u24 v5, 7, v4
    v_sub_u32 v5, v3, v5
    v_lshlrev_b32 v4, 17, v4
    v_lshl_add_u32 v4, v44, 6, v4
    v_lshl_add_u32 v57, v5, 3, v4
    v_permlane32_swap_b32 v52, v54
    v_permlane32_swap_b32 v53, v55
    buffer_store_dwordx4 v[52:55], v57, s[16:19], 0 offen
    v_add_u32 v58, 0x20000, v4
    v_cmp_eq_u32 vcc, 6, v5
    s_nop 0
    s_and_saveexec_b64 s[52:53], vcc
    s_nop 2
    s_cbranch_execz L_q6_g1_1_kernel
    buffer_store_dwordx2 v[54:55], v58, s[16:19], 0 offen
L_q6_g1_1_kernel:
    s_mov_b64 exec, s[52:53]
L_end_g1_1_kernel:
    s_endpgm
.globl attn_1_kernel
.p2align 8
.type attn_1_kernel,@function
attn_1_kernel:
    s_load_dwordx16 s[24:39], s[0:1], 0
    s_load_dwordx4 s[40:43], s[0:1], 64
    s_cmp_ge_u32 s2, 512
    s_cbranch_scc1 L_end_attn_1_kernel
    s_and_b32 s16, s2, 7
    s_lshl_b32 s16, s16, 1
    s_bfe_u32 s18, s2, 0x10003
    s_add_u32 s16, s16, s18
    s_lshr_b32 s17, s2, 4
    s_mov_b32 s22, 0x3e8b97f6
    s_mov_b32 s23, 0x3e8b97f6
    v_and_b32 v1, 63, v0
    v_lshrrev_b32 v2, 6, v0
    v_lshrrev_b32 v3, 5, v1
    v_lshrrev_b32 v4, 1, v2
    v_and_b32 v5, 31, v1
    v_and_b32 v6, 1, v2
    v_lshl_add_u32 v5, v6, 5, v5
    s_lshl_b32 s18, s17, 6
    v_add_u32 v5, s18, v5
    v_mov_b32 v21, v5
    s_lshl_b32 s18, s16, 11
    v_add_u32 v5, s18, v5
    v_lshlrev_b32 v20, 6, v5
    v_lshl_add_u32 v20, v3, 4, v20
    v_bfe_u32 v5, v0, 2, 5
    v_and_b32 v6, 3, v0
    v_lshrrev_b32 v7, 7, v0
    v_lshl_add_u32 v8, v7, 10, v5
    v_lshlrev_b32 v22, 6, v8
    v_lshl_add_u32 v22, v6, 4, v22
    v_mul_u32_u24 v23, 80, v5
    v_lshl_add_u32 v23, v6, 4, v23
    v_mul_u32_u24 v8, 20480, v7
    v_add_u32 v23, v23, v8
    v_mul_u32_u24 v24, 64, v5
    v_lshl_add_u32 v24, v6, 4, v24
    v_mul_u32_u24 v8, 16384, v7
    v_add_u32 v24, v24, v8
    v_add_u32 v24, 40960, v24
    v_cmp_eq_u32 vcc, 3, v6
    s_nop 1
    v_cndmask_b32 v25, -1, 0, vcc
    v_mov_b32 v7, 0x3f80
    v_cndmask_b32 v26, 0, v7, vcc
    s_lshl_b32 s19, s16, 17
    s_add_u32 s20, s19, 0x400000
    s_add_u32 s19, s19, 0x200000
    v_and_b32 v5, 31, v1
    v_mul_u32_u24 v60, 80, v5
    v_lshl_add_u32 v60, v3, 4, v60
    v_mul_u32_u24 v6, 20480, v4
    v_add_u32 v60, v60, v6
    v_bfe_u32 v5, v1, 2, 2
    v_lshl_add_u32 v5, v3, 2, v5
    v_mul_u32_u24 v61, 64, v5
    v_bfe_u32 v6, v1, 4, 1
    v_lshl_add_u32 v61, v6, 5, v61
    v_and_b32 v6, 3, v1
    v_lshl_add_u32 v61, v6, 3, v61
    v_mul_u32_u24 v6, 16384, v4
    v_add_u32 v61, v61, v6
    v_add_u32 v61, 40960, v61
    v_mov_b32 v160, 0
    v_mov_b32 v161, 0
    v_mov_b32 v162, 0
    v_mov_b32 v163, 0
    v_mov_b32 v164, 0
    v_mov_b32 v165, 0
    v_mov_b32 v166, 0
    v_mov_b32 v167, 0
    v_mov_b32 v168, 0
    v_mov_b32 v169, 0
    v_mov_b32 v170, 0
    v_mov_b32 v171, 0
    v_mov_b32 v172, 0
    v_mov_b32 v173, 0
    v_mov_b32 v174, 0
    v_mov_b32 v175, 0
    v_mov_b32 v240, 0xff800000
    s_waitcnt lgkmcnt(0)
    s_mov_b32 s8, s42
    s_and_b32 s9, s43, 0xffff
    s_mov_b32 s10, 0x600000
    s_mov_b32 s11, 0x00020000
    s_add_u32 s12, s42, 0x600000
    s_addc_u32 s13, s43, 0
    s_and_b32 s13, s13, 0xffff
    s_mov_b32 s14, 0x1c0000
    s_mov_b32 s15, 0x00020000
    buffer_load_dwordx4 v[28:31], v22, s[8:11], s19 offen offset:0
    buffer_load_dwordx4 v[44:47], v22, s[8:11], s20 offen offset:0
    buffer_load_dwordx4 v[32:35], v22, s[8:11], s19 offen offset:2048
    buffer_load_dwordx4 v[48:51], v22, s[8:11], s20 offen offset:2048
    s_add_u32 s19, s19, 4096
    s_add_u32 s20, s20, 4096
    buffer_load_dwordx4 v[36:39], v22, s[8:11], s19 offen offset:0
    buffer_load_dwordx4 v[52:55], v22, s[8:11], s20 offen offset:0
    buffer_load_dwordx4 v[40:43], v22, s[8:11], s19 offen offset:2048
    buffer_load_dwordx4 v[56:59], v22, s[8:11], s20 offen offset:2048
    s_add_u32 s19, s19, 4096
    s_add_u32 s20, s20, 4096
    buffer_load_dwordx4 v[12:15], v20, s[8:11], 0 offen
    buffer_load_dwordx4 v[16:19], v20, s[8:11], 0 offen offset:32
    s_waitcnt vmcnt(9)
    v_and_b32 v30, v25, v30
    v_and_b32 v31, v25, v31
    s_waitcnt vmcnt(8)
    v_and_or_b32 v46, v46, v25, v26
    v_and_b32 v47, v25, v47
    ds_write_b128 v23, v[28:31] offset:0
    ds_write_b128 v24, v[44:47] offset:0
    s_waitcnt vmcnt(7)
    v_and_b32 v34, v25, v34
    v_and_b32 v35, v25, v35
    s_waitcnt vmcnt(6)
    v_and_or_b32 v50, v50, v25, v26
    v_and_b32 v51, v25, v51
    ds_write_b128 v23, v[32:35] offset:2560
    ds_write_b128 v24, v[48:51] offset:2048
    s_waitcnt vmcnt(5)
    v_and_b32 v38, v25, v38
    v_and_b32 v39, v25, v39
    s_waitcnt vmcnt(4)
    v_and_or_b32 v54, v54, v25, v26
    v_and_b32 v55, v25, v55
    ds_write_b128 v23, v[36:39] offset:5120
    ds_write_b128 v24, v[52:55] offset:4096
    s_waitcnt vmcnt(3)
    v_and_b32 v42, v25, v42
    v_and_b32 v43, v25, v43
    s_waitcnt vmcnt(2)
    v_and_or_b32 v58, v58, v25, v26
    v_and_b32 v59, v25, v59
    ds_write_b128 v23, v[40:43] offset:7680
    ds_write_b128 v24, v[56:59] offset:6144
    v_cmp_eq_u32 vcc, 1, v3
    s_nop 1
    v_cndmask_b32 v5, -1, 0, vcc
    s_waitcnt vmcnt(0)
    v_and_b32 v18, v5, v18
    v_and_b32 v19, v5, v19
    s_waitcnt lgkmcnt(0)
    s_barrier
    s_mov_b32 s21, 0
L_loop_attn_1_kernel:
    buffer_load_dwordx4 v[28:31], v22, s[8:11], s19 offen offset:0
    buffer_load_dwordx4 v[44:47], v22, s[8:11], s20 offen offset:0
    buffer_load_dwordx4 v[32:35], v22, s[8:11], s19 offen offset:2048
    buffer_load_dwordx4 v[48:51], v22, s[8:11], s20 offen offset:2048
    s_add_u32 s19, s19, 4096
    s_add_u32 s20, s20, 4096
    buffer_load_dwordx4 v[36:39], v22, s[8:11], s19 offen offset:0
    buffer_load_dwordx4 v[52:55], v22, s[8:11], s20 offen offset:0
    buffer_load_dwordx4 v[40:43], v22, s[8:11], s19 offen offset:2048
    buffer_load_dwordx4 v[56:59], v22, s[8:11], s20 offen offset:2048
    s_add_u32 s19, s19, 4096
    s_add_u32 s20, s20, 4096
    ds_read_b128 v[176:179], v60 offset:0
    ds_read_b128 v[180:183], v60 offset:32
    ds_read_b128 v[184:187], v60 offset:2560
    ds_read_b128 v[188:191], v60 offset:2592
    ds_read_b128 v[192:195], v60 offset:5120
    ds_read_b128 v[196:199], v60 offset:5152
    ds_read_b128 v[200:203], v60 offset:7680
    ds_read_b128 v[204:207], v60 offset:7712
    s_waitcnt lgkmcnt(7)
    v_mfma_f32_32x32x16_bf16 v[64:79], v[176:179], v[12:15], 0
    s_waitcnt lgkmcnt(6)
    v_mfma_f32_32x32x16_bf16 v[64:79], v[180:183], v[16:19], v[64:79]
    s_waitcnt lgkmcnt(5)
    v_mfma_f32_32x32x16_bf16 v[80:95], v[184:187], v[12:15], 0
    s_waitcnt lgkmcnt(4)
    v_mfma_f32_32x32x16_bf16 v[80:95], v[188:191], v[16:19], v[80:95]
    s_waitcnt lgkmcnt(3)
    v_mfma_f32_32x32x16_bf16 v[96:111], v[192:195], v[12:15], 0
    s_waitcnt lgkmcnt(2)
    v_mfma_f32_32x32x16_bf16 v[96:111], v[196:199], v[16:19], v[96:111]
    s_waitcnt lgkmcnt(1)
    v_mfma_f32_32x32x16_bf16 v[112:127], v[200:203], v[12:15], 0
    s_waitcnt lgkmcnt(0)
    v_mfma_f32_32x32x16_bf16 v[112:127], v[204:207], v[16:19], v[112:127]
    ds_read_b64_tr_b16 v[208:209], v61 offset:0
    ds_read_b64_tr_b16 v[210:211], v61 offset:512
    ds_read_b64_tr_b16 v[212:213], v61 offset:1024
    ds_read_b64_tr_b16 v[214:215], v61 offset:1536
    ds_read_b64_tr_b16 v[216:217], v61 offset:2048
    ds_read_b64_tr_b16 v[218:219], v61 offset:2560
    ds_read_b64_tr_b16 v[220:221], v61 offset:3072
    ds_read_b64_tr_b16 v[222:223], v61 offset:3584
    ds_read_b64_tr_b16 v[224:225], v61 offset:4096
    ds_read_b64_tr_b16 v[226:227], v61 offset:4608
    ds_read_b64_tr_b16 v[228:229], v61 offset:5120
    ds_read_b64_tr_b16 v[230:231], v61 offset:5632
    ds_read_b64_tr_b16 v[232:233], v61 offset:6144
    ds_read_b64_tr_b16 v[234:235], v61 offset:6656
    ds_read_b64_tr_b16 v[236:237], v61 offset:7168
    ds_read_b64_tr_b16 v[238:239], v61 offset:7680
    v_max3_f32 v241, v64, v65, v66
    v_max3_f32 v242, v96, v97, v98
    v_max3_f32 v241, v241, v67, v68
    v_max3_f32 v242, v242, v99, v100
    v_max3_f32 v241, v241, v69, v70
    v_max3_f32 v242, v242, v101, v102
    v_max3_f32 v241, v241, v71, v72
    v_max3_f32 v242, v242, v103, v104
    v_max3_f32 v241, v241, v73, v74
    v_max3_f32 v242, v242, v105, v106
    v_max3_f32 v241, v241, v75, v76
    v_max3_f32 v242, v242, v107, v108
    v_max3_f32 v241, v241, v77, v78
    v_max3_f32 v242, v242, v109, v110
    v_max3_f32 v241, v241, v79, v80
    v_max3_f32 v242, v242, v111, v112
    v_max3_f32 v241, v241, v81, v82
    v_max3_f32 v242, v242, v113, v114
    v_max3_f32 v241, v241, v83, v84
    v_max3_f32 v242, v242, v115, v116
    v_max3_f32 v241, v241, v85, v86
    v_max3_f32 v242, v242, v117, v118
    v_max3_f32 v241, v241, v87, v88
    v_max3_f32 v242, v242, v119, v120
    v_max3_f32 v241, v241, v89, v90
    v_max3_f32 v242, v242, v121, v122
    v_max3_f32 v241, v241, v91, v92
    v_max3_f32 v242, v242, v123, v124
    v_max3_f32 v241, v241, v93, v94
    v_max3_f32 v242, v242, v125, v126
    v_max3_f32 v241, v241, v95, v127
    v_max_f32 v241, v241, v242
    v_mov_b32 v5, v241
    s_nop 1
    v_permlane32_swap_b32 v241, v5
    v_max3_f32 v241, v241, v5, v240
    v_sub_f32 v244, v240, v241
    v_mul_f32 v244, s22, v244
    v_exp_f32 v244, v244
    v_mov_b32 v240, v241
    v_mul_f32 v246, s22, v241
    v_sub_f32 v246, 0, v246
    v_mov_b32 v247, v246
    v_mov_b32 v245, v244
    v_pk_fma_f32 v[64:65], v[64:65], s[22:23], v[246:247]
    v_pk_fma_f32 v[66:67], v[66:67], s[22:23], v[246:247]
    v_pk_fma_f32 v[68:69], v[68:69], s[22:23], v[246:247]
    v_pk_fma_f32 v[70:71], v[70:71], s[22:23], v[246:247]
    v_pk_fma_f32 v[72:73], v[72:73], s[22:23], v[246:247]
    v_pk_fma_f32 v[74:75], v[74:75], s[22:23], v[246:247]
    v_pk_fma_f32 v[76:77], v[76:77], s[22:23], v[246:247]
    v_pk_fma_f32 v[78:79], v[78:79], s[22:23], v[246:247]
    v_pk_fma_f32 v[80:81], v[80:81], s[22:23], v[246:247]
    v_pk_fma_f32 v[82:83], v[82:83], s[22:23], v[246:247]
    v_pk_fma_f32 v[84:85], v[84:85], s[22:23], v[246:247]
    v_pk_fma_f32 v[86:87], v[86:87], s[22:23], v[246:247]
    v_pk_fma_f32 v[88:89], v[88:89], s[22:23], v[246:247]
    v_pk_fma_f32 v[90:91], v[90:91], s[22:23], v[246:247]
    v_pk_fma_f32 v[92:93], v[92:93], s[22:23], v[246:247]
    v_pk_fma_f32 v[94:95], v[94:95], s[22:23], v[246:247]
    v_pk_fma_f32 v[96:97], v[96:97], s[22:23], v[246:247]
    v_pk_fma_f32 v[98:99], v[98:99], s[22:23], v[246:247]
    v_pk_fma_f32 v[100:101], v[100:101], s[22:23], v[246:247]
    v_pk_fma_f32 v[102:103], v[102:103], s[22:23], v[246:247]
    v_pk_fma_f32 v[104:105], v[104:105], s[22:23], v[246:247]
    v_pk_fma_f32 v[106:107], v[106:107], s[22:23], v[246:247]
    v_pk_fma_f32 v[108:109], v[108:109], s[22:23], v[246:247]
    v_pk_fma_f32 v[110:111], v[110:111], s[22:23], v[246:247]
    v_pk_fma_f32 v[112:113], v[112:113], s[22:23], v[246:247]
    v_pk_fma_f32 v[114:115], v[114:115], s[22:23], v[246:247]
    v_pk_fma_f32 v[116:117], v[116:117], s[22:23], v[246:247]
    v_pk_fma_f32 v[118:119], v[118:119], s[22:23], v[246:247]
    v_pk_fma_f32 v[120:121], v[120:121], s[22:23], v[246:247]
    v_pk_fma_f32 v[122:123], v[122:123], s[22:23], v[246:247]
    v_pk_fma_f32 v[124:125], v[124:125], s[22:23], v[246:247]
    v_pk_fma_f32 v[126:127], v[126:127], s[22:23], v[246:247]
    v_exp_f32 v64, v64
    v_exp_f32 v65, v65
    v_exp_f32 v66, v66
    v_exp_f32 v67, v67
    v_exp_f32 v68, v68
    v_exp_f32 v69, v69
    v_exp_f32 v70, v70
    v_exp_f32 v71, v71
    v_exp_f32 v72, v72
    v_exp_f32 v73, v73
    v_exp_f32 v74, v74
    v_exp_f32 v75, v75
    v_exp_f32 v76, v76
    v_exp_f32 v77, v77
    v_exp_f32 v78, v78
    v_exp_f32 v79, v79
    v_exp_f32 v80, v80
    v_exp_f32 v81, v81
    v_exp_f32 v82, v82
    v_exp_f32 v83, v83
    v_exp_f32 v84, v84
    v_exp_f32 v85, v85
    v_exp_f32 v86, v86
    v_exp_f32 v87, v87
    v_exp_f32 v88, v88
    v_exp_f32 v89, v89
    v_exp_f32 v90, v90
    v_exp_f32 v91, v91
    v_exp_f32 v92, v92
    v_exp_f32 v93, v93
    v_exp_f32 v94, v94
    v_exp_f32 v95, v95
    v_exp_f32 v96, v96
    v_exp_f32 v97, v97
    v_exp_f32 v98, v98
    v_exp_f32 v99, v99
    v_exp_f32 v100, v100
    v_exp_f32 v101, v101
    v_exp_f32 v102, v102
    v_exp_f32 v103, v103
    v_exp_f32 v104, v104
    v_exp_f32 v105, v105
    v_exp_f32 v106, v106
    v_exp_f32 v107, v107
    v_exp_f32 v108, v108
    v_exp_f32 v109, v109
    v_exp_f32 v110, v110
    v_exp_f32 v111, v111
    v_exp_f32 v112, v112
    v_exp_f32 v113, v113
    v_exp_f32 v114, v114
    v_exp_f32 v115, v115
    v_exp_f32 v116, v116
    v_exp_f32 v117, v117
    v_exp_f32 v118, v118
    v_exp_f32 v119, v119
    v_exp_f32 v120, v120
    v_exp_f32 v121, v121
    v_exp_f32 v122, v122
    v_exp_f32 v123, v123
    v_exp_f32 v124, v124
    v_exp_f32 v125, v125
    v_exp_f32 v126, v126
    v_exp_f32 v127, v127
    v_cvt_pk_bf16_f32 v128, v64, v65
    v_cvt_pk_bf16_f32 v129, v66, v67
    v_cvt_pk_bf16_f32 v130, v68, v69
    v_cvt_pk_bf16_f32 v131, v70, v71
    v_cvt_pk_bf16_f32 v132, v72, v73
    v_cvt_pk_bf16_f32 v133, v74, v75
    v_cvt_pk_bf16_f32 v134, v76, v77
    v_cvt_pk_bf16_f32 v135, v78, v79
    v_cvt_pk_bf16_f32 v136, v80, v81
    v_cvt_pk_bf16_f32 v137, v82, v83
    v_cvt_pk_bf16_f32 v138, v84, v85
    v_cvt_pk_bf16_f32 v139, v86, v87
    v_cvt_pk_bf16_f32 v140, v88, v89
    v_cvt_pk_bf16_f32 v141, v90, v91
    v_cvt_pk_bf16_f32 v142, v92, v93
    v_cvt_pk_bf16_f32 v143, v94, v95
    v_cvt_pk_bf16_f32 v144, v96, v97
    v_cvt_pk_bf16_f32 v145, v98, v99
    v_cvt_pk_bf16_f32 v146, v100, v101
    v_cvt_pk_bf16_f32 v147, v102, v103
    v_cvt_pk_bf16_f32 v148, v104, v105
    v_cvt_pk_bf16_f32 v149, v106, v107
    v_cvt_pk_bf16_f32 v150, v108, v109
    v_cvt_pk_bf16_f32 v151, v110, v111
    v_cvt_pk_bf16_f32 v152, v112, v113
    v_cvt_pk_bf16_f32 v153, v114, v115
    v_cvt_pk_bf16_f32 v154, v116, v117
    v_cvt_pk_bf16_f32 v155, v118, v119
    v_cvt_pk_bf16_f32 v156, v120, v121
    v_cvt_pk_bf16_f32 v157, v122, v123
    v_cvt_pk_bf16_f32 v158, v124, v125
    v_cvt_pk_bf16_f32 v159, v126, v127
    v_pk_mul_f32 v[160:161], v[160:161], v[244:245]
    v_pk_mul_f32 v[162:163], v[162:163], v[244:245]
    v_pk_mul_f32 v[164:165], v[164:165], v[244:245]
    v_pk_mul_f32 v[166:167], v[166:167], v[244:245]
    v_pk_mul_f32 v[168:169], v[168:169], v[244:245]
    v_pk_mul_f32 v[170:171], v[170:171], v[244:245]
    v_pk_mul_f32 v[172:173], v[172:173], v[244:245]
    v_pk_mul_f32 v[174:175], v[174:175], v[244:245]
    s_waitcnt lgkmcnt(14)
    s_nop 0
    v_mfma_f32_32x32x16_bf16 v[160:175], v[208:211], v[128:131], v[160:175]
    s_waitcnt vmcnt(7)
    v_and_b32 v30, v25, v30
    v_and_b32 v31, v25, v31
    s_waitcnt vmcnt(6)
    v_and_or_b32 v46, v46, v25, v26
    v_and_b32 v47, v25, v47
    ds_write_b128 v23, v[28:31] offset:10240
    ds_write_b128 v24, v[44:47] offset:8192
    s_waitcnt lgkmcnt(14)
    v_mfma_f32_32x32x16_bf16 v[160:175], v[212:215], v[132:135], v[160:175]
    s_waitcnt lgkmcnt(12)
    v_mfma_f32_32x32x16_bf16 v[160:175], v[216:219], v[136:139], v[160:175]
    s_waitcnt vmcnt(5)
    v_and_b32 v34, v25, v34
    v_and_b32 v35, v25, v35
    s_waitcnt vmcnt(4)
    v_and_or_b32 v50, v50, v25, v26
    v_and_b32 v51, v25, v51
    ds_write_b128 v23, v[32:35] offset:12800
    ds_write_b128 v24, v[48:51] offset:10240
    s_waitcnt lgkmcnt(12)
    v_mfma_f32_32x32x16_bf16 v[160:175], v[220:223], v[140:143], v[160:175]
    s_waitcnt lgkmcnt(10)
    v_mfma_f32_32x32x16_bf16 v[160:175], v[224:227], v[144:147], v[160:175]
    s_waitcnt vmcnt(3)
    v_and_b32 v38, v25, v38
    v_and_b32 v39, v25, v39
    s_waitcnt vmcnt(2)
    v_and_or_b32 v54, v54, v25, v26
    v_and_b32 v55, v25, v55
    ds_write_b128 v23, v[36:39] offset:15360
    ds_write_b128 v24, v[52:55] offset:12288
    s_waitcnt lgkmcnt(10)
    v_mfma_f32_32x32x16_bf16 v[160:175], v[228:231], v[148:151], v[160:175]
    s_waitcnt lgkmcnt(8)
    v_mfma_f32_32x32x16_bf16 v[160:175], v[232:235], v[152:155], v[160:175]
    s_waitcnt vmcnt(1)
    v_and_b32 v42, v25, v42
    v_and_b32 v43, v25, v43
    s_waitcnt vmcnt(0)
    v_and_or_b32 v58, v58, v25, v26
    v_and_b32 v59, v25, v59
    ds_write_b128 v23, v[40:43] offset:17920
    ds_write_b128 v24, v[56:59] offset:14336
    s_waitcnt lgkmcnt(8)
    v_mfma_f32_32x32x16_bf16 v[160:175], v[236:239], v[156:159], v[160:175]
    s_waitcnt lgkmcnt(0)
    s_barrier
    buffer_load_dwordx4 v[28:31], v22, s[8:11], s19 offen offset:0
    buffer_load_dwordx4 v[44:47], v22, s[8:11], s20 offen offset:0
    buffer_load_dwordx4 v[32:35], v22, s[8:11], s19 offen offset:2048
    buffer_load_dwordx4 v[48:51], v22, s[8:11], s20 offen offset:2048
    s_add_u32 s19, s19, 4096
    s_add_u32 s20, s20, 4096
    buffer_load_dwordx4 v[36:39], v22, s[8:11], s19 offen offset:0
    buffer_load_dwordx4 v[52:55], v22, s[8:11], s20 offen offset:0
    buffer_load_dwordx4 v[40:43], v22, s[8:11], s19 offen offset:2048
    buffer_load_dwordx4 v[56:59], v22, s[8:11], s20 offen offset:2048
    s_add_u32 s19, s19, 4096
    s_add_u32 s20, s20, 4096
    ds_read_b128 v[176:179], v60 offset:10240
    ds_read_b128 v[180:183], v60 offset:10272
    ds_read_b128 v[184:187], v60 offset:12800
    ds_read_b128 v[188:191], v60 offset:12832
    ds_read_b128 v[192:195], v60 offset:15360
    ds_read_b128 v[196:199], v60 offset:15392
    ds_read_b128 v[200:203], v60 offset:17920
    ds_read_b128 v[204:207], v60 offset:17952
    s_waitcnt lgkmcnt(7)
    v_mfma_f32_32x32x16_bf16 v[64:79], v[176:179], v[12:15], 0
    s_waitcnt lgkmcnt(6)
    v_mfma_f32_32x32x16_bf16 v[64:79], v[180:183], v[16:19], v[64:79]
    s_waitcnt lgkmcnt(5)
    v_mfma_f32_32x32x16_bf16 v[80:95], v[184:187], v[12:15], 0
    s_waitcnt lgkmcnt(4)
    v_mfma_f32_32x32x16_bf16 v[80:95], v[188:191], v[16:19], v[80:95]
    s_waitcnt lgkmcnt(3)
    v_mfma_f32_32x32x16_bf16 v[96:111], v[192:195], v[12:15], 0
    s_waitcnt lgkmcnt(2)
    v_mfma_f32_32x32x16_bf16 v[96:111], v[196:199], v[16:19], v[96:111]
    s_waitcnt lgkmcnt(1)
    v_mfma_f32_32x32x16_bf16 v[112:127], v[200:203], v[12:15], 0
    s_waitcnt lgkmcnt(0)
    v_mfma_f32_32x32x16_bf16 v[112:127], v[204:207], v[16:19], v[112:127]
    ds_read_b64_tr_b16 v[208:209], v61 offset:8192
    ds_read_b64_tr_b16 v[210:211], v61 offset:8704
    ds_read_b64_tr_b16 v[212:213], v61 offset:9216
    ds_read_b64_tr_b16 v[214:215], v61 offset:9728
    ds_read_b64_tr_b16 v[216:217], v61 offset:10240
    ds_read_b64_tr_b16 v[218:219], v61 offset:10752
    ds_read_b64_tr_b16 v[220:221], v61 offset:11264
    ds_read_b64_tr_b16 v[222:223], v61 offset:11776
    ds_read_b64_tr_b16 v[224:225], v61 offset:12288
    ds_read_b64_tr_b16 v[226:227], v61 offset:12800
    ds_read_b64_tr_b16 v[228:229], v61 offset:13312
    ds_read_b64_tr_b16 v[230:231], v61 offset:13824
    ds_read_b64_tr_b16 v[232:233], v61 offset:14336
    ds_read_b64_tr_b16 v[234:235], v61 offset:14848
    ds_read_b64_tr_b16 v[236:237], v61 offset:15360
    ds_read_b64_tr_b16 v[238:239], v61 offset:15872
    v_max3_f32 v241, v64, v65, v66
    v_max3_f32 v242, v96, v97, v98
    v_max3_f32 v241, v241, v67, v68
    v_max3_f32 v242, v242, v99, v100
    v_max3_f32 v241, v241, v69, v70
    v_max3_f32 v242, v242, v101, v102
    v_max3_f32 v241, v241, v71, v72
    v_max3_f32 v242, v242, v103, v104
    v_max3_f32 v241, v241, v73, v74
    v_max3_f32 v242, v242, v105, v106
    v_max3_f32 v241, v241, v75, v76
    v_max3_f32 v242, v242, v107, v108
    v_max3_f32 v241, v241, v77, v78
    v_max3_f32 v242, v242, v109, v110
    v_max3_f32 v241, v241, v79, v80
    v_max3_f32 v242, v242, v111, v112
    v_max3_f32 v241, v241, v81, v82
    v_max3_f32 v242, v242, v113, v114
    v_max3_f32 v241, v241, v83, v84
    v_max3_f32 v242, v242, v115, v116
    v_max3_f32 v241, v241, v85, v86
    v_max3_f32 v242, v242, v117, v118
    v_max3_f32 v241, v241, v87, v88
    v_max3_f32 v242, v242, v119, v120
    v_max3_f32 v241, v241, v89, v90
    v_max3_f32 v242, v242, v121, v122
    v_max3_f32 v241, v241, v91, v92
    v_max3_f32 v242, v242, v123, v124
    v_max3_f32 v241, v241, v93, v94
    v_max3_f32 v242, v242, v125, v126
    v_max3_f32 v241, v241, v95, v127
    v_max_f32 v241, v241, v242
    v_mov_b32 v5, v241
    s_nop 1
    v_permlane32_swap_b32 v241, v5
    v_max3_f32 v241, v241, v5, v240
    v_sub_f32 v244, v240, v241
    v_mul_f32 v244, s22, v244
    v_exp_f32 v244, v244
    v_mov_b32 v240, v241
    v_mul_f32 v246, s22, v241
    v_sub_f32 v246, 0, v246
    v_mov_b32 v247, v246
    v_mov_b32 v245, v244
    v_pk_fma_f32 v[64:65], v[64:65], s[22:23], v[246:247]
    v_pk_fma_f32 v[66:67], v[66:67], s[22:23], v[246:247]
    v_pk_fma_f32 v[68:69], v[68:69], s[22:23], v[246:247]
    v_pk_fma_f32 v[70:71], v[70:71], s[22:23], v[246:247]
    v_pk_fma_f32 v[72:73], v[72:73], s[22:23], v[246:247]
    v_pk_fma_f32 v[74:75], v[74:75], s[22:23], v[246:247]
    v_pk_fma_f32 v[76:77], v[76:77], s[22:23], v[246:247]
    v_pk_fma_f32 v[78:79], v[78:79], s[22:23], v[246:247]
    v_pk_fma_f32 v[80:81], v[80:81], s[22:23], v[246:247]
    v_pk_fma_f32 v[82:83], v[82:83], s[22:23], v[246:247]
    v_pk_fma_f32 v[84:85], v[84:85], s[22:23], v[246:247]
    v_pk_fma_f32 v[86:87], v[86:87], s[22:23], v[246:247]
    v_pk_fma_f32 v[88:89], v[88:89], s[22:23], v[246:247]
    v_pk_fma_f32 v[90:91], v[90:91], s[22:23], v[246:247]
    v_pk_fma_f32 v[92:93], v[92:93], s[22:23], v[246:247]
    v_pk_fma_f32 v[94:95], v[94:95], s[22:23], v[246:247]
    v_pk_fma_f32 v[96:97], v[96:97], s[22:23], v[246:247]
    v_pk_fma_f32 v[98:99], v[98:99], s[22:23], v[246:247]
    v_pk_fma_f32 v[100:101], v[100:101], s[22:23], v[246:247]
    v_pk_fma_f32 v[102:103], v[102:103], s[22:23], v[246:247]
    v_pk_fma_f32 v[104:105], v[104:105], s[22:23], v[246:247]
    v_pk_fma_f32 v[106:107], v[106:107], s[22:23], v[246:247]
    v_pk_fma_f32 v[108:109], v[108:109], s[22:23], v[246:247]
    v_pk_fma_f32 v[110:111], v[110:111], s[22:23], v[246:247]
    v_pk_fma_f32 v[112:113], v[112:113], s[22:23], v[246:247]
    v_pk_fma_f32 v[114:115], v[114:115], s[22:23], v[246:247]
    v_pk_fma_f32 v[116:117], v[116:117], s[22:23], v[246:247]
    v_pk_fma_f32 v[118:119], v[118:119], s[22:23], v[246:247]
    v_pk_fma_f32 v[120:121], v[120:121], s[22:23], v[246:247]
    v_pk_fma_f32 v[122:123], v[122:123], s[22:23], v[246:247]
    v_pk_fma_f32 v[124:125], v[124:125], s[22:23], v[246:247]
    v_pk_fma_f32 v[126:127], v[126:127], s[22:23], v[246:247]
    v_exp_f32 v64, v64
    v_exp_f32 v65, v65
    v_exp_f32 v66, v66
    v_exp_f32 v67, v67
    v_exp_f32 v68, v68
    v_exp_f32 v69, v69
    v_exp_f32 v70, v70
    v_exp_f32 v71, v71
    v_exp_f32 v72, v72
    v_exp_f32 v73, v73
    v_exp_f32 v74, v74
    v_exp_f32 v75, v75
    v_exp_f32 v76, v76
    v_exp_f32 v77, v77
    v_exp_f32 v78, v78
    v_exp_f32 v79, v79
    v_exp_f32 v80, v80
    v_exp_f32 v81, v81
    v_exp_f32 v82, v82
    v_exp_f32 v83, v83
    v_exp_f32 v84, v84
    v_exp_f32 v85, v85
    v_exp_f32 v86, v86
    v_exp_f32 v87, v87
    v_exp_f32 v88, v88
    v_exp_f32 v89, v89
    v_exp_f32 v90, v90
    v_exp_f32 v91, v91
    v_exp_f32 v92, v92
    v_exp_f32 v93, v93
    v_exp_f32 v94, v94
    v_exp_f32 v95, v95
    v_exp_f32 v96, v96
    v_exp_f32 v97, v97
    v_exp_f32 v98, v98
    v_exp_f32 v99, v99
    v_exp_f32 v100, v100
    v_exp_f32 v101, v101
    v_exp_f32 v102, v102
    v_exp_f32 v103, v103
    v_exp_f32 v104, v104
    v_exp_f32 v105, v105
    v_exp_f32 v106, v106
    v_exp_f32 v107, v107
    v_exp_f32 v108, v108
    v_exp_f32 v109, v109
    v_exp_f32 v110, v110
    v_exp_f32 v111, v111
    v_exp_f32 v112, v112
    v_exp_f32 v113, v113
    v_exp_f32 v114, v114
    v_exp_f32 v115, v115
    v_exp_f32 v116, v116
    v_exp_f32 v117, v117
    v_exp_f32 v118, v118
    v_exp_f32 v119, v119
    v_exp_f32 v120, v120
    v_exp_f32 v121, v121
    v_exp_f32 v122, v122
    v_exp_f32 v123, v123
    v_exp_f32 v124, v124
    v_exp_f32 v125, v125
    v_exp_f32 v126, v126
    v_exp_f32 v127, v127
    v_cvt_pk_bf16_f32 v128, v64, v65
    v_cvt_pk_bf16_f32 v129, v66, v67
    v_cvt_pk_bf16_f32 v130, v68, v69
    v_cvt_pk_bf16_f32 v131, v70, v71
    v_cvt_pk_bf16_f32 v132, v72, v73
    v_cvt_pk_bf16_f32 v133, v74, v75
    v_cvt_pk_bf16_f32 v134, v76, v77
    v_cvt_pk_bf16_f32 v135, v78, v79
    v_cvt_pk_bf16_f32 v136, v80, v81
    v_cvt_pk_bf16_f32 v137, v82, v83
    v_cvt_pk_bf16_f32 v138, v84, v85
    v_cvt_pk_bf16_f32 v139, v86, v87
    v_cvt_pk_bf16_f32 v140, v88, v89
    v_cvt_pk_bf16_f32 v141, v90, v91
    v_cvt_pk_bf16_f32 v142, v92, v93
    v_cvt_pk_bf16_f32 v143, v94, v95
    v_cvt_pk_bf16_f32 v144, v96, v97
    v_cvt_pk_bf16_f32 v145, v98, v99
    v_cvt_pk_bf16_f32 v146, v100, v101
    v_cvt_pk_bf16_f32 v147, v102, v103
    v_cvt_pk_bf16_f32 v148, v104, v105
    v_cvt_pk_bf16_f32 v149, v106, v107
    v_cvt_pk_bf16_f32 v150, v108, v109
    v_cvt_pk_bf16_f32 v151, v110, v111
    v_cvt_pk_bf16_f32 v152, v112, v113
    v_cvt_pk_bf16_f32 v153, v114, v115
    v_cvt_pk_bf16_f32 v154, v116, v117
    v_cvt_pk_bf16_f32 v155, v118, v119
    v_cvt_pk_bf16_f32 v156, v120, v121
    v_cvt_pk_bf16_f32 v157, v122, v123
    v_cvt_pk_bf16_f32 v158, v124, v125
    v_cvt_pk_bf16_f32 v159, v126, v127
    v_pk_mul_f32 v[160:161], v[160:161], v[244:245]
    v_pk_mul_f32 v[162:163], v[162:163], v[244:245]
    v_pk_mul_f32 v[164:165], v[164:165], v[244:245]
    v_pk_mul_f32 v[166:167], v[166:167], v[244:245]
    v_pk_mul_f32 v[168:169], v[168:169], v[244:245]
    v_pk_mul_f32 v[170:171], v[170:171], v[244:245]
    v_pk_mul_f32 v[172:173], v[172:173], v[244:245]
    v_pk_mul_f32 v[174:175], v[174:175], v[244:245]
    s_waitcnt lgkmcnt(14)
    s_nop 0
    v_mfma_f32_32x32x16_bf16 v[160:175], v[208:211], v[128:131], v[160:175]
    s_waitcnt vmcnt(7)
    v_and_b32 v30, v25, v30
    v_and_b32 v31, v25, v31
    s_waitcnt vmcnt(6)
    v_and_or_b32 v46, v46, v25, v26
    v_and_b32 v47, v25, v47
    ds_write_b128 v23, v[28:31] offset:0
    ds_write_b128 v24, v[44:47] offset:0
    s_waitcnt lgkmcnt(14)
    v_mfma_f32_32x32x16_bf16 v[160:175], v[212:215], v[132:135], v[160:175]
    s_waitcnt lgkmcnt(12)
    v_mfma_f32_32x32x16_bf16 v[160:175], v[216:219], v[136:139], v[160:175]
    s_waitcnt vmcnt(5)
    v_and_b32 v34, v25, v34
    v_and_b32 v35, v25, v35
    s_waitcnt vmcnt(4)
    v_and_or_b32 v50, v50, v25, v26
    v_and_b32 v51, v25, v51
    ds_write_b128 v23, v[32:35] offset:2560
    ds_write_b128 v24, v[48:51] offset:2048
    s_waitcnt lgkmcnt(12)
    v_mfma_f32_32x32x16_bf16 v[160:175], v[220:223], v[140:143], v[160:175]
    s_waitcnt lgkmcnt(10)
    v_mfma_f32_32x32x16_bf16 v[160:175], v[224:227], v[144:147], v[160:175]
    s_waitcnt vmcnt(3)
    v_and_b32 v38, v25, v38
    v_and_b32 v39, v25, v39
    s_waitcnt vmcnt(2)
    v_and_or_b32 v54, v54, v25, v26
    v_and_b32 v55, v25, v55
    ds_write_b128 v23, v[36:39] offset:5120
    ds_write_b128 v24, v[52:55] offset:4096
    s_waitcnt lgkmcnt(10)
    v_mfma_f32_32x32x16_bf16 v[160:175], v[228:231], v[148:151], v[160:175]
    s_waitcnt lgkmcnt(8)
    v_mfma_f32_32x32x16_bf16 v[160:175], v[232:235], v[152:155], v[160:175]
    s_waitcnt vmcnt(1)
    v_and_b32 v42, v25, v42
    v_and_b32 v43, v25, v43
    s_waitcnt vmcnt(0)
    v_and_or_b32 v58, v58, v25, v26
    v_and_b32 v59, v25, v59
    ds_write_b128 v23, v[40:43] offset:7680
    ds_write_b128 v24, v[56:59] offset:6144
    s_waitcnt lgkmcnt(8)
    v_mfma_f32_32x32x16_bf16 v[160:175], v[236:239], v[156:159], v[160:175]
    s_waitcnt lgkmcnt(0)
    s_barrier
    s_add_u32 s21, s21, 1
    s_cmp_lt_u32 s21, 4
    s_nop 7
    s_cbranch_scc1 L_loop_attn_1_kernel
    v_and_b32 v5, 1, v2
    v_mul_u32_u24 v5, 4352, v5
    v_lshl_add_u32 v248, v1, 2, v5
    v_cmp_eq_u32 vcc, 1, v4
    s_nop 0
    s_and_saveexec_b64 s[4:5], vcc
    s_nop 2
    s_cbranch_execz L_skipw_attn_1_kernel
    ds_write_b32 v248, v160 offset:0
    ds_write_b32 v248, v161 offset:256
    ds_write_b32 v248, v162 offset:512
    ds_write_b32 v248, v163 offset:768
    ds_write_b32 v248, v164 offset:1024
    ds_write_b32 v248, v165 offset:1280
    ds_write_b32 v248, v166 offset:1536
    ds_write_b32 v248, v167 offset:1792
    ds_write_b32 v248, v168 offset:2048
    ds_write_b32 v248, v169 offset:2304
    ds_write_b32 v248, v170 offset:2560
    ds_write_b32 v248, v171 offset:2816
    ds_write_b32 v248, v172 offset:3072
    ds_write_b32 v248, v173 offset:3328
    ds_write_b32 v248, v174 offset:3584
    ds_write_b32 v248, v175 offset:3840
    ds_write_b32 v248, v240 offset:4096
L_skipw_attn_1_kernel:
    s_mov_b64 exec, s[4:5]
    s_waitcnt lgkmcnt(0)
    s_barrier
    v_cmp_eq_u32 vcc, 0, v4
    s_nop 0
    s_and_saveexec_b64 s[4:5], vcc
    s_nop 2
    s_cbranch_execz L_end_attn_1_kernel
    ds_read_b32 v64, v248 offset:0
    ds_read_b32 v65, v248 offset:256
    ds_read_b32 v66, v248 offset:512
    ds_read_b32 v67, v248 offset:768
    ds_read_b32 v68, v248 offset:1024
    ds_read_b32 v69, v248 offset:1280
    ds_read_b32 v70, v248 offset:1536
    ds_read_b32 v71, v248 offset:1792
    ds_read_b32 v72, v248 offset:2048
    ds_read_b32 v73, v248 offset:2304
    ds_read_b32 v74, v248 offset:2560
    ds_read_b32 v75, v248 offset:2816
    ds_read_b32 v76, v248 offset:3072
    ds_read_b32 v77, v248 offset:3328
    ds_read_b32 v78, v248 offset:3584
    ds_read_b32 v79, v248 offset:3840
    ds_read_b32 v7, v248 offset:4096
    s_waitcnt lgkmcnt(0)
    v_max_f32 v241, v240, v7
    v_sub_f32 v5, v240, v241
    v_sub_f32 v6, v7, v241
    v_mul_f32 v5, s22, v5
    v_mul_f32 v6, s22, v6
    v_exp_f32 v5, v5
    v_exp_f32 v6, v6
    v_mul_f32 v160, v5, v160
    v_fmac_f32 v160, v6, v64
    v_mul_f32 v161, v5, v161
    v_fmac_f32 v161, v6, v65
    v_mul_f32 v162, v5, v162
    v_fmac_f32 v162, v6, v66
    v_mul_f32 v163, v5, v163
    v_fmac_f32 v163, v6, v67
    v_mul_f32 v164, v5, v164
    v_fmac_f32 v164, v6, v68
    v_mul_f32 v165, v5, v165
    v_fmac_f32 v165, v6, v69
    v_mul_f32 v166, v5, v166
    v_fmac_f32 v166, v6, v70
    v_mul_f32 v167, v5, v167
    v_fmac_f32 v167, v6, v71
    v_mul_f32 v168, v5, v168
    v_fmac_f32 v168, v6, v72
    v_mul_f32 v169, v5, v169
    v_fmac_f32 v169, v6, v73
    v_mul_f32 v170, v5, v170
    v_fmac_f32 v170, v6, v74
    v_mul_f32 v171, v5, v171
    v_fmac_f32 v171, v6, v75
    v_mul_f32 v172, v5, v172
    v_fmac_f32 v172, v6, v76
    v_mul_f32 v173, v5, v173
    v_fmac_f32 v173, v6, v77
    v_mul_f32 v174, v5, v174
    v_fmac_f32 v174, v6, v78
    v_mul_f32 v175, v5, v175
    v_fmac_f32 v175, v6, v79
    v_mov_b32 v5, v172
    v_mov_b32 v6, v172
    s_nop 1
    v_permlane32_swap_b32 v5, v6
    v_rcp_f32 v6, v6
    v_mul_u32_u24 v249, 896, v21
    s_mul_i32 s18, s16, 56
    v_add_u32 v249, s18, v249
    v_lshl_add_u32 v249, v3, 3, v249
    v_mul_f32 v160, v6, v160
    v_mul_f32 v161, v6, v161
    v_mul_f32 v162, v6, v162
    v_mul_f32 v163, v6, v163
    v_mul_f32 v164, v6, v164
    v_mul_f32 v165, v6, v165
    v_mul_f32 v166, v6, v166
    v_mul_f32 v167, v6, v167
    v_mul_f32 v168, v6, v168
    v_mul_f32 v169, v6, v169
    v_mul_f32 v170, v6, v170
    v_mul_f32 v171, v6, v171
    v_mul_f32 v172, v6, v172
    v_mul_f32 v173, v6, v173
    v_mul_f32 v174, v6, v174
    v_mul_f32 v175, v6, v175
    v_cvt_pk_bf16_f32 v128, v160, v161
    v_cvt_pk_bf16_f32 v129, v162, v163
    v_cvt_pk_bf16_f32 v130, v164, v165
    v_cvt_pk_bf16_f32 v131, v166, v167
    v_cvt_pk_bf16_f32 v132, v168, v169
    v_cvt_pk_bf16_f32 v133, v170, v171
    v_cvt_pk_bf16_f32 v134, v172, v173
    v_cvt_pk_bf16_f32 v135, v174, v175
    buffer_store_dwordx2 v[128:129], v249, s[12:15], 0 offen offset:0
    buffer_store_dwordx2 v[130:131], v249, s[12:15], 0 offen offset:16
    buffer_store_dwordx2 v[132:133], v249, s[12:15], 0 offen offset:32
    s_mov_b32 exec_hi, 0
    buffer_store_dwordx2 v[134:135], v249, s[12:15], 0 offen offset:48
L_end_attn_1_kernel:
    s_endpgm
.globl g3_1_kernel
.p2align 8
.type g3_1_kernel,@function
g3_1_kernel:
    s_load_dwordx16 s[32:47], s[0:1], 0
    s_load_dwordx4 s[48:51], s[0:1], 64
    s_cmp_ge_u32 s2, 224
    s_cbranch_scc1 L_end_g3_1_kernel
    s_lshr_b32 s28, s2, 3
    s_and_b32 s29, s2, 7
    s_mul_hi_u32 s24, s28, 0x24924925
    s_mul_i32 s27, s24, 7
    s_sub_u32 s25, s28, s27
    s_and_b32 s27, s29, 7
    s_mul_i32 s27, s27, 4
    s_add_u32 s24, s24, s27
    s_lshr_b32 s27, s29, 3
    s_mul_i32 s27, s27, 7
    s_add_u32 s25, s25, s27
    s_mov_b32 s30, 0
    s_mov_b32 s31, 28672
    v_and_b32 v1, 63, v0
    v_lshrrev_b32 v2, 6, v0
    v_lshrrev_b32 v3, 3, v0
    v_and_b32 v4, 7, v0
    v_lshlrev_b32 v4, 4, v4
    s_mul_i32 s27, s24, 57344
    v_mul_u32_u24 v7, 896, v3
    v_add3_u32 v7, v7, v4, s27
    v_mul_u32_u24 v8, 144, v3
    v_add_u32 v8, v8, v4
    s_mul_i32 s27, s25, 128
    v_lshrrev_b32 v3, 3, v0
    v_and_b32 v4, 7, v0
    v_lshlrev_b32 v4, 4, v4
    v_mul_u32_u24 v9, 896, v3
    v_add3_u32 v9, v9, v4, s27
    v_mul_u32_u24 v10, 192, v3
    v_add_u32 v10, v10, v4
    v_add_u32 v10, 9216, v10
    v_and_b32 v5, 31, v1
    v_mul_u32_u24 v11, 144, v5
    v_lshrrev_b32 v6, 5, v1
    v_lshlrev_b32 v6, 4, v6
    v_add_u32 v11, v11, v6
    v_lshl_add_u32 v11, v2, 5, v11
    v_lshrrev_b32 v3, 5, v1
    v_lshlrev_b32 v3, 3, v3
    v_bfe_u32 v5, v1, 2, 2
    v_add_u32 v3, v3, v5
    v_lshl_add_u32 v3, v2, 4, v3
    v_mul_u32_u24 v12, 192, v3
    v_bfe_u32 v5, v1, 4, 1
    v_lshlrev_b32 v5, 5, v5
    v_and_b32 v6, 3, v1
    v_lshlrev_b32 v6, 3, v6
    v_add3_u32 v12, v12, v5, v6
    v_add_u32 v12, 9216, v12
    v_add_u32 v13, 21504, v11
    v_add_u32 v14, 43008, v11
    v_add_u32 v15, 21504, v12
    v_add_u32 v16, 43008, v12
    v_add_u32 v17, 21504, v8
    v_add_u32 v18, 43008, v8
    v_add_u32 v19, 21504, v10
    v_add_u32 v20, 43008, v10
    s_waitcnt lgkmcnt(0)
    s_add_u32 s8, s50, 0x600000
    s_addc_u32 s9, s51, 0
    s_and_b32 s9, s9, 0xffff
    s_mov_b32 s10, 0x1c0000
    s_mov_b32 s11, 0x00020000
    s_mov_b32 s12, s36
    s_and_b32 s13, s37, 0xffff
    s_mov_b32 s14, 0x62000
    s_mov_b32 s15, 0x00020000
    buffer_load_dwordx4 v[24:27], v7, s[8:11], s30 offen offset:0
    buffer_load_dwordx4 v[28:31], v7, s[8:11], s31 offen offset:0
    buffer_load_dwordx4 v[32:35], v7, s[8:11], s30 offen offset:128
    buffer_load_dwordx4 v[36:39], v7, s[8:11], s31 offen offset:128
    buffer_load_dwordx4 v[40:43], v7, s[8:11], s30 offen offset:256
    buffer_load_dwordx4 v[44:47], v7, s[8:11], s31 offen offset:256
    buffer_load_dwordx4 v[48:51], v7, s[8:11], s30 offen offset:384
    buffer_load_dwordx4 v[52:55], v7, s[8:11], s31 offen offset:384
    s_mov_b32 s26, 0
    buffer_load_dwordx4 v[56:59], v9, s[12:15], s26 offen
    s_mov_b32 s26, 28672
    buffer_load_dwordx4 v[60:63], v9, s[12:15], s26 offen
    s_mov_b32 s26, 57344
    buffer_load_dwordx4 v[64:67], v9, s[12:15], s26 offen
    s_mov_b32 s26, 86016
    buffer_load_dwordx4 v[68:71], v9, s[12:15], s26 offen
    s_mov_b32 s26, 114688
    buffer_load_dwordx4 v[72:75], v9, s[12:15], s26 offen
    s_mov_b32 s26, 143360
    buffer_load_dwordx4 v[76:79], v9, s[12:15], s26 offen
    s_mov_b32 s26, 172032
    buffer_load_dwordx4 v[80:83], v9, s[12:15], s26 offen
    s_mov_b32 s26, 200704
    buffer_load_dwordx4 v[84:87], v9, s[12:15], s26 offen
    s_waitcnt vmcnt(15)
    ds_write_b128 v8, v[24:27] offset:0
    s_waitcnt vmcnt(14)
    ds_write_b128 v8, v[28:31] offset:4608
    s_waitcnt vmcnt(7)
    ds_write_b128 v10, v[56:59] offset:0
    s_waitcnt vmcnt(6)
    ds_write_b128 v10, v[60:63] offset:6144
    buffer_load_dwordx4 v[24:27], v7, s[8:11], s30 offen offset:512
    buffer_load_dwordx4 v[28:31], v7, s[8:11], s31 offen offset:512
    s_mov_b32 s26, 229376
    buffer_load_dwordx4 v[56:59], v9, s[12:15], s26 offen
    s_mov_b32 s26, 258048
    buffer_load_dwordx4 v[60:63], v9, s[12:15], s26 offen
    ds_write_b128 v17, v[32:35] offset:0
    ds_write_b128 v17, v[36:39] offset:4608
    s_waitcnt vmcnt(9)
    ds_write_b128 v19, v[64:67] offset:0
    s_waitcnt vmcnt(8)
    ds_write_b128 v19, v[68:71] offset:6144
    buffer_load_dwordx4 v[32:35], v7, s[8:11], s30 offen offset:640
    buffer_load_dwordx4 v[36:39], v7, s[8:11], s31 offen offset:640
    s_mov_b32 s26, 286720
    buffer_load_dwordx4 v[64:67], v9, s[12:15], s26 offen
    s_mov_b32 s26, 315392
    buffer_load_dwordx4 v[68:71], v9, s[12:15], s26 offen
    s_waitcnt lgkmcnt(0)
    s_barrier
    ds_read_b128 v[88:91], v11 offset:0
    ds_read_b128 v[92:95], v11 offset:4608
    ds_read_b64_tr_b16 v[104:105], v12 offset:0
    ds_read_b64_tr_b16 v[106:107], v12 offset:768
    ds_read_b64_tr_b16 v[108:109], v12 offset:64
    ds_read_b64_tr_b16 v[110:111], v12 offset:832
    s_waitcnt lgkmcnt(2)
    v_mfma_f32_32x32x16_bf16 v[120:135], v[104:107], v[88:91], 0
    ds_read_b128 v[96:99], v13 offset:0
    ds_read_b128 v[100:103], v13 offset:4608
    ds_write_b128 v18, v[40:43] offset:0
    ds_write_b128 v18, v[44:47] offset:4608
    s_waitcnt vmcnt(11)
    ds_write_b128 v20, v[72:75] offset:0
    v_mfma_f32_32x32x16_bf16 v[136:151], v[104:107], v[92:95], 0
    ds_read_b64_tr_b16 v[112:113], v15 offset:0
    ds_read_b64_tr_b16 v[114:115], v15 offset:768
    s_waitcnt vmcnt(10)
    ds_write_b128 v20, v[76:79] offset:6144
    buffer_load_dwordx4 v[40:43], v7, s[8:11], s30 offen offset:768
    s_waitcnt lgkmcnt(8)
    v_mfma_f32_32x32x16_bf16 v[152:167], v[108:111], v[88:91], 0
    ds_read_b64_tr_b16 v[116:117], v15 offset:64
    ds_read_b64_tr_b16 v[118:119], v15 offset:832
    buffer_load_dwordx4 v[44:47], v7, s[8:11], s31 offen offset:768
    s_mov_b32 s26, 344064
    buffer_load_dwordx4 v[72:75], v9, s[12:15], s26 offen
    s_mov_b32 s26, 372736
    buffer_load_dwordx4 v[76:79], v9, s[12:15], s26 offen
    v_mfma_f32_32x32x16_bf16 v[168:183], v[108:111], v[92:95], 0
    s_waitcnt lgkmcnt(2)
    s_barrier
    v_mfma_f32_32x32x16_bf16 v[120:135], v[112:115], v[96:99], v[120:135]
    ds_read_b128 v[88:91], v14 offset:0
    ds_read_b128 v[92:95], v14 offset:4608
    ds_write_b128 v8, v[48:51] offset:0
    ds_write_b128 v8, v[52:55] offset:4608
    v_mfma_f32_32x32x16_bf16 v[136:151], v[112:115], v[100:103], v[136:151]
    ds_read_b64_tr_b16 v[104:105], v16 offset:0
    ds_read_b64_tr_b16 v[106:107], v16 offset:768
    s_waitcnt vmcnt(13)
    ds_write_b128 v10, v[80:83] offset:0
    s_waitcnt lgkmcnt(7)
    v_mfma_f32_32x32x16_bf16 v[152:167], v[116:119], v[96:99], v[152:167]
    ds_read_b64_tr_b16 v[108:109], v16 offset:64
    ds_read_b64_tr_b16 v[110:111], v16 offset:832
    s_waitcnt vmcnt(12)
    ds_write_b128 v10, v[84:87] offset:6144
    v_mfma_f32_32x32x16_bf16 v[168:183], v[116:119], v[100:103], v[168:183]
    s_waitcnt lgkmcnt(0)
    s_barrier
    v_mfma_f32_32x32x16_bf16 v[120:135], v[104:107], v[88:91], v[120:135]
    ds_read_b128 v[96:99], v11 offset:0
    ds_read_b128 v[100:103], v11 offset:4608
    s_waitcnt vmcnt(11)
    ds_write_b128 v17, v[24:27] offset:0
    s_waitcnt vmcnt(10)
    ds_write_b128 v17, v[28:31] offset:4608
    v_mfma_f32_32x32x16_bf16 v[136:151], v[104:107], v[92:95], v[136:151]
    ds_read_b64_tr_b16 v[112:113], v12 offset:0
    ds_read_b64_tr_b16 v[114:115], v12 offset:768
    s_waitcnt vmcnt(9)
    ds_write_b128 v19, v[56:59] offset:0
    v_mfma_f32_32x32x16_bf16 v[152:167], v[108:111], v[88:91], v[152:167]
    ds_read_b64_tr_b16 v[116:117], v12 offset:64
    ds_read_b64_tr_b16 v[118:119], v12 offset:832
    s_waitcnt vmcnt(8)
    ds_write_b128 v19, v[60:63] offset:6144
    v_mfma_f32_32x32x16_bf16 v[168:183], v[108:111], v[92:95], v[168:183]
    s_waitcnt lgkmcnt(0)
    s_barrier
    v_mfma_f32_32x32x16_bf16 v[120:135], v[112:115], v[96:99], v[120:135]
    ds_read_b128 v[88:91], v13 offset:0
    ds_read_b128 v[92:95], v13 offset:4608
    s_waitcnt vmcnt(7)
    ds_write_b128 v18, v[32:35] offset:0
    s_waitcnt vmcnt(6)
    ds_write_b128 v18, v[36:39] offset:4608
    v_mfma_f32_32x32x16_bf16 v[136:151], v[112:115], v[100:103], v[136:151]
    ds_read_b64_tr_b16 v[104:105], v15 offset:0
    ds_read_b64_tr_b16 v[106:107], v15 offset:768
    s_waitcnt vmcnt(5)
    ds_write_b128 v20, v[64:67] offset:0
    v_mfma_f32_32x32x16_bf16 v[152:167], v[116:119], v[96:99], v[152:167]
    ds_read_b64_tr_b16 v[108:109], v15 offset:64
    ds_read_b64_tr_b16 v[110:111], v15 offset:832
    s_waitcnt vmcnt(4)
    ds_write_b128 v20, v[68:71] offset:6144
    v_mfma_f32_32x32x16_bf16 v[168:183], v[116:119], v[100:103], v[168:183]
    s_waitcnt lgkmcnt(0)
    s_barrier
    v_mfma_f32_32x32x16_bf16 v[120:135], v[104:107], v[88:91], v[120:135]
    ds_read_b128 v[96:99], v14 offset:0
    ds_read_b128 v[100:103], v14 offset:4608
    s_waitcnt vmcnt(3)
    ds_write_b128 v8, v[40:43] offset:0
    s_waitcnt vmcnt(2)
    ds_write_b128 v8, v[44:47] offset:4608
    v_mfma_f32_32x32x16_bf16 v[136:151], v[104:107], v[92:95], v[136:151]
    ds_read_b64_tr_b16 v[112:113], v16 offset:0
    ds_read_b64_tr_b16 v[114:115], v16 offset:768
    s_waitcnt vmcnt(1)
    ds_write_b128 v10, v[72:75] offset:0
    v_mfma_f32_32x32x16_bf16 v[152:167], v[108:111], v[88:91], v[152:167]
    ds_read_b64_tr_b16 v[116:117], v16 offset:64
    ds_read_b64_tr_b16 v[118:119], v16 offset:832
    s_waitcnt vmcnt(0)
    ds_write_b128 v10, v[76:79] offset:6144
    v_mfma_f32_32x32x16_bf16 v[168:183], v[108:111], v[92:95], v[168:183]
    s_waitcnt lgkmcnt(0)
    s_barrier
    v_mfma_f32_32x32x16_bf16 v[120:135], v[112:115], v[96:99], v[120:135]
    ds_read_b128 v[88:91], v11 offset:0
    ds_read_b128 v[92:95], v11 offset:4608
    v_mfma_f32_32x32x16_bf16 v[136:151], v[112:115], v[100:103], v[136:151]
    ds_read_b64_tr_b16 v[104:105], v12 offset:0
    ds_read_b64_tr_b16 v[106:107], v12 offset:768
    v_mfma_f32_32x32x16_bf16 v[152:167], v[116:119], v[96:99], v[152:167]
    ds_read_b64_tr_b16 v[108:109], v12 offset:64
    ds_read_b64_tr_b16 v[110:111], v12 offset:832
    v_mfma_f32_32x32x16_bf16 v[168:183], v[116:119], v[100:103], v[168:183]
    s_waitcnt lgkmcnt(2)
    v_mfma_f32_32x32x16_bf16 v[120:135], v[104:107], v[88:91], v[120:135]
    v_mfma_f32_32x32x16_bf16 v[136:151], v[104:107], v[92:95], v[136:151]
    s_waitcnt lgkmcnt(0)
    v_mfma_f32_32x32x16_bf16 v[152:167], v[108:111], v[88:91], v[152:167]
    v_mfma_f32_32x32x16_bf16 v[168:183], v[108:111], v[92:95], v[168:183]
    s_mul_i32 s27, s24, 64
    s_mul_i32 s28, s25, 64
    v_and_b32 v5, 31, v1
    v_lshrrev_b32 v6, 5, v1
    v_lshlrev_b32 v6, 2, v6
    v_and_b32 v3, 1, v2
    v_lshrrev_b32 v4, 1, v2
    v_lshlrev_b32 v3, 5, v3
    v_lshlrev_b32 v4, 5, v4
    v_add3_u32 v24, v3, v5, s27
    v_add3_u32 v25, v4, v6, s28
    s_add_u32 s16, s50, 0x800000
    s_addc_u32 s17, s51, 0
    s_and_b32 s17, s17, 0xffff
    s_mov_b32 s18, 0x1c0000
    s_mov_b32 s19, 0x00020000
    s_add_u32 s20, s50, 0xa00000
    s_addc_u32 s21, s51, 0
    s_and_b32 s21, s21, 0xffff
    s_mov_b32 s22, 0x1c0000
    s_mov_b32 s23, 0x00020000
    v_lshrrev_b32 v3, 5, v1
    v_lshl_add_u32 v3, v3, 2, v25
    v_mul_u32_u24 v26, 896, v24
    v_lshl_add_u32 v26, v3, 1, v26
    buffer_load_dwordx4 v[28:31], v26, s[20:23], 0 offen offset:0
    buffer_load_dwordx4 v[32:35], v26, s[20:23], 0 offen offset:32
    s_waitcnt lgkmcnt(0)
    s_barrier
    v_lshlrev_b32 v3, 4, v1
    v_lshl_add_u32 v36, v2, 14, v3
    v_lshl_add_u32 v37, v2, 12, v3
    ds_write_b128 v36, v[120:123] offset:0
    ds_write_b128 v36, v[124:127] offset:1024
    ds_write_b128 v36, v[128:131] offset:2048
    ds_write_b128 v36, v[132:135] offset:3072
    ds_write_b128 v36, v[136:139] offset:4096
    ds_write_b128 v36, v[140:143] offset:5120
    ds_write_b128 v36, v[144:147] offset:6144
    ds_write_b128 v36, v[148:151] offset:7168
    ds_write_b128 v36, v[152:155] offset:8192
    ds_write_b128 v36, v[156:159] offset:9216
    ds_write_b128 v36, v[160:163] offset:10240
    ds_write_b128 v36, v[164:167] offset:11264
    ds_write_b128 v36, v[168:171] offset:12288
    ds_write_b128 v36, v[172:175] offset:13312
    ds_write_b128 v36, v[176:179] offset:14336
    ds_write_b128 v36, v[180:183] offset:15360
    s_waitcnt lgkmcnt(0)
    s_barrier
    ds_read_b128 v[184:187], v37 offset:0
    ds_read_b128 v[188:191], v37 offset:1024
    ds_read_b128 v[192:195], v37 offset:2048
    ds_read_b128 v[196:199], v37 offset:3072
    ds_read_b128 v[200:203], v37 offset:16384
    ds_read_b128 v[204:207], v37 offset:17408
    ds_read_b128 v[208:211], v37 offset:18432
    ds_read_b128 v[212:215], v37 offset:19456
    ds_read_b128 v[216:219], v37 offset:32768
    ds_read_b128 v[220:223], v37 offset:33792
    ds_read_b128 v[224:227], v37 offset:34816
    ds_read_b128 v[228:231], v37 offset:35840
    ds_read_b128 v[232:235], v37 offset:49152
    ds_read_b128 v[236:239], v37 offset:50176
    ds_read_b128 v[240:243], v37 offset:51200
    ds_read_b128 v[244:247], v37 offset:52224
    s_waitcnt lgkmcnt(11)
    v_pk_add_f32 v[184:185], v[184:185], v[200:201]
    s_waitcnt lgkmcnt(3)
    v_pk_add_f32 v[216:217], v[216:217], v[232:233]
    v_pk_add_f32 v[184:185], v[184:185], v[216:217]
    v_pk_add_f32 v[186:187], v[186:187], v[202:203]
    v_pk_add_f32 v[218:219], v[218:219], v[234:235]
    v_pk_add_f32 v[186:187], v[186:187], v[218:219]
    v_pk_add_f32 v[188:189], v[188:189], v[204:205]
    s_waitcnt lgkmcnt(2)
    v_pk_add_f32 v[220:221], v[220:221], v[236:237]
    v_pk_add_f32 v[188:189], v[188:189], v[220:221]
    v_pk_add_f32 v[190:191], v[190:191], v[206:207]
    v_pk_add_f32 v[222:223], v[222:223], v[238:239]
    v_pk_add_f32 v[190:191], v[190:191], v[222:223]
    v_pk_add_f32 v[192:193], v[192:193], v[208:209]
    s_waitcnt lgkmcnt(1)
    v_pk_add_f32 v[224:225], v[224:225], v[240:241]
    v_pk_add_f32 v[192:193], v[192:193], v[224:225]
    v_pk_add_f32 v[194:195], v[194:195], v[210:211]
    v_pk_add_f32 v[226:227], v[226:227], v[242:243]
    v_pk_add_f32 v[194:195], v[194:195], v[226:227]
    v_pk_add_f32 v[196:197], v[196:197], v[212:213]
    s_waitcnt lgkmcnt(0)
    v_pk_add_f32 v[228:229], v[228:229], v[244:245]
    v_pk_add_f32 v[196:197], v[196:197], v[228:229]
    v_pk_add_f32 v[198:199], v[198:199], v[214:215]
    v_pk_add_f32 v[230:231], v[230:231], v[246:247]
    v_pk_add_f32 v[198:199], v[198:199], v[230:231]
    v_cvt_pk_bf16_f32 v40, v184, v185
    v_cvt_pk_bf16_f32 v41, v186, v187
    v_cvt_pk_bf16_f32 v42, v188, v189
    v_cvt_pk_bf16_f32 v43, v190, v191
    s_nop 0
    v_permlane32_swap_b32 v40, v42
    v_permlane32_swap_b32 v41, v43
    v_lshlrev_b32 v4, 16, v40
    v_and_b32 v3, 0xffff0000, v40
    s_waitcnt vmcnt(1)
    v_lshlrev_b32 v5, 16, v28
    v_and_b32 v6, 0xffff0000, v28
    v_add_f32 v4, v4, v5
    v_add_f32 v3, v3, v6
    v_cvt_pk_bf16_f32 v28, v4, v3
    v_lshlrev_b32 v4, 16, v41
    v_and_b32 v3, 0xffff0000, v41
    v_lshlrev_b32 v5, 16, v29
    v_and_b32 v6, 0xffff0000, v29
    v_add_f32 v4, v4, v5
    v_add_f32 v3, v3, v6
    v_cvt_pk_bf16_f32 v29, v4, v3
    v_lshlrev_b32 v4, 16, v42
    v_and_b32 v3, 0xffff0000, v42
    v_lshlrev_b32 v5, 16, v30
    v_and_b32 v6, 0xffff0000, v30
    v_add_f32 v4, v4, v5
    v_add_f32 v3, v3, v6
    v_cvt_pk_bf16_f32 v30, v4, v3
    v_lshlrev_b32 v4, 16, v43
    v_and_b32 v3, 0xffff0000, v43
    v_lshlrev_b32 v5, 16, v31
    v_and_b32 v6, 0xffff0000, v31
    v_add_f32 v4, v4, v5
    v_add_f32 v3, v3, v6
    v_cvt_pk_bf16_f32 v31, v4, v3
    buffer_store_dwordx4 v[28:31], v26, s[16:19], 0 offen offset:0
    v_cvt_pk_bf16_f32 v40, v192, v193
    v_cvt_pk_bf16_f32 v41, v194, v195
    v_cvt_pk_bf16_f32 v42, v196, v197
    v_cvt_pk_bf16_f32 v43, v198, v199
    s_nop 0
    v_permlane32_swap_b32 v40, v42
    v_permlane32_swap_b32 v41, v43
    v_lshlrev_b32 v4, 16, v40
    v_and_b32 v3, 0xffff0000, v40
    s_waitcnt vmcnt(1)
    v_lshlrev_b32 v5, 16, v32
    v_and_b32 v6, 0xffff0000, v32
    v_add_f32 v4, v4, v5
    v_add_f32 v3, v3, v6
    v_cvt_pk_bf16_f32 v32, v4, v3
    v_lshlrev_b32 v4, 16, v41
    v_and_b32 v3, 0xffff0000, v41
    v_lshlrev_b32 v5, 16, v33
    v_and_b32 v6, 0xffff0000, v33
    v_add_f32 v4, v4, v5
    v_add_f32 v3, v3, v6
    v_cvt_pk_bf16_f32 v33, v4, v3
    v_lshlrev_b32 v4, 16, v42
    v_and_b32 v3, 0xffff0000, v42
    v_lshlrev_b32 v5, 16, v34
    v_and_b32 v6, 0xffff0000, v34
    v_add_f32 v4, v4, v5
    v_add_f32 v3, v3, v6
    v_cvt_pk_bf16_f32 v34, v4, v3
    v_lshlrev_b32 v4, 16, v43
    v_and_b32 v3, 0xffff0000, v43
    v_lshlrev_b32 v5, 16, v35
    v_and_b32 v6, 0xffff0000, v35
    v_add_f32 v4, v4, v5
    v_add_f32 v3, v3, v6
    v_cvt_pk_bf16_f32 v35, v4, v3
    buffer_store_dwordx4 v[32:35], v26, s[16:19], 0 offen offset:32
L_end_g3_1_kernel:
    s_endpgm
.globl g4_1_kernel
.p2align 8
.type g4_1_kernel,@function
g4_1_kernel:
    s_load_dwordx16 s[40:55], s[0:1], 0
    s_load_dwordx4 s[56:59], s[0:1], 64
    s_cmp_ge_u32 s2, 224
    s_cbranch_scc1 L_end_g4_1_kernel
    s_lshr_b32 s32, s2, 3
    s_and_b32 s33, s2, 7
    s_mul_hi_u32 s28, s32, 0x24924925
    s_mul_i32 s31, s28, 7
    s_sub_u32 s29, s32, s31
    s_and_b32 s31, s33, 3
    s_mul_i32 s31, s31, 4
    s_add_u32 s28, s28, s31
    s_lshr_b32 s31, s33, 2
    s_mul_i32 s31, s31, 7
    s_add_u32 s29, s29, s31
    s_mov_b32 s34, 0
    s_mov_b32 s35, 28672
    s_mov_b32 s36, 57344
    s_mov_b32 s37, 86016
    v_and_b32 v1, 63, v0
    v_lshrrev_b32 v2, 6, v0
    v_lshrrev_b32 v3, 3, v0
    v_and_b32 v4, 7, v0
    v_lshlrev_b32 v4, 4, v4
    s_mul_i32 s31, s28, 114688
    v_mul_u32_u24 v7, 896, v3
    v_add3_u32 v7, v7, v4, s31
    v_mul_u32_u24 v8, 144, v3
    v_add_u32 v8, v8, v4
    s_lshl_b32 s31, s29, 2
    v_add_u32 v3, s31, v2
    v_mul_u32_u24 v124, 28672, v3
    v_lshl_add_u32 v124, v1, 4, v124
    v_and_b32 v5, 31, v1
    v_mul_u32_u24 v176, 144, v5
    v_lshrrev_b32 v6, 5, v1
    v_lshlrev_b32 v6, 4, v6
    v_add_u32 v176, v176, v6
    v_add_u32 v177, 18432, v176
    v_add_u32 v178, 36864, v176
    v_add_u32 v179, 18432, v8
    v_add_u32 v180, 36864, v8
    s_waitcnt lgkmcnt(0)
    s_add_u32 s8, s58, 0x800000
    s_addc_u32 s9, s59, 0
    s_and_b32 s9, s9, 0xffff
    s_mov_b32 s10, 0x1c0000
    s_mov_b32 s11, 0x00020000
    s_add_u32 s12, s58, 0x1500000
    s_addc_u32 s13, s59, 0
    s_and_b32 s13, s13, 0xffff
    s_mov_b32 s14, 0x188000
    s_mov_b32 s15, 0x00020000
    s_add_u32 s16, s58, 0x1690000
    s_addc_u32 s17, s59, 0
    s_and_b32 s17, s17, 0xffff
    s_mov_b32 s18, 0x188000
    s_mov_b32 s19, 0x00020000
    buffer_load_dwordx4 v[12:15], v7, s[8:11], s34 offen offset:0
    buffer_load_dwordx4 v[16:19], v7, s[8:11], s35 offen offset:0
    buffer_load_dwordx4 v[20:23], v7, s[8:11], s36 offen offset:0
    buffer_load_dwordx4 v[24:27], v7, s[8:11], s37 offen offset:0
    buffer_load_dwordx4 v[28:31], v7, s[8:11], s34 offen offset:128
    buffer_load_dwordx4 v[32:35], v7, s[8:11], s35 offen offset:128
    buffer_load_dwordx4 v[36:39], v7, s[8:11], s36 offen offset:128
    buffer_load_dwordx4 v[40:43], v7, s[8:11], s37 offen offset:128
    buffer_load_dwordx4 v[44:47], v7, s[8:11], s34 offen offset:256
    buffer_load_dwordx4 v[48:51], v7, s[8:11], s35 offen offset:256
    buffer_load_dwordx4 v[52:55], v7, s[8:11], s36 offen offset:256
    buffer_load_dwordx4 v[56:59], v7, s[8:11], s37 offen offset:256
    buffer_load_dwordx4 v[60:63], v7, s[8:11], s34 offen offset:384
    buffer_load_dwordx4 v[64:67], v7, s[8:11], s35 offen offset:384
    buffer_load_dwordx4 v[68:71], v7, s[8:11], s36 offen offset:384
    buffer_load_dwordx4 v[72:75], v7, s[8:11], s37 offen offset:384
    buffer_load_dwordx4 v[76:79], v7, s[8:11], s34 offen offset:512
    buffer_load_dwordx4 v[80:83], v7, s[8:11], s35 offen offset:512
    buffer_load_dwordx4 v[84:87], v7, s[8:11], s36 offen offset:512
    buffer_load_dwordx4 v[88:91], v7, s[8:11], s37 offen offset:512
    buffer_load_dwordx4 v[92:95], v7, s[8:11], s34 offen offset:640
    buffer_load_dwordx4 v[96:99], v7, s[8:11], s35 offen offset:640
    buffer_load_dwordx4 v[100:103], v7, s[8:11], s36 offen offset:640
    buffer_load_dwordx4 v[104:107], v7, s[8:11], s37 offen offset:640
    buffer_load_dwordx4 v[108:111], v7, s[8:11], s34 offen offset:768
    buffer_load_dwordx4 v[112:115], v7, s[8:11], s35 offen offset:768
    buffer_load_dwordx4 v[116:119], v7, s[8:11], s36 offen offset:768
    buffer_load_dwordx4 v[120:123], v7, s[8:11], s37 offen offset:768
    s_mov_b32 s30, 0
    buffer_load_dwordx4 v[128:131], v124, s[12:15], s30 offen offset:0
    buffer_load_dwordx4 v[132:135], v124, s[16:19], s30 offen offset:0
    buffer_load_dwordx4 v[136:139], v124, s[12:15], s30 offen offset:1024
    buffer_load_dwordx4 v[140:143], v124, s[16:19], s30 offen offset:1024
    buffer_load_dwordx4 v[144:147], v124, s[12:15], s30 offen offset:2048
    buffer_load_dwordx4 v[148:151], v124, s[16:19], s30 offen offset:2048
    buffer_load_dwordx4 v[152:155], v124, s[12:15], s30 offen offset:3072
    buffer_load_dwordx4 v[156:159], v124, s[16:19], s30 offen offset:3072
    s_mov_b32 s30, 4096
    buffer_load_dwordx4 v[160:163], v124, s[12:15], s30 offen offset:0
    buffer_load_dwordx4 v[164:167], v124, s[16:19], s30 offen offset:0
    buffer_load_dwordx4 v[168:171], v124, s[12:15], s30 offen offset:1024
    buffer_load_dwordx4 v[172:175], v124, s[16:19], s30 offen offset:1024
    v_mov_b32 v224, 0x3f803f80
    v_mov_b32 v216, 0
    v_mov_b32 v220, 0
    v_mov_b32 v217, 0
    v_mov_b32 v221, 0
    v_mov_b32 v218, 0
    v_mov_b32 v222, 0
    v_mov_b32 v219, 0
    v_mov_b32 v223, 0
    s_waitcnt vmcnt(39)
    v_dot2_f32_bf16 v216, v12, v224, v216
    v_dot2_f32_bf16 v220, v12, v12, v220
    v_dot2_f32_bf16 v216, v13, v224, v216
    v_dot2_f32_bf16 v220, v13, v13, v220
    v_dot2_f32_bf16 v216, v14, v224, v216
    v_dot2_f32_bf16 v220, v14, v14, v220
    v_dot2_f32_bf16 v216, v15, v224, v216
    v_dot2_f32_bf16 v220, v15, v15, v220
    s_waitcnt vmcnt(38)
    v_dot2_f32_bf16 v217, v16, v224, v217
    v_dot2_f32_bf16 v221, v16, v16, v221
    v_dot2_f32_bf16 v217, v17, v224, v217
    v_dot2_f32_bf16 v221, v17, v17, v221
    v_dot2_f32_bf16 v217, v18, v224, v217
    v_dot2_f32_bf16 v221, v18, v18, v221
    v_dot2_f32_bf16 v217, v19, v224, v217
    v_dot2_f32_bf16 v221, v19, v19, v221
    s_waitcnt vmcnt(37)
    v_dot2_f32_bf16 v218, v20, v224, v218
    v_dot2_f32_bf16 v222, v20, v20, v222
    v_dot2_f32_bf16 v218, v21, v224, v218
    v_dot2_f32_bf16 v222, v21, v21, v222
    v_dot2_f32_bf16 v218, v22, v224, v218
    v_dot2_f32_bf16 v222, v22, v22, v222
    v_dot2_f32_bf16 v218, v23, v224, v218
    v_dot2_f32_bf16 v222, v23, v23, v222
    s_waitcnt vmcnt(36)
    v_dot2_f32_bf16 v219, v24, v224, v219
    v_dot2_f32_bf16 v223, v24, v24, v223
    v_dot2_f32_bf16 v219, v25, v224, v219
    v_dot2_f32_bf16 v223, v25, v25, v223
    v_dot2_f32_bf16 v219, v26, v224, v219
    v_dot2_f32_bf16 v223, v26, v26, v223
    v_dot2_f32_bf16 v219, v27, v224, v219
    v_dot2_f32_bf16 v223, v27, v27, v223
    s_waitcnt vmcnt(35)
    v_dot2_f32_bf16 v216, v28, v224, v216
    v_dot2_f32_bf16 v220, v28, v28, v220
    v_dot2_f32_bf16 v216, v29, v224, v216
    v_dot2_f32_bf16 v220, v29, v29, v220
    v_dot2_f32_bf16 v216, v30, v224, v216
    v_dot2_f32_bf16 v220, v30, v30, v220
    v_dot2_f32_bf16 v216, v31, v224, v216
    v_dot2_f32_bf16 v220, v31, v31, v220
    s_waitcnt vmcnt(34)
    v_dot2_f32_bf16 v217, v32, v224, v217
    v_dot2_f32_bf16 v221, v32, v32, v221
    v_dot2_f32_bf16 v217, v33, v224, v217
    v_dot2_f32_bf16 v221, v33, v33, v221
    v_dot2_f32_bf16 v217, v34, v224, v217
    v_dot2_f32_bf16 v221, v34, v34, v221
    v_dot2_f32_bf16 v217, v35, v224, v217
    v_dot2_f32_bf16 v221, v35, v35, v221
    s_waitcnt vmcnt(33)
    v_dot2_f32_bf16 v218, v36, v224, v218
    v_dot2_f32_bf16 v222, v36, v36, v222
    v_dot2_f32_bf16 v218, v37, v224, v218
    v_dot2_f32_bf16 v222, v37, v37, v222
    v_dot2_f32_bf16 v218, v38, v224, v218
    v_dot2_f32_bf16 v222, v38, v38, v222
    v_dot2_f32_bf16 v218, v39, v224, v218
    v_dot2_f32_bf16 v222, v39, v39, v222
    s_waitcnt vmcnt(32)
    v_dot2_f32_bf16 v219, v40, v224, v219
    v_dot2_f32_bf16 v223, v40, v40, v223
    v_dot2_f32_bf16 v219, v41, v224, v219
    v_dot2_f32_bf16 v223, v41, v41, v223
    v_dot2_f32_bf16 v219, v42, v224, v219
    v_dot2_f32_bf16 v223, v42, v42, v223
    v_dot2_f32_bf16 v219, v43, v224, v219
    v_dot2_f32_bf16 v223, v43, v43, v223
    s_waitcnt vmcnt(31)
    v_dot2_f32_bf16 v216, v44, v224, v216
    v_dot2_f32_bf16 v220, v44, v44, v220
    v_dot2_f32_bf16 v216, v45, v224, v216
    v_dot2_f32_bf16 v220, v45, v45, v220
    v_dot2_f32_bf16 v216, v46, v224, v216
    v_dot2_f32_bf16 v220, v46, v46, v220
    v_dot2_f32_bf16 v216, v47, v224, v216
    v_dot2_f32_bf16 v220, v47, v47, v220
    s_waitcnt vmcnt(30)
    v_dot2_f32_bf16 v217, v48, v224, v217
    v_dot2_f32_bf16 v221, v48, v48, v221
    v_dot2_f32_bf16 v217, v49, v224, v217
    v_dot2_f32_bf16 v221, v49, v49, v221
    v_dot2_f32_bf16 v217, v50, v224, v217
    v_dot2_f32_bf16 v221, v50, v50, v221
    v_dot2_f32_bf16 v217, v51, v224, v217
    v_dot2_f32_bf16 v221, v51, v51, v221
    s_waitcnt vmcnt(29)
    v_dot2_f32_bf16 v218, v52, v224, v218
    v_dot2_f32_bf16 v222, v52, v52, v222
    v_dot2_f32_bf16 v218, v53, v224, v218
    v_dot2_f32_bf16 v222, v53, v53, v222
    v_dot2_f32_bf16 v218, v54, v224, v218
    v_dot2_f32_bf16 v222, v54, v54, v222
    v_dot2_f32_bf16 v218, v55, v224, v218
    v_dot2_f32_bf16 v222, v55, v55, v222
    s_waitcnt vmcnt(28)
    v_dot2_f32_bf16 v219, v56, v224, v219
    v_dot2_f32_bf16 v223, v56, v56, v223
    v_dot2_f32_bf16 v219, v57, v224, v219
    v_dot2_f32_bf16 v223, v57, v57, v223
    v_dot2_f32_bf16 v219, v58, v224, v219
    v_dot2_f32_bf16 v223, v58, v58, v223
    v_dot2_f32_bf16 v219, v59, v224, v219
    v_dot2_f32_bf16 v223, v59, v59, v223
    s_waitcnt vmcnt(27)
    v_dot2_f32_bf16 v216, v60, v224, v216
    v_dot2_f32_bf16 v220, v60, v60, v220
    v_dot2_f32_bf16 v216, v61, v224, v216
    v_dot2_f32_bf16 v220, v61, v61, v220
    v_dot2_f32_bf16 v216, v62, v224, v216
    v_dot2_f32_bf16 v220, v62, v62, v220
    v_dot2_f32_bf16 v216, v63, v224, v216
    v_dot2_f32_bf16 v220, v63, v63, v220
    s_waitcnt vmcnt(26)
    v_dot2_f32_bf16 v217, v64, v224, v217
    v_dot2_f32_bf16 v221, v64, v64, v221
    v_dot2_f32_bf16 v217, v65, v224, v217
    v_dot2_f32_bf16 v221, v65, v65, v221
    v_dot2_f32_bf16 v217, v66, v224, v217
    v_dot2_f32_bf16 v221, v66, v66, v221
    v_dot2_f32_bf16 v217, v67, v224, v217
    v_dot2_f32_bf16 v221, v67, v67, v221
    s_waitcnt vmcnt(25)
    v_dot2_f32_bf16 v218, v68, v224, v218
    v_dot2_f32_bf16 v222, v68, v68, v222
    v_dot2_f32_bf16 v218, v69, v224, v218
    v_dot2_f32_bf16 v222, v69, v69, v222
    v_dot2_f32_bf16 v218, v70, v224, v218
    v_dot2_f32_bf16 v222, v70, v70, v222
    v_dot2_f32_bf16 v218, v71, v224, v218
    v_dot2_f32_bf16 v222, v71, v71, v222
    s_waitcnt vmcnt(24)
    v_dot2_f32_bf16 v219, v72, v224, v219
    v_dot2_f32_bf16 v223, v72, v72, v223
    v_dot2_f32_bf16 v219, v73, v224, v219
    v_dot2_f32_bf16 v223, v73, v73, v223
    v_dot2_f32_bf16 v219, v74, v224, v219
    v_dot2_f32_bf16 v223, v74, v74, v223
    v_dot2_f32_bf16 v219, v75, v224, v219
    v_dot2_f32_bf16 v223, v75, v75, v223
    s_waitcnt vmcnt(23)
    v_dot2_f32_bf16 v216, v76, v224, v216
    v_dot2_f32_bf16 v220, v76, v76, v220
    v_dot2_f32_bf16 v216, v77, v224, v216
    v_dot2_f32_bf16 v220, v77, v77, v220
    v_dot2_f32_bf16 v216, v78, v224, v216
    v_dot2_f32_bf16 v220, v78, v78, v220
    v_dot2_f32_bf16 v216, v79, v224, v216
    v_dot2_f32_bf16 v220, v79, v79, v220
    s_waitcnt vmcnt(22)
    v_dot2_f32_bf16 v217, v80, v224, v217
    v_dot2_f32_bf16 v221, v80, v80, v221
    v_dot2_f32_bf16 v217, v81, v224, v217
    v_dot2_f32_bf16 v221, v81, v81, v221
    v_dot2_f32_bf16 v217, v82, v224, v217
    v_dot2_f32_bf16 v221, v82, v82, v221
    v_dot2_f32_bf16 v217, v83, v224, v217
    v_dot2_f32_bf16 v221, v83, v83, v221
    s_waitcnt vmcnt(21)
    v_dot2_f32_bf16 v218, v84, v224, v218
    v_dot2_f32_bf16 v222, v84, v84, v222
    v_dot2_f32_bf16 v218, v85, v224, v218
    v_dot2_f32_bf16 v222, v85, v85, v222
    v_dot2_f32_bf16 v218, v86, v224, v218
    v_dot2_f32_bf16 v222, v86, v86, v222
    v_dot2_f32_bf16 v218, v87, v224, v218
    v_dot2_f32_bf16 v222, v87, v87, v222
    s_waitcnt vmcnt(20)
    v_dot2_f32_bf16 v219, v88, v224, v219
    v_dot2_f32_bf16 v223, v88, v88, v223
    v_dot2_f32_bf16 v219, v89, v224, v219
    v_dot2_f32_bf16 v223, v89, v89, v223
    v_dot2_f32_bf16 v219, v90, v224, v219
    v_dot2_f32_bf16 v223, v90, v90, v223
    v_dot2_f32_bf16 v219, v91, v224, v219
    v_dot2_f32_bf16 v223, v91, v91, v223
    s_waitcnt vmcnt(19)
    v_dot2_f32_bf16 v216, v92, v224, v216
    v_dot2_f32_bf16 v220, v92, v92, v220
    v_dot2_f32_bf16 v216, v93, v224, v216
    v_dot2_f32_bf16 v220, v93, v93, v220
    v_dot2_f32_bf16 v216, v94, v224, v216
    v_dot2_f32_bf16 v220, v94, v94, v220
    v_dot2_f32_bf16 v216, v95, v224, v216
    v_dot2_f32_bf16 v220, v95, v95, v220
    s_waitcnt vmcnt(18)
    v_dot2_f32_bf16 v217, v96, v224, v217
    v_dot2_f32_bf16 v221, v96, v96, v221
    v_dot2_f32_bf16 v217, v97, v224, v217
    v_dot2_f32_bf16 v221, v97, v97, v221
    v_dot2_f32_bf16 v217, v98, v224, v217
    v_dot2_f32_bf16 v221, v98, v98, v221
    v_dot2_f32_bf16 v217, v99, v224, v217
    v_dot2_f32_bf16 v221, v99, v99, v221
    s_waitcnt vmcnt(17)
    v_dot2_f32_bf16 v218, v100, v224, v218
    v_dot2_f32_bf16 v222, v100, v100, v222
    v_dot2_f32_bf16 v218, v101, v224, v218
    v_dot2_f32_bf16 v222, v101, v101, v222
    v_dot2_f32_bf16 v218, v102, v224, v218
    v_dot2_f32_bf16 v222, v102, v102, v222
    v_dot2_f32_bf16 v218, v103, v224, v218
    v_dot2_f32_bf16 v222, v103, v103, v222
    s_waitcnt vmcnt(16)
    v_dot2_f32_bf16 v219, v104, v224, v219
    v_dot2_f32_bf16 v223, v104, v104, v223
    v_dot2_f32_bf16 v219, v105, v224, v219
    v_dot2_f32_bf16 v223, v105, v105, v223
    v_dot2_f32_bf16 v219, v106, v224, v219
    v_dot2_f32_bf16 v223, v106, v106, v223
    v_dot2_f32_bf16 v219, v107, v224, v219
    v_dot2_f32_bf16 v223, v107, v107, v223
    s_waitcnt vmcnt(15)
    v_dot2_f32_bf16 v216, v108, v224, v216
    v_dot2_f32_bf16 v220, v108, v108, v220
    v_dot2_f32_bf16 v216, v109, v224, v216
    v_dot2_f32_bf16 v220, v109, v109, v220
    v_dot2_f32_bf16 v216, v110, v224, v216
    v_dot2_f32_bf16 v220, v110, v110, v220
    v_dot2_f32_bf16 v216, v111, v224, v216
    v_dot2_f32_bf16 v220, v111, v111, v220
    s_waitcnt vmcnt(14)
    v_dot2_f32_bf16 v217, v112, v224, v217
    v_dot2_f32_bf16 v221, v112, v112, v221
    v_dot2_f32_bf16 v217, v113, v224, v217
    v_dot2_f32_bf16 v221, v113, v113, v221
    v_dot2_f32_bf16 v217, v114, v224, v217
    v_dot2_f32_bf16 v221, v114, v114, v221
    v_dot2_f32_bf16 v217, v115, v224, v217
    v_dot2_f32_bf16 v221, v115, v115, v221
    s_waitcnt vmcnt(13)
    v_dot2_f32_bf16 v218, v116, v224, v218
    v_dot2_f32_bf16 v222, v116, v116, v222
    v_dot2_f32_bf16 v218, v117, v224, v218
    v_dot2_f32_bf16 v222, v117, v117, v222
    v_dot2_f32_bf16 v218, v118, v224, v218
    v_dot2_f32_bf16 v222, v118, v118, v222
    v_dot2_f32_bf16 v218, v119, v224, v218
    v_dot2_f32_bf16 v222, v119, v119, v222
    s_waitcnt vmcnt(12)
    v_dot2_f32_bf16 v219, v120, v224, v219
    v_dot2_f32_bf16 v223, v120, v120, v223
    v_dot2_f32_bf16 v219, v121, v224, v219
    v_dot2_f32_bf16 v223, v121, v121, v223
    v_dot2_f32_bf16 v219, v122, v224, v219
    v_dot2_f32_bf16 v223, v122, v122, v223
    v_dot2_f32_bf16 v219, v123, v224, v219
    v_dot2_f32_bf16 v223, v123, v123, v223
    v_add_f32_dpp v3, v216, v216 quad_perm:[1,0,3,2] row_mask:0xf bank_mask:0xf
    v_add_f32_dpp v4, v220, v220 quad_perm:[1,0,3,2] row_mask:0xf bank_mask:0xf
    v_mov_b32 v216, v3
    v_mov_b32 v220, v4
    s_nop 0
    v_add_f32_dpp v3, v216, v216 quad_perm:[2,3,0,1] row_mask:0xf bank_mask:0xf
    v_add_f32_dpp v4, v220, v220 quad_perm:[2,3,0,1] row_mask:0xf bank_mask:0xf
    v_mov_b32 v216, v3
    v_mov_b32 v220, v4
    s_nop 0
    v_add_f32_dpp v3, v216, v216 row_half_mirror row_mask:0xf bank_mask:0xf
    v_add_f32_dpp v4, v220, v220 row_half_mirror row_mask:0xf bank_mask:0xf
    v_mov_b32 v216, v3
    v_mov_b32 v220, v4
    v_mul_f32 v216, 0x3b124925, v216
    v_mul_f32 v220, 0x3b124925, v220
    v_fma_f32 v220, -v216, v216, v220
    v_max_f32 v220, 0, v220
    v_cvt_pk_bf16_f32 v3, v216, v220
    v_lshlrev_b32 v216, 16, v3
    v_and_b32 v220, 0xffff0000, v3
    v_add_f32 v220, 0x3727c5ac, v220
    v_cvt_pk_bf16_f32 v3, v220, v220
    v_lshlrev_b32 v220, 16, v3
    v_sqrt_f32 v220, v220
    s_nop 0
    v_cvt_pk_bf16_f32 v3, v220, v220
    v_lshlrev_b32 v220, 16, v3
    v_rcp_f32 v225, v220
    s_nop 0
    v_mul_f32 v229, v216, v225
    v_sub_f32 v229, 0, v229
    v_add_f32_dpp v3, v217, v217 quad_perm:[1,0,3,2] row_mask:0xf bank_mask:0xf
    v_add_f32_dpp v4, v221, v221 quad_perm:[1,0,3,2] row_mask:0xf bank_mask:0xf
    v_mov_b32 v217, v3
    v_mov_b32 v221, v4
    s_nop 0
    v_add_f32_dpp v3, v217, v217 quad_perm:[2,3,0,1] row_mask:0xf bank_mask:0xf
    v_add_f32_dpp v4, v221, v221 quad_perm:[2,3,0,1] row_mask:0xf bank_mask:0xf
    v_mov_b32 v217, v3
    v_mov_b32 v221, v4
    s_nop 0
    v_add_f32_dpp v3, v217, v217 row_half_mirror row_mask:0xf bank_mask:0xf
    v_add_f32_dpp v4, v221, v221 row_half_mirror row_mask:0xf bank_mask:0xf
    v_mov_b32 v217, v3
    v_mov_b32 v221, v4
    v_mul_f32 v217, 0x3b124925, v217
    v_mul_f32 v221, 0x3b124925, v221
    v_fma_f32 v221, -v217, v217, v221
    v_max_f32 v221, 0, v221
    v_cvt_pk_bf16_f32 v3, v217, v221
    v_lshlrev_b32 v217, 16, v3
    v_and_b32 v221, 0xffff0000, v3
    v_add_f32 v221, 0x3727c5ac, v221
    v_cvt_pk_bf16_f32 v3, v221, v221
    v_lshlrev_b32 v221, 16, v3
    v_sqrt_f32 v221, v221
    s_nop 0
    v_cvt_pk_bf16_f32 v3, v221, v221
    v_lshlrev_b32 v221, 16, v3
    v_rcp_f32 v226, v221
    s_nop 0
    v_mul_f32 v230, v217, v226
    v_sub_f32 v230, 0, v230
    v_add_f32_dpp v3, v218, v218 quad_perm:[1,0,3,2] row_mask:0xf bank_mask:0xf
    v_add_f32_dpp v4, v222, v222 quad_perm:[1,0,3,2] row_mask:0xf bank_mask:0xf
    v_mov_b32 v218, v3
    v_mov_b32 v222, v4
    s_nop 0
    v_add_f32_dpp v3, v218, v218 quad_perm:[2,3,0,1] row_mask:0xf bank_mask:0xf
    v_add_f32_dpp v4, v222, v222 quad_perm:[2,3,0,1] row_mask:0xf bank_mask:0xf
    v_mov_b32 v218, v3
    v_mov_b32 v222, v4
    s_nop 0
    v_add_f32_dpp v3, v218, v218 row_half_mirror row_mask:0xf bank_mask:0xf
    v_add_f32_dpp v4, v222, v222 row_half_mirror row_mask:0xf bank_mask:0xf
    v_mov_b32 v218, v3
    v_mov_b32 v222, v4
    v_mul_f32 v218, 0x3b124925, v218
    v_mul_f32 v222, 0x3b124925, v222
    v_fma_f32 v222, -v218, v218, v222
    v_max_f32 v222, 0, v222
    v_cvt_pk_bf16_f32 v3, v218, v222
    v_lshlrev_b32 v218, 16, v3
    v_and_b32 v222, 0xffff0000, v3
    v_add_f32 v222, 0x3727c5ac, v222
    v_cvt_pk_bf16_f32 v3, v222, v222
    v_lshlrev_b32 v222, 16, v3
    v_sqrt_f32 v222, v222
    s_nop 0
    v_cvt_pk_bf16_f32 v3, v222, v222
    v_lshlrev_b32 v222, 16, v3
    v_rcp_f32 v227, v222
    s_nop 0
    v_mul_f32 v231, v218, v227
    v_sub_f32 v231, 0, v231
    v_add_f32_dpp v3, v219, v219 quad_perm:[1,0,3,2] row_mask:0xf bank_mask:0xf
    v_add_f32_dpp v4, v223, v223 quad_perm:[1,0,3,2] row_mask:0xf bank_mask:0xf
    v_mov_b32 v219, v3
    v_mov_b32 v223, v4
    s_nop 0
    v_add_f32_dpp v3, v219, v219 quad_perm:[2,3,0,1] row_mask:0xf bank_mask:0xf
    v_add_f32_dpp v4, v223, v223 quad_perm:[2,3,0,1] row_mask:0xf bank_mask:0xf
    v_mov_b32 v219, v3
    v_mov_b32 v223, v4
    s_nop 0
    v_add_f32_dpp v3, v219, v219 row_half_mirror row_mask:0xf bank_mask:0xf
    v_add_f32_dpp v4, v223, v223 row_half_mirror row_mask:0xf bank_mask:0xf
    v_mov_b32 v219, v3
    v_mov_b32 v223, v4
    v_mul_f32 v219, 0x3b124925, v219
    v_mul_f32 v223, 0x3b124925, v223
    v_fma_f32 v223, -v219, v219, v223
    v_max_f32 v223, 0, v223
    v_cvt_pk_bf16_f32 v3, v219, v223
    v_lshlrev_b32 v219, 16, v3
    v_and_b32 v223, 0xffff0000, v3
    v_add_f32 v223, 0x3727c5ac, v223
    v_cvt_pk_bf16_f32 v3, v223, v223
    v_lshlrev_b32 v223, 16, v3
    v_sqrt_f32 v223, v223
    s_nop 0
    v_cvt_pk_bf16_f32 v3, v223, v223
    v_lshlrev_b32 v223, 16, v3
    v_rcp_f32 v228, v223
    s_nop 0
    v_mul_f32 v232, v219, v228
    v_sub_f32 v232, 0, v232
    v_lshlrev_b32 v234, 16, v12
    v_and_b32 v235, 0xffff0000, v12
    v_fma_f32 v234, v234, v225, v229
    v_fma_f32 v235, v235, v225, v229
    v_cvt_pk_bf16_f32 v12, v234, v235
    v_lshlrev_b32 v234, 16, v13
    v_and_b32 v235, 0xffff0000, v13
    v_fma_f32 v234, v234, v225, v229
    v_fma_f32 v235, v235, v225, v229
    v_cvt_pk_bf16_f32 v13, v234, v235
    v_lshlrev_b32 v234, 16, v14
    v_and_b32 v235, 0xffff0000, v14
    v_fma_f32 v234, v234, v225, v229
    v_fma_f32 v235, v235, v225, v229
    v_cvt_pk_bf16_f32 v14, v234, v235
    v_lshlrev_b32 v234, 16, v15
    v_and_b32 v235, 0xffff0000, v15
    v_fma_f32 v234, v234, v225, v229
    v_fma_f32 v235, v235, v225, v229
    v_cvt_pk_bf16_f32 v15, v234, v235
    ds_write_b128 v8, v[12:15] offset:0
    v_lshlrev_b32 v234, 16, v16
    v_and_b32 v235, 0xffff0000, v16
    v_fma_f32 v234, v234, v226, v230
    v_fma_f32 v235, v235, v226, v230
    v_cvt_pk_bf16_f32 v16, v234, v235
    v_lshlrev_b32 v234, 16, v17
    v_and_b32 v235, 0xffff0000, v17
    v_fma_f32 v234, v234, v226, v230
    v_fma_f32 v235, v235, v226, v230
    v_cvt_pk_bf16_f32 v17, v234, v235
    v_lshlrev_b32 v234, 16, v18
    v_and_b32 v235, 0xffff0000, v18
    v_fma_f32 v234, v234, v226, v230
    v_fma_f32 v235, v235, v226, v230
    v_cvt_pk_bf16_f32 v18, v234, v235
    v_lshlrev_b32 v234, 16, v19
    v_and_b32 v235, 0xffff0000, v19
    v_fma_f32 v234, v234, v226, v230
    v_fma_f32 v235, v235, v226, v230
    v_cvt_pk_bf16_f32 v19, v234, v235
    ds_write_b128 v8, v[16:19] offset:4608
    v_lshlrev_b32 v234, 16, v20
    v_and_b32 v235, 0xffff0000, v20
    v_fma_f32 v234, v234, v227, v231
    v_fma_f32 v235, v235, v227, v231
    v_cvt_pk_bf16_f32 v20, v234, v235
    v_lshlrev_b32 v234, 16, v21
    v_and_b32 v235, 0xffff0000, v21
    v_fma_f32 v234, v234, v227, v231
    v_fma_f32 v235, v235, v227, v231
    v_cvt_pk_bf16_f32 v21, v234, v235
    v_lshlrev_b32 v234, 16, v22
    v_and_b32 v235, 0xffff0000, v22
    v_fma_f32 v234, v234, v227, v231
    v_fma_f32 v235, v235, v227, v231
    v_cvt_pk_bf16_f32 v22, v234, v235
    v_lshlrev_b32 v234, 16, v23
    v_and_b32 v235, 0xffff0000, v23
    v_fma_f32 v234, v234, v227, v231
    v_fma_f32 v235, v235, v227, v231
    v_cvt_pk_bf16_f32 v23, v234, v235
    ds_write_b128 v8, v[20:23] offset:9216
    v_lshlrev_b32 v234, 16, v24
    v_and_b32 v235, 0xffff0000, v24
    v_fma_f32 v234, v234, v228, v232
    v_fma_f32 v235, v235, v228, v232
    v_cvt_pk_bf16_f32 v24, v234, v235
    v_lshlrev_b32 v234, 16, v25
    v_and_b32 v235, 0xffff0000, v25
    v_fma_f32 v234, v234, v228, v232
    v_fma_f32 v235, v235, v228, v232
    v_cvt_pk_bf16_f32 v25, v234, v235
    v_lshlrev_b32 v234, 16, v26
    v_and_b32 v235, 0xffff0000, v26
    v_fma_f32 v234, v234, v228, v232
    v_fma_f32 v235, v235, v228, v232
    v_cvt_pk_bf16_f32 v26, v234, v235
    v_lshlrev_b32 v234, 16, v27
    v_and_b32 v235, 0xffff0000, v27
    v_fma_f32 v234, v234, v228, v232
    v_fma_f32 v235, v235, v228, v232
    v_cvt_pk_bf16_f32 v27, v234, v235
    ds_write_b128 v8, v[24:27] offset:13824
    v_lshlrev_b32 v234, 16, v28
    v_and_b32 v235, 0xffff0000, v28
    v_fma_f32 v234, v234, v225, v229
    v_fma_f32 v235, v235, v225, v229
    v_cvt_pk_bf16_f32 v28, v234, v235
    v_lshlrev_b32 v234, 16, v29
    v_and_b32 v235, 0xffff0000, v29
    v_fma_f32 v234, v234, v225, v229
    v_fma_f32 v235, v235, v225, v229
    v_cvt_pk_bf16_f32 v29, v234, v235
    v_lshlrev_b32 v234, 16, v30
    v_and_b32 v235, 0xffff0000, v30
    v_fma_f32 v234, v234, v225, v229
    v_fma_f32 v235, v235, v225, v229
    v_cvt_pk_bf16_f32 v30, v234, v235
    v_lshlrev_b32 v234, 16, v31
    v_and_b32 v235, 0xffff0000, v31
    v_fma_f32 v234, v234, v225, v229
    v_fma_f32 v235, v235, v225, v229
    v_cvt_pk_bf16_f32 v31, v234, v235
    ds_write_b128 v179, v[28:31] offset:0
    v_lshlrev_b32 v234, 16, v32
    v_and_b32 v235, 0xffff0000, v32
    v_fma_f32 v234, v234, v226, v230
    v_fma_f32 v235, v235, v226, v230
    v_cvt_pk_bf16_f32 v32, v234, v235
    v_lshlrev_b32 v234, 16, v33
    v_and_b32 v235, 0xffff0000, v33
    v_fma_f32 v234, v234, v226, v230
    v_fma_f32 v235, v235, v226, v230
    v_cvt_pk_bf16_f32 v33, v234, v235
    v_lshlrev_b32 v234, 16, v34
    v_and_b32 v235, 0xffff0000, v34
    v_fma_f32 v234, v234, v226, v230
    v_fma_f32 v235, v235, v226, v230
    v_cvt_pk_bf16_f32 v34, v234, v235
    v_lshlrev_b32 v234, 16, v35
    v_and_b32 v235, 0xffff0000, v35
    v_fma_f32 v234, v234, v226, v230
    v_fma_f32 v235, v235, v226, v230
    v_cvt_pk_bf16_f32 v35, v234, v235
    ds_write_b128 v179, v[32:35] offset:4608
    v_lshlrev_b32 v234, 16, v36
    v_and_b32 v235, 0xffff0000, v36
    v_fma_f32 v234, v234, v227, v231
    v_fma_f32 v235, v235, v227, v231
    v_cvt_pk_bf16_f32 v36, v234, v235
    v_lshlrev_b32 v234, 16, v37
    v_and_b32 v235, 0xffff0000, v37
    v_fma_f32 v234, v234, v227, v231
    v_fma_f32 v235, v235, v227, v231
    v_cvt_pk_bf16_f32 v37, v234, v235
    v_lshlrev_b32 v234, 16, v38
    v_and_b32 v235, 0xffff0000, v38
    v_fma_f32 v234, v234, v227, v231
    v_fma_f32 v235, v235, v227, v231
    v_cvt_pk_bf16_f32 v38, v234, v235
    v_lshlrev_b32 v234, 16, v39
    v_and_b32 v235, 0xffff0000, v39
    v_fma_f32 v234, v234, v227, v231
    v_fma_f32 v235, v235, v227, v231
    v_cvt_pk_bf16_f32 v39, v234, v235
    ds_write_b128 v179, v[36:39] offset:9216
    v_lshlrev_b32 v234, 16, v40
    v_and_b32 v235, 0xffff0000, v40
    v_fma_f32 v234, v234, v228, v232
    v_fma_f32 v235, v235, v228, v232
    v_cvt_pk_bf16_f32 v40, v234, v235
    v_lshlrev_b32 v234, 16, v41
    v_and_b32 v235, 0xffff0000, v41
    v_fma_f32 v234, v234, v228, v232
    v_fma_f32 v235, v235, v228, v232
    v_cvt_pk_bf16_f32 v41, v234, v235
    v_lshlrev_b32 v234, 16, v42
    v_and_b32 v235, 0xffff0000, v42
    v_fma_f32 v234, v234, v228, v232
    v_fma_f32 v235, v235, v228, v232
    v_cvt_pk_bf16_f32 v42, v234, v235
    v_lshlrev_b32 v234, 16, v43
    v_and_b32 v235, 0xffff0000, v43
    v_fma_f32 v234, v234, v228, v232
    v_fma_f32 v235, v235, v228, v232
    v_cvt_pk_bf16_f32 v43, v234, v235
    ds_write_b128 v179, v[40:43] offset:13824
    s_waitcnt lgkmcnt(0)
    s_barrier
    ds_read_b128 v[184:187], v176 offset:0
    ds_read_b128 v[188:191], v176 offset:4608
    ds_read_b128 v[192:195], v176 offset:9216
    ds_read_b128 v[196:199], v176 offset:13824
    s_waitcnt vmcnt(11) lgkmcnt(3)
    v_mfma_f32_32x32x16_bf16 a[0:15], v[128:131], v[184:187], 0
    v_lshlrev_b32 v234, 16, v44
    v_and_b32 v235, 0xffff0000, v44
    v_fma_f32 v234, v234, v225, v229
    v_fma_f32 v235, v235, v225, v229
    s_waitcnt lgkmcnt(2)
    v_mfma_f32_32x32x16_bf16 a[16:31], v[128:131], v[188:191], 0
    ds_read_b128 v[200:203], v176 offset:32
    v_cvt_pk_bf16_f32 v44, v234, v235
    v_lshlrev_b32 v234, 16, v45
    v_and_b32 v235, 0xffff0000, v45
    v_fma_f32 v234, v234, v225, v229
    s_waitcnt lgkmcnt(2)
    v_mfma_f32_32x32x16_bf16 a[32:47], v[128:131], v[192:195], 0
    ds_read_b128 v[204:207], v176 offset:4640
    v_fma_f32 v235, v235, v225, v229
    v_cvt_pk_bf16_f32 v45, v234, v235
    v_lshlrev_b32 v234, 16, v46
    s_waitcnt lgkmcnt(2)
    v_mfma_f32_32x32x16_bf16 a[48:63], v[128:131], v[196:199], 0
    buffer_load_dwordx4 v[128:131], v124, s[12:15], s30 offen offset:2048
    v_and_b32 v235, 0xffff0000, v46
    v_fma_f32 v234, v234, v225, v229
    v_fma_f32 v235, v235, v225, v229
    v_cvt_pk_bf16_f32 v46, v234, v235
    s_waitcnt vmcnt(11)
    v_mfma_f32_32x32x16_bf16 a[64:79], v[132:135], v[184:187], 0
    ds_read_b128 v[208:211], v176 offset:9248
    v_lshlrev_b32 v234, 16, v47
    v_and_b32 v235, 0xffff0000, v47
    v_fma_f32 v234, v234, v225, v229
    v_fma_f32 v235, v235, v225, v229
    v_mfma_f32_32x32x16_bf16 a[80:95], v[132:135], v[188:191], 0
    ds_read_b128 v[212:215], v176 offset:13856
    v_cvt_pk_bf16_f32 v47, v234, v235
    ds_write_b128 v180, v[44:47] offset:0
    v_mfma_f32_32x32x16_bf16 a[96:111], v[132:135], v[192:195], 0
    v_lshlrev_b32 v234, 16, v48
    v_and_b32 v235, 0xffff0000, v48
    v_fma_f32 v234, v234, v226, v230
    v_mfma_f32_32x32x16_bf16 a[112:127], v[132:135], v[196:199], 0
    buffer_load_dwordx4 v[132:135], v124, s[16:19], s30 offen offset:2048
    v_fma_f32 v235, v235, v226, v230
    v_cvt_pk_bf16_f32 v48, v234, v235
    v_lshlrev_b32 v234, 16, v49
    s_waitcnt vmcnt(11) lgkmcnt(4)
    v_mfma_f32_32x32x16_bf16 a[0:15], v[136:139], v[200:203], a[0:15]
    v_and_b32 v235, 0xffff0000, v49
    v_fma_f32 v234, v234, v226, v230
    v_fma_f32 v235, v235, v226, v230
    v_cvt_pk_bf16_f32 v49, v234, v235
    s_waitcnt lgkmcnt(3)
    v_mfma_f32_32x32x16_bf16 a[16:31], v[136:139], v[204:207], a[16:31]
    ds_read_b128 v[184:187], v176 offset:64
    v_lshlrev_b32 v234, 16, v50
    v_and_b32 v235, 0xffff0000, v50
    v_fma_f32 v234, v234, v226, v230
    v_fma_f32 v235, v235, v226, v230
    s_waitcnt lgkmcnt(3)
    v_mfma_f32_32x32x16_bf16 a[32:47], v[136:139], v[208:211], a[32:47]
    ds_read_b128 v[188:191], v176 offset:4672
    v_cvt_pk_bf16_f32 v50, v234, v235
    v_lshlrev_b32 v234, 16, v51
    v_and_b32 v235, 0xffff0000, v51
    s_waitcnt lgkmcnt(3)
    v_mfma_f32_32x32x16_bf16 a[48:63], v[136:139], v[212:215], a[48:63]
    buffer_load_dwordx4 v[136:139], v124, s[12:15], s30 offen offset:3072
    v_fma_f32 v234, v234, v226, v230
    v_fma_f32 v235, v235, v226, v230
    v_cvt_pk_bf16_f32 v51, v234, v235
    ds_write_b128 v180, v[48:51] offset:4608
    s_waitcnt vmcnt(11)
    v_mfma_f32_32x32x16_bf16 a[64:79], v[140:143], v[200:203], a[64:79]
    ds_read_b128 v[192:195], v176 offset:9280
    v_lshlrev_b32 v234, 16, v52
    v_mfma_f32_32x32x16_bf16 a[80:95], v[140:143], v[204:207], a[80:95]
    ds_read_b128 v[196:199], v176 offset:13888
    v_and_b32 v235, 0xffff0000, v52
    v_fma_f32 v234, v234, v227, v231
    v_fma_f32 v235, v235, v227, v231
    v_cvt_pk_bf16_f32 v52, v234, v235
    v_mfma_f32_32x32x16_bf16 a[96:111], v[140:143], v[208:211], a[96:111]
    v_lshlrev_b32 v234, 16, v53
    v_and_b32 v235, 0xffff0000, v53
    v_fma_f32 v234, v234, v227, v231
    v_mfma_f32_32x32x16_bf16 a[112:127], v[140:143], v[212:215], a[112:127]
    buffer_load_dwordx4 v[140:143], v124, s[16:19], s30 offen offset:3072
    v_fma_f32 v235, v235, v227, v231
    v_cvt_pk_bf16_f32 v53, v234, v235
    v_lshlrev_b32 v234, 16, v54
    v_and_b32 v235, 0xffff0000, v54
    s_waitcnt vmcnt(11) lgkmcnt(4)
    v_mfma_f32_32x32x16_bf16 a[0:15], v[144:147], v[184:187], a[0:15]
    v_fma_f32 v234, v234, v227, v231
    v_fma_f32 v235, v235, v227, v231
    v_cvt_pk_bf16_f32 v54, v234, v235
    v_lshlrev_b32 v234, 16, v55
    s_waitcnt lgkmcnt(3)
    v_mfma_f32_32x32x16_bf16 a[16:31], v[144:147], v[188:191], a[16:31]
    ds_read_b128 v[200:203], v176 offset:96
    v_and_b32 v235, 0xffff0000, v55
    v_fma_f32 v234, v234, v227, v231
    v_fma_f32 v235, v235, v227, v231
    s_waitcnt lgkmcnt(2)
    v_mfma_f32_32x32x16_bf16 a[32:47], v[144:147], v[192:195], a[32:47]
    ds_read_b128 v[204:207], v176 offset:4704
    v_cvt_pk_bf16_f32 v55, v234, v235
    ds_write_b128 v180, v[52:55] offset:9216
    s_waitcnt lgkmcnt(3)
    v_mfma_f32_32x32x16_bf16 a[48:63], v[144:147], v[196:199], a[48:63]
    s_mov_b32 s30, 8192
    buffer_load_dwordx4 v[144:147], v124, s[12:15], s30 offen offset:0
    v_lshlrev_b32 v234, 16, v56
    v_and_b32 v235, 0xffff0000, v56
    v_fma_f32 v234, v234, v228, v232
    s_waitcnt vmcnt(11)
    v_mfma_f32_32x32x16_bf16 a[64:79], v[148:151], v[184:187], a[64:79]
    ds_read_b128 v[208:211], v176 offset:9312
    v_fma_f32 v235, v235, v228, v232
    v_cvt_pk_bf16_f32 v56, v234, v235
    v_lshlrev_b32 v234, 16, v57
    v_and_b32 v235, 0xffff0000, v57
    v_mfma_f32_32x32x16_bf16 a[80:95], v[148:151], v[188:191], a[80:95]
    ds_read_b128 v[212:215], v176 offset:13920
    v_fma_f32 v234, v234, v228, v232
    v_fma_f32 v235, v235, v228, v232
    v_cvt_pk_bf16_f32 v57, v234, v235
    v_lshlrev_b32 v234, 16, v58
    v_mfma_f32_32x32x16_bf16 a[96:111], v[148:151], v[192:195], a[96:111]
    v_and_b32 v235, 0xffff0000, v58
    v_fma_f32 v234, v234, v228, v232
    v_fma_f32 v235, v235, v228, v232
    v_mfma_f32_32x32x16_bf16 a[112:127], v[148:151], v[196:199], a[112:127]
    buffer_load_dwordx4 v[148:151], v124, s[16:19], s30 offen offset:0
    v_cvt_pk_bf16_f32 v58, v234, v235
    v_lshlrev_b32 v234, 16, v59
    v_and_b32 v235, 0xffff0000, v59
    v_fma_f32 v234, v234, v228, v232
    s_waitcnt vmcnt(11) lgkmcnt(4)
    v_mfma_f32_32x32x16_bf16 a[0:15], v[152:155], v[200:203], a[0:15]
    v_fma_f32 v235, v235, v228, v232
    v_cvt_pk_bf16_f32 v59, v234, v235
    ds_write_b128 v180, v[56:59] offset:13824
    s_waitcnt lgkmcnt(4)
    v_mfma_f32_32x32x16_bf16 a[16:31], v[152:155], v[204:207], a[16:31]
    ds_read_b128 v[184:187], v177 offset:0
    s_waitcnt lgkmcnt(3)
    v_mfma_f32_32x32x16_bf16 a[32:47], v[152:155], v[208:211], a[32:47]
    ds_read_b128 v[188:191], v177 offset:4608
    s_waitcnt lgkmcnt(3)
    v_mfma_f32_32x32x16_bf16 a[48:63], v[152:155], v[212:215], a[48:63]
    buffer_load_dwordx4 v[152:155], v124, s[12:15], s30 offen offset:1024
    s_waitcnt vmcnt(11)
    v_mfma_f32_32x32x16_bf16 a[64:79], v[156:159], v[200:203], a[64:79]
    ds_read_b128 v[192:195], v177 offset:9216
    v_mfma_f32_32x32x16_bf16 a[80:95], v[156:159], v[204:207], a[80:95]
    ds_read_b128 v[196:199], v177 offset:13824
    v_mfma_f32_32x32x16_bf16 a[96:111], v[156:159], v[208:211], a[96:111]
    v_mfma_f32_32x32x16_bf16 a[112:127], v[156:159], v[212:215], a[112:127]
    buffer_load_dwordx4 v[156:159], v124, s[16:19], s30 offen offset:1024
    s_waitcnt lgkmcnt(4)
    s_barrier
    s_waitcnt vmcnt(11) lgkmcnt(3)
    v_mfma_f32_32x32x16_bf16 a[0:15], v[160:163], v[184:187], a[0:15]
    v_lshlrev_b32 v234, 16, v60
    v_and_b32 v235, 0xffff0000, v60
    v_fma_f32 v234, v234, v225, v229
    v_fma_f32 v235, v235, v225, v229
    s_waitcnt lgkmcnt(2)
    v_mfma_f32_32x32x16_bf16 a[16:31], v[160:163], v[188:191], a[16:31]
    ds_read_b128 v[200:203], v177 offset:32
    v_cvt_pk_bf16_f32 v60, v234, v235
    v_lshlrev_b32 v234, 16, v61
    v_and_b32 v235, 0xffff0000, v61
    v_fma_f32 v234, v234, v225, v229
    s_waitcnt lgkmcnt(2)
    v_mfma_f32_32x32x16_bf16 a[32:47], v[160:163], v[192:195], a[32:47]
    ds_read_b128 v[204:207], v177 offset:4640
    v_fma_f32 v235, v235, v225, v229
    v_cvt_pk_bf16_f32 v61, v234, v235
    v_lshlrev_b32 v234, 16, v62
    s_waitcnt lgkmcnt(2)
    v_mfma_f32_32x32x16_bf16 a[48:63], v[160:163], v[196:199], a[48:63]
    buffer_load_dwordx4 v[160:163], v124, s[12:15], s30 offen offset:2048
    v_and_b32 v235, 0xffff0000, v62
    v_fma_f32 v234, v234, v225, v229
    v_fma_f32 v235, v235, v225, v229
    v_cvt_pk_bf16_f32 v62, v234, v235
    s_waitcnt vmcnt(11)
    v_mfma_f32_32x32x16_bf16 a[64:79], v[164:167], v[184:187], a[64:79]
    ds_read_b128 v[208:211], v177 offset:9248
    v_lshlrev_b32 v234, 16, v63
    v_and_b32 v235, 0xffff0000, v63
    v_fma_f32 v234, v234, v225, v229
    v_fma_f32 v235, v235, v225, v229
    v_mfma_f32_32x32x16_bf16 a[80:95], v[164:167], v[188:191], a[80:95]
    ds_read_b128 v[212:215], v177 offset:13856
    v_cvt_pk_bf16_f32 v63, v234, v235
    ds_write_b128 v8, v[60:63] offset:0
    v_mfma_f32_32x32x16_bf16 a[96:111], v[164:167], v[192:195], a[96:111]
    v_lshlrev_b32 v234, 16, v64
    v_and_b32 v235, 0xffff0000, v64
    v_fma_f32 v234, v234, v226, v230
    v_mfma_f32_32x32x16_bf16 a[112:127], v[164:167], v[196:199], a[112:127]
    buffer_load_dwordx4 v[164:167], v124, s[16:19], s30 offen offset:2048
    v_fma_f32 v235, v235, v226, v230
    v_cvt_pk_bf16_f32 v64, v234, v235
    v_lshlrev_b32 v234, 16, v65
    s_waitcnt vmcnt(11) lgkmcnt(4)
    v_mfma_f32_32x32x16_bf16 a[0:15], v[168:171], v[200:203], a[0:15]
    v_and_b32 v235, 0xffff0000, v65
    v_fma_f32 v234, v234, v226, v230
    v_fma_f32 v235, v235, v226, v230
    v_cvt_pk_bf16_f32 v65, v234, v235
    s_waitcnt lgkmcnt(3)
    v_mfma_f32_32x32x16_bf16 a[16:31], v[168:171], v[204:207], a[16:31]
    ds_read_b128 v[184:187], v177 offset:64
    v_lshlrev_b32 v234, 16, v66
    v_and_b32 v235, 0xffff0000, v66
    v_fma_f32 v234, v234, v226, v230
    v_fma_f32 v235, v235, v226, v230
    s_waitcnt lgkmcnt(3)
    v_mfma_f32_32x32x16_bf16 a[32:47], v[168:171], v[208:211], a[32:47]
    ds_read_b128 v[188:191], v177 offset:4672
    v_cvt_pk_bf16_f32 v66, v234, v235
    v_lshlrev_b32 v234, 16, v67
    v_and_b32 v235, 0xffff0000, v67
    s_waitcnt lgkmcnt(3)
    v_mfma_f32_32x32x16_bf16 a[48:63], v[168:171], v[212:215], a[48:63]
    buffer_load_dwordx4 v[168:171], v124, s[12:15], s30 offen offset:3072
    v_fma_f32 v234, v234, v226, v230
    v_fma_f32 v235, v235, v226, v230
    v_cvt_pk_bf16_f32 v67, v234, v235
    ds_write_b128 v8, v[64:67] offset:4608
    s_waitcnt vmcnt(11)
    v_mfma_f32_32x32x16_bf16 a[64:79], v[172:175], v[200:203], a[64:79]
    ds_read_b128 v[192:195], v177 offset:9280
    v_lshlrev_b32 v234, 16, v68
    v_mfma_f32_32x32x16_bf16 a[80:95], v[172:175], v[204:207], a[80:95]
    ds_read_b128 v[196:199], v177 offset:13888
    v_and_b32 v235, 0xffff0000, v68
    v_fma_f32 v234, v234, v227, v231
    v_fma_f32 v235, v235, v227, v231
    v_cvt_pk_bf16_f32 v68, v234, v235
    v_mfma_f32_32x32x16_bf16 a[96:111], v[172:175], v[208:211], a[96:111]
    v_lshlrev_b32 v234, 16, v69
    v_and_b32 v235, 0xffff0000, v69
    v_fma_f32 v234, v234, v227, v231
    v_mfma_f32_32x32x16_bf16 a[112:127], v[172:175], v[212:215], a[112:127]
    buffer_load_dwordx4 v[172:175], v124, s[16:19], s30 offen offset:3072
    v_fma_f32 v235, v235, v227, v231
    v_cvt_pk_bf16_f32 v69, v234, v235
    v_lshlrev_b32 v234, 16, v70
    v_and_b32 v235, 0xffff0000, v70
    s_waitcnt vmcnt(11) lgkmcnt(4)
    v_mfma_f32_32x32x16_bf16 a[0:15], v[128:131], v[184:187], a[0:15]
    v_fma_f32 v234, v234, v227, v231
    v_fma_f32 v235, v235, v227, v231
    v_cvt_pk_bf16_f32 v70, v234, v235
    v_lshlrev_b32 v234, 16, v71
    s_waitcnt lgkmcnt(3)
    v_mfma_f32_32x32x16_bf16 a[16:31], v[128:131], v[188:191], a[16:31]
    ds_read_b128 v[200:203], v177 offset:96
    v_and_b32 v235, 0xffff0000, v71
    v_fma_f32 v234, v234, v227, v231
    v_fma_f32 v235, v235, v227, v231
    s_waitcnt lgkmcnt(2)
    v_mfma_f32_32x32x16_bf16 a[32:47], v[128:131], v[192:195], a[32:47]
    ds_read_b128 v[204:207], v177 offset:4704
    v_cvt_pk_bf16_f32 v71, v234, v235
    ds_write_b128 v8, v[68:71] offset:9216
    s_waitcnt lgkmcnt(3)
    v_mfma_f32_32x32x16_bf16 a[48:63], v[128:131], v[196:199], a[48:63]
    s_mov_b32 s30, 12288
    buffer_load_dwordx4 v[128:131], v124, s[12:15], s30 offen offset:0
    v_lshlrev_b32 v234, 16, v72
    v_and_b32 v235, 0xffff0000, v72
    v_fma_f32 v234, v234, v228, v232
    s_waitcnt vmcnt(11)
    v_mfma_f32_32x32x16_bf16 a[64:79], v[132:135], v[184:187], a[64:79]
    ds_read_b128 v[208:211], v177 offset:9312
    v_fma_f32 v235, v235, v228, v232
    v_cvt_pk_bf16_f32 v72, v234, v235
    v_lshlrev_b32 v234, 16, v73
    v_and_b32 v235, 0xffff0000, v73
    v_mfma_f32_32x32x16_bf16 a[80:95], v[132:135], v[188:191], a[80:95]
    ds_read_b128 v[212:215], v177 offset:13920
    v_fma_f32 v234, v234, v228, v232
    v_fma_f32 v235, v235, v228, v232
    v_cvt_pk_bf16_f32 v73, v234, v235
    v_lshlrev_b32 v234, 16, v74
    v_mfma_f32_32x32x16_bf16 a[96:111], v[132:135], v[192:195], a[96:111]
    v_and_b32 v235, 0xffff0000, v74
    v_fma_f32 v234, v234, v228, v232
    v_fma_f32 v235, v235, v228, v232
    v_mfma_f32_32x32x16_bf16 a[112:127], v[132:135], v[196:199], a[112:127]
    buffer_load_dwordx4 v[132:135], v124, s[16:19], s30 offen offset:0
    v_cvt_pk_bf16_f32 v74, v234, v235
    v_lshlrev_b32 v234, 16, v75
    v_and_b32 v235, 0xffff0000, v75
    v_fma_f32 v234, v234, v228, v232
    s_waitcnt vmcnt(11) lgkmcnt(4)
    v_mfma_f32_32x32x16_bf16 a[0:15], v[136:139], v[200:203], a[0:15]
    v_fma_f32 v235, v235, v228, v232
    v_cvt_pk_bf16_f32 v75, v234, v235
    ds_write_b128 v8, v[72:75] offset:13824
    s_waitcnt lgkmcnt(4)
    v_mfma_f32_32x32x16_bf16 a[16:31], v[136:139], v[204:207], a[16:31]
    ds_read_b128 v[184:187], v178 offset:0
    s_waitcnt lgkmcnt(3)
    v_mfma_f32_32x32x16_bf16 a[32:47], v[136:139], v[208:211], a[32:47]
    ds_read_b128 v[188:191], v178 offset:4608
    s_waitcnt lgkmcnt(3)
    v_mfma_f32_32x32x16_bf16 a[48:63], v[136:139], v[212:215], a[48:63]
    buffer_load_dwordx4 v[136:139], v124, s[12:15], s30 offen offset:1024
    s_waitcnt vmcnt(11)
    v_mfma_f32_32x32x16_bf16 a[64:79], v[140:143], v[200:203], a[64:79]
    ds_read_b128 v[192:195], v178 offset:9216
    v_mfma_f32_32x32x16_bf16 a[80:95], v[140:143], v[204:207], a[80:95]
    ds_read_b128 v[196:199], v178 offset:13824
    v_mfma_f32_32x32x16_bf16 a[96:111], v[140:143], v[208:211], a[96:111]
    v_mfma_f32_32x32x16_bf16 a[112:127], v[140:143], v[212:215], a[112:127]
    buffer_load_dwordx4 v[140:143], v124, s[16:19], s30 offen offset:1024
    s_waitcnt lgkmcnt(4)
    s_barrier
    s_waitcnt vmcnt(11) lgkmcnt(3)
    v_mfma_f32_32x32x16_bf16 a[0:15], v[144:147], v[184:187], a[0:15]
    v_lshlrev_b32 v234, 16, v76
    v_and_b32 v235, 0xffff0000, v76
    v_fma_f32 v234, v234, v225, v229
    v_fma_f32 v235, v235, v225, v229
    s_waitcnt lgkmcnt(2)
    v_mfma_f32_32x32x16_bf16 a[16:31], v[144:147], v[188:191], a[16:31]
    ds_read_b128 v[200:203], v178 offset:32
    v_cvt_pk_bf16_f32 v76, v234, v235
    v_lshlrev_b32 v234, 16, v77
    v_and_b32 v235, 0xffff0000, v77
    v_fma_f32 v234, v234, v225, v229
    s_waitcnt lgkmcnt(2)
    v_mfma_f32_32x32x16_bf16 a[32:47], v[144:147], v[192:195], a[32:47]
    ds_read_b128 v[204:207], v178 offset:4640
    v_fma_f32 v235, v235, v225, v229
    v_cvt_pk_bf16_f32 v77, v234, v235
    v_lshlrev_b32 v234, 16, v78
    s_waitcnt lgkmcnt(2)
    v_mfma_f32_32x32x16_bf16 a[48:63], v[144:147], v[196:199], a[48:63]
    buffer_load_dwordx4 v[144:147], v124, s[12:15], s30 offen offset:2048
    v_and_b32 v235, 0xffff0000, v78
    v_fma_f32 v234, v234, v225, v229
    v_fma_f32 v235, v235, v225, v229
    v_cvt_pk_bf16_f32 v78, v234, v235
    s_waitcnt vmcnt(11)
    v_mfma_f32_32x32x16_bf16 a[64:79], v[148:151], v[184:187], a[64:79]
    ds_read_b128 v[208:211], v178 offset:9248
    v_lshlrev_b32 v234, 16, v79
    v_and_b32 v235, 0xffff0000, v79
    v_fma_f32 v234, v234, v225, v229
    v_fma_f32 v235, v235, v225, v229
    v_mfma_f32_32x32x16_bf16 a[80:95], v[148:151], v[188:191], a[80:95]
    ds_read_b128 v[212:215], v178 offset:13856
    v_cvt_pk_bf16_f32 v79, v234, v235
    ds_write_b128 v179, v[76:79] offset:0
    v_mfma_f32_32x32x16_bf16 a[96:111], v[148:151], v[192:195], a[96:111]
    v_lshlrev_b32 v234, 16, v80
    v_and_b32 v235, 0xffff0000, v80
    v_fma_f32 v234, v234, v226, v230
    v_mfma_f32_32x32x16_bf16 a[112:127], v[148:151], v[196:199], a[112:127]
    buffer_load_dwordx4 v[148:151], v124, s[16:19], s30 offen offset:2048
    v_fma_f32 v235, v235, v226, v230
    v_cvt_pk_bf16_f32 v80, v234, v235
    v_lshlrev_b32 v234, 16, v81
    s_waitcnt vmcnt(11) lgkmcnt(4)
    v_mfma_f32_32x32x16_bf16 a[0:15], v[152:155], v[200:203], a[0:15]
    v_and_b32 v235, 0xffff0000, v81
    v_fma_f32 v234, v234, v226, v230
    v_fma_f32 v235, v235, v226, v230
    v_cvt_pk_bf16_f32 v81, v234, v235
    s_waitcnt lgkmcnt(3)
    v_mfma_f32_32x32x16_bf16 a[16:31], v[152:155], v[204:207], a[16:31]
    ds_read_b128 v[184:187], v178 offset:64
    v_lshlrev_b32 v234, 16, v82
    v_and_b32 v235, 0xffff0000, v82
    v_fma_f32 v234, v234, v226, v230
    v_fma_f32 v235, v235, v226, v230
    s_waitcnt lgkmcnt(3)
    v_mfma_f32_32x32x16_bf16 a[32:47], v[152:155], v[208:211], a[32:47]
    ds_read_b128 v[188:191], v178 offset:4672
    v_cvt_pk_bf16_f32 v82, v234, v235
    v_lshlrev_b32 v234, 16, v83
    v_and_b32 v235, 0xffff0000, v83
    s_waitcnt lgkmcnt(3)
    v_mfma_f32_32x32x16_bf16 a[48:63], v[152:155], v[212:215], a[48:63]
    buffer_load_dwordx4 v[152:155], v124, s[12:15], s30 offen offset:3072
    v_fma_f32 v234, v234, v226, v230
    v_fma_f32 v235, v235, v226, v230
    v_cvt_pk_bf16_f32 v83, v234, v235
    ds_write_b128 v179, v[80:83] offset:4608
    s_waitcnt vmcnt(11)
    v_mfma_f32_32x32x16_bf16 a[64:79], v[156:159], v[200:203], a[64:79]
    ds_read_b128 v[192:195], v178 offset:9280
    v_lshlrev_b32 v234, 16, v84
    v_mfma_f32_32x32x16_bf16 a[80:95], v[156:159], v[204:207], a[80:95]
    ds_read_b128 v[196:199], v178 offset:13888
    v_and_b32 v235, 0xffff0000, v84
    v_fma_f32 v234, v234, v227, v231
    v_fma_f32 v235, v235, v227, v231
    v_cvt_pk_bf16_f32 v84, v234, v235
    v_mfma_f32_32x32x16_bf16 a[96:111], v[156:159], v[208:211], a[96:111]
    v_lshlrev_b32 v234, 16, v85
    v_and_b32 v235, 0xffff0000, v85
    v_fma_f32 v234, v234, v227, v231
    v_mfma_f32_32x32x16_bf16 a[112:127], v[156:159], v[212:215], a[112:127]
    buffer_load_dwordx4 v[156:159], v124, s[16:19], s30 offen offset:3072
    v_fma_f32 v235, v235, v227, v231
    v_cvt_pk_bf16_f32 v85, v234, v235
    v_lshlrev_b32 v234, 16, v86
    v_and_b32 v235, 0xffff0000, v86
    s_waitcnt vmcnt(11) lgkmcnt(4)
    v_mfma_f32_32x32x16_bf16 a[0:15], v[160:163], v[184:187], a[0:15]
    v_fma_f32 v234, v234, v227, v231
    v_fma_f32 v235, v235, v227, v231
    v_cvt_pk_bf16_f32 v86, v234, v235
    v_lshlrev_b32 v234, 16, v87
    s_waitcnt lgkmcnt(3)
    v_mfma_f32_32x32x16_bf16 a[16:31], v[160:163], v[188:191], a[16:31]
    ds_read_b128 v[200:203], v178 offset:96
    v_and_b32 v235, 0xffff0000, v87
    v_fma_f32 v234, v234, v227, v231
    v_fma_f32 v235, v235, v227, v231
    s_waitcnt lgkmcnt(2)
    v_mfma_f32_32x32x16_bf16 a[32:47], v[160:163], v[192:195], a[32:47]
    ds_read_b128 v[204:207], v178 offset:4704
    v_cvt_pk_bf16_f32 v87, v234, v235
    ds_write_b128 v179, v[84:87] offset:9216
    s_waitcnt lgkmcnt(3)
    v_mfma_f32_32x32x16_bf16 a[48:63], v[160:163], v[196:199], a[48:63]
    s_mov_b32 s30, 16384
    buffer_load_dwordx4 v[160:163], v124, s[12:15], s30 offen offset:0
    v_lshlrev_b32 v234, 16, v88
    v_and_b32 v235, 0xffff0000, v88
    v_fma_f32 v234, v234, v228, v232
    s_waitcnt vmcnt(11)
    v_mfma_f32_32x32x16_bf16 a[64:79], v[164:167], v[184:187], a[64:79]
    ds_read_b128 v[208:211], v178 offset:9312
    v_fma_f32 v235, v235, v228, v232
    v_cvt_pk_bf16_f32 v88, v234, v235
    v_lshlrev_b32 v234, 16, v89
    v_and_b32 v235, 0xffff0000, v89
    v_mfma_f32_32x32x16_bf16 a[80:95], v[164:167], v[188:191], a[80:95]
    ds_read_b128 v[212:215], v178 offset:13920
    v_fma_f32 v234, v234, v228, v232
    v_fma_f32 v235, v235, v228, v232
    v_cvt_pk_bf16_f32 v89, v234, v235
    v_lshlrev_b32 v234, 16, v90
    v_mfma_f32_32x32x16_bf16 a[96:111], v[164:167], v[192:195], a[96:111]
    v_and_b32 v235, 0xffff0000, v90
    v_fma_f32 v234, v234, v228, v232
    v_fma_f32 v235, v235, v228, v232
    v_mfma_f32_32x32x16_bf16 a[112:127], v[164:167], v[196:199], a[112:127]
    buffer_load_dwordx4 v[164:167], v124, s[16:19], s30 offen offset:0
    v_cvt_pk_bf16_f32 v90, v234, v235
    v_lshlrev_b32 v234, 16, v91
    v_and_b32 v235, 0xffff0000, v91
    v_fma_f32 v234, v234, v228, v232
    s_waitcnt vmcnt(11) lgkmcnt(4)
    v_mfma_f32_32x32x16_bf16 a[0:15], v[168:171], v[200:203], a[0:15]
    v_fma_f32 v235, v235, v228, v232
    v_cvt_pk_bf16_f32 v91, v234, v235
    ds_write_b128 v179, v[88:91] offset:13824
    s_waitcnt lgkmcnt(4)
    v_mfma_f32_32x32x16_bf16 a[16:31], v[168:171], v[204:207], a[16:31]
    ds_read_b128 v[184:187], v176 offset:0
    s_waitcnt lgkmcnt(3)
    v_mfma_f32_32x32x16_bf16 a[32:47], v[168:171], v[208:211], a[32:47]
    ds_read_b128 v[188:191], v176 offset:4608
    s_waitcnt lgkmcnt(3)
    v_mfma_f32_32x32x16_bf16 a[48:63], v[168:171], v[212:215], a[48:63]
    buffer_load_dwordx4 v[168:171], v124, s[12:15], s30 offen offset:1024
    s_waitcnt vmcnt(11)
    v_mfma_f32_32x32x16_bf16 a[64:79], v[172:175], v[200:203], a[64:79]
    ds_read_b128 v[192:195], v176 offset:9216
    v_mfma_f32_32x32x16_bf16 a[80:95], v[172:175], v[204:207], a[80:95]
    ds_read_b128 v[196:199], v176 offset:13824
    v_mfma_f32_32x32x16_bf16 a[96:111], v[172:175], v[208:211], a[96:111]
    v_mfma_f32_32x32x16_bf16 a[112:127], v[172:175], v[212:215], a[112:127]
    buffer_load_dwordx4 v[172:175], v124, s[16:19], s30 offen offset:1024
    s_waitcnt lgkmcnt(4)
    s_barrier
    s_waitcnt vmcnt(11) lgkmcnt(3)
    v_mfma_f32_32x32x16_bf16 a[0:15], v[128:131], v[184:187], a[0:15]
    v_lshlrev_b32 v234, 16, v92
    v_and_b32 v235, 0xffff0000, v92
    v_fma_f32 v234, v234, v225, v229
    v_fma_f32 v235, v235, v225, v229
    s_waitcnt lgkmcnt(2)
    v_mfma_f32_32x32x16_bf16 a[16:31], v[128:131], v[188:191], a[16:31]
    ds_read_b128 v[200:203], v176 offset:32
    v_cvt_pk_bf16_f32 v92, v234, v235
    v_lshlrev_b32 v234, 16, v93
    v_and_b32 v235, 0xffff0000, v93
    v_fma_f32 v234, v234, v225, v229
    s_waitcnt lgkmcnt(2)
    v_mfma_f32_32x32x16_bf16 a[32:47], v[128:131], v[192:195], a[32:47]
    ds_read_b128 v[204:207], v176 offset:4640
    v_fma_f32 v235, v235, v225, v229
    v_cvt_pk_bf16_f32 v93, v234, v235
    v_lshlrev_b32 v234, 16, v94
    s_waitcnt lgkmcnt(2)
    v_mfma_f32_32x32x16_bf16 a[48:63], v[128:131], v[196:199], a[48:63]
    buffer_load_dwordx4 v[128:131], v124, s[12:15], s30 offen offset:2048
    v_and_b32 v235, 0xffff0000, v94
    v_fma_f32 v234, v234, v225, v229
    v_fma_f32 v235, v235, v225, v229
    v_cvt_pk_bf16_f32 v94, v234, v235
    s_waitcnt vmcnt(11)
    v_mfma_f32_32x32x16_bf16 a[64:79], v[132:135], v[184:187], a[64:79]
    ds_read_b128 v[208:211], v176 offset:9248
    v_lshlrev_b32 v234, 16, v95
    v_and_b32 v235, 0xffff0000, v95
    v_fma_f32 v234, v234, v225, v229
    v_fma_f32 v235, v235, v225, v229
    v_mfma_f32_32x32x16_bf16 a[80:95], v[132:135], v[188:191], a[80:95]
    ds_read_b128 v[212:215], v176 offset:13856
    v_cvt_pk_bf16_f32 v95, v234, v235
    ds_write_b128 v180, v[92:95] offset:0
    v_mfma_f32_32x32x16_bf16 a[96:111], v[132:135], v[192:195], a[96:111]
    v_lshlrev_b32 v234, 16, v96
    v_and_b32 v235, 0xffff0000, v96
    v_fma_f32 v234, v234, v226, v230
    v_mfma_f32_32x32x16_bf16 a[112:127], v[132:135], v[196:199], a[112:127]
    buffer_load_dwordx4 v[132:135], v124, s[16:19], s30 offen offset:2048
    v_fma_f32 v235, v235, v226, v230
    v_cvt_pk_bf16_f32 v96, v234, v235
    v_lshlrev_b32 v234, 16, v97
    s_waitcnt vmcnt(11) lgkmcnt(4)
    v_mfma_f32_32x32x16_bf16 a[0:15], v[136:139], v[200:203], a[0:15]
    v_and_b32 v235, 0xffff0000, v97
    v_fma_f32 v234, v234, v226, v230
    v_fma_f32 v235, v235, v226, v230
    v_cvt_pk_bf16_f32 v97, v234, v235
    s_waitcnt lgkmcnt(3)
    v_mfma_f32_32x32x16_bf16 a[16:31], v[136:139], v[204:207], a[16:31]
    ds_read_b128 v[184:187], v176 offset:64
    v_lshlrev_b32 v234, 16, v98
    v_and_b32 v235, 0xffff0000, v98
    v_fma_f32 v234, v234, v226, v230
    v_fma_f32 v235, v235, v226, v230
    s_waitcnt lgkmcnt(3)
    v_mfma_f32_32x32x16_bf16 a[32:47], v[136:139], v[208:211], a[32:47]
    ds_read_b128 v[188:191], v176 offset:4672
    v_cvt_pk_bf16_f32 v98, v234, v235
    v_lshlrev_b32 v234, 16, v99
    v_and_b32 v235, 0xffff0000, v99
    s_waitcnt lgkmcnt(3)
    v_mfma_f32_32x32x16_bf16 a[48:63], v[136:139], v[212:215], a[48:63]
    buffer_load_dwordx4 v[136:139], v124, s[12:15], s30 offen offset:3072
    v_fma_f32 v234, v234, v226, v230
    v_fma_f32 v235, v235, v226, v230
    v_cvt_pk_bf16_f32 v99, v234, v235
    ds_write_b128 v180, v[96:99] offset:4608
    s_waitcnt vmcnt(11)
    v_mfma_f32_32x32x16_bf16 a[64:79], v[140:143], v[200:203], a[64:79]
    ds_read_b128 v[192:195], v176 offset:9280
    v_lshlrev_b32 v234, 16, v100
    v_mfma_f32_32x32x16_bf16 a[80:95], v[140:143], v[204:207], a[80:95]
    ds_read_b128 v[196:199], v176 offset:13888
    v_and_b32 v235, 0xffff0000, v100
    v_fma_f32 v234, v234, v227, v231
    v_fma_f32 v235, v235, v227, v231
    v_cvt_pk_bf16_f32 v100, v234, v235
    v_mfma_f32_32x32x16_bf16 a[96:111], v[140:143], v[208:211], a[96:111]
    v_lshlrev_b32 v234, 16, v101
    v_and_b32 v235, 0xffff0000, v101
    v_fma_f32 v234, v234, v227, v231
    v_mfma_f32_32x32x16_bf16 a[112:127], v[140:143], v[212:215], a[112:127]
    buffer_load_dwordx4 v[140:143], v124, s[16:19], s30 offen offset:3072
    v_fma_f32 v235, v235, v227, v231
    v_cvt_pk_bf16_f32 v101, v234, v235
    v_lshlrev_b32 v234, 16, v102
    v_and_b32 v235, 0xffff0000, v102
    s_waitcnt vmcnt(11) lgkmcnt(4)
    v_mfma_f32_32x32x16_bf16 a[0:15], v[144:147], v[184:187], a[0:15]
    v_fma_f32 v234, v234, v227, v231
    v_fma_f32 v235, v235, v227, v231
    v_cvt_pk_bf16_f32 v102, v234, v235
    v_lshlrev_b32 v234, 16, v103
    s_waitcnt lgkmcnt(3)
    v_mfma_f32_32x32x16_bf16 a[16:31], v[144:147], v[188:191], a[16:31]
    ds_read_b128 v[200:203], v176 offset:96
    v_and_b32 v235, 0xffff0000, v103
    v_fma_f32 v234, v234, v227, v231
    v_fma_f32 v235, v235, v227, v231
    s_waitcnt lgkmcnt(2)
    v_mfma_f32_32x32x16_bf16 a[32:47], v[144:147], v[192:195], a[32:47]
    ds_read_b128 v[204:207], v176 offset:4704
    v_cvt_pk_bf16_f32 v103, v234, v235
    ds_write_b128 v180, v[100:103] offset:9216
    s_waitcnt lgkmcnt(3)
    v_mfma_f32_32x32x16_bf16 a[48:63], v[144:147], v[196:199], a[48:63]
    s_mov_b32 s30, 20480
    buffer_load_dwordx4 v[144:147], v124, s[12:15], s30 offen offset:0
    v_lshlrev_b32 v234, 16, v104
    v_and_b32 v235, 0xffff0000, v104
    v_fma_f32 v234, v234, v228, v232
    s_waitcnt vmcnt(11)
    v_mfma_f32_32x32x16_bf16 a[64:79], v[148:151], v[184:187], a[64:79]
    ds_read_b128 v[208:211], v176 offset:9312
    v_fma_f32 v235, v235, v228, v232
    v_cvt_pk_bf16_f32 v104, v234, v235
    v_lshlrev_b32 v234, 16, v105
    v_and_b32 v235, 0xffff0000, v105
    v_mfma_f32_32x32x16_bf16 a[80:95], v[148:151], v[188:191], a[80:95]
    ds_read_b128 v[212:215], v176 offset:13920
    v_fma_f32 v234, v234, v228, v232
    v_fma_f32 v235, v235, v228, v232
    v_cvt_pk_bf16_f32 v105, v234, v235
    v_lshlrev_b32 v234, 16, v106
    v_mfma_f32_32x32x16_bf16 a[96:111], v[148:151], v[192:195], a[96:111]
    v_and_b32 v235, 0xffff0000, v106
    v_fma_f32 v234, v234, v228, v232
    v_fma_f32 v235, v235, v228, v232
    v_mfma_f32_32x32x16_bf16 a[112:127], v[148:151], v[196:199], a[112:127]
    buffer_load_dwordx4 v[148:151], v124, s[16:19], s30 offen offset:0
    v_cvt_pk_bf16_f32 v106, v234, v235
    v_lshlrev_b32 v234, 16, v107
    v_and_b32 v235, 0xffff0000, v107
    v_fma_f32 v234, v234, v228, v232
    s_waitcnt vmcnt(11) lgkmcnt(4)
    v_mfma_f32_32x32x16_bf16 a[0:15], v[152:155], v[200:203], a[0:15]
    v_fma_f32 v235, v235, v228, v232
    v_cvt_pk_bf16_f32 v107, v234, v235
    ds_write_b128 v180, v[104:107] offset:13824
    s_waitcnt lgkmcnt(4)
    v_mfma_f32_32x32x16_bf16 a[16:31], v[152:155], v[204:207], a[16:31]
    ds_read_b128 v[184:187], v177 offset:0
    s_waitcnt lgkmcnt(3)
    v_mfma_f32_32x32x16_bf16 a[32:47], v[152:155], v[208:211], a[32:47]
    ds_read_b128 v[188:191], v177 offset:4608
    s_waitcnt lgkmcnt(3)
    v_mfma_f32_32x32x16_bf16 a[48:63], v[152:155], v[212:215], a[48:63]
    buffer_load_dwordx4 v[152:155], v124, s[12:15], s30 offen offset:1024
    s_waitcnt vmcnt(11)
    v_mfma_f32_32x32x16_bf16 a[64:79], v[156:159], v[200:203], a[64:79]
    ds_read_b128 v[192:195], v177 offset:9216
    v_mfma_f32_32x32x16_bf16 a[80:95], v[156:159], v[204:207], a[80:95]
    ds_read_b128 v[196:199], v177 offset:13824
    v_mfma_f32_32x32x16_bf16 a[96:111], v[156:159], v[208:211], a[96:111]
    v_mfma_f32_32x32x16_bf16 a[112:127], v[156:159], v[212:215], a[112:127]
    buffer_load_dwordx4 v[156:159], v124, s[16:19], s30 offen offset:1024
    s_waitcnt lgkmcnt(4)
    s_barrier
    s_waitcnt vmcnt(11) lgkmcnt(3)
    v_mfma_f32_32x32x16_bf16 a[0:15], v[160:163], v[184:187], a[0:15]
    v_lshlrev_b32 v234, 16, v108
    v_and_b32 v235, 0xffff0000, v108
    v_fma_f32 v234, v234, v225, v229
    v_fma_f32 v235, v235, v225, v229
    s_waitcnt lgkmcnt(2)
    v_mfma_f32_32x32x16_bf16 a[16:31], v[160:163], v[188:191], a[16:31]
    ds_read_b128 v[200:203], v177 offset:32
    v_cvt_pk_bf16_f32 v108, v234, v235
    v_lshlrev_b32 v234, 16, v109
    v_and_b32 v235, 0xffff0000, v109
    v_fma_f32 v234, v234, v225, v229
    s_waitcnt lgkmcnt(2)
    v_mfma_f32_32x32x16_bf16 a[32:47], v[160:163], v[192:195], a[32:47]
    ds_read_b128 v[204:207], v177 offset:4640
    v_fma_f32 v235, v235, v225, v229
    v_cvt_pk_bf16_f32 v109, v234, v235
    v_lshlrev_b32 v234, 16, v110
    s_waitcnt lgkmcnt(2)
    v_mfma_f32_32x32x16_bf16 a[48:63], v[160:163], v[196:199], a[48:63]
    buffer_load_dwordx4 v[160:163], v124, s[12:15], s30 offen offset:2048
    v_and_b32 v235, 0xffff0000, v110
    v_fma_f32 v234, v234, v225, v229
    v_fma_f32 v235, v235, v225, v229
    v_cvt_pk_bf16_f32 v110, v234, v235
    s_waitcnt vmcnt(11)
    v_mfma_f32_32x32x16_bf16 a[64:79], v[164:167], v[184:187], a[64:79]
    ds_read_b128 v[208:211], v177 offset:9248
    v_lshlrev_b32 v234, 16, v111
    v_and_b32 v235, 0xffff0000, v111
    v_fma_f32 v234, v234, v225, v229
    v_fma_f32 v235, v235, v225, v229
    v_mfma_f32_32x32x16_bf16 a[80:95], v[164:167], v[188:191], a[80:95]
    ds_read_b128 v[212:215], v177 offset:13856
    v_cvt_pk_bf16_f32 v111, v234, v235
    ds_write_b128 v8, v[108:111] offset:0
    v_mfma_f32_32x32x16_bf16 a[96:111], v[164:167], v[192:195], a[96:111]
    v_lshlrev_b32 v234, 16, v112
    v_and_b32 v235, 0xffff0000, v112
    v_fma_f32 v234, v234, v226, v230
    v_mfma_f32_32x32x16_bf16 a[112:127], v[164:167], v[196:199], a[112:127]
    buffer_load_dwordx4 v[164:167], v124, s[16:19], s30 offen offset:2048
    v_fma_f32 v235, v235, v226, v230
    v_cvt_pk_bf16_f32 v112, v234, v235
    v_lshlrev_b32 v234, 16, v113
    s_waitcnt vmcnt(11) lgkmcnt(4)
    v_mfma_f32_32x32x16_bf16 a[0:15], v[168:171], v[200:203], a[0:15]
    v_and_b32 v235, 0xffff0000, v113
    v_fma_f32 v234, v234, v226, v230
    v_fma_f32 v235, v235, v226, v230
    v_cvt_pk_bf16_f32 v113, v234, v235
    s_waitcnt lgkmcnt(3)
    v_mfma_f32_32x32x16_bf16 a[16:31], v[168:171], v[204:207], a[16:31]
    ds_read_b128 v[184:187], v177 offset:64
    v_lshlrev_b32 v234, 16, v114
    v_and_b32 v235, 0xffff0000, v114
    v_fma_f32 v234, v234, v226, v230
    v_fma_f32 v235, v235, v226, v230
    s_waitcnt lgkmcnt(3)
    v_mfma_f32_32x32x16_bf16 a[32:47], v[168:171], v[208:211], a[32:47]
    ds_read_b128 v[188:191], v177 offset:4672
    v_cvt_pk_bf16_f32 v114, v234, v235
    v_lshlrev_b32 v234, 16, v115
    v_and_b32 v235, 0xffff0000, v115
    s_waitcnt lgkmcnt(3)
    v_mfma_f32_32x32x16_bf16 a[48:63], v[168:171], v[212:215], a[48:63]
    buffer_load_dwordx4 v[168:171], v124, s[12:15], s30 offen offset:3072
    v_fma_f32 v234, v234, v226, v230
    v_fma_f32 v235, v235, v226, v230
    v_cvt_pk_bf16_f32 v115, v234, v235
    ds_write_b128 v8, v[112:115] offset:4608
    s_waitcnt vmcnt(11)
    v_mfma_f32_32x32x16_bf16 a[64:79], v[172:175], v[200:203], a[64:79]
    ds_read_b128 v[192:195], v177 offset:9280
    v_lshlrev_b32 v234, 16, v116
    v_mfma_f32_32x32x16_bf16 a[80:95], v[172:175], v[204:207], a[80:95]
    ds_read_b128 v[196:199], v177 offset:13888
    v_and_b32 v235, 0xffff0000, v116
    v_fma_f32 v234, v234, v227, v231
    v_fma_f32 v235, v235, v227, v231
    v_cvt_pk_bf16_f32 v116, v234, v235
    v_mfma_f32_32x32x16_bf16 a[96:111], v[172:175], v[208:211], a[96:111]
    v_lshlrev_b32 v234, 16, v117
    v_and_b32 v235, 0xffff0000, v117
    v_fma_f32 v234, v234, v227, v231
    v_mfma_f32_32x32x16_bf16 a[112:127], v[172:175], v[212:215], a[112:127]
    buffer_load_dwordx4 v[172:175], v124, s[16:19], s30 offen offset:3072
    v_fma_f32 v235, v235, v227, v231
    v_cvt_pk_bf16_f32 v117, v234, v235
    v_lshlrev_b32 v234, 16, v118
    v_and_b32 v235, 0xffff0000, v118
    s_waitcnt vmcnt(11) lgkmcnt(4)
    v_mfma_f32_32x32x16_bf16 a[0:15], v[128:131], v[184:187], a[0:15]
    v_fma_f32 v234, v234, v227, v231
    v_fma_f32 v235, v235, v227, v231
    v_cvt_pk_bf16_f32 v118, v234, v235
    v_lshlrev_b32 v234, 16, v119
    s_waitcnt lgkmcnt(3)
    v_mfma_f32_32x32x16_bf16 a[16:31], v[128:131], v[188:191], a[16:31]
    ds_read_b128 v[200:203], v177 offset:96
    v_and_b32 v235, 0xffff0000, v119
    v_fma_f32 v234, v234, v227, v231
    v_fma_f32 v235, v235, v227, v231
    s_waitcnt lgkmcnt(2)
    v_mfma_f32_32x32x16_bf16 a[32:47], v[128:131], v[192:195], a[32:47]
    ds_read_b128 v[204:207], v177 offset:4704
    v_cvt_pk_bf16_f32 v119, v234, v235
    ds_write_b128 v8, v[116:119] offset:9216
    s_waitcnt lgkmcnt(3)
    v_mfma_f32_32x32x16_bf16 a[48:63], v[128:131], v[196:199], a[48:63]
    s_mov_b32 s30, 24576
    buffer_load_dwordx4 v[128:131], v124, s[12:15], s30 offen offset:0
    v_lshlrev_b32 v234, 16, v120
    v_and_b32 v235, 0xffff0000, v120
    v_fma_f32 v234, v234, v228, v232
    s_waitcnt vmcnt(11)
    v_mfma_f32_32x32x16_bf16 a[64:79], v[132:135], v[184:187], a[64:79]
    ds_read_b128 v[208:211], v177 offset:9312
    v_fma_f32 v235, v235, v228, v232
    v_cvt_pk_bf16_f32 v120, v234, v235
    v_lshlrev_b32 v234, 16, v121
    v_and_b32 v235, 0xffff0000, v121
    v_mfma_f32_32x32x16_bf16 a[80:95], v[132:135], v[188:191], a[80:95]
    ds_read_b128 v[212:215], v177 offset:13920
    v_fma_f32 v234, v234, v228, v232
    v_fma_f32 v235, v235, v228, v232
    v_cvt_pk_bf16_f32 v121, v234, v235
    v_lshlrev_b32 v234, 16, v122
    v_mfma_f32_32x32x16_bf16 a[96:111], v[132:135], v[192:195], a[96:111]
    v_and_b32 v235, 0xffff0000, v122
    v_fma_f32 v234, v234, v228, v232
    v_fma_f32 v235, v235, v228, v232
    v_mfma_f32_32x32x16_bf16 a[112:127], v[132:135], v[196:199], a[112:127]
    buffer_load_dwordx4 v[132:135], v124, s[16:19], s30 offen offset:0
    v_cvt_pk_bf16_f32 v122, v234, v235
    v_lshlrev_b32 v234, 16, v123
    v_and_b32 v235, 0xffff0000, v123
    v_fma_f32 v234, v234, v228, v232
    s_waitcnt vmcnt(11) lgkmcnt(4)
    v_mfma_f32_32x32x16_bf16 a[0:15], v[136:139], v[200:203], a[0:15]
    v_fma_f32 v235, v235, v228, v232
    v_cvt_pk_bf16_f32 v123, v234, v235
    ds_write_b128 v8, v[120:123] offset:13824
    s_waitcnt lgkmcnt(4)
    v_mfma_f32_32x32x16_bf16 a[16:31], v[136:139], v[204:207], a[16:31]
    ds_read_b128 v[184:187], v178 offset:0
    s_waitcnt lgkmcnt(3)
    v_mfma_f32_32x32x16_bf16 a[32:47], v[136:139], v[208:211], a[32:47]
    ds_read_b128 v[188:191], v178 offset:4608
    s_waitcnt lgkmcnt(3)
    v_mfma_f32_32x32x16_bf16 a[48:63], v[136:139], v[212:215], a[48:63]
    buffer_load_dwordx4 v[136:139], v124, s[12:15], s30 offen offset:1024
    s_waitcnt vmcnt(11)
    v_mfma_f32_32x32x16_bf16 a[64:79], v[140:143], v[200:203], a[64:79]
    ds_read_b128 v[192:195], v178 offset:9216
    v_mfma_f32_32x32x16_bf16 a[80:95], v[140:143], v[204:207], a[80:95]
    ds_read_b128 v[196:199], v178 offset:13824
    v_mfma_f32_32x32x16_bf16 a[96:111], v[140:143], v[208:211], a[96:111]
    v_mfma_f32_32x32x16_bf16 a[112:127], v[140:143], v[212:215], a[112:127]
    buffer_load_dwordx4 v[140:143], v124, s[16:19], s30 offen offset:1024
    s_waitcnt lgkmcnt(4)
    s_barrier
    s_waitcnt vmcnt(11) lgkmcnt(3)
    v_mfma_f32_32x32x16_bf16 a[0:15], v[144:147], v[184:187], a[0:15]
    s_waitcnt lgkmcnt(2)
    v_mfma_f32_32x32x16_bf16 a[16:31], v[144:147], v[188:191], a[16:31]
    ds_read_b128 v[200:203], v178 offset:32
    s_waitcnt lgkmcnt(2)
    v_mfma_f32_32x32x16_bf16 a[32:47], v[144:147], v[192:195], a[32:47]
    ds_read_b128 v[204:207], v178 offset:4640
    s_waitcnt lgkmcnt(2)
    v_mfma_f32_32x32x16_bf16 a[48:63], v[144:147], v[196:199], a[48:63]
    buffer_load_dwordx4 v[144:147], v124, s[12:15], s30 offen offset:2048
    s_waitcnt vmcnt(11)
    v_mfma_f32_32x32x16_bf16 a[64:79], v[148:151], v[184:187], a[64:79]
    ds_read_b128 v[208:211], v178 offset:9248
    v_mfma_f32_32x32x16_bf16 a[80:95], v[148:151], v[188:191], a[80:95]
    ds_read_b128 v[212:215], v178 offset:13856
    v_mfma_f32_32x32x16_bf16 a[96:111], v[148:151], v[192:195], a[96:111]
    v_mfma_f32_32x32x16_bf16 a[112:127], v[148:151], v[196:199], a[112:127]
    buffer_load_dwordx4 v[148:151], v124, s[16:19], s30 offen offset:2048
    s_waitcnt vmcnt(11) lgkmcnt(3)
    v_mfma_f32_32x32x16_bf16 a[0:15], v[152:155], v[200:203], a[0:15]
    s_waitcnt lgkmcnt(2)
    v_mfma_f32_32x32x16_bf16 a[16:31], v[152:155], v[204:207], a[16:31]
    ds_read_b128 v[184:187], v178 offset:64
    s_waitcnt lgkmcnt(2)
    v_mfma_f32_32x32x16_bf16 a[32:47], v[152:155], v[208:211], a[32:47]
    ds_read_b128 v[188:191], v178 offset:4672
    s_waitcnt lgkmcnt(2)
    v_mfma_f32_32x32x16_bf16 a[48:63], v[152:155], v[212:215], a[48:63]
    buffer_load_dwordx4 v[152:155], v124, s[12:15], s30 offen offset:3072
    s_waitcnt vmcnt(11)
    v_mfma_f32_32x32x16_bf16 a[64:79], v[156:159], v[200:203], a[64:79]
    ds_read_b128 v[192:195], v178 offset:9280
    v_mfma_f32_32x32x16_bf16 a[80:95], v[156:159], v[204:207], a[80:95]
    ds_read_b128 v[196:199], v178 offset:13888
    v_mfma_f32_32x32x16_bf16 a[96:111], v[156:159], v[208:211], a[96:111]
    v_mfma_f32_32x32x16_bf16 a[112:127], v[156:159], v[212:215], a[112:127]
    buffer_load_dwordx4 v[156:159], v124, s[16:19], s30 offen offset:3072
    s_waitcnt vmcnt(11) lgkmcnt(3)
    v_mfma_f32_32x32x16_bf16 a[0:15], v[160:163], v[184:187], a[0:15]
    s_waitcnt lgkmcnt(2)
    v_mfma_f32_32x32x16_bf16 a[16:31], v[160:163], v[188:191], a[16:31]
    ds_read_b128 v[200:203], v178 offset:96
    s_waitcnt lgkmcnt(2)
    v_mfma_f32_32x32x16_bf16 a[32:47], v[160:163], v[192:195], a[32:47]
    ds_read_b128 v[204:207], v178 offset:4704
    s_waitcnt lgkmcnt(2)
    v_mfma_f32_32x32x16_bf16 a[48:63], v[160:163], v[196:199], a[48:63]
    s_waitcnt vmcnt(10)
    v_mfma_f32_32x32x16_bf16 a[64:79], v[164:167], v[184:187], a[64:79]
    ds_read_b128 v[208:211], v178 offset:9312
    v_mfma_f32_32x32x16_bf16 a[80:95], v[164:167], v[188:191], a[80:95]
    ds_read_b128 v[212:215], v178 offset:13920
    v_mfma_f32_32x32x16_bf16 a[96:111], v[164:167], v[192:195], a[96:111]
    v_mfma_f32_32x32x16_bf16 a[112:127], v[164:167], v[196:199], a[112:127]
    s_waitcnt vmcnt(9) lgkmcnt(3)
    v_mfma_f32_32x32x16_bf16 a[0:15], v[168:171], v[200:203], a[0:15]
    s_waitcnt lgkmcnt(2)
    v_mfma_f32_32x32x16_bf16 a[16:31], v[168:171], v[204:207], a[16:31]
    ds_read_b128 v[184:187], v176 offset:0
    s_waitcnt lgkmcnt(2)
    v_mfma_f32_32x32x16_bf16 a[32:47], v[168:171], v[208:211], a[32:47]
    ds_read_b128 v[188:191], v176 offset:4608
    s_waitcnt lgkmcnt(2)
    v_mfma_f32_32x32x16_bf16 a[48:63], v[168:171], v[212:215], a[48:63]
    s_waitcnt vmcnt(8)
    v_mfma_f32_32x32x16_bf16 a[64:79], v[172:175], v[200:203], a[64:79]
    ds_read_b128 v[192:195], v176 offset:9216
    v_mfma_f32_32x32x16_bf16 a[80:95], v[172:175], v[204:207], a[80:95]
    ds_read_b128 v[196:199], v176 offset:13824
    v_mfma_f32_32x32x16_bf16 a[96:111], v[172:175], v[208:211], a[96:111]
    v_mfma_f32_32x32x16_bf16 a[112:127], v[172:175], v[212:215], a[112:127]
    s_waitcnt vmcnt(7) lgkmcnt(3)
    v_mfma_f32_32x32x16_bf16 a[0:15], v[128:131], v[184:187], a[0:15]
    s_waitcnt lgkmcnt(2)
    v_mfma_f32_32x32x16_bf16 a[16:31], v[128:131], v[188:191], a[16:31]
    ds_read_b128 v[200:203], v176 offset:32
    s_waitcnt lgkmcnt(2)
    v_mfma_f32_32x32x16_bf16 a[32:47], v[128:131], v[192:195], a[32:47]
    ds_read_b128 v[204:207], v176 offset:4640
    s_waitcnt lgkmcnt(2)
    v_mfma_f32_32x32x16_bf16 a[48:63], v[128:131], v[196:199], a[48:63]
    s_waitcnt vmcnt(6)
    v_mfma_f32_32x32x16_bf16 a[64:79], v[132:135], v[184:187], a[64:79]
    ds_read_b128 v[208:211], v176 offset:9248
    v_mfma_f32_32x32x16_bf16 a[80:95], v[132:135], v[188:191], a[80:95]
    ds_read_b128 v[212:215], v176 offset:13856
    v_mfma_f32_32x32x16_bf16 a[96:111], v[132:135], v[192:195], a[96:111]
    v_mfma_f32_32x32x16_bf16 a[112:127], v[132:135], v[196:199], a[112:127]
    s_waitcnt vmcnt(5) lgkmcnt(3)
    v_mfma_f32_32x32x16_bf16 a[0:15], v[136:139], v[200:203], a[0:15]
    s_waitcnt lgkmcnt(2)
    v_mfma_f32_32x32x16_bf16 a[16:31], v[136:139], v[204:207], a[16:31]
    ds_read_b128 v[184:187], v176 offset:64
    s_waitcnt lgkmcnt(2)
    v_mfma_f32_32x32x16_bf16 a[32:47], v[136:139], v[208:211], a[32:47]
    ds_read_b128 v[188:191], v176 offset:4672
    s_waitcnt lgkmcnt(2)
    v_mfma_f32_32x32x16_bf16 a[48:63], v[136:139], v[212:215], a[48:63]
    s_waitcnt vmcnt(4)
    v_mfma_f32_32x32x16_bf16 a[64:79], v[140:143], v[200:203], a[64:79]
    ds_read_b128 v[192:195], v176 offset:9280
    v_mfma_f32_32x32x16_bf16 a[80:95], v[140:143], v[204:207], a[80:95]
    ds_read_b128 v[196:199], v176 offset:13888
    v_mfma_f32_32x32x16_bf16 a[96:111], v[140:143], v[208:211], a[96:111]
    v_mfma_f32_32x32x16_bf16 a[112:127], v[140:143], v[212:215], a[112:127]
    s_waitcnt vmcnt(3) lgkmcnt(3)
    v_mfma_f32_32x32x16_bf16 a[0:15], v[144:147], v[184:187], a[0:15]
    s_waitcnt lgkmcnt(2)
    v_mfma_f32_32x32x16_bf16 a[16:31], v[144:147], v[188:191], a[16:31]
    ds_read_b128 v[200:203], v176 offset:96
    s_waitcnt lgkmcnt(2)
    v_mfma_f32_32x32x16_bf16 a[32:47], v[144:147], v[192:195], a[32:47]
    ds_read_b128 v[204:207], v176 offset:4704
    s_waitcnt lgkmcnt(2)
    v_mfma_f32_32x32x16_bf16 a[48:63], v[144:147], v[196:199], a[48:63]
    s_waitcnt vmcnt(2)
    v_mfma_f32_32x32x16_bf16 a[64:79], v[148:151], v[184:187], a[64:79]
    ds_read_b128 v[208:211], v176 offset:9312
    v_mfma_f32_32x32x16_bf16 a[80:95], v[148:151], v[188:191], a[80:95]
    ds_read_b128 v[212:215], v176 offset:13920
    v_mfma_f32_32x32x16_bf16 a[96:111], v[148:151], v[192:195], a[96:111]
    v_mfma_f32_32x32x16_bf16 a[112:127], v[148:151], v[196:199], a[112:127]
    s_waitcnt vmcnt(1) lgkmcnt(3)
    v_mfma_f32_32x32x16_bf16 a[0:15], v[152:155], v[200:203], a[0:15]
    s_waitcnt lgkmcnt(2)
    v_mfma_f32_32x32x16_bf16 a[16:31], v[152:155], v[204:207], a[16:31]
    s_waitcnt lgkmcnt(1)
    v_mfma_f32_32x32x16_bf16 a[32:47], v[152:155], v[208:211], a[32:47]
    s_waitcnt lgkmcnt(0)
    v_mfma_f32_32x32x16_bf16 a[48:63], v[152:155], v[212:215], a[48:63]
    s_waitcnt vmcnt(0)
    v_mfma_f32_32x32x16_bf16 a[64:79], v[156:159], v[200:203], a[64:79]
    v_mfma_f32_32x32x16_bf16 a[80:95], v[156:159], v[204:207], a[80:95]
    v_mfma_f32_32x32x16_bf16 a[96:111], v[156:159], v[208:211], a[96:111]
    v_mfma_f32_32x32x16_bf16 a[112:127], v[156:159], v[212:215], a[112:127]
    s_mul_i32 s31, s28, 128
    s_mul_i32 s32, s29, 128
    v_and_b32 v5, 31, v1
    v_lshrrev_b32 v6, 5, v1
    v_lshlrev_b32 v6, 2, v6
    v_lshlrev_b32 v4, 5, v2
    v_add_u32 v12, s31, v5
    v_add3_u32 v13, v4, v6, s32
    s_add_u32 s20, s58, 0xc00000
    s_addc_u32 s21, s59, 0
    s_and_b32 s21, s21, 0xffff
    s_mov_b32 s22, 0x700000
    s_mov_b32 s23, 0x00020000
    v_mul_u32_u24 v14, 3584, v12
    v_lshl_add_u32 v14, v13, 1, v14
    v_add_u32 v15, 114688, v14
    v_add_u32 v16, 229376, v14
    v_add_u32 v17, 344064, v14
    v_mov_b32 v18, 0xbfb8aa3b
    v_mov_b32 v19, 0xbfb8aa3b
    v_mov_b32 v20, 1.0
    v_mov_b32 v21, 1.0
    v_lshrrev_b32 v3, 5, v1
    v_lshlrev_b32 v3, 3, v3
    v_add_u32 v14, v14, v3
    v_add_u32 v15, v15, v3
    v_add_u32 v16, v16, v3
    v_add_u32 v17, v17, v3
    v_accvgpr_read_b32 v22, a0
    v_accvgpr_read_b32 v23, a1
    v_accvgpr_read_b32 v24, a2
    v_accvgpr_read_b32 v25, a3
    v_accvgpr_read_b32 v26, a64
    v_accvgpr_read_b32 v27, a65
    v_accvgpr_read_b32 v28, a66
    v_accvgpr_read_b32 v29, a67
    v_pk_mul_f32 v[30:31], v[22:23], v[18:19]
    v_pk_mul_f32 v[32:33], v[24:25], v[18:19]
    v_exp_f32 v30, v30
    v_exp_f32 v31, v31
    v_exp_f32 v32, v32
    v_exp_f32 v33, v33
    v_pk_add_f32 v[30:31], v[30:31], v[20:21]
    v_pk_add_f32 v[32:33], v[32:33], v[20:21]
    v_pk_mul_f32 v[26:27], v[22:23], v[26:27]
    v_pk_mul_f32 v[28:29], v[24:25], v[28:29]
    v_rcp_f32 v30, v30
    v_rcp_f32 v31, v31
    v_rcp_f32 v32, v32
    v_rcp_f32 v33, v33
    v_pk_mul_f32 v[26:27], v[26:27], v[30:31]
    v_pk_mul_f32 v[28:29], v[28:29], v[32:33]
    v_cvt_pk_bf16_f32 v48, v26, v27
    v_cvt_pk_bf16_f32 v49, v28, v29
    v_accvgpr_read_b32 v34, a4
    v_accvgpr_read_b32 v35, a5
    v_accvgpr_read_b32 v36, a6
    v_accvgpr_read_b32 v37, a7
    v_accvgpr_read_b32 v38, a68
    v_accvgpr_read_b32 v39, a69
    v_accvgpr_read_b32 v40, a70
    v_accvgpr_read_b32 v41, a71
    v_pk_mul_f32 v[42:43], v[34:35], v[18:19]
    v_pk_mul_f32 v[44:45], v[36:37], v[18:19]
    v_exp_f32 v42, v42
    v_exp_f32 v43, v43
    v_exp_f32 v44, v44
    v_exp_f32 v45, v45
    v_pk_add_f32 v[42:43], v[42:43], v[20:21]
    v_pk_add_f32 v[44:45], v[44:45], v[20:21]
    v_pk_mul_f32 v[38:39], v[34:35], v[38:39]
    v_pk_mul_f32 v[40:41], v[36:37], v[40:41]
    v_rcp_f32 v42, v42
    v_rcp_f32 v43, v43
    v_rcp_f32 v44, v44
    v_rcp_f32 v45, v45
    v_pk_mul_f32 v[38:39], v[38:39], v[42:43]
    v_pk_mul_f32 v[40:41], v[40:41], v[44:45]
    v_cvt_pk_bf16_f32 v50, v38, v39
    v_cvt_pk_bf16_f32 v51, v40, v41
    s_nop 0
    v_permlane32_swap_b32 v48, v50
    v_permlane32_swap_b32 v49, v51
    buffer_store_dwordx4 v[48:51], v14, s[20:23], 0 offen offset:0
    v_accvgpr_read_b32 v22, a8
    v_accvgpr_read_b32 v23, a9
    v_accvgpr_read_b32 v24, a10
    v_accvgpr_read_b32 v25, a11
    v_accvgpr_read_b32 v26, a72
    v_accvgpr_read_b32 v27, a73
    v_accvgpr_read_b32 v28, a74
    v_accvgpr_read_b32 v29, a75
    v_pk_mul_f32 v[30:31], v[22:23], v[18:19]
    v_pk_mul_f32 v[32:33], v[24:25], v[18:19]
    v_exp_f32 v30, v30
    v_exp_f32 v31, v31
    v_exp_f32 v32, v32
    v_exp_f32 v33, v33
    v_pk_add_f32 v[30:31], v[30:31], v[20:21]
    v_pk_add_f32 v[32:33], v[32:33], v[20:21]
    v_pk_mul_f32 v[26:27], v[22:23], v[26:27]
    v_pk_mul_f32 v[28:29], v[24:25], v[28:29]
    v_rcp_f32 v30, v30
    v_rcp_f32 v31, v31
    v_rcp_f32 v32, v32
    v_rcp_f32 v33, v33
    v_pk_mul_f32 v[26:27], v[26:27], v[30:31]
    v_pk_mul_f32 v[28:29], v[28:29], v[32:33]
    v_cvt_pk_bf16_f32 v52, v26, v27
    v_cvt_pk_bf16_f32 v53, v28, v29
    v_accvgpr_read_b32 v34, a12
    v_accvgpr_read_b32 v35, a13
    v_accvgpr_read_b32 v36, a14
    v_accvgpr_read_b32 v37, a15
    v_accvgpr_read_b32 v38, a76
    v_accvgpr_read_b32 v39, a77
    v_accvgpr_read_b32 v40, a78
    v_accvgpr_read_b32 v41, a79
    v_pk_mul_f32 v[42:43], v[34:35], v[18:19]
    v_pk_mul_f32 v[44:45], v[36:37], v[18:19]
    v_exp_f32 v42, v42
    v_exp_f32 v43, v43
    v_exp_f32 v44, v44
    v_exp_f32 v45, v45
    v_pk_add_f32 v[42:43], v[42:43], v[20:21]
    v_pk_add_f32 v[44:45], v[44:45], v[20:21]
    v_pk_mul_f32 v[38:39], v[34:35], v[38:39]
    v_pk_mul_f32 v[40:41], v[36:37], v[40:41]
    v_rcp_f32 v42, v42
    v_rcp_f32 v43, v43
    v_rcp_f32 v44, v44
    v_rcp_f32 v45, v45
    v_pk_mul_f32 v[38:39], v[38:39], v[42:43]
    v_pk_mul_f32 v[40:41], v[40:41], v[44:45]
    v_cvt_pk_bf16_f32 v54, v38, v39
    v_cvt_pk_bf16_f32 v55, v40, v41
    s_nop 0
    v_permlane32_swap_b32 v52, v54
    v_permlane32_swap_b32 v53, v55
    buffer_store_dwordx4 v[52:55], v14, s[20:23], 0 offen offset:32
    v_accvgpr_read_b32 v22, a16
    v_accvgpr_read_b32 v23, a17
    v_accvgpr_read_b32 v24, a18
    v_accvgpr_read_b32 v25, a19
    v_accvgpr_read_b32 v26, a80
    v_accvgpr_read_b32 v27, a81
    v_accvgpr_read_b32 v28, a82
    v_accvgpr_read_b32 v29, a83
    v_pk_mul_f32 v[30:31], v[22:23], v[18:19]
    v_pk_mul_f32 v[32:33], v[24:25], v[18:19]
    v_exp_f32 v30, v30
    v_exp_f32 v31, v31
    v_exp_f32 v32, v32
    v_exp_f32 v33, v33
    v_pk_add_f32 v[30:31], v[30:31], v[20:21]
    v_pk_add_f32 v[32:33], v[32:33], v[20:21]
    v_pk_mul_f32 v[26:27], v[22:23], v[26:27]
    v_pk_mul_f32 v[28:29], v[24:25], v[28:29]
    v_rcp_f32 v30, v30
    v_rcp_f32 v31, v31
    v_rcp_f32 v32, v32
    v_rcp_f32 v33, v33
    v_pk_mul_f32 v[26:27], v[26:27], v[30:31]
    v_pk_mul_f32 v[28:29], v[28:29], v[32:33]
    v_cvt_pk_bf16_f32 v48, v26, v27
    v_cvt_pk_bf16_f32 v49, v28, v29
    v_accvgpr_read_b32 v34, a20
    v_accvgpr_read_b32 v35, a21
    v_accvgpr_read_b32 v36, a22
    v_accvgpr_read_b32 v37, a23
    v_accvgpr_read_b32 v38, a84
    v_accvgpr_read_b32 v39, a85
    v_accvgpr_read_b32 v40, a86
    v_accvgpr_read_b32 v41, a87
    v_pk_mul_f32 v[42:43], v[34:35], v[18:19]
    v_pk_mul_f32 v[44:45], v[36:37], v[18:19]
    v_exp_f32 v42, v42
    v_exp_f32 v43, v43
    v_exp_f32 v44, v44
    v_exp_f32 v45, v45
    v_pk_add_f32 v[42:43], v[42:43], v[20:21]
    v_pk_add_f32 v[44:45], v[44:45], v[20:21]
    v_pk_mul_f32 v[38:39], v[34:35], v[38:39]
    v_pk_mul_f32 v[40:41], v[36:37], v[40:41]
    v_rcp_f32 v42, v42
    v_rcp_f32 v43, v43
    v_rcp_f32 v44, v44
    v_rcp_f32 v45, v45
    v_pk_mul_f32 v[38:39], v[38:39], v[42:43]
    v_pk_mul_f32 v[40:41], v[40:41], v[44:45]
    v_cvt_pk_bf16_f32 v50, v38, v39
    v_cvt_pk_bf16_f32 v51, v40, v41
    s_nop 0
    v_permlane32_swap_b32 v48, v50
    v_permlane32_swap_b32 v49, v51
    buffer_store_dwordx4 v[48:51], v15, s[20:23], 0 offen offset:0
    v_accvgpr_read_b32 v22, a24
    v_accvgpr_read_b32 v23, a25
    v_accvgpr_read_b32 v24, a26
    v_accvgpr_read_b32 v25, a27
    v_accvgpr_read_b32 v26, a88
    v_accvgpr_read_b32 v27, a89
    v_accvgpr_read_b32 v28, a90
    v_accvgpr_read_b32 v29, a91
    v_pk_mul_f32 v[30:31], v[22:23], v[18:19]
    v_pk_mul_f32 v[32:33], v[24:25], v[18:19]
    v_exp_f32 v30, v30
    v_exp_f32 v31, v31
    v_exp_f32 v32, v32
    v_exp_f32 v33, v33
    v_pk_add_f32 v[30:31], v[30:31], v[20:21]
    v_pk_add_f32 v[32:33], v[32:33], v[20:21]
    v_pk_mul_f32 v[26:27], v[22:23], v[26:27]
    v_pk_mul_f32 v[28:29], v[24:25], v[28:29]
    v_rcp_f32 v30, v30
    v_rcp_f32 v31, v31
    v_rcp_f32 v32, v32
    v_rcp_f32 v33, v33
    v_pk_mul_f32 v[26:27], v[26:27], v[30:31]
    v_pk_mul_f32 v[28:29], v[28:29], v[32:33]
    v_cvt_pk_bf16_f32 v52, v26, v27
    v_cvt_pk_bf16_f32 v53, v28, v29
    v_accvgpr_read_b32 v34, a28
    v_accvgpr_read_b32 v35, a29
    v_accvgpr_read_b32 v36, a30
    v_accvgpr_read_b32 v37, a31
    v_accvgpr_read_b32 v38, a92
    v_accvgpr_read_b32 v39, a93
    v_accvgpr_read_b32 v40, a94
    v_accvgpr_read_b32 v41, a95
    v_pk_mul_f32 v[42:43], v[34:35], v[18:19]
    v_pk_mul_f32 v[44:45], v[36:37], v[18:19]
    v_exp_f32 v42, v42
    v_exp_f32 v43, v43
    v_exp_f32 v44, v44
    v_exp_f32 v45, v45
    v_pk_add_f32 v[42:43], v[42:43], v[20:21]
    v_pk_add_f32 v[44:45], v[44:45], v[20:21]
    v_pk_mul_f32 v[38:39], v[34:35], v[38:39]
    v_pk_mul_f32 v[40:41], v[36:37], v[40:41]
    v_rcp_f32 v42, v42
    v_rcp_f32 v43, v43
    v_rcp_f32 v44, v44
    v_rcp_f32 v45, v45
    v_pk_mul_f32 v[38:39], v[38:39], v[42:43]
    v_pk_mul_f32 v[40:41], v[40:41], v[44:45]
    v_cvt_pk_bf16_f32 v54, v38, v39
    v_cvt_pk_bf16_f32 v55, v40, v41
    s_nop 0
    v_permlane32_swap_b32 v52, v54
    v_permlane32_swap_b32 v53, v55
    buffer_store_dwordx4 v[52:55], v15, s[20:23], 0 offen offset:32
    v_accvgpr_read_b32 v22, a32
    v_accvgpr_read_b32 v23, a33
    v_accvgpr_read_b32 v24, a34
    v_accvgpr_read_b32 v25, a35
    v_accvgpr_read_b32 v26, a96
    v_accvgpr_read_b32 v27, a97
    v_accvgpr_read_b32 v28, a98
    v_accvgpr_read_b32 v29, a99
    v_pk_mul_f32 v[30:31], v[22:23], v[18:19]
    v_pk_mul_f32 v[32:33], v[24:25], v[18:19]
    v_exp_f32 v30, v30
    v_exp_f32 v31, v31
    v_exp_f32 v32, v32
    v_exp_f32 v33, v33
    v_pk_add_f32 v[30:31], v[30:31], v[20:21]
    v_pk_add_f32 v[32:33], v[32:33], v[20:21]
    v_pk_mul_f32 v[26:27], v[22:23], v[26:27]
    v_pk_mul_f32 v[28:29], v[24:25], v[28:29]
    v_rcp_f32 v30, v30
    v_rcp_f32 v31, v31
    v_rcp_f32 v32, v32
    v_rcp_f32 v33, v33
    v_pk_mul_f32 v[26:27], v[26:27], v[30:31]
    v_pk_mul_f32 v[28:29], v[28:29], v[32:33]
    v_cvt_pk_bf16_f32 v48, v26, v27
    v_cvt_pk_bf16_f32 v49, v28, v29
    v_accvgpr_read_b32 v34, a36
    v_accvgpr_read_b32 v35, a37
    v_accvgpr_read_b32 v36, a38
    v_accvgpr_read_b32 v37, a39
    v_accvgpr_read_b32 v38, a100
    v_accvgpr_read_b32 v39, a101
    v_accvgpr_read_b32 v40, a102
    v_accvgpr_read_b32 v41, a103
    v_pk_mul_f32 v[42:43], v[34:35], v[18:19]
    v_pk_mul_f32 v[44:45], v[36:37], v[18:19]
    v_exp_f32 v42, v42
    v_exp_f32 v43, v43
    v_exp_f32 v44, v44
    v_exp_f32 v45, v45
    v_pk_add_f32 v[42:43], v[42:43], v[20:21]
    v_pk_add_f32 v[44:45], v[44:45], v[20:21]
    v_pk_mul_f32 v[38:39], v[34:35], v[38:39]
    v_pk_mul_f32 v[40:41], v[36:37], v[40:41]
    v_rcp_f32 v42, v42
    v_rcp_f32 v43, v43
    v_rcp_f32 v44, v44
    v_rcp_f32 v45, v45
    v_pk_mul_f32 v[38:39], v[38:39], v[42:43]
    v_pk_mul_f32 v[40:41], v[40:41], v[44:45]
    v_cvt_pk_bf16_f32 v50, v38, v39
    v_cvt_pk_bf16_f32 v51, v40, v41
    s_nop 0
    v_permlane32_swap_b32 v48, v50
    v_permlane32_swap_b32 v49, v51
    buffer_store_dwordx4 v[48:51], v16, s[20:23], 0 offen offset:0
    v_accvgpr_read_b32 v22, a40
    v_accvgpr_read_b32 v23, a41
    v_accvgpr_read_b32 v24, a42
    v_accvgpr_read_b32 v25, a43
    v_accvgpr_read_b32 v26, a104
    v_accvgpr_read_b32 v27, a105
    v_accvgpr_read_b32 v28, a106
    v_accvgpr_read_b32 v29, a107
    v_pk_mul_f32 v[30:31], v[22:23], v[18:19]
    v_pk_mul_f32 v[32:33], v[24:25], v[18:19]
    v_exp_f32 v30, v30
    v_exp_f32 v31, v31
    v_exp_f32 v32, v32
    v_exp_f32 v33, v33
    v_pk_add_f32 v[30:31], v[30:31], v[20:21]
    v_pk_add_f32 v[32:33], v[32:33], v[20:21]
    v_pk_mul_f32 v[26:27], v[22:23], v[26:27]
    v_pk_mul_f32 v[28:29], v[24:25], v[28:29]
    v_rcp_f32 v30, v30
    v_rcp_f32 v31, v31
    v_rcp_f32 v32, v32
    v_rcp_f32 v33, v33
    v_pk_mul_f32 v[26:27], v[26:27], v[30:31]
    v_pk_mul_f32 v[28:29], v[28:29], v[32:33]
    v_cvt_pk_bf16_f32 v52, v26, v27
    v_cvt_pk_bf16_f32 v53, v28, v29
    v_accvgpr_read_b32 v34, a44
    v_accvgpr_read_b32 v35, a45
    v_accvgpr_read_b32 v36, a46
    v_accvgpr_read_b32 v37, a47
    v_accvgpr_read_b32 v38, a108
    v_accvgpr_read_b32 v39, a109
    v_accvgpr_read_b32 v40, a110
    v_accvgpr_read_b32 v41, a111
    v_pk_mul_f32 v[42:43], v[34:35], v[18:19]
    v_pk_mul_f32 v[44:45], v[36:37], v[18:19]
    v_exp_f32 v42, v42
    v_exp_f32 v43, v43
    v_exp_f32 v44, v44
    v_exp_f32 v45, v45
    v_pk_add_f32 v[42:43], v[42:43], v[20:21]
    v_pk_add_f32 v[44:45], v[44:45], v[20:21]
    v_pk_mul_f32 v[38:39], v[34:35], v[38:39]
    v_pk_mul_f32 v[40:41], v[36:37], v[40:41]
    v_rcp_f32 v42, v42
    v_rcp_f32 v43, v43
    v_rcp_f32 v44, v44
    v_rcp_f32 v45, v45
    v_pk_mul_f32 v[38:39], v[38:39], v[42:43]
    v_pk_mul_f32 v[40:41], v[40:41], v[44:45]
    v_cvt_pk_bf16_f32 v54, v38, v39
    v_cvt_pk_bf16_f32 v55, v40, v41
    s_nop 0
    v_permlane32_swap_b32 v52, v54
    v_permlane32_swap_b32 v53, v55
    buffer_store_dwordx4 v[52:55], v16, s[20:23], 0 offen offset:32
    v_accvgpr_read_b32 v22, a48
    v_accvgpr_read_b32 v23, a49
    v_accvgpr_read_b32 v24, a50
    v_accvgpr_read_b32 v25, a51
    v_accvgpr_read_b32 v26, a112
    v_accvgpr_read_b32 v27, a113
    v_accvgpr_read_b32 v28, a114
    v_accvgpr_read_b32 v29, a115
    v_pk_mul_f32 v[30:31], v[22:23], v[18:19]
    v_pk_mul_f32 v[32:33], v[24:25], v[18:19]
    v_exp_f32 v30, v30
    v_exp_f32 v31, v31
    v_exp_f32 v32, v32
    v_exp_f32 v33, v33
    v_pk_add_f32 v[30:31], v[30:31], v[20:21]
    v_pk_add_f32 v[32:33], v[32:33], v[20:21]
    v_pk_mul_f32 v[26:27], v[22:23], v[26:27]
    v_pk_mul_f32 v[28:29], v[24:25], v[28:29]
    v_rcp_f32 v30, v30
    v_rcp_f32 v31, v31
    v_rcp_f32 v32, v32
    v_rcp_f32 v33, v33
    v_pk_mul_f32 v[26:27], v[26:27], v[30:31]
    v_pk_mul_f32 v[28:29], v[28:29], v[32:33]
    v_cvt_pk_bf16_f32 v48, v26, v27
    v_cvt_pk_bf16_f32 v49, v28, v29
    v_accvgpr_read_b32 v34, a52
    v_accvgpr_read_b32 v35, a53
    v_accvgpr_read_b32 v36, a54
    v_accvgpr_read_b32 v37, a55
    v_accvgpr_read_b32 v38, a116
    v_accvgpr_read_b32 v39, a117
    v_accvgpr_read_b32 v40, a118
    v_accvgpr_read_b32 v41, a119
    v_pk_mul_f32 v[42:43], v[34:35], v[18:19]
    v_pk_mul_f32 v[44:45], v[36:37], v[18:19]
    v_exp_f32 v42, v42
    v_exp_f32 v43, v43
    v_exp_f32 v44, v44
    v_exp_f32 v45, v45
    v_pk_add_f32 v[42:43], v[42:43], v[20:21]
    v_pk_add_f32 v[44:45], v[44:45], v[20:21]
    v_pk_mul_f32 v[38:39], v[34:35], v[38:39]
    v_pk_mul_f32 v[40:41], v[36:37], v[40:41]
    v_rcp_f32 v42, v42
    v_rcp_f32 v43, v43
    v_rcp_f32 v44, v44
    v_rcp_f32 v45, v45
    v_pk_mul_f32 v[38:39], v[38:39], v[42:43]
    v_pk_mul_f32 v[40:41], v[40:41], v[44:45]
    v_cvt_pk_bf16_f32 v50, v38, v39
    v_cvt_pk_bf16_f32 v51, v40, v41
    s_nop 0
    v_permlane32_swap_b32 v48, v50
    v_permlane32_swap_b32 v49, v51
    buffer_store_dwordx4 v[48:51], v17, s[20:23], 0 offen offset:0
    v_accvgpr_read_b32 v22, a56
    v_accvgpr_read_b32 v23, a57
    v_accvgpr_read_b32 v24, a58
    v_accvgpr_read_b32 v25, a59
    v_accvgpr_read_b32 v26, a120
    v_accvgpr_read_b32 v27, a121
    v_accvgpr_read_b32 v28, a122
    v_accvgpr_read_b32 v29, a123
    v_pk_mul_f32 v[30:31], v[22:23], v[18:19]
    v_pk_mul_f32 v[32:33], v[24:25], v[18:19]
    v_exp_f32 v30, v30
    v_exp_f32 v31, v31
    v_exp_f32 v32, v32
    v_exp_f32 v33, v33
    v_pk_add_f32 v[30:31], v[30:31], v[20:21]
    v_pk_add_f32 v[32:33], v[32:33], v[20:21]
    v_pk_mul_f32 v[26:27], v[22:23], v[26:27]
    v_pk_mul_f32 v[28:29], v[24:25], v[28:29]
    v_rcp_f32 v30, v30
    v_rcp_f32 v31, v31
    v_rcp_f32 v32, v32
    v_rcp_f32 v33, v33
    v_pk_mul_f32 v[26:27], v[26:27], v[30:31]
    v_pk_mul_f32 v[28:29], v[28:29], v[32:33]
    v_cvt_pk_bf16_f32 v52, v26, v27
    v_cvt_pk_bf16_f32 v53, v28, v29
    v_accvgpr_read_b32 v34, a60
    v_accvgpr_read_b32 v35, a61
    v_accvgpr_read_b32 v36, a62
    v_accvgpr_read_b32 v37, a63
    v_accvgpr_read_b32 v38, a124
    v_accvgpr_read_b32 v39, a125
    v_accvgpr_read_b32 v40, a126
    v_accvgpr_read_b32 v41, a127
    v_pk_mul_f32 v[42:43], v[34:35], v[18:19]
    v_pk_mul_f32 v[44:45], v[36:37], v[18:19]
    v_exp_f32 v42, v42
    v_exp_f32 v43, v43
    v_exp_f32 v44, v44
    v_exp_f32 v45, v45
    v_pk_add_f32 v[42:43], v[42:43], v[20:21]
    v_pk_add_f32 v[44:45], v[44:45], v[20:21]
    v_pk_mul_f32 v[38:39], v[34:35], v[38:39]
    v_pk_mul_f32 v[40:41], v[36:37], v[40:41]
    v_rcp_f32 v42, v42
    v_rcp_f32 v43, v43
    v_rcp_f32 v44, v44
    v_rcp_f32 v45, v45
    v_pk_mul_f32 v[38:39], v[38:39], v[42:43]
    v_pk_mul_f32 v[40:41], v[40:41], v[44:45]
    v_cvt_pk_bf16_f32 v54, v38, v39
    v_cvt_pk_bf16_f32 v55, v40, v41
    s_nop 0
    v_permlane32_swap_b32 v52, v54
    v_permlane32_swap_b32 v53, v55
    buffer_store_dwordx4 v[52:55], v17, s[20:23], 0 offen offset:32
L_end_g4_1_kernel:
    s_endpgm
.globl g5_1_kernel
.p2align 8
.type g5_1_kernel,@function
g5_1_kernel:
    s_load_dwordx16 s[32:47], s[0:1], 0
    s_load_dwordx4 s[48:51], s[0:1], 64
    s_cmp_ge_u32 s2, 224
    s_cbranch_scc1 L_end_g5_1_kernel
    s_lshr_b32 s28, s2, 3
    s_and_b32 s29, s2, 7
    s_mul_hi_u32 s24, s28, 0x24924925
    s_mul_i32 s27, s24, 7
    s_sub_u32 s25, s28, s27
    s_and_b32 s27, s29, 7
    s_mul_i32 s27, s27, 4
    s_add_u32 s24, s24, s27
    s_lshr_b32 s27, s29, 3
    s_mul_i32 s27, s27, 7
    s_add_u32 s25, s25, s27
    s_mov_b32 s30, 0
    s_mov_b32 s31, 114688
    v_and_b32 v1, 63, v0
    v_lshrrev_b32 v2, 6, v0
    v_lshrrev_b32 v3, 3, v0
    v_and_b32 v4, 7, v0
    v_lshlrev_b32 v4, 4, v4
    s_mul_i32 s27, s24, 229376
    v_mul_u32_u24 v7, 3584, v3
    v_add3_u32 v7, v7, v4, s27
    v_mul_u32_u24 v8, 144, v3
    v_add_u32 v8, v8, v4
    s_mul_i32 s27, s25, 128
    v_lshrrev_b32 v3, 3, v0
    v_and_b32 v4, 7, v0
    v_lshlrev_b32 v4, 4, v4
    v_mul_u32_u24 v9, 896, v3
    v_add3_u32 v9, v9, v4, s27
    v_mul_u32_u24 v10, 192, v3
    v_add_u32 v10, v10, v4
    v_add_u32 v10, 9216, v10
    v_and_b32 v5, 31, v1
    v_mul_u32_u24 v11, 144, v5
    v_lshrrev_b32 v6, 5, v1
    v_lshlrev_b32 v6, 4, v6
    v_add_u32 v11, v11, v6
    v_lshl_add_u32 v11, v2, 5, v11
    v_lshrrev_b32 v3, 5, v1
    v_lshlrev_b32 v3, 3, v3
    v_bfe_u32 v5, v1, 2, 2
    v_add_u32 v3, v3, v5
    v_lshl_add_u32 v3, v2, 4, v3
    v_mul_u32_u24 v12, 192, v3
    v_bfe_u32 v5, v1, 4, 1
    v_lshlrev_b32 v5, 5, v5
    v_and_b32 v6, 3, v1
    v_lshlrev_b32 v6, 3, v6
    v_add3_u32 v12, v12, v5, v6
    v_add_u32 v12, 9216, v12
    v_add_u32 v13, 21504, v11
    v_add_u32 v14, 43008, v11
    v_add_u32 v15, 21504, v12
    v_add_u32 v16, 43008, v12
    v_add_u32 v17, 21504, v8
    v_add_u32 v18, 43008, v8
    v_add_u32 v19, 21504, v10
    v_add_u32 v20, 43008, v10
    s_waitcnt lgkmcnt(0)
    s_add_u32 s8, s50, 0xc00000
    s_addc_u32 s9, s51, 0
    s_and_b32 s9, s9, 0xffff
    s_mov_b32 s10, 0x700000
    s_mov_b32 s11, 0x00020000
    s_mov_b32 s12, s44
    s_and_b32 s13, s45, 0xffff
    s_mov_b32 s14, 0x188000
    s_mov_b32 s15, 0x00020000
    buffer_load_dwordx4 v[24:27], v7, s[8:11], s30 offen offset:0
    buffer_load_dwordx4 v[28:31], v7, s[8:11], s31 offen offset:0
    buffer_load_dwordx4 v[32:35], v7, s[8:11], s30 offen offset:128
    buffer_load_dwordx4 v[36:39], v7, s[8:11], s31 offen offset:128
    buffer_load_dwordx4 v[40:43], v7, s[8:11], s30 offen offset:256
    buffer_load_dwordx4 v[44:47], v7, s[8:11], s31 offen offset:256
    buffer_load_dwordx4 v[48:51], v7, s[8:11], s30 offen offset:384
    buffer_load_dwordx4 v[52:55], v7, s[8:11], s31 offen offset:384
    s_mov_b32 s26, 0
    buffer_load_dwordx4 v[56:59], v9, s[12:15], s26 offen
    s_mov_b32 s26, 28672
    buffer_load_dwordx4 v[60:63], v9, s[12:15], s26 offen
    s_mov_b32 s26, 57344
    buffer_load_dwordx4 v[64:67], v9, s[12:15], s26 offen
    s_mov_b32 s26, 86016
    buffer_load_dwordx4 v[68:71], v9, s[12:15], s26 offen
    s_mov_b32 s26, 114688
    buffer_load_dwordx4 v[72:75], v9, s[12:15], s26 offen
    s_mov_b32 s26, 143360
    buffer_load_dwordx4 v[76:79], v9, s[12:15], s26 offen
    s_mov_b32 s26, 172032
    buffer_load_dwordx4 v[80:83], v9, s[12:15], s26 offen
    s_mov_b32 s26, 200704
    buffer_load_dwordx4 v[84:87], v9, s[12:15], s26 offen
    s_waitcnt vmcnt(15)
    ds_write_b128 v8, v[24:27] offset:0
    s_waitcnt vmcnt(14)
    ds_write_b128 v8, v[28:31] offset:4608
    s_waitcnt vmcnt(7)
    ds_write_b128 v10, v[56:59] offset:0
    s_waitcnt vmcnt(6)
    ds_write_b128 v10, v[60:63] offset:6144
    buffer_load_dwordx4 v[24:27], v7, s[8:11], s30 offen offset:512
    buffer_load_dwordx4 v[28:31], v7, s[8:11], s31 offen offset:512
    s_mov_b32 s26, 229376
    buffer_load_dwordx4 v[56:59], v9, s[12:15], s26 offen
    s_mov_b32 s26, 258048
    buffer_load_dwordx4 v[60:63], v9, s[12:15], s26 offen
    ds_write_b128 v17, v[32:35] offset:0
    ds_write_b128 v17, v[36:39] offset:4608
    s_waitcnt vmcnt(9)
    ds_write_b128 v19, v[64:67] offset:0
    s_waitcnt vmcnt(8)
    ds_write_b128 v19, v[68:71] offset:6144
    buffer_load_dwordx4 v[32:35], v7, s[8:11], s30 offen offset:640
    buffer_load_dwordx4 v[36:39], v7, s[8:11], s31 offen offset:640
    s_mov_b32 s26, 286720
    buffer_load_dwordx4 v[64:67], v9, s[12:15], s26 offen
    s_mov_b32 s26, 315392
    buffer_load_dwordx4 v[68:71], v9, s[12:15], s26 offen
    s_waitcnt lgkmcnt(0)
    s_barrier
    ds_read_b128 v[88:91], v11 offset:0
    ds_read_b128 v[92:95], v11 offset:4608
    ds_read_b64_tr_b16 v[104:105], v12 offset:0
    ds_read_b64_tr_b16 v[106:107], v12 offset:768
    ds_read_b64_tr_b16 v[108:109], v12 offset:64
    ds_read_b64_tr_b16 v[110:111], v12 offset:832
    s_waitcnt lgkmcnt(2)
    v_mfma_f32_32x32x16_bf16 v[120:135], v[104:107], v[88:91], 0
    ds_read_b128 v[96:99], v13 offset:0
    ds_read_b128 v[100:103], v13 offset:4608
    ds_write_b128 v18, v[40:43] offset:0
    ds_write_b128 v18, v[44:47] offset:4608
    s_waitcnt vmcnt(11)
    ds_write_b128 v20, v[72:75] offset:0
    v_mfma_f32_32x32x16_bf16 v[136:151], v[104:107], v[92:95], 0
    ds_read_b64_tr_b16 v[112:113], v15 offset:0
    ds_read_b64_tr_b16 v[114:115], v15 offset:768
    s_waitcnt vmcnt(10)
    ds_write_b128 v20, v[76:79] offset:6144
    buffer_load_dwordx4 v[40:43], v7, s[8:11], s30 offen offset:768
    s_waitcnt lgkmcnt(8)
    v_mfma_f32_32x32x16_bf16 v[152:167], v[108:111], v[88:91], 0
    ds_read_b64_tr_b16 v[116:117], v15 offset:64
    ds_read_b64_tr_b16 v[118:119], v15 offset:832
    buffer_load_dwordx4 v[44:47], v7, s[8:11], s31 offen offset:768
    s_mov_b32 s26, 344064
    buffer_load_dwordx4 v[72:75], v9, s[12:15], s26 offen
    s_mov_b32 s26, 372736
    buffer_load_dwordx4 v[76:79], v9, s[12:15], s26 offen
    v_mfma_f32_32x32x16_bf16 v[168:183], v[108:111], v[92:95], 0
    s_waitcnt lgkmcnt(2)
    s_barrier
    v_mfma_f32_32x32x16_bf16 v[120:135], v[112:115], v[96:99], v[120:135]
    ds_read_b128 v[88:91], v14 offset:0
    ds_read_b128 v[92:95], v14 offset:4608
    ds_write_b128 v8, v[48:51] offset:0
    ds_write_b128 v8, v[52:55] offset:4608
    s_waitcnt vmcnt(13)
    ds_write_b128 v10, v[80:83] offset:0
    v_mfma_f32_32x32x16_bf16 v[136:151], v[112:115], v[100:103], v[136:151]
    ds_read_b64_tr_b16 v[104:105], v16 offset:0
    ds_read_b64_tr_b16 v[106:107], v16 offset:768
    s_waitcnt vmcnt(12)
    ds_write_b128 v10, v[84:87] offset:6144
    buffer_load_dwordx4 v[48:51], v7, s[8:11], s30 offen offset:896
    s_waitcnt lgkmcnt(8)
    v_mfma_f32_32x32x16_bf16 v[152:167], v[116:119], v[96:99], v[152:167]
    ds_read_b64_tr_b16 v[108:109], v16 offset:64
    ds_read_b64_tr_b16 v[110:111], v16 offset:832
    buffer_load_dwordx4 v[52:55], v7, s[8:11], s31 offen offset:896
    s_mov_b32 s26, 401408
    buffer_load_dwordx4 v[80:83], v9, s[12:15], s26 offen
    s_mov_b32 s26, 430080
    buffer_load_dwordx4 v[84:87], v9, s[12:15], s26 offen
    v_mfma_f32_32x32x16_bf16 v[168:183], v[116:119], v[100:103], v[168:183]
    s_waitcnt lgkmcnt(2)
    s_barrier
    v_mfma_f32_32x32x16_bf16 v[120:135], v[104:107], v[88:91], v[120:135]
    ds_read_b128 v[96:99], v11 offset:0
    ds_read_b128 v[100:103], v11 offset:4608
    s_waitcnt vmcnt(15)
    ds_write_b128 v17, v[24:27] offset:0
    s_waitcnt vmcnt(14)
    ds_write_b128 v17, v[28:31] offset:4608
    s_waitcnt vmcnt(13)
    ds_write_b128 v19, v[56:59] offset:0
    v_mfma_f32_32x32x16_bf16 v[136:151], v[104:107], v[92:95], v[136:151]
    ds_read_b64_tr_b16 v[112:113], v12 offset:0
    ds_read_b64_tr_b16 v[114:115], v12 offset:768
    s_waitcnt vmcnt(12)
    ds_write_b128 v19, v[60:63] offset:6144
    buffer_load_dwordx4 v[24:27], v7, s[8:11], s30 offen offset:1024
    s_waitcnt lgkmcnt(8)
    v_mfma_f32_32x32x16_bf16 v[152:167], v[108:111], v[88:91], v[152:167]
    ds_read_b64_tr_b16 v[116:117], v12 offset:64
    ds_read_b64_tr_b16 v[118:119], v12 offset:832
    buffer_load_dwordx4 v[28:31], v7, s[8:11], s31 offen offset:1024
    s_mov_b32 s26, 458752
    buffer_load_dwordx4 v[56:59], v9, s[12:15], s26 offen
    s_mov_b32 s26, 487424
    buffer_load_dwordx4 v[60:63], v9, s[12:15], s26 offen
    v_mfma_f32_32x32x16_bf16 v[168:183], v[108:111], v[92:95], v[168:183]
    s_waitcnt lgkmcnt(2)
    s_barrier
    v_mfma_f32_32x32x16_bf16 v[120:135], v[112:115], v[96:99], v[120:135]
    ds_read_b128 v[88:91], v13 offset:0
    ds_read_b128 v[92:95], v13 offset:4608
    s_waitcnt vmcnt(15)
    ds_write_b128 v18, v[32:35] offset:0
    s_waitcnt vmcnt(14)
    ds_write_b128 v18, v[36:39] offset:4608
    s_waitcnt vmcnt(13)
    ds_write_b128 v20, v[64:67] offset:0
    v_mfma_f32_32x32x16_bf16 v[136:151], v[112:115], v[100:103], v[136:151]
    ds_read_b64_tr_b16 v[104:105], v15 offset:0
    ds_read_b64_tr_b16 v[106:107], v15 offset:768
    s_waitcnt vmcnt(12)
    ds_write_b128 v20, v[68:71] offset:6144
    buffer_load_dwordx4 v[32:35], v7, s[8:11], s30 offen offset:1152
    s_waitcnt lgkmcnt(8)
    v_mfma_f32_32x32x16_bf16 v[152:167], v[116:119], v[96:99], v[152:167]
    ds_read_b64_tr_b16 v[108:109], v15 offset:64
    ds_read_b64_tr_b16 v[110:111], v15 offset:832
    buffer_load_dwordx4 v[36:39], v7, s[8:11], s31 offen offset:1152
    s_mov_b32 s26, 516096
    buffer_load_dwordx4 v[64:67], v9, s[12:15], s26 offen
    s_mov_b32 s26, 544768
    buffer_load_dwordx4 v[68:71], v9, s[12:15], s26 offen
    v_mfma_f32_32x32x16_bf16 v[168:183], v[116:119], v[100:103], v[168:183]
    s_waitcnt lgkmcnt(2)
    s_barrier
    v_mfma_f32_32x32x16_bf16 v[120:135], v[104:107], v[88:91], v[120:135]
    ds_read_b128 v[96:99], v14 offset:0
    ds_read_b128 v[100:103], v14 offset:4608
    s_waitcnt vmcnt(15)
    ds_write_b128 v8, v[40:43] offset:0
    s_waitcnt vmcnt(14)
    ds_write_b128 v8, v[44:47] offset:4608
    s_waitcnt vmcnt(13)
    ds_write_b128 v10, v[72:75] offset:0
    v_mfma_f32_32x32x16_bf16 v[136:151], v[104:107], v[92:95], v[136:151]
    ds_read_b64_tr_b16 v[112:113], v16 offset:0
    ds_read_b64_tr_b16 v[114:115], v16 offset:768
    s_waitcnt vmcnt(12)
    ds_write_b128 v10, v[76:79] offset:6144
    buffer_load_dwordx4 v[40:43], v7, s[8:11], s30 offen offset:1280
    s_waitcnt lgkmcnt(8)
    v_mfma_f32_32x32x16_bf16 v[152:167], v[108:111], v[88:91], v[152:167]
    ds_read_b64_tr_b16 v[116:117], v16 offset:64
    ds_read_b64_tr_b16 v[118:119], v16 offset:832
    buffer_load_dwordx4 v[44:47], v7, s[8:11], s31 offen offset:1280
    s_mov_b32 s26, 573440
    buffer_load_dwordx4 v[72:75], v9, s[12:15], s26 offen
    s_mov_b32 s26, 602112
    buffer_load_dwordx4 v[76:79], v9, s[12:15], s26 offen
    v_mfma_f32_32x32x16_bf16 v[168:183], v[108:111], v[92:95], v[168:183]
    s_waitcnt lgkmcnt(2)
    s_barrier
    v_mfma_f32_32x32x16_bf16 v[120:135], v[112:115], v[96:99], v[120:135]
    ds_read_b128 v[88:91], v11 offset:0
    ds_read_b128 v[92:95], v11 offset:4608
    s_waitcnt vmcnt(15)
    ds_write_b128 v17, v[48:51] offset:0
    s_waitcnt vmcnt(14)
    ds_write_b128 v17, v[52:55] offset:4608
    s_waitcnt vmcnt(13)
    ds_write_b128 v19, v[80:83] offset:0
    v_mfma_f32_32x32x16_bf16 v[136:151], v[112:115], v[100:103], v[136:151]
    ds_read_b64_tr_b16 v[104:105], v12 offset:0
    ds_read_b64_tr_b16 v[106:107], v12 offset:768
    s_waitcnt vmcnt(12)
    ds_write_b128 v19, v[84:87] offset:6144
    buffer_load_dwordx4 v[48:51], v7, s[8:11], s30 offen offset:1408
    s_waitcnt lgkmcnt(8)
    v_mfma_f32_32x32x16_bf16 v[152:167], v[116:119], v[96:99], v[152:167]
    ds_read_b64_tr_b16 v[108:109], v12 offset:64
    ds_read_b64_tr_b16 v[110:111], v12 offset:832
    buffer_load_dwordx4 v[52:55], v7, s[8:11], s31 offen offset:1408
    s_mov_b32 s26, 630784
    buffer_load_dwordx4 v[80:83], v9, s[12:15], s26 offen
    s_mov_b32 s26, 659456
    buffer_load_dwordx4 v[84:87], v9, s[12:15], s26 offen
    v_mfma_f32_32x32x16_bf16 v[168:183], v[116:119], v[100:103], v[168:183]
    s_waitcnt lgkmcnt(2)
    s_barrier
    v_mfma_f32_32x32x16_bf16 v[120:135], v[104:107], v[88:91], v[120:135]
    ds_read_b128 v[96:99], v13 offset:0
    ds_read_b128 v[100:103], v13 offset:4608
    s_waitcnt vmcnt(15)
    ds_write_b128 v18, v[24:27] offset:0
    s_waitcnt vmcnt(14)
    ds_write_b128 v18, v[28:31] offset:4608
    s_waitcnt vmcnt(13)
    ds_write_b128 v20, v[56:59] offset:0
    v_mfma_f32_32x32x16_bf16 v[136:151], v[104:107], v[92:95], v[136:151]
    ds_read_b64_tr_b16 v[112:113], v15 offset:0
    ds_read_b64_tr_b16 v[114:115], v15 offset:768
    s_waitcnt vmcnt(12)
    ds_write_b128 v20, v[60:63] offset:6144
    buffer_load_dwordx4 v[24:27], v7, s[8:11], s30 offen offset:1536
    s_waitcnt lgkmcnt(8)
    v_mfma_f32_32x32x16_bf16 v[152:167], v[108:111], v[88:91], v[152:167]
    ds_read_b64_tr_b16 v[116:117], v15 offset:64
    ds_read_b64_tr_b16 v[118:119], v15 offset:832
    buffer_load_dwordx4 v[28:31], v7, s[8:11], s31 offen offset:1536
    s_mov_b32 s26, 688128
    buffer_load_dwordx4 v[56:59], v9, s[12:15], s26 offen
    s_mov_b32 s26, 716800
    buffer_load_dwordx4 v[60:63], v9, s[12:15], s26 offen
    v_mfma_f32_32x32x16_bf16 v[168:183], v[108:111], v[92:95], v[168:183]
    s_waitcnt lgkmcnt(2)
    s_barrier
    v_mfma_f32_32x32x16_bf16 v[120:135], v[112:115], v[96:99], v[120:135]
    ds_read_b128 v[88:91], v14 offset:0
    ds_read_b128 v[92:95], v14 offset:4608
    s_waitcnt vmcnt(15)
    ds_write_b128 v8, v[32:35] offset:0
    s_waitcnt vmcnt(14)
    ds_write_b128 v8, v[36:39] offset:4608
    s_waitcnt vmcnt(13)
    ds_write_b128 v10, v[64:67] offset:0
    v_mfma_f32_32x32x16_bf16 v[136:151], v[112:115], v[100:103], v[136:151]
    ds_read_b64_tr_b16 v[104:105], v16 offset:0
    ds_read_b64_tr_b16 v[106:107], v16 offset:768
    s_waitcnt vmcnt(12)
    ds_write_b128 v10, v[68:71] offset:6144
    buffer_load_dwordx4 v[32:35], v7, s[8:11], s30 offen offset:1664
    s_waitcnt lgkmcnt(8)
    v_mfma_f32_32x32x16_bf16 v[152:167], v[116:119], v[96:99], v[152:167]
    ds_read_b64_tr_b16 v[108:109], v16 offset:64
    ds_read_b64_tr_b16 v[110:111], v16 offset:832
    buffer_load_dwordx4 v[36:39], v7, s[8:11], s31 offen offset:1664
    s_mov_b32 s26, 745472
    buffer_load_dwordx4 v[64:67], v9, s[12:15], s26 offen
    s_mov_b32 s26, 774144
    buffer_load_dwordx4 v[68:71], v9, s[12:15], s26 offen
    v_mfma_f32_32x32x16_bf16 v[168:183], v[116:119], v[100:103], v[168:183]
    s_waitcnt lgkmcnt(2)
    s_barrier
    v_mfma_f32_32x32x16_bf16 v[120:135], v[104:107], v[88:91], v[120:135]
    ds_read_b128 v[96:99], v11 offset:0
    ds_read_b128 v[100:103], v11 offset:4608
    s_waitcnt vmcnt(15)
    ds_write_b128 v17, v[40:43] offset:0
    s_waitcnt vmcnt(14)
    ds_write_b128 v17, v[44:47] offset:4608
    s_waitcnt vmcnt(13)
    ds_write_b128 v19, v[72:75] offset:0
    v_mfma_f32_32x32x16_bf16 v[136:151], v[104:107], v[92:95], v[136:151]
    ds_read_b64_tr_b16 v[112:113], v12 offset:0
    ds_read_b64_tr_b16 v[114:115], v12 offset:768
    s_waitcnt vmcnt(12)
    ds_write_b128 v19, v[76:79] offset:6144
    buffer_load_dwordx4 v[40:43], v7, s[8:11], s30 offen offset:1792
    s_waitcnt lgkmcnt(8)
    v_mfma_f32_32x32x16_bf16 v[152:167], v[108:111], v[88:91], v[152:167]
    ds_read_b64_tr_b16 v[116:117], v12 offset:64
    ds_read_b64_tr_b16 v[118:119], v12 offset:832
    buffer_load_dwordx4 v[44:47], v7, s[8:11], s31 offen offset:1792
    s_mov_b32 s26, 802816
    buffer_load_dwordx4 v[72:75], v9, s[12:15], s26 offen
    s_mov_b32 s26, 831488
    buffer_load_dwordx4 v[76:79], v9, s[12:15], s26 offen
    v_mfma_f32_32x32x16_bf16 v[168:183], v[108:111], v[92:95], v[168:183]
    s_waitcnt lgkmcnt(2)
    s_barrier
    v_mfma_f32_32x32x16_bf16 v[120:135], v[112:115], v[96:99], v[120:135]
    ds_read_b128 v[88:91], v13 offset:0
    ds_read_b128 v[92:95], v13 offset:4608
    s_waitcnt vmcnt(15)
    ds_write_b128 v18, v[48:51] offset:0
    s_waitcnt vmcnt(14)
    ds_write_b128 v18, v[52:55] offset:4608
    s_waitcnt vmcnt(13)
    ds_write_b128 v20, v[80:83] offset:0
    v_mfma_f32_32x32x16_bf16 v[136:151], v[112:115], v[100:103], v[136:151]
    ds_read_b64_tr_b16 v[104:105], v15 offset:0
    ds_read_b64_tr_b16 v[106:107], v15 offset:768
    s_waitcnt vmcnt(12)
    ds_write_b128 v20, v[84:87] offset:6144
    buffer_load_dwordx4 v[48:51], v7, s[8:11], s30 offen offset:1920
    s_waitcnt lgkmcnt(8)
    v_mfma_f32_32x32x16_bf16 v[152:167], v[116:119], v[96:99], v[152:167]
    ds_read_b64_tr_b16 v[108:109], v15 offset:64
    ds_read_b64_tr_b16 v[110:111], v15 offset:832
    buffer_load_dwordx4 v[52:55], v7, s[8:11], s31 offen offset:1920
    s_mov_b32 s26, 860160
    buffer_load_dwordx4 v[80:83], v9, s[12:15], s26 offen
    s_mov_b32 s26, 888832
    buffer_load_dwordx4 v[84:87], v9, s[12:15], s26 offen
    v_mfma_f32_32x32x16_bf16 v[168:183], v[116:119], v[100:103], v[168:183]
    s_waitcnt lgkmcnt(2)
    s_barrier
    v_mfma_f32_32x32x16_bf16 v[120:135], v[104:107], v[88:91], v[120:135]
    ds_read_b128 v[96:99], v14 offset:0
    ds_read_b128 v[100:103], v14 offset:4608
    s_waitcnt vmcnt(15)
    ds_write_b128 v8, v[24:27] offset:0
    s_waitcnt vmcnt(14)
    ds_write_b128 v8, v[28:31] offset:4608
    s_waitcnt vmcnt(13)
    ds_write_b128 v10, v[56:59] offset:0
    v_mfma_f32_32x32x16_bf16 v[136:151], v[104:107], v[92:95], v[136:151]
    ds_read_b64_tr_b16 v[112:113], v16 offset:0
    ds_read_b64_tr_b16 v[114:115], v16 offset:768
    s_waitcnt vmcnt(12)
    ds_write_b128 v10, v[60:63] offset:6144
    buffer_load_dwordx4 v[24:27], v7, s[8:11], s30 offen offset:2048
    s_waitcnt lgkmcnt(8)
    v_mfma_f32_32x32x16_bf16 v[152:167], v[108:111], v[88:91], v[152:167]
    ds_read_b64_tr_b16 v[116:117], v16 offset:64
    ds_read_b64_tr_b16 v[118:119], v16 offset:832
    buffer_load_dwordx4 v[28:31], v7, s[8:11], s31 offen offset:2048
    s_mov_b32 s26, 917504
    buffer_load_dwordx4 v[56:59], v9, s[12:15], s26 offen
    s_mov_b32 s26, 946176
    buffer_load_dwordx4 v[60:63], v9, s[12:15], s26 offen
    v_mfma_f32_32x32x16_bf16 v[168:183], v[108:111], v[92:95], v[168:183]
    s_waitcnt lgkmcnt(2)
    s_barrier
    v_mfma_f32_32x32x16_bf16 v[120:135], v[112:115], v[96:99], v[120:135]
    ds_read_b128 v[88:91], v11 offset:0
    ds_read_b128 v[92:95], v11 offset:4608
    s_waitcnt vmcnt(15)
    ds_write_b128 v17, v[32:35] offset:0
    s_waitcnt vmcnt(14)
    ds_write_b128 v17, v[36:39] offset:4608
    s_waitcnt vmcnt(13)
    ds_write_b128 v19, v[64:67] offset:0
    v_mfma_f32_32x32x16_bf16 v[136:151], v[112:115], v[100:103], v[136:151]
    ds_read_b64_tr_b16 v[104:105], v12 offset:0
    ds_read_b64_tr_b16 v[106:107], v12 offset:768
    s_waitcnt vmcnt(12)
    ds_write_b128 v19, v[68:71] offset:6144
    buffer_load_dwordx4 v[32:35], v7, s[8:11], s30 offen offset:2176
    s_waitcnt lgkmcnt(8)
    v_mfma_f32_32x32x16_bf16 v[152:167], v[116:119], v[96:99], v[152:167]
    ds_read_b64_tr_b16 v[108:109], v12 offset:64
    ds_read_b64_tr_b16 v[110:111], v12 offset:832
    buffer_load_dwordx4 v[36:39], v7, s[8:11], s31 offen offset:2176
    s_mov_b32 s26, 974848
    buffer_load_dwordx4 v[64:67], v9, s[12:15], s26 offen
    s_mov_b32 s26, 1003520
    buffer_load_dwordx4 v[68:71], v9, s[12:15], s26 offen
    v_mfma_f32_32x32x16_bf16 v[168:183], v[116:119], v[100:103], v[168:183]
    s_waitcnt lgkmcnt(2)
    s_barrier
    v_mfma_f32_32x32x16_bf16 v[120:135], v[104:107], v[88:91], v[120:135]
    ds_read_b128 v[96:99], v13 offset:0
    ds_read_b128 v[100:103], v13 offset:4608
    s_waitcnt vmcnt(15)
    ds_write_b128 v18, v[40:43] offset:0
    s_waitcnt vmcnt(14)
    ds_write_b128 v18, v[44:47] offset:4608
    s_waitcnt vmcnt(13)
    ds_write_b128 v20, v[72:75] offset:0
    v_mfma_f32_32x32x16_bf16 v[136:151], v[104:107], v[92:95], v[136:151]
    ds_read_b64_tr_b16 v[112:113], v15 offset:0
    ds_read_b64_tr_b16 v[114:115], v15 offset:768
    s_waitcnt vmcnt(12)
    ds_write_b128 v20, v[76:79] offset:6144
    buffer_load_dwordx4 v[40:43], v7, s[8:11], s30 offen offset:2304
    s_waitcnt lgkmcnt(8)
    v_mfma_f32_32x32x16_bf16 v[152:167], v[108:111], v[88:91], v[152:167]
    ds_read_b64_tr_b16 v[116:117], v15 offset:64
    ds_read_b64_tr_b16 v[118:119], v15 offset:832
    buffer_load_dwordx4 v[44:47], v7, s[8:11], s31 offen offset:2304
    s_mov_b32 s26, 1032192
    buffer_load_dwordx4 v[72:75], v9, s[12:15], s26 offen
    s_mov_b32 s26, 1060864
    buffer_load_dwordx4 v[76:79], v9, s[12:15], s26 offen
    v_mfma_f32_32x32x16_bf16 v[168:183], v[108:111], v[92:95], v[168:183]
    s_waitcnt lgkmcnt(2)
    s_barrier
    v_mfma_f32_32x32x16_bf16 v[120:135], v[112:115], v[96:99], v[120:135]
    ds_read_b128 v[88:91], v14 offset:0
    ds_read_b128 v[92:95], v14 offset:4608
    s_waitcnt vmcnt(15)
    ds_write_b128 v8, v[48:51] offset:0
    s_waitcnt vmcnt(14)
    ds_write_b128 v8, v[52:55] offset:4608
    s_waitcnt vmcnt(13)
    ds_write_b128 v10, v[80:83] offset:0
    v_mfma_f32_32x32x16_bf16 v[136:151], v[112:115], v[100:103], v[136:151]
    ds_read_b64_tr_b16 v[104:105], v16 offset:0
    ds_read_b64_tr_b16 v[106:107], v16 offset:768
    s_waitcnt vmcnt(12)
    ds_write_b128 v10, v[84:87] offset:6144
    buffer_load_dwordx4 v[48:51], v7, s[8:11], s30 offen offset:2432
    s_waitcnt lgkmcnt(8)
    v_mfma_f32_32x32x16_bf16 v[152:167], v[116:119], v[96:99], v[152:167]
    ds_read_b64_tr_b16 v[108:109], v16 offset:64
    ds_read_b64_tr_b16 v[110:111], v16 offset:832
    buffer_load_dwordx4 v[52:55], v7, s[8:11], s31 offen offset:2432
    s_mov_b32 s26, 1089536
    buffer_load_dwordx4 v[80:83], v9, s[12:15], s26 offen
    s_mov_b32 s26, 1118208
    buffer_load_dwordx4 v[84:87], v9, s[12:15], s26 offen
    v_mfma_f32_32x32x16_bf16 v[168:183], v[116:119], v[100:103], v[168:183]
    s_waitcnt lgkmcnt(2)
    s_barrier
    v_mfma_f32_32x32x16_bf16 v[120:135], v[104:107], v[88:91], v[120:135]
    ds_read_b128 v[96:99], v11 offset:0
    ds_read_b128 v[100:103], v11 offset:4608
    s_waitcnt vmcnt(15)
    ds_write_b128 v17, v[24:27] offset:0
    s_waitcnt vmcnt(14)
    ds_write_b128 v17, v[28:31] offset:4608
    s_waitcnt vmcnt(13)
    ds_write_b128 v19, v[56:59] offset:0
    v_mfma_f32_32x32x16_bf16 v[136:151], v[104:107], v[92:95], v[136:151]
    ds_read_b64_tr_b16 v[112:113], v12 offset:0
    ds_read_b64_tr_b16 v[114:115], v12 offset:768
    s_waitcnt vmcnt(12)
    ds_write_b128 v19, v[60:63] offset:6144
    buffer_load_dwordx4 v[24:27], v7, s[8:11], s30 offen offset:2560
    s_waitcnt lgkmcnt(8)
    v_mfma_f32_32x32x16_bf16 v[152:167], v[108:111], v[88:91], v[152:167]
    ds_read_b64_tr_b16 v[116:117], v12 offset:64
    ds_read_b64_tr_b16 v[118:119], v12 offset:832
    buffer_load_dwordx4 v[28:31], v7, s[8:11], s31 offen offset:2560
    s_mov_b32 s26, 1146880
    buffer_load_dwordx4 v[56:59], v9, s[12:15], s26 offen
    s_mov_b32 s26, 1175552
    buffer_load_dwordx4 v[60:63], v9, s[12:15], s26 offen
    v_mfma_f32_32x32x16_bf16 v[168:183], v[108:111], v[92:95], v[168:183]
    s_waitcnt lgkmcnt(2)
    s_barrier
    v_mfma_f32_32x32x16_bf16 v[120:135], v[112:115], v[96:99], v[120:135]
    ds_read_b128 v[88:91], v13 offset:0
    ds_read_b128 v[92:95], v13 offset:4608
    s_waitcnt vmcnt(15)
    ds_write_b128 v18, v[32:35] offset:0
    s_waitcnt vmcnt(14)
    ds_write_b128 v18, v[36:39] offset:4608
    s_waitcnt vmcnt(13)
    ds_write_b128 v20, v[64:67] offset:0
    v_mfma_f32_32x32x16_bf16 v[136:151], v[112:115], v[100:103], v[136:151]
    ds_read_b64_tr_b16 v[104:105], v15 offset:0
    ds_read_b64_tr_b16 v[106:107], v15 offset:768
    s_waitcnt vmcnt(12)
    ds_write_b128 v20, v[68:71] offset:6144
    buffer_load_dwordx4 v[32:35], v7, s[8:11], s30 offen offset:2688
    s_waitcnt lgkmcnt(8)
    v_mfma_f32_32x32x16_bf16 v[152:167], v[116:119], v[96:99], v[152:167]
    ds_read_b64_tr_b16 v[108:109], v15 offset:64
    ds_read_b64_tr_b16 v[110:111], v15 offset:832
    buffer_load_dwordx4 v[36:39], v7, s[8:11], s31 offen offset:2688
    s_mov_b32 s26, 1204224
    buffer_load_dwordx4 v[64:67], v9, s[12:15], s26 offen
    s_mov_b32 s26, 1232896
    buffer_load_dwordx4 v[68:71], v9, s[12:15], s26 offen
    v_mfma_f32_32x32x16_bf16 v[168:183], v[116:119], v[100:103], v[168:183]
    s_waitcnt lgkmcnt(2)
    s_barrier
    v_mfma_f32_32x32x16_bf16 v[120:135], v[104:107], v[88:91], v[120:135]
    ds_read_b128 v[96:99], v14 offset:0
    ds_read_b128 v[100:103], v14 offset:4608
    s_waitcnt vmcnt(15)
    ds_write_b128 v8, v[40:43] offset:0
    s_waitcnt vmcnt(14)
    ds_write_b128 v8, v[44:47] offset:4608
    s_waitcnt vmcnt(13)
    ds_write_b128 v10, v[72:75] offset:0
    v_mfma_f32_32x32x16_bf16 v[136:151], v[104:107], v[92:95], v[136:151]
    ds_read_b64_tr_b16 v[112:113], v16 offset:0
    ds_read_b64_tr_b16 v[114:115], v16 offset:768
    s_waitcnt vmcnt(12)
    ds_write_b128 v10, v[76:79] offset:6144
    buffer_load_dwordx4 v[40:43], v7, s[8:11], s30 offen offset:2816
    s_waitcnt lgkmcnt(8)
    v_mfma_f32_32x32x16_bf16 v[152:167], v[108:111], v[88:91], v[152:167]
    ds_read_b64_tr_b16 v[116:117], v16 offset:64
    ds_read_b64_tr_b16 v[118:119], v16 offset:832
    buffer_load_dwordx4 v[44:47], v7, s[8:11], s31 offen offset:2816
    s_mov_b32 s26, 1261568
    buffer_load_dwordx4 v[72:75], v9, s[12:15], s26 offen
    s_mov_b32 s26, 1290240
    buffer_load_dwordx4 v[76:79], v9, s[12:15], s26 offen
    v_mfma_f32_32x32x16_bf16 v[168:183], v[108:111], v[92:95], v[168:183]
    s_waitcnt lgkmcnt(2)
    s_barrier
    v_mfma_f32_32x32x16_bf16 v[120:135], v[112:115], v[96:99], v[120:135]
    ds_read_b128 v[88:91], v11 offset:0
    ds_read_b128 v[92:95], v11 offset:4608
    s_waitcnt vmcnt(15)
    ds_write_b128 v17, v[48:51] offset:0
    s_waitcnt vmcnt(14)
    ds_write_b128 v17, v[52:55] offset:4608
    s_waitcnt vmcnt(13)
    ds_write_b128 v19, v[80:83] offset:0
    v_mfma_f32_32x32x16_bf16 v[136:151], v[112:115], v[100:103], v[136:151]
    ds_read_b64_tr_b16 v[104:105], v12 offset:0
    ds_read_b64_tr_b16 v[106:107], v12 offset:768
    s_waitcnt vmcnt(12)
    ds_write_b128 v19, v[84:87] offset:6144
    buffer_load_dwordx4 v[48:51], v7, s[8:11], s30 offen offset:2944
    s_waitcnt lgkmcnt(8)
    v_mfma_f32_32x32x16_bf16 v[152:167], v[116:119], v[96:99], v[152:167]
    ds_read_b64_tr_b16 v[108:109], v12 offset:64
    ds_read_b64_tr_b16 v[110:111], v12 offset:832
    buffer_load_dwordx4 v[52:55], v7, s[8:11], s31 offen offset:2944
    s_mov_b32 s26, 1318912
    buffer_load_dwordx4 v[80:83], v9, s[12:15], s26 offen
    s_mov_b32 s26, 1347584
    buffer_load_dwordx4 v[84:87], v9, s[12:15], s26 offen
    v_mfma_f32_32x32x16_bf16 v[168:183], v[116:119], v[100:103], v[168:183]
    s_waitcnt lgkmcnt(2)
    s_barrier
    v_mfma_f32_32x32x16_bf16 v[120:135], v[104:107], v[88:91], v[120:135]
    ds_read_b128 v[96:99], v13 offset:0
    ds_read_b128 v[100:103], v13 offset:4608
    s_waitcnt vmcnt(15)
    ds_write_b128 v18, v[24:27] offset:0
    s_waitcnt vmcnt(14)
    ds_write_b128 v18, v[28:31] offset:4608
    s_waitcnt vmcnt(13)
    ds_write_b128 v20, v[56:59] offset:0
    v_mfma_f32_32x32x16_bf16 v[136:151], v[104:107], v[92:95], v[136:151]
    ds_read_b64_tr_b16 v[112:113], v15 offset:0
    ds_read_b64_tr_b16 v[114:115], v15 offset:768
    s_waitcnt vmcnt(12)
    ds_write_b128 v20, v[60:63] offset:6144
    buffer_load_dwordx4 v[24:27], v7, s[8:11], s30 offen offset:3072
    s_waitcnt lgkmcnt(8)
    v_mfma_f32_32x32x16_bf16 v[152:167], v[108:111], v[88:91], v[152:167]
    ds_read_b64_tr_b16 v[116:117], v15 offset:64
    ds_read_b64_tr_b16 v[118:119], v15 offset:832
    buffer_load_dwordx4 v[28:31], v7, s[8:11], s31 offen offset:3072
    s_mov_b32 s26, 1376256
    buffer_load_dwordx4 v[56:59], v9, s[12:15], s26 offen
    s_mov_b32 s26, 1404928
    buffer_load_dwordx4 v[60:63], v9, s[12:15], s26 offen
    v_mfma_f32_32x32x16_bf16 v[168:183], v[108:111], v[92:95], v[168:183]
    s_waitcnt lgkmcnt(2)
    s_barrier
    v_mfma_f32_32x32x16_bf16 v[120:135], v[112:115], v[96:99], v[120:135]
    ds_read_b128 v[88:91], v14 offset:0
    ds_read_b128 v[92:95], v14 offset:4608
    s_waitcnt vmcnt(15)
    ds_write_b128 v8, v[32:35] offset:0
    s_waitcnt vmcnt(14)
    ds_write_b128 v8, v[36:39] offset:4608
    s_waitcnt vmcnt(13)
    ds_write_b128 v10, v[64:67] offset:0
    v_mfma_f32_32x32x16_bf16 v[136:151], v[112:115], v[100:103], v[136:151]
    ds_read_b64_tr_b16 v[104:105], v16 offset:0
    ds_read_b64_tr_b16 v[106:107], v16 offset:768
    s_waitcnt vmcnt(12)
    ds_write_b128 v10, v[68:71] offset:6144
    buffer_load_dwordx4 v[32:35], v7, s[8:11], s30 offen offset:3200
    s_waitcnt lgkmcnt(8)
    v_mfma_f32_32x32x16_bf16 v[152:167], v[116:119], v[96:99], v[152:167]
    ds_read_b64_tr_b16 v[108:109], v16 offset:64
    ds_read_b64_tr_b16 v[110:111], v16 offset:832
    buffer_load_dwordx4 v[36:39], v7, s[8:11], s31 offen offset:3200
    s_mov_b32 s26, 1433600
    buffer_load_dwordx4 v[64:67], v9, s[12:15], s26 offen
    s_mov_b32 s26, 1462272
    buffer_load_dwordx4 v[68:71], v9, s[12:15], s26 offen
    v_mfma_f32_32x32x16_bf16 v[168:183], v[116:119], v[100:103], v[168:183]
    s_waitcnt lgkmcnt(2)
    s_barrier
    v_mfma_f32_32x32x16_bf16 v[120:135], v[104:107], v[88:91], v[120:135]
    ds_read_b128 v[96:99], v11 offset:0
    ds_read_b128 v[100:103], v11 offset:4608
    s_waitcnt vmcnt(15)
    ds_write_b128 v17, v[40:43] offset:0
    s_waitcnt vmcnt(14)
    ds_write_b128 v17, v[44:47] offset:4608
    s_waitcnt vmcnt(13)
    ds_write_b128 v19, v[72:75] offset:0
    v_mfma_f32_32x32x16_bf16 v[136:151], v[104:107], v[92:95], v[136:151]
    ds_read_b64_tr_b16 v[112:113], v12 offset:0
    ds_read_b64_tr_b16 v[114:115], v12 offset:768
    s_waitcnt vmcnt(12)
    ds_write_b128 v19, v[76:79] offset:6144
    buffer_load_dwordx4 v[40:43], v7, s[8:11], s30 offen offset:3328
    s_waitcnt lgkmcnt(8)
    v_mfma_f32_32x32x16_bf16 v[152:167], v[108:111], v[88:91], v[152:167]
    ds_read_b64_tr_b16 v[116:117], v12 offset:64
    ds_read_b64_tr_b16 v[118:119], v12 offset:832
    buffer_load_dwordx4 v[44:47], v7, s[8:11], s31 offen offset:3328
    s_mov_b32 s26, 1490944
    buffer_load_dwordx4 v[72:75], v9, s[12:15], s26 offen
    s_mov_b32 s26, 1519616
    buffer_load_dwordx4 v[76:79], v9, s[12:15], s26 offen
    v_mfma_f32_32x32x16_bf16 v[168:183], v[108:111], v[92:95], v[168:183]
    s_waitcnt lgkmcnt(2)
    s_barrier
    v_mfma_f32_32x32x16_bf16 v[120:135], v[112:115], v[96:99], v[120:135]
    ds_read_b128 v[88:91], v13 offset:0
    ds_read_b128 v[92:95], v13 offset:4608
    s_waitcnt vmcnt(15)
    ds_write_b128 v18, v[48:51] offset:0
    s_waitcnt vmcnt(14)
    ds_write_b128 v18, v[52:55] offset:4608
    s_waitcnt vmcnt(13)
    ds_write_b128 v20, v[80:83] offset:0
    v_mfma_f32_32x32x16_bf16 v[136:151], v[112:115], v[100:103], v[136:151]
    ds_read_b64_tr_b16 v[104:105], v15 offset:0
    ds_read_b64_tr_b16 v[106:107], v15 offset:768
    s_waitcnt vmcnt(12)
    ds_write_b128 v20, v[84:87] offset:6144
    buffer_load_dwordx4 v[48:51], v7, s[8:11], s30 offen offset:3456
    s_waitcnt lgkmcnt(8)
    v_mfma_f32_32x32x16_bf16 v[152:167], v[116:119], v[96:99], v[152:167]
    ds_read_b64_tr_b16 v[108:109], v15 offset:64
    ds_read_b64_tr_b16 v[110:111], v15 offset:832
    buffer_load_dwordx4 v[52:55], v7, s[8:11], s31 offen offset:3456
    s_mov_b32 s26, 1548288
    buffer_load_dwordx4 v[80:83], v9, s[12:15], s26 offen
    s_mov_b32 s26, 1576960
    buffer_load_dwordx4 v[84:87], v9, s[12:15], s26 offen
    v_mfma_f32_32x32x16_bf16 v[168:183], v[116:119], v[100:103], v[168:183]
    s_waitcnt lgkmcnt(2)
    s_barrier
    v_mfma_f32_32x32x16_bf16 v[120:135], v[104:107], v[88:91], v[120:135]
    ds_read_b128 v[96:99], v14 offset:0
    ds_read_b128 v[100:103], v14 offset:4608
    s_waitcnt vmcnt(15)
    ds_write_b128 v8, v[24:27] offset:0
    s_waitcnt vmcnt(14)
    ds_write_b128 v8, v[28:31] offset:4608
    v_mfma_f32_32x32x16_bf16 v[136:151], v[104:107], v[92:95], v[136:151]
    ds_read_b64_tr_b16 v[112:113], v16 offset:0
    ds_read_b64_tr_b16 v[114:115], v16 offset:768
    s_waitcnt vmcnt(13)
    ds_write_b128 v10, v[56:59] offset:0
    s_waitcnt lgkmcnt(7)
    v_mfma_f32_32x32x16_bf16 v[152:167], v[108:111], v[88:91], v[152:167]
    ds_read_b64_tr_b16 v[116:117], v16 offset:64
    ds_read_b64_tr_b16 v[118:119], v16 offset:832
    s_waitcnt vmcnt(12)
    ds_write_b128 v10, v[60:63] offset:6144
    v_mfma_f32_32x32x16_bf16 v[168:183], v[108:111], v[92:95], v[168:183]
    s_waitcnt lgkmcnt(0)
    s_barrier
    v_mfma_f32_32x32x16_bf16 v[120:135], v[112:115], v[96:99], v[120:135]
    ds_read_b128 v[88:91], v11 offset:0
    ds_read_b128 v[92:95], v11 offset:4608
    s_waitcnt vmcnt(11)
    ds_write_b128 v17, v[32:35] offset:0
    s_waitcnt vmcnt(10)
    ds_write_b128 v17, v[36:39] offset:4608
    v_mfma_f32_32x32x16_bf16 v[136:151], v[112:115], v[100:103], v[136:151]
    ds_read_b64_tr_b16 v[104:105], v12 offset:0
    ds_read_b64_tr_b16 v[106:107], v12 offset:768
    s_waitcnt vmcnt(9)
    ds_write_b128 v19, v[64:67] offset:0
    v_mfma_f32_32x32x16_bf16 v[152:167], v[116:119], v[96:99], v[152:167]
    ds_read_b64_tr_b16 v[108:109], v12 offset:64
    ds_read_b64_tr_b16 v[110:111], v12 offset:832
    s_waitcnt vmcnt(8)
    ds_write_b128 v19, v[68:71] offset:6144
    v_mfma_f32_32x32x16_bf16 v[168:183], v[116:119], v[100:103], v[168:183]
    s_waitcnt lgkmcnt(0)
    s_barrier
    v_mfma_f32_32x32x16_bf16 v[120:135], v[104:107], v[88:91], v[120:135]
    ds_read_b128 v[96:99], v13 offset:0
    ds_read_b128 v[100:103], v13 offset:4608
    s_waitcnt vmcnt(7)
    ds_write_b128 v18, v[40:43] offset:0
    s_waitcnt vmcnt(6)
    ds_write_b128 v18, v[44:47] offset:4608
    v_mfma_f32_32x32x16_bf16 v[136:151], v[104:107], v[92:95], v[136:151]
    ds_read_b64_tr_b16 v[112:113], v15 offset:0
    ds_read_b64_tr_b16 v[114:115], v15 offset:768
    s_waitcnt vmcnt(5)
    ds_write_b128 v20, v[72:75] offset:0
    v_mfma_f32_32x32x16_bf16 v[152:167], v[108:111], v[88:91], v[152:167]
    ds_read_b64_tr_b16 v[116:117], v15 offset:64
    ds_read_b64_tr_b16 v[118:119], v15 offset:832
    s_waitcnt vmcnt(4)
    ds_write_b128 v20, v[76:79] offset:6144
    v_mfma_f32_32x32x16_bf16 v[168:183], v[108:111], v[92:95], v[168:183]
    s_waitcnt lgkmcnt(0)
    s_barrier
    v_mfma_f32_32x32x16_bf16 v[120:135], v[112:115], v[96:99], v[120:135]
    ds_read_b128 v[88:91], v14 offset:0
    ds_read_b128 v[92:95], v14 offset:4608
    s_waitcnt vmcnt(3)
    ds_write_b128 v8, v[48:51] offset:0
    s_waitcnt vmcnt(2)
    ds_write_b128 v8, v[52:55] offset:4608
    v_mfma_f32_32x32x16_bf16 v[136:151], v[112:115], v[100:103], v[136:151]
    ds_read_b64_tr_b16 v[104:105], v16 offset:0
    ds_read_b64_tr_b16 v[106:107], v16 offset:768
    s_waitcnt vmcnt(1)
    ds_write_b128 v10, v[80:83] offset:0
    v_mfma_f32_32x32x16_bf16 v[152:167], v[116:119], v[96:99], v[152:167]
    ds_read_b64_tr_b16 v[108:109], v16 offset:64
    ds_read_b64_tr_b16 v[110:111], v16 offset:832
    s_waitcnt vmcnt(0)
    ds_write_b128 v10, v[84:87] offset:6144
    v_mfma_f32_32x32x16_bf16 v[168:183], v[116:119], v[100:103], v[168:183]
    s_waitcnt lgkmcnt(0)
    s_barrier
    v_mfma_f32_32x32x16_bf16 v[120:135], v[104:107], v[88:91], v[120:135]
    ds_read_b128 v[96:99], v11 offset:0
    ds_read_b128 v[100:103], v11 offset:4608
    v_mfma_f32_32x32x16_bf16 v[136:151], v[104:107], v[92:95], v[136:151]
    ds_read_b64_tr_b16 v[112:113], v12 offset:0
    ds_read_b64_tr_b16 v[114:115], v12 offset:768
    v_mfma_f32_32x32x16_bf16 v[152:167], v[108:111], v[88:91], v[152:167]
    ds_read_b64_tr_b16 v[116:117], v12 offset:64
    ds_read_b64_tr_b16 v[118:119], v12 offset:832
    v_mfma_f32_32x32x16_bf16 v[168:183], v[108:111], v[92:95], v[168:183]
    s_waitcnt lgkmcnt(2)
    v_mfma_f32_32x32x16_bf16 v[120:135], v[112:115], v[96:99], v[120:135]
    v_mfma_f32_32x32x16_bf16 v[136:151], v[112:115], v[100:103], v[136:151]
    s_waitcnt lgkmcnt(0)
    v_mfma_f32_32x32x16_bf16 v[152:167], v[116:119], v[96:99], v[152:167]
    v_mfma_f32_32x32x16_bf16 v[168:183], v[116:119], v[100:103], v[168:183]
    s_mul_i32 s27, s24, 64
    s_mul_i32 s28, s25, 64
    v_and_b32 v5, 31, v1
    v_lshrrev_b32 v6, 5, v1
    v_lshlrev_b32 v6, 2, v6
    v_and_b32 v3, 1, v2
    v_lshrrev_b32 v4, 1, v2
    v_lshlrev_b32 v3, 5, v3
    v_lshlrev_b32 v4, 5, v4
    v_add3_u32 v24, v3, v5, s27
    v_add3_u32 v25, v4, v6, s28
    s_mov_b32 s16, s46
    s_and_b32 s17, s47, 0xffff
    s_mov_b32 s18, 0x1c0000
    s_mov_b32 s19, 0x00020000
    s_add_u32 s20, s50, 0x800000
    s_addc_u32 s21, s51, 0
    s_and_b32 s21, s21, 0xffff
    s_mov_b32 s22, 0x1c0000
    s_mov_b32 s23, 0x00020000
    v_lshrrev_b32 v3, 5, v1
    v_lshl_add_u32 v3, v3, 2, v25
    v_mul_u32_u24 v26, 896, v24
    v_lshl_add_u32 v26, v3, 1, v26
    buffer_load_dwordx4 v[28:31], v26, s[20:23], 0 offen offset:0
    buffer_load_dwordx4 v[32:35], v26, s[20:23], 0 offen offset:32
    s_waitcnt lgkmcnt(0)
    s_barrier
    v_lshlrev_b32 v3, 4, v1
    v_lshl_add_u32 v36, v2, 14, v3
    v_lshl_add_u32 v37, v2, 12, v3
    ds_write_b128 v36, v[120:123] offset:0
    ds_write_b128 v36, v[124:127] offset:1024
    ds_write_b128 v36, v[128:131] offset:2048
    ds_write_b128 v36, v[132:135] offset:3072
    ds_write_b128 v36, v[136:139] offset:4096
    ds_write_b128 v36, v[140:143] offset:5120
    ds_write_b128 v36, v[144:147] offset:6144
    ds_write_b128 v36, v[148:151] offset:7168
    ds_write_b128 v36, v[152:155] offset:8192
    ds_write_b128 v36, v[156:159] offset:9216
    ds_write_b128 v36, v[160:163] offset:10240
    ds_write_b128 v36, v[164:167] offset:11264
    ds_write_b128 v36, v[168:171] offset:12288
    ds_write_b128 v36, v[172:175] offset:13312
    ds_write_b128 v36, v[176:179] offset:14336
    ds_write_b128 v36, v[180:183] offset:15360
    s_waitcnt lgkmcnt(0)
    s_barrier
    ds_read_b128 v[184:187], v37 offset:0
    ds_read_b128 v[188:191], v37 offset:1024
    ds_read_b128 v[192:195], v37 offset:2048
    ds_read_b128 v[196:199], v37 offset:3072
    ds_read_b128 v[200:203], v37 offset:16384
    ds_read_b128 v[204:207], v37 offset:17408
    ds_read_b128 v[208:211], v37 offset:18432
    ds_read_b128 v[212:215], v37 offset:19456
    ds_read_b128 v[216:219], v37 offset:32768
    ds_read_b128 v[220:223], v37 offset:33792
    ds_read_b128 v[224:227], v37 offset:34816
    ds_read_b128 v[228:231], v37 offset:35840
    ds_read_b128 v[232:235], v37 offset:49152
    ds_read_b128 v[236:239], v37 offset:50176
    ds_read_b128 v[240:243], v37 offset:51200
    ds_read_b128 v[244:247], v37 offset:52224
    s_waitcnt lgkmcnt(11)
    v_pk_add_f32 v[184:185], v[184:185], v[200:201]
    s_waitcnt lgkmcnt(3)
    v_pk_add_f32 v[216:217], v[216:217], v[232:233]
    v_pk_add_f32 v[184:185], v[184:185], v[216:217]
    v_pk_add_f32 v[186:187], v[186:187], v[202:203]
    v_pk_add_f32 v[218:219], v[218:219], v[234:235]
    v_pk_add_f32 v[186:187], v[186:187], v[218:219]
    v_pk_add_f32 v[188:189], v[188:189], v[204:205]
    s_waitcnt lgkmcnt(2)
    v_pk_add_f32 v[220:221], v[220:221], v[236:237]
    v_pk_add_f32 v[188:189], v[188:189], v[220:221]
    v_pk_add_f32 v[190:191], v[190:191], v[206:207]
    v_pk_add_f32 v[222:223], v[222:223], v[238:239]
    v_pk_add_f32 v[190:191], v[190:191], v[222:223]
    v_pk_add_f32 v[192:193], v[192:193], v[208:209]
    s_waitcnt lgkmcnt(1)
    v_pk_add_f32 v[224:225], v[224:225], v[240:241]
    v_pk_add_f32 v[192:193], v[192:193], v[224:225]
    v_pk_add_f32 v[194:195], v[194:195], v[210:211]
    v_pk_add_f32 v[226:227], v[226:227], v[242:243]
    v_pk_add_f32 v[194:195], v[194:195], v[226:227]
    v_pk_add_f32 v[196:197], v[196:197], v[212:213]
    s_waitcnt lgkmcnt(0)
    v_pk_add_f32 v[228:229], v[228:229], v[244:245]
    v_pk_add_f32 v[196:197], v[196:197], v[228:229]
    v_pk_add_f32 v[198:199], v[198:199], v[214:215]
    v_pk_add_f32 v[230:231], v[230:231], v[246:247]
    v_pk_add_f32 v[198:199], v[198:199], v[230:231]
    v_cvt_pk_bf16_f32 v40, v184, v185
    v_cvt_pk_bf16_f32 v41, v186, v187
    v_cvt_pk_bf16_f32 v42, v188, v189
    v_cvt_pk_bf16_f32 v43, v190, v191
    s_nop 0
    v_permlane32_swap_b32 v40, v42
    v_permlane32_swap_b32 v41, v43
    v_lshlrev_b32 v4, 16, v40
    v_and_b32 v3, 0xffff0000, v40
    s_waitcnt vmcnt(1)
    v_lshlrev_b32 v5, 16, v28
    v_and_b32 v6, 0xffff0000, v28
    v_add_f32 v4, v4, v5
    v_add_f32 v3, v3, v6
    v_cvt_pk_bf16_f32 v28, v4, v3
    v_lshlrev_b32 v4, 16, v41
    v_and_b32 v3, 0xffff0000, v41
    v_lshlrev_b32 v5, 16, v29
    v_and_b32 v6, 0xffff0000, v29
    v_add_f32 v4, v4, v5
    v_add_f32 v3, v3, v6
    v_cvt_pk_bf16_f32 v29, v4, v3
    v_lshlrev_b32 v4, 16, v42
    v_and_b32 v3, 0xffff0000, v42
    v_lshlrev_b32 v5, 16, v30
    v_and_b32 v6, 0xffff0000, v30
    v_add_f32 v4, v4, v5
    v_add_f32 v3, v3, v6
    v_cvt_pk_bf16_f32 v30, v4, v3
    v_lshlrev_b32 v4, 16, v43
    v_and_b32 v3, 0xffff0000, v43
    v_lshlrev_b32 v5, 16, v31
    v_and_b32 v6, 0xffff0000, v31
    v_add_f32 v4, v4, v5
    v_add_f32 v3, v3, v6
    v_cvt_pk_bf16_f32 v31, v4, v3
    buffer_store_dwordx4 v[28:31], v26, s[16:19], 0 offen offset:0
    v_cvt_pk_bf16_f32 v40, v192, v193
    v_cvt_pk_bf16_f32 v41, v194, v195
    v_cvt_pk_bf16_f32 v42, v196, v197
    v_cvt_pk_bf16_f32 v43, v198, v199
    s_nop 0
    v_permlane32_swap_b32 v40, v42
    v_permlane32_swap_b32 v41, v43
    v_lshlrev_b32 v4, 16, v40
    v_and_b32 v3, 0xffff0000, v40
    s_waitcnt vmcnt(1)
    v_lshlrev_b32 v5, 16, v32
    v_and_b32 v6, 0xffff0000, v32
    v_add_f32 v4, v4, v5
    v_add_f32 v3, v3, v6
    v_cvt_pk_bf16_f32 v32, v4, v3
    v_lshlrev_b32 v4, 16, v41
    v_and_b32 v3, 0xffff0000, v41
    v_lshlrev_b32 v5, 16, v33
    v_and_b32 v6, 0xffff0000, v33
    v_add_f32 v4, v4, v5
    v_add_f32 v3, v3, v6
    v_cvt_pk_bf16_f32 v33, v4, v3
    v_lshlrev_b32 v4, 16, v42
    v_and_b32 v3, 0xffff0000, v42
    v_lshlrev_b32 v5, 16, v34
    v_and_b32 v6, 0xffff0000, v34
    v_add_f32 v4, v4, v5
    v_add_f32 v3, v3, v6
    v_cvt_pk_bf16_f32 v34, v4, v3
    v_lshlrev_b32 v4, 16, v43
    v_and_b32 v3, 0xffff0000, v43
    v_lshlrev_b32 v5, 16, v35
    v_and_b32 v6, 0xffff0000, v35
    v_add_f32 v4, v4, v5
    v_add_f32 v3, v3, v6
    v_cvt_pk_bf16_f32 v35, v4, v3
    buffer_store_dwordx4 v[32:35], v26, s[16:19], 0 offen offset:32
L_end_g5_1_kernel:
    s_endpgm
.section .rodata,"a"
.p2align 6
.amdhsa_kernel g1_0_kernel
  .amdhsa_next_free_vgpr 246
  .amdhsa_next_free_sgpr 54
  .amdhsa_accum_offset 248
  .amdhsa_group_segment_fixed_size 0
  .amdhsa_kernarg_size 80
  .amdhsa_user_sgpr_count 2
  .amdhsa_user_sgpr_kernarg_segment_ptr 1
  .amdhsa_system_sgpr_workgroup_id_x 1
.end_amdhsa_kernel
.p2align 6
.amdhsa_kernel attn_0_kernel
  .amdhsa_next_free_vgpr 250
  .amdhsa_next_free_sgpr 44
  .amdhsa_accum_offset 252
  .amdhsa_group_segment_fixed_size 0
  .amdhsa_kernarg_size 80
  .amdhsa_user_sgpr_count 2
  .amdhsa_user_sgpr_kernarg_segment_ptr 1
  .amdhsa_system_sgpr_workgroup_id_x 1
.end_amdhsa_kernel
.p2align 6
.amdhsa_kernel g3_0_kernel
  .amdhsa_next_free_vgpr 248
  .amdhsa_next_free_sgpr 52
  .amdhsa_accum_offset 248
  .amdhsa_group_segment_fixed_size 0
  .amdhsa_kernarg_size 80
  .amdhsa_user_sgpr_count 2
  .amdhsa_user_sgpr_kernarg_segment_ptr 1
  .amdhsa_system_sgpr_workgroup_id_x 1
.end_amdhsa_kernel
.p2align 6
.amdhsa_kernel g4_0_kernel
  .amdhsa_next_free_vgpr 364
  .amdhsa_next_free_sgpr 60
  .amdhsa_accum_offset 236
  .amdhsa_group_segment_fixed_size 0
  .amdhsa_kernarg_size 80
  .amdhsa_user_sgpr_count 2
  .amdhsa_user_sgpr_kernarg_segment_ptr 1
  .amdhsa_system_sgpr_workgroup_id_x 1
.end_amdhsa_kernel
.p2align 6
.amdhsa_kernel g5_0_kernel
  .amdhsa_next_free_vgpr 248
  .amdhsa_next_free_sgpr 52
  .amdhsa_accum_offset 248
  .amdhsa_group_segment_fixed_size 0
  .amdhsa_kernarg_size 80
  .amdhsa_user_sgpr_count 2
  .amdhsa_user_sgpr_kernarg_segment_ptr 1
  .amdhsa_system_sgpr_workgroup_id_x 1
.end_amdhsa_kernel
.p2align 6
.amdhsa_kernel g1_1_kernel
  .amdhsa_next_free_vgpr 244
  .amdhsa_next_free_sgpr 54
  .amdhsa_accum_offset 244
  .amdhsa_group_segment_fixed_size 0
  .amdhsa_kernarg_size 80
  .amdhsa_user_sgpr_count 2
  .amdhsa_user_sgpr_kernarg_segment_ptr 1
  .amdhsa_system_sgpr_workgroup_id_x 1
.end_amdhsa_kernel
.p2align 6
.amdhsa_kernel attn_1_kernel
  .amdhsa_next_free_vgpr 250
  .amdhsa_next_free_sgpr 44
  .amdhsa_accum_offset 252
  .amdhsa_group_segment_fixed_size 0
  .amdhsa_kernarg_size 80
  .amdhsa_user_sgpr_count 2
  .amdhsa_user_sgpr_kernarg_segment_ptr 1
  .amdhsa_system_sgpr_workgroup_id_x 1
.end_amdhsa_kernel
.p2align 6
.amdhsa_kernel g3_1_kernel
  .amdhsa_next_free_vgpr 248
  .amdhsa_next_free_sgpr 52
  .amdhsa_accum_offset 248
  .amdhsa_group_segment_fixed_size 0
  .amdhsa_kernarg_size 80
  .amdhsa_user_sgpr_count 2
  .amdhsa_user_sgpr_kernarg_segment_ptr 1
  .amdhsa_system_sgpr_workgroup_id_x 1
.end_amdhsa_kernel
.p2align 6
.amdhsa_kernel g4_1_kernel
  .amdhsa_next_free_vgpr 364
  .amdhsa_next_free_sgpr 60
  .amdhsa_accum_offset 236
  .amdhsa_group_segment_fixed_size 0
  .amdhsa_kernarg_size 80
  .amdhsa_user_sgpr_count 2
  .amdhsa_user_sgpr_kernarg_segment_ptr 1
  .amdhsa_system_sgpr_workgroup_id_x 1
.end_amdhsa_kernel
.p2align 6
.amdhsa_kernel g5_1_kernel
  .amdhsa_next_free_vgpr 248
  .amdhsa_next_free_sgpr 52
  .amdhsa_accum_offset 248
  .amdhsa_group_segment_fixed_size 0
  .amdhsa_kernarg_size 80
  .amdhsa_user_sgpr_count 2
  .amdhsa_user_sgpr_kernarg_segment_ptr 1
  .amdhsa_system_sgpr_workgroup_id_x 1
.end_amdhsa_kernel
```
